```python
import torch

def _softmax(x, axis=-1):
    return torch.softmax(x, dim=axis)
def _gelu(x):
    return torch.nn.functional.gelu(x, approximate="tanh")
def _silu(x):
    return torch.nn.functional.silu(x)
def _sigmoid(x):
    return torch.sigmoid(x)
def _layernorm(x, axis=-1, eps=1e-5):
    m = x.mean(dim=axis, keepdim=True)
    v = x.var(dim=axis, keepdim=True, unbiased=False)
    return (x - m) / torch.sqrt(v + eps)
def _scatter_add(tgt, idx, src, axis=0):
    return tgt.clone().index_add_(axis, idx, src)
def _segment_sum(src, seg, n):
    out = torch.zeros((n,) + src.shape[1:], dtype=src.dtype)
    return out.index_add_(0, seg, src)
def _pad(x, pw):
    flat = tuple(v for pair in reversed(pw) for v in pair)
    return torch.nn.functional.pad(x, flat)

kernel_name = 'standalone__mha_block_cached__near_ridge'

def setup_inputs():

    _w = (lambda a: (lambda t: t.to(torch.bfloat16) if t.is_floating_point() else t)(torch.as_tensor(a)))
    B, Sq, D = 16, 112, 512
    H, Sk, Dh = 32, 512, 128
    return {
        "x": _w((lambda *s: torch.randn(*s, dtype=torch.bfloat16) * 0.8)(B, Sq, D)),
        "k_cache": _w((lambda *s: torch.randn(*s, dtype=torch.bfloat16) * 0.8)(B, H, Sk, Dh)),
        "v_cache": _w((lambda *s: torch.randn(*s, dtype=torch.bfloat16) * 0.05)(B, H, Sk, Dh)),
        "wq": _w((lambda *s: torch.randn(*s, dtype=torch.bfloat16) * 0.8)(D, H * Dh) * (D ** -0.5)),
        "wo": _w((lambda *s: torch.randn(*s, dtype=torch.bfloat16) * 0.05)(H * Dh, D) * ((H * Dh) ** -0.5)),
    }

def reference(x, k_cache, v_cache, wq, wo):
    B, Sq, D = x.shape
    H, Dh = 32, 128
    q = (lambda x, *d: x.permute(*d))((x @ wq).reshape(B, Sq, H, Dh), 0, 2, 1, 3)
    scores = torch.einsum("bhqd,bhkd->bhqk", q, k_cache) * (Dh ** -0.5)
    p = _softmax(scores, axis=-1)
    o = torch.einsum("bhqk,bhkd->bhqd", p, v_cache)
    return (lambda x, *d: x.permute(*d))(o, 0, 2, 1, 3).reshape(B, Sq, H * Dh) @ wo
```

```asm
; @launch grid=(256,1,1) block=(256,1,1) lds=163840
.amdgcn_target "amdgcn-amd-amdhsa--gfx950"
.text

.globl standalone__mha_block_cached__near_ridge_kernel
.p2align 8
.type standalone__mha_block_cached__near_ridge_kernel,@function
standalone__mha_block_cached__near_ridge_kernel:

    s_cmp_ge_u32 s2, 256
    s_cbranch_scc1 k1_end
    s_load_dwordx16 s[64:79], s[0:1], 0
    v_lshrrev_b32 v1, 6, v0
    v_and_b32 v0, 63, v0
    v_readfirstlane_b32 s36, v1
    v_lshlrev_b32 v16, 4, v0
    s_and_b32 s3, s2, 7
    s_lshr_b32 s42, s2, 3
    s_lshr_b32 s48, s3, 2
    s_lshl_b32 s48, s48, 3
    s_lshr_b32 s43, s42, 2
    s_add_u32 s48, s48, s43
    s_and_b32 s51, s3, 3
    s_and_b32 s50, s42, 3
    s_lshl2_add_u32 s49, s51, s50
    s_lshl_b32 s37, s36, 12
    s_lshl1_add_u32 s41, s50, s43
    s_and_b32 s41, s41, 7
    s_lshl_b32 s52, s41, 19
    s_lshl_b32 s41, s41, 7
    s_lshl2_add_u32 s42, s42, s36
    s_min_u32 s42, s42, (k1_codeend-k1_pf)/1024-1
    s_lshl_b32 s42, s42, 10
    v_lshlrev_b32 v67, 0, v16
    v_add_u32 v67, s42, v67
    s_getpc_b64 s[88:89]
k1_pf:
    global_load_dword v10, v67, s[88:89]
    s_mul_i32 s38, s48, 114688
    s_lshl_b32 s42, s36, 15
    s_add_u32 s38, s38, s42
    s_lshl_b32 s40, s36, 17
    s_lshl_b32 s42, s49, 9
    s_add_u32 s40, s40, s42
    s_lshl_b32 s39, s48, 22
    s_lshl_b32 s42, s49, 18
    s_add_u32 s39, s39, s42
    s_add_u32 s39, s39, s37
    v_lshrrev_b32 v2, 4, v0
    v_and_b32 v3, 15, v0
    v_lshrrev_b32 v4, 3, v0
    v_and_b32 v5, 7, v0
    v_add_u32 v6, 0, v2
    v_xor_b32 v6, v6, v5
    v_lshlrev_b32 v6, 4, v6
    v_lshl_add_u32 v6, v4, 10, v6
    v_add_u32 v160, 0, v6
    v_add_u32 v162, 14336, v6
    v_add_u32 v6, 4, v2
    v_xor_b32 v6, v6, v5
    v_lshlrev_b32 v6, 4, v6
    v_lshl_add_u32 v6, v4, 10, v6
    v_add_u32 v161, 7168, v6
    v_add_u32 v163, 21504, v6
    v_add_u32 v6, 0, v2
    v_lshlrev_b32 v6, 1, v6
    v_xor_b32 v6, v6, v3
    v_lshlrev_b32 v7, 4, v6
    v_lshl_add_u32 v60, v2, 8, v7
    v_lshl_add_u32 v6, v2, 13, v7
    v_add_u32 v62, 0, v6
    v_add_u32 v64, 63488, v6
    v_add_u32 v6, 4, v2
    v_lshlrev_b32 v6, 1, v6
    v_xor_b32 v6, v6, v3
    v_lshlrev_b32 v7, 4, v6
    v_lshl_add_u32 v61, v2, 8, v7
    v_lshl_add_u32 v6, v2, 13, v7
    v_add_u32 v63, 31744, v6
    v_add_u32 v65, 95232, v6
    v_add_u32 v6, 0, v2
    v_xor_b32 v6, v6, v3
    v_lshlrev_b32 v6, 4, v6
    v_lshl_add_u32 v56, v2, 8, v6
    v_add_u32 v6, 4, v2
    v_xor_b32 v6, v6, v3
    v_lshlrev_b32 v6, 4, v6
    v_lshl_add_u32 v57, v2, 8, v6
    v_add_u32 v6, 8, v2
    v_xor_b32 v6, v6, v3
    v_lshlrev_b32 v6, 4, v6
    v_lshl_add_u32 v58, v2, 8, v6
    v_add_u32 v6, 12, v2
    v_xor_b32 v6, v6, v3
    v_lshlrev_b32 v6, 4, v6
    v_lshl_add_u32 v59, v2, 8, v6
    s_waitcnt lgkmcnt(0)
    s_mov_b32 s4, s64
    s_mov_b32 s5, s65
    s_mov_b32 s6, 1835008
    s_mov_b32 s7, 0x20000
    s_mov_b32 s16, s70
    s_mov_b32 s17, s71
    s_mov_b32 s18, 4194304
    s_mov_b32 s19, 0x20000
    s_mov_b32 s8, s66
    s_mov_b32 s9, s67
    s_mov_b32 s10, 67108864
    s_mov_b32 s11, 0x20000
    s_mov_b32 s12, s68
    s_mov_b32 s13, s69
    s_mov_b32 s14, 67108864
    s_mov_b32 s15, 0x20000

    s_add_u32 s42, s41, 0
    s_and_b32 s42, s42, 0x3ff
    s_add_u32 m0, s37, 0
    s_add_u32 s42, s42, s38
    buffer_load_dwordx4 v160, s[4:7], s42 offen offset:0  lds
    buffer_load_dwordx4 v161, s[4:7], s42 offen offset:1024  lds
    buffer_load_dwordx4 v162, s[4:7], s42 offen offset:2048  lds
    buffer_load_dwordx4 v163, s[4:7], s42 offen offset:3072  lds
    s_add_u32 s42, s52, 0
    s_and_b32 s42, s42, 0x3fffff
    s_add_u32 m0, s37, 16384
    s_add_u32 s42, s42, s40
    buffer_load_dwordx4 v62, s[16:19], s42 offen offset:0  lds
    buffer_load_dwordx4 v63, s[16:19], s42 offen offset:1024  lds
    buffer_load_dwordx4 v64, s[16:19], s42 offen offset:2048  lds
    buffer_load_dwordx4 v65, s[16:19], s42 offen offset:3072  lds
    s_add_u32 s42, s41, 128
    s_and_b32 s42, s42, 0x3ff
    s_add_u32 m0, s37, 32768
    s_add_u32 s42, s42, s38
    buffer_load_dwordx4 v160, s[4:7], s42 offen offset:0  lds
    buffer_load_dwordx4 v161, s[4:7], s42 offen offset:1024  lds
    buffer_load_dwordx4 v162, s[4:7], s42 offen offset:2048  lds
    buffer_load_dwordx4 v163, s[4:7], s42 offen offset:3072  lds
    s_and_b32 s43, s48, 3
    s_cmp_eq_u32 s43, s50
    s_cselect_b32 s1, s51, 4
    s_cmp_lt_u32 s1, 3
    s_cbranch_scc0 k1_noclear
    s_mov_b32 s24, s78
    s_mov_b32 s25, s79
    s_mov_b32 s26, 268435456
    s_mov_b32 s27, 0x20000
    s_lshl_b32 s43, s1, 17
    s_lshl2_add_u32 s62, s48, s36
    s_lshl_b32 s62, s62, 11
    s_add_u32 s43, s43, s62
    s_add_u32 s43, s43, 4194304
    v_mov_b32 v248, 0
    v_mov_b32 v249, 0
    v_mov_b32 v250, 0
    v_mov_b32 v251, 0
    buffer_store_dwordx4 v[248:251], v16, s[24:27], s43 offen offset:0 sc1
    buffer_store_dwordx4 v[248:251], v16, s[24:27], s43 offen offset:1024 sc1
k1_noclear:
    s_mov_b32 s24, s78
    s_mov_b32 s25, s79
    s_mov_b32 s26, 268435456
    s_mov_b32 s27, 0x20000
    s_mov_b32 s20, s72
    s_mov_b32 s21, s73
    s_mov_b32 s22, 4194304
    s_mov_b32 s23, 0x20000
    s_mov_b32 s28, s74
    s_mov_b32 s29, s75
    s_mov_b32 s30, 1835008
    s_mov_b32 s31, 0x20000
    s_mov_b32 s32, s76
    s_mov_b32 s33, s77
    s_mov_b32 s34, 256
    s_mov_b32 s35, 0x20000
    v_lshrrev_b32 v4, 2, v0
    v_and_b32 v5, 7, v4
    v_lshlrev_b32 v5, 5, v5
    v_lshl_add_u32 v5, v4, 8, v5
    v_and_b32 v6, 3, v0
    v_lshl_add_u32 v5, v6, 3, v5
    v_xor_b32 v20, 0, v5
    v_xor_b32 v21, 32, v5
    v_xor_b32 v22, 64, v5
    v_xor_b32 v23, 96, v5
    v_xor_b32 v24, 128, v5
    v_xor_b32 v25, 160, v5
    v_xor_b32 v26, 192, v5
    v_xor_b32 v27, 224, v5
    v_add_u32 v28, 65536, v20
    v_add_u32 v29, 65536, v21
    v_add_u32 v30, 65536, v22
    v_add_u32 v31, 65536, v23
    v_add_u32 v32, 65536, v24
    v_add_u32 v33, 65536, v25
    v_add_u32 v34, 65536, v26
    v_add_u32 v35, 65536, v27
    v_add_u32 v36, 131072, v20
    v_add_u32 v37, 131072, v21
    v_add_u32 v38, 131072, v22
    v_add_u32 v39, 131072, v23
    v_add_u32 v40, 131072, v24
    v_add_u32 v41, 131072, v25
    v_add_u32 v42, 131072, v26
    v_add_u32 v43, 131072, v27
    v_max_u32 v7, 1, v6
    v_add_u32 v11, s50, v7
    v_add_u32 v12, s51, v7
    v_and_b32 v11, 3, v11
    v_and_b32 v12, 3, v12
    v_lshlrev_b32 v11, 9, v11
    v_lshlrev_b32 v12, 11, v12
    v_xor_b32 v5, v2, v3
    v_lshlrev_b32 v5, 4, v5
    v_lshl_add_u32 v5, v3, 8, v5
    v_xor_b32 v44, 0, v5
    v_xor_b32 v45, 64, v5
    v_xor_b32 v46, 128, v5
    v_xor_b32 v47, 192, v5
    v_add_u32 v48, 65536, v44
    v_add_u32 v49, 65536, v45
    v_add_u32 v50, 65536, v46
    v_add_u32 v51, 65536, v47
    v_add_u32 v52, 131072, v44
    v_add_u32 v53, 131072, v45
    v_add_u32 v54, 131072, v46
    v_add_u32 v55, 131072, v47
    v_lshrrev_b32 v4, 1, v2
    v_lshrrev_b32 v5, 1, v3
    v_xor_b32 v4, v4, v5
    v_lshlrev_b32 v4, 4, v4
    v_lshl_add_u32 v4, v3, 7, v4
    v_and_b32 v5, 1, v2
    v_lshl_add_u32 v4, v5, 3, v4
    v_add_u32 v4, s37, v4
    v_xor_b32 v148, 0, v4
    v_xor_b32 v149, 32, v4
    v_xor_b32 v150, 64, v4
    v_xor_b32 v151, 96, v4
    v_add_u32 v152, 65536, v148
    v_add_u32 v153, 65536, v149
    v_add_u32 v154, 65536, v150
    v_add_u32 v155, 65536, v151
    v_add_u32 v156, 131072, v148
    v_add_u32 v157, 131072, v149
    v_add_u32 v158, 131072, v150
    v_add_u32 v159, 131072, v151
    v_mov_b32 v4, 0x3f803f80
    v_accvgpr_write_b32 a224, v4
    v_accvgpr_write_b32 a225, v4
    v_accvgpr_write_b32 a226, v4
    v_accvgpr_write_b32 a227, v4
    v_lshlrev_b32 v66, 10, v3
    v_lshl_add_u32 v66, v2, 4, v66
    v_mov_b32 v13, 1
    v_mov_b32 v4, 1073741824
    v_cmp_eq_u32 vcc, 0, v0
    s_nop 1
    v_cndmask_b32 v14, v4, 0, vcc
    s_lshr_b32 s0, s2, 0
    s_and_b32 s0, s0, 7
    s_lshl_b32 s0, s0, 14
    s_mov_b32 s3, 0x010101
    s_mov_b32 s46, 0x3e0293ee
    s_mov_b32 s47, 0x41200000
    s_lshl4_add_u32 s42, s48, s49
    s_lshl2_add_u32 s42, s42, s36
    s_lshl_b32 s53, s42, 7
    s_add_u32 s53, s53, 4194304
    s_lshl_b32 s42, s50, 9
    s_sub_u32 s54, s53, s42
    s_lshl_b32 s42, s51, 11
    s_sub_u32 s55, s53, s42
    s_add_u32 s55, s55, 262144
    s_lshl_b32 s62, s51, 20
    s_lshl_b32 s42, s36, 14
    s_add_u32 s62, s62, s42
    s_lshl_b32 s42, s50, 8
    s_add_u32 s62, s62, s42
    s_lshl2_add_u32 s63, s48, s51
    s_mul_i32 s63, s63, 57344
    s_add_u32 s63, s63, s37
    s_add_u32 s63, s63, 16777216
    s_add_u32 s42, s50, 0
    s_and_b32 s42, s42, 3
    s_lshl_b32 s43, s42, 18
    s_add_u32 s80, s62, s43
    s_mul_i32 s43, s42, 14336
    s_add_u32 s84, s63, s43
    s_add_u32 s42, s50, 1
    s_and_b32 s42, s42, 3
    s_lshl_b32 s43, s42, 18
    s_add_u32 s81, s62, s43
    s_mul_i32 s43, s42, 14336
    s_add_u32 s85, s63, s43
    s_add_u32 s42, s50, 2
    s_and_b32 s42, s42, 3
    s_lshl_b32 s43, s42, 18
    s_add_u32 s82, s62, s43
    s_mul_i32 s43, s42, 14336
    s_add_u32 s86, s63, s43
    s_add_u32 s42, s50, 3
    s_and_b32 s42, s42, 3
    s_lshl_b32 s43, s42, 18
    s_add_u32 s83, s62, s43
    s_mul_i32 s43, s42, 14336
    s_add_u32 s87, s63, s43
    s_lshl4_add_u32 s62, s48, s50
    s_mul_i32 s62, s62, 7168
    s_lshl_b32 s42, s36, 11
    s_add_u32 s62, s62, s42
    s_add_u32 s62, s62, 33554432
    s_mul_i32 s42, s51, 28672
    s_add_u32 s59, s62, s42
    s_add_u32 s42, s51, 1
    s_and_b32 s42, s42, 3
    s_mul_i32 s42, s42, 28672
    s_add_u32 s42, s42, 0
    s_add_u32 s56, s62, s42
    s_add_u32 s42, s51, 2
    s_and_b32 s42, s42, 3
    s_mul_i32 s42, s42, 28672
    s_add_u32 s42, s42, 1835008
    s_add_u32 s57, s62, s42
    s_add_u32 s42, s51, 3
    s_and_b32 s42, s42, 3
    s_mul_i32 s42, s42, 28672
    s_add_u32 s42, s42, 3670016
    s_add_u32 s58, s62, s42
    s_lshl_b32 s42, s50, 8
    s_add_u32 s60, s38, s42
    s_lshl_b32 s42, s51, 6
    s_add_u32 s60, s60, s42

    s_cmp_eq_u32 s36, 3
    s_cbranch_scc1 k1_w3
    s_waitcnt vmcnt(4)
    s_barrier
    ds_read_b64 a[0:1], v148 offset:0
    ds_read_b64 a[2:3], v149 offset:0
    ds_read_b64 a[4:5], v148 offset:2048
    ds_read_b64 a[6:7], v149 offset:2048
    ds_read_b64_tr_b16 a[192:193], v20 offset:16384
    ds_read_b64_tr_b16 a[194:195], v20 offset:20480
    ds_read_b64_tr_b16 a[196:197], v21 offset:16384
    ds_read_b64_tr_b16 a[198:199], v21 offset:20480
    ds_read_b64_tr_b16 a[200:201], v22 offset:16384
    ds_read_b64_tr_b16 a[202:203], v22 offset:20480
    ds_read_b64_tr_b16 a[204:205], v23 offset:16384
    ds_read_b64_tr_b16 a[206:207], v23 offset:20480
    ds_read_b64_tr_b16 a[208:209], v24 offset:16384
    ds_read_b64_tr_b16 a[210:211], v24 offset:20480
    s_waitcnt lgkmcnt(8)
    v_mfma_f32_16x16x32_bf16 v[84:87], a[192:195], a[0:3], 0
    s_add_u32 s42, s52, 524288
    s_and_b32 s42, s42, 0x3fffff
    s_add_u32 m0, s37, 49152
    v_mfma_f32_16x16x32_bf16 v[88:91], a[192:195], a[4:7], 0
    s_waitcnt lgkmcnt(6)
    ds_read_b64_tr_b16 a[212:213], v25 offset:16384
    ds_read_b64_tr_b16 a[214:215], v25 offset:20480
    v_mfma_f32_16x16x32_bf16 v[92:95], a[196:199], a[0:3], 0
    s_add_u32 s42, s42, s40
    buffer_load_dwordx4 v62, s[16:19], s42 offen offset:0  lds
    v_mfma_f32_16x16x32_bf16 v[96:99], a[196:199], a[4:7], 0
    s_waitcnt lgkmcnt(6)
    ds_read_b64_tr_b16 a[216:217], v26 offset:16384
    ds_read_b64_tr_b16 a[218:219], v26 offset:20480
    v_mfma_f32_16x16x32_bf16 v[100:103], a[200:203], a[0:3], 0
    buffer_load_dwordx4 v63, s[16:19], s42 offen offset:1024  lds
    v_mfma_f32_16x16x32_bf16 v[104:107], a[200:203], a[4:7], 0
    s_waitcnt lgkmcnt(6)
    ds_read_b64_tr_b16 a[220:221], v27 offset:16384
    ds_read_b64_tr_b16 a[222:223], v27 offset:20480
    v_mfma_f32_16x16x32_bf16 v[108:111], a[204:207], a[0:3], 0
    buffer_load_dwordx4 v64, s[16:19], s42 offen offset:2048  lds
    v_mfma_f32_16x16x32_bf16 v[112:115], a[204:207], a[4:7], 0
    s_waitcnt lgkmcnt(6)
    ds_read_b64 a[8:9], v150 offset:0
    ds_read_b64 a[10:11], v151 offset:0
    v_mfma_f32_16x16x32_bf16 v[116:119], a[208:211], a[0:3], 0
    ds_read_b64 a[12:13], v150 offset:2048
    ds_read_b64 a[14:15], v151 offset:2048
    v_mfma_f32_16x16x32_bf16 v[120:123], a[208:211], a[4:7], 0
    s_waitcnt lgkmcnt(8)
    ds_read_b64_tr_b16 a[192:193], v20 offset:24576
    ds_read_b64_tr_b16 a[194:195], v20 offset:28672
    v_mfma_f32_16x16x32_bf16 v[124:127], a[212:215], a[0:3], 0
    ds_read_b64_tr_b16 a[196:197], v21 offset:24576
    ds_read_b64_tr_b16 a[198:199], v21 offset:28672
    v_mfma_f32_16x16x32_bf16 v[128:131], a[212:215], a[4:7], 0
    s_waitcnt lgkmcnt(10)
    ds_read_b64_tr_b16 a[200:201], v22 offset:24576
    ds_read_b64_tr_b16 a[202:203], v22 offset:28672
    v_mfma_f32_16x16x32_bf16 v[132:135], a[216:219], a[0:3], 0
    buffer_load_dwordx4 v65, s[16:19], s42 offen offset:3072  lds
    v_mfma_f32_16x16x32_bf16 v[136:139], a[216:219], a[4:7], 0
    s_waitcnt lgkmcnt(10)
    ds_read_b64_tr_b16 a[204:205], v23 offset:24576
    ds_read_b64_tr_b16 a[206:207], v23 offset:28672
    v_mfma_f32_16x16x32_bf16 v[140:143], a[220:223], a[0:3], 0
    s_add_u32 s42, s52, 256
    s_and_b32 s42, s42, 0x3fffff
    s_add_u32 m0, s37, 65536
    v_mfma_f32_16x16x32_bf16 v[144:147], a[220:223], a[4:7], 0
    s_waitcnt lgkmcnt(6)
    ds_read_b64_tr_b16 a[208:209], v24 offset:24576
    ds_read_b64_tr_b16 a[210:211], v24 offset:28672
    v_mfma_f32_16x16x32_bf16 v[84:87], a[192:195], a[8:11], v[84:87]
    s_add_u32 s42, s42, s40
    buffer_load_dwordx4 v62, s[16:19], s42 offen offset:0  lds
    v_mfma_f32_16x16x32_bf16 v[88:91], a[192:195], a[12:15], v[88:91]
    s_waitcnt lgkmcnt(6)
    ds_read_b64_tr_b16 a[212:213], v25 offset:24576
    ds_read_b64_tr_b16 a[214:215], v25 offset:28672
    v_mfma_f32_16x16x32_bf16 v[92:95], a[196:199], a[8:11], v[92:95]
    buffer_load_dwordx4 v63, s[16:19], s42 offen offset:1024  lds
    v_mfma_f32_16x16x32_bf16 v[96:99], a[196:199], a[12:15], v[96:99]
    s_waitcnt lgkmcnt(6)
    ds_read_b64_tr_b16 a[216:217], v26 offset:24576
    ds_read_b64_tr_b16 a[218:219], v26 offset:28672
    v_mfma_f32_16x16x32_bf16 v[100:103], a[200:203], a[8:11], v[100:103]
    buffer_load_dwordx4 v64, s[16:19], s42 offen offset:2048  lds
    v_mfma_f32_16x16x32_bf16 v[104:107], a[200:203], a[12:15], v[104:107]
    s_waitcnt lgkmcnt(6)
    ds_read_b64_tr_b16 a[220:221], v27 offset:24576
    ds_read_b64_tr_b16 a[222:223], v27 offset:28672
    v_mfma_f32_16x16x32_bf16 v[108:111], a[204:207], a[8:11], v[108:111]
    buffer_load_dwordx4 v65, s[16:19], s42 offen offset:3072  lds
    v_mfma_f32_16x16x32_bf16 v[112:115], a[204:207], a[12:15], v[112:115]
    s_waitcnt lgkmcnt(6)
    s_waitcnt vmcnt(4)
    s_barrier
    ds_read_b64 a[16:17], v148 offset:32768
    ds_read_b64 a[18:19], v149 offset:32768
    v_mfma_f32_16x16x32_bf16 v[116:119], a[208:211], a[8:11], v[116:119]
    s_add_u32 s42, s41, 256
    ds_read_b64 a[20:21], v148 offset:34816
    ds_read_b64 a[22:23], v149 offset:34816
    v_mfma_f32_16x16x32_bf16 v[120:123], a[208:211], a[12:15], v[120:123]
    s_waitcnt lgkmcnt(8)
    ds_read_b64_tr_b16 a[192:193], v20 offset:49152
    ds_read_b64_tr_b16 a[194:195], v20 offset:53248
    v_mfma_f32_16x16x32_bf16 v[124:127], a[212:215], a[8:11], v[124:127]
    s_and_b32 s42, s42, 0x3ff
    ds_read_b64_tr_b16 a[196:197], v21 offset:49152
    ds_read_b64_tr_b16 a[198:199], v21 offset:53248
    v_mfma_f32_16x16x32_bf16 v[128:131], a[212:215], a[12:15], v[128:131]
    s_waitcnt lgkmcnt(10)
    ds_read_b64_tr_b16 a[200:201], v22 offset:49152
    ds_read_b64_tr_b16 a[202:203], v22 offset:53248
    v_mfma_f32_16x16x32_bf16 v[132:135], a[216:219], a[8:11], v[132:135]
    s_add_u32 m0, s37, 81920
    s_add_u32 s42, s42, s38
    v_mfma_f32_16x16x32_bf16 v[136:139], a[216:219], a[12:15], v[136:139]
    s_waitcnt lgkmcnt(10)
    ds_read_b64_tr_b16 a[204:205], v23 offset:49152
    ds_read_b64_tr_b16 a[206:207], v23 offset:53248
    v_mfma_f32_16x16x32_bf16 v[140:143], a[220:223], a[8:11], v[140:143]
    buffer_load_dwordx4 v160, s[4:7], s42 offen offset:0  lds
    v_mfma_f32_16x16x32_bf16 v[144:147], a[220:223], a[12:15], v[144:147]
    s_waitcnt lgkmcnt(6)
    ds_read_b64_tr_b16 a[208:209], v24 offset:49152
    ds_read_b64_tr_b16 a[210:211], v24 offset:53248
    v_mfma_f32_16x16x32_bf16 v[84:87], a[192:195], a[16:19], v[84:87]
    buffer_load_dwordx4 v161, s[4:7], s42 offen offset:1024  lds
    v_mfma_f32_16x16x32_bf16 v[88:91], a[192:195], a[20:23], v[88:91]
    s_waitcnt lgkmcnt(6)
    ds_read_b64_tr_b16 a[212:213], v25 offset:49152
    ds_read_b64_tr_b16 a[214:215], v25 offset:53248
    v_mfma_f32_16x16x32_bf16 v[92:95], a[196:199], a[16:19], v[92:95]
    buffer_load_dwordx4 v162, s[4:7], s42 offen offset:2048  lds
    v_mfma_f32_16x16x32_bf16 v[96:99], a[196:199], a[20:23], v[96:99]
    s_waitcnt lgkmcnt(6)
    ds_read_b64_tr_b16 a[216:217], v26 offset:49152
    ds_read_b64_tr_b16 a[218:219], v26 offset:53248
    v_mfma_f32_16x16x32_bf16 v[100:103], a[200:203], a[16:19], v[100:103]
    buffer_load_dwordx4 v163, s[4:7], s42 offen offset:3072  lds
    v_mfma_f32_16x16x32_bf16 v[104:107], a[200:203], a[20:23], v[104:107]
    s_waitcnt lgkmcnt(6)
    ds_read_b64_tr_b16 a[220:221], v27 offset:49152
    ds_read_b64_tr_b16 a[222:223], v27 offset:53248
    v_mfma_f32_16x16x32_bf16 v[108:111], a[204:207], a[16:19], v[108:111]
    s_add_u32 s42, s52, 1048576
    s_and_b32 s42, s42, 0x3fffff
    s_add_u32 m0, s37, 98304
    v_mfma_f32_16x16x32_bf16 v[112:115], a[204:207], a[20:23], v[112:115]
    s_waitcnt lgkmcnt(6)
    ds_read_b64 a[24:25], v150 offset:32768
    ds_read_b64 a[26:27], v151 offset:32768
    v_mfma_f32_16x16x32_bf16 v[116:119], a[208:211], a[16:19], v[116:119]
    s_add_u32 s42, s42, s40
    ds_read_b64 a[28:29], v150 offset:34816
    ds_read_b64 a[30:31], v151 offset:34816
    v_mfma_f32_16x16x32_bf16 v[120:123], a[208:211], a[20:23], v[120:123]
    s_waitcnt lgkmcnt(8)
    ds_read_b64_tr_b16 a[192:193], v20 offset:57344
    ds_read_b64_tr_b16 a[194:195], v20 offset:61440
    v_mfma_f32_16x16x32_bf16 v[124:127], a[212:215], a[16:19], v[124:127]
    ds_read_b64_tr_b16 a[196:197], v21 offset:57344
    ds_read_b64_tr_b16 a[198:199], v21 offset:61440
    v_mfma_f32_16x16x32_bf16 v[128:131], a[212:215], a[20:23], v[128:131]
    s_waitcnt lgkmcnt(10)
    ds_read_b64_tr_b16 a[200:201], v22 offset:57344
    ds_read_b64_tr_b16 a[202:203], v22 offset:61440
    v_mfma_f32_16x16x32_bf16 v[132:135], a[216:219], a[16:19], v[132:135]
    buffer_load_dwordx4 v62, s[16:19], s42 offen offset:0  lds
    v_mfma_f32_16x16x32_bf16 v[136:139], a[216:219], a[20:23], v[136:139]
    s_waitcnt lgkmcnt(10)
    ds_read_b64_tr_b16 a[204:205], v23 offset:57344
    ds_read_b64_tr_b16 a[206:207], v23 offset:61440
    v_mfma_f32_16x16x32_bf16 v[140:143], a[220:223], a[16:19], v[140:143]
    buffer_load_dwordx4 v63, s[16:19], s42 offen offset:1024  lds
    v_mfma_f32_16x16x32_bf16 v[144:147], a[220:223], a[20:23], v[144:147]
    s_waitcnt lgkmcnt(6)
    ds_read_b64_tr_b16 a[208:209], v24 offset:57344
    ds_read_b64_tr_b16 a[210:211], v24 offset:61440
    v_mfma_f32_16x16x32_bf16 v[84:87], a[192:195], a[24:27], v[84:87]
    buffer_load_dwordx4 v64, s[16:19], s42 offen offset:2048  lds
    v_mfma_f32_16x16x32_bf16 v[88:91], a[192:195], a[28:31], v[88:91]
    s_waitcnt lgkmcnt(6)
    ds_read_b64_tr_b16 a[212:213], v25 offset:57344
    ds_read_b64_tr_b16 a[214:215], v25 offset:61440
    v_mfma_f32_16x16x32_bf16 v[92:95], a[196:199], a[24:27], v[92:95]
    buffer_load_dwordx4 v65, s[16:19], s42 offen offset:3072  lds
    v_mfma_f32_16x16x32_bf16 v[96:99], a[196:199], a[28:31], v[96:99]
    s_waitcnt lgkmcnt(6)
    ds_read_b64_tr_b16 a[216:217], v26 offset:57344
    ds_read_b64_tr_b16 a[218:219], v26 offset:61440
    v_mfma_f32_16x16x32_bf16 v[100:103], a[200:203], a[24:27], v[100:103]
    s_add_u32 s42, s52, 524544
    s_and_b32 s42, s42, 0x3fffff
    s_add_u32 m0, s37, 114688
    v_mfma_f32_16x16x32_bf16 v[104:107], a[200:203], a[28:31], v[104:107]
    s_waitcnt lgkmcnt(6)
    ds_read_b64_tr_b16 a[220:221], v27 offset:57344
    ds_read_b64_tr_b16 a[222:223], v27 offset:61440
    v_mfma_f32_16x16x32_bf16 v[108:111], a[204:207], a[24:27], v[108:111]
    s_add_u32 s42, s42, s40
    buffer_load_dwordx4 v62, s[16:19], s42 offen offset:0  lds
    v_mfma_f32_16x16x32_bf16 v[112:115], a[204:207], a[28:31], v[112:115]
    s_waitcnt lgkmcnt(6)
    s_waitcnt vmcnt(9)
    s_barrier
    ds_read_b64_tr_b16 a[192:193], v28 offset:0
    ds_read_b64_tr_b16 a[194:195], v28 offset:4096
    v_mfma_f32_16x16x32_bf16 v[116:119], a[208:211], a[24:27], v[116:119]
    buffer_load_dwordx4 v63, s[16:19], s42 offen offset:1024  lds
    v_mfma_f32_16x16x32_bf16 v[120:123], a[208:211], a[28:31], v[120:123]
    s_waitcnt lgkmcnt(6)
    ds_read_b64_tr_b16 a[196:197], v29 offset:0
    ds_read_b64_tr_b16 a[198:199], v29 offset:4096
    v_mfma_f32_16x16x32_bf16 v[124:127], a[212:215], a[24:27], v[124:127]
    buffer_load_dwordx4 v64, s[16:19], s42 offen offset:2048  lds
    v_mfma_f32_16x16x32_bf16 v[128:131], a[212:215], a[28:31], v[128:131]
    s_waitcnt lgkmcnt(6)
    ds_read_b64_tr_b16 a[200:201], v30 offset:0
    ds_read_b64_tr_b16 a[202:203], v30 offset:4096
    v_mfma_f32_16x16x32_bf16 v[132:135], a[216:219], a[24:27], v[132:135]
    buffer_load_dwordx4 v65, s[16:19], s42 offen offset:3072  lds
    v_mfma_f32_16x16x32_bf16 v[136:139], a[216:219], a[28:31], v[136:139]
    s_waitcnt lgkmcnt(6)
    ds_read_b64_tr_b16 a[204:205], v31 offset:0
    ds_read_b64_tr_b16 a[206:207], v31 offset:4096
    v_mfma_f32_16x16x32_bf16 v[140:143], a[220:223], a[24:27], v[140:143]
    s_add_u32 s42, s41, 384
    s_and_b32 s42, s42, 0x3ff
    s_add_u32 m0, s37, 131072
    v_mfma_f32_16x16x32_bf16 v[144:147], a[220:223], a[28:31], v[144:147]
    s_waitcnt lgkmcnt(6)
    ds_read_b64_tr_b16 a[208:209], v32 offset:0
    ds_read_b64_tr_b16 a[210:211], v32 offset:4096
    v_mfma_f32_16x16x32_bf16 v[180:183], a[192:195], a[0:3], 0
    s_add_u32 s42, s42, s38
    buffer_load_dwordx4 v160, s[4:7], s42 offen offset:0  lds
    v_mfma_f32_16x16x32_bf16 v[184:187], a[192:195], a[4:7], 0
    s_waitcnt lgkmcnt(6)
    ds_read_b64_tr_b16 a[212:213], v33 offset:0
    ds_read_b64_tr_b16 a[214:215], v33 offset:4096
    v_mfma_f32_16x16x32_bf16 v[188:191], a[196:199], a[0:3], 0
    buffer_load_dwordx4 v161, s[4:7], s42 offen offset:1024  lds
    v_mfma_f32_16x16x32_bf16 v[192:195], a[196:199], a[4:7], 0
    s_waitcnt lgkmcnt(6)
    ds_read_b64_tr_b16 a[216:217], v34 offset:0
    ds_read_b64_tr_b16 a[218:219], v34 offset:4096
    v_mfma_f32_16x16x32_bf16 v[196:199], a[200:203], a[0:3], 0
    buffer_load_dwordx4 v162, s[4:7], s42 offen offset:2048  lds
    v_mfma_f32_16x16x32_bf16 v[200:203], a[200:203], a[4:7], 0
    s_waitcnt lgkmcnt(6)
    ds_read_b64_tr_b16 a[220:221], v35 offset:0
    ds_read_b64_tr_b16 a[222:223], v35 offset:4096
    v_mfma_f32_16x16x32_bf16 v[204:207], a[204:207], a[0:3], 0
    buffer_load_dwordx4 v163, s[4:7], s42 offen offset:3072  lds
    v_mfma_f32_16x16x32_bf16 v[208:211], a[204:207], a[4:7], 0
    s_waitcnt lgkmcnt(6)
    ds_read_b64_tr_b16 a[192:193], v28 offset:8192
    ds_read_b64_tr_b16 a[194:195], v28 offset:12288
    v_mfma_f32_16x16x32_bf16 v[212:215], a[208:211], a[0:3], 0
    s_add_u32 s42, s52, 1572864
    s_and_b32 s42, s42, 0x3fffff
    s_add_u32 m0, s37, 147456
    v_mfma_f32_16x16x32_bf16 v[216:219], a[208:211], a[4:7], 0
    s_waitcnt lgkmcnt(6)
    ds_read_b64_tr_b16 a[196:197], v29 offset:8192
    ds_read_b64_tr_b16 a[198:199], v29 offset:12288
    v_mfma_f32_16x16x32_bf16 v[220:223], a[212:215], a[0:3], 0
    s_add_u32 s42, s42, s40
    buffer_load_dwordx4 v62, s[16:19], s42 offen offset:0  lds
    v_mfma_f32_16x16x32_bf16 v[224:227], a[212:215], a[4:7], 0
    s_waitcnt lgkmcnt(6)
    ds_read_b64_tr_b16 a[200:201], v30 offset:8192
    ds_read_b64_tr_b16 a[202:203], v30 offset:12288
    v_mfma_f32_16x16x32_bf16 v[228:231], a[216:219], a[0:3], 0
    buffer_load_dwordx4 v63, s[16:19], s42 offen offset:1024  lds
    v_mfma_f32_16x16x32_bf16 v[232:235], a[216:219], a[4:7], 0
    s_waitcnt lgkmcnt(6)
    ds_read_b64_tr_b16 a[204:205], v31 offset:8192
    ds_read_b64_tr_b16 a[206:207], v31 offset:12288
    v_mfma_f32_16x16x32_bf16 v[236:239], a[220:223], a[0:3], 0
    buffer_load_dwordx4 v64, s[16:19], s42 offen offset:2048  lds
    v_mfma_f32_16x16x32_bf16 v[240:243], a[220:223], a[4:7], 0
    s_waitcnt lgkmcnt(6)
    ds_read_b64_tr_b16 a[208:209], v32 offset:8192
    ds_read_b64_tr_b16 a[210:211], v32 offset:12288
    v_mfma_f32_16x16x32_bf16 v[180:183], a[192:195], a[8:11], v[180:183]
    buffer_load_dwordx4 v65, s[16:19], s42 offen offset:3072  lds
    v_mfma_f32_16x16x32_bf16 v[184:187], a[192:195], a[12:15], v[184:187]
    s_waitcnt lgkmcnt(6)
    ds_read_b64_tr_b16 a[212:213], v33 offset:8192
    ds_read_b64_tr_b16 a[214:215], v33 offset:12288
    v_mfma_f32_16x16x32_bf16 v[188:191], a[196:199], a[8:11], v[188:191]
    s_add_u32 s42, s52, 1048832
    s_and_b32 s42, s42, 0x3fffff
    s_add_u32 m0, s37, 0
    v_mfma_f32_16x16x32_bf16 v[192:195], a[196:199], a[12:15], v[192:195]
    s_waitcnt lgkmcnt(6)
    ds_read_b64_tr_b16 a[216:217], v34 offset:8192
    ds_read_b64_tr_b16 a[218:219], v34 offset:12288
    v_mfma_f32_16x16x32_bf16 v[196:199], a[200:203], a[8:11], v[196:199]
    s_add_u32 s42, s42, s40
    buffer_load_dwordx4 v62, s[16:19], s42 offen offset:0  lds
    v_mfma_f32_16x16x32_bf16 v[200:203], a[200:203], a[12:15], v[200:203]
    s_waitcnt lgkmcnt(6)
    ds_read_b64_tr_b16 a[220:221], v35 offset:8192
    ds_read_b64_tr_b16 a[222:223], v35 offset:12288
    v_mfma_f32_16x16x32_bf16 v[204:207], a[204:207], a[8:11], v[204:207]
    buffer_load_dwordx4 v63, s[16:19], s42 offen offset:1024  lds
    v_mfma_f32_16x16x32_bf16 v[208:211], a[204:207], a[12:15], v[208:211]
    s_waitcnt lgkmcnt(6)
    s_waitcnt vmcnt(14)
    s_barrier
    ds_read_b64 a[32:33], v152 offset:16384
    ds_read_b64 a[34:35], v153 offset:16384
    v_mfma_f32_16x16x32_bf16 v[212:215], a[208:211], a[8:11], v[212:215]
    ds_read_b64 a[36:37], v152 offset:18432
    ds_read_b64 a[38:39], v153 offset:18432
    v_mfma_f32_16x16x32_bf16 v[216:219], a[208:211], a[12:15], v[216:219]
    s_waitcnt lgkmcnt(8)
    ds_read_b64_tr_b16 a[192:193], v28 offset:32768
    ds_read_b64_tr_b16 a[194:195], v28 offset:36864
    v_mfma_f32_16x16x32_bf16 v[220:223], a[212:215], a[8:11], v[220:223]
    ds_read_b64_tr_b16 a[196:197], v29 offset:32768
    ds_read_b64_tr_b16 a[198:199], v29 offset:36864
    v_mfma_f32_16x16x32_bf16 v[224:227], a[212:215], a[12:15], v[224:227]
    s_waitcnt lgkmcnt(10)
    ds_read_b64_tr_b16 a[200:201], v30 offset:32768
    ds_read_b64_tr_b16 a[202:203], v30 offset:36864
    v_mfma_f32_16x16x32_bf16 v[228:231], a[216:219], a[8:11], v[228:231]
    buffer_load_dwordx4 v64, s[16:19], s42 offen offset:2048  lds
    v_mfma_f32_16x16x32_bf16 v[232:235], a[216:219], a[12:15], v[232:235]
    s_waitcnt lgkmcnt(10)
    ds_read_b64_tr_b16 a[204:205], v31 offset:32768
    ds_read_b64_tr_b16 a[206:207], v31 offset:36864
    v_mfma_f32_16x16x32_bf16 v[236:239], a[220:223], a[8:11], v[236:239]
    buffer_load_dwordx4 v65, s[16:19], s42 offen offset:3072  lds
    v_mfma_f32_16x16x32_bf16 v[240:243], a[220:223], a[12:15], v[240:243]
    s_waitcnt lgkmcnt(6)
    ds_read_b64_tr_b16 a[208:209], v32 offset:32768
    ds_read_b64_tr_b16 a[210:211], v32 offset:36864
    v_mfma_f32_16x16x32_bf16 v[84:87], a[192:195], a[32:35], v[84:87]
    s_add_u32 s42, s41, 512
    s_and_b32 s42, s42, 0x3ff
    s_add_u32 m0, s37, 16384
    v_mfma_f32_16x16x32_bf16 v[88:91], a[192:195], a[36:39], v[88:91]
    s_waitcnt lgkmcnt(6)
    ds_read_b64_tr_b16 a[212:213], v33 offset:32768
    ds_read_b64_tr_b16 a[214:215], v33 offset:36864
    v_mfma_f32_16x16x32_bf16 v[92:95], a[196:199], a[32:35], v[92:95]
    s_add_u32 s42, s42, s38
    buffer_load_dwordx4 v160, s[4:7], s42 offen offset:0  lds
    v_mfma_f32_16x16x32_bf16 v[96:99], a[196:199], a[36:39], v[96:99]
    s_waitcnt lgkmcnt(6)
    ds_read_b64_tr_b16 a[216:217], v34 offset:32768
    ds_read_b64_tr_b16 a[218:219], v34 offset:36864
    v_mfma_f32_16x16x32_bf16 v[100:103], a[200:203], a[32:35], v[100:103]
    buffer_load_dwordx4 v161, s[4:7], s42 offen offset:1024  lds
    v_mfma_f32_16x16x32_bf16 v[104:107], a[200:203], a[36:39], v[104:107]
    s_waitcnt lgkmcnt(6)
    ds_read_b64_tr_b16 a[220:221], v35 offset:32768
    ds_read_b64_tr_b16 a[222:223], v35 offset:36864
    v_mfma_f32_16x16x32_bf16 v[108:111], a[204:207], a[32:35], v[108:111]
    buffer_load_dwordx4 v162, s[4:7], s42 offen offset:2048  lds
    v_mfma_f32_16x16x32_bf16 v[112:115], a[204:207], a[36:39], v[112:115]
    s_waitcnt lgkmcnt(6)
    ds_read_b64 a[40:41], v154 offset:16384
    ds_read_b64 a[42:43], v155 offset:16384
    v_mfma_f32_16x16x32_bf16 v[116:119], a[208:211], a[32:35], v[116:119]
    ds_read_b64 a[44:45], v154 offset:18432
    ds_read_b64 a[46:47], v155 offset:18432
    v_mfma_f32_16x16x32_bf16 v[120:123], a[208:211], a[36:39], v[120:123]
    s_waitcnt lgkmcnt(8)
    ds_read_b64_tr_b16 a[192:193], v28 offset:40960
    ds_read_b64_tr_b16 a[194:195], v28 offset:45056
    v_mfma_f32_16x16x32_bf16 v[124:127], a[212:215], a[32:35], v[124:127]
    ds_read_b64_tr_b16 a[196:197], v29 offset:40960
    ds_read_b64_tr_b16 a[198:199], v29 offset:45056
    v_mfma_f32_16x16x32_bf16 v[128:131], a[212:215], a[36:39], v[128:131]
    s_waitcnt lgkmcnt(10)
    ds_read_b64_tr_b16 a[200:201], v30 offset:40960
    ds_read_b64_tr_b16 a[202:203], v30 offset:45056
    v_mfma_f32_16x16x32_bf16 v[132:135], a[216:219], a[32:35], v[132:135]
    buffer_load_dwordx4 v163, s[4:7], s42 offen offset:3072  lds
    v_mfma_f32_16x16x32_bf16 v[136:139], a[216:219], a[36:39], v[136:139]
    s_waitcnt lgkmcnt(10)
    ds_read_b64_tr_b16 a[204:205], v31 offset:40960
    ds_read_b64_tr_b16 a[206:207], v31 offset:45056
    v_mfma_f32_16x16x32_bf16 v[140:143], a[220:223], a[32:35], v[140:143]
    s_add_u32 s42, s52, 2097152
    s_and_b32 s42, s42, 0x3fffff
    s_add_u32 m0, s37, 32768
    v_mfma_f32_16x16x32_bf16 v[144:147], a[220:223], a[36:39], v[144:147]
    s_waitcnt lgkmcnt(6)
    ds_read_b64_tr_b16 a[208:209], v32 offset:40960
    ds_read_b64_tr_b16 a[210:211], v32 offset:45056
    v_mfma_f32_16x16x32_bf16 v[84:87], a[192:195], a[40:43], v[84:87]
    s_add_u32 s42, s42, s40
    buffer_load_dwordx4 v62, s[16:19], s42 offen offset:0  lds
    v_mfma_f32_16x16x32_bf16 v[88:91], a[192:195], a[44:47], v[88:91]
    s_waitcnt lgkmcnt(6)
    ds_read_b64_tr_b16 a[212:213], v33 offset:40960
    ds_read_b64_tr_b16 a[214:215], v33 offset:45056
    v_mfma_f32_16x16x32_bf16 v[92:95], a[196:199], a[40:43], v[92:95]
    buffer_load_dwordx4 v63, s[16:19], s42 offen offset:1024  lds
    v_mfma_f32_16x16x32_bf16 v[96:99], a[196:199], a[44:47], v[96:99]
    s_waitcnt lgkmcnt(6)
    ds_read_b64_tr_b16 a[216:217], v34 offset:40960
    ds_read_b64_tr_b16 a[218:219], v34 offset:45056
    v_mfma_f32_16x16x32_bf16 v[100:103], a[200:203], a[40:43], v[100:103]
    buffer_load_dwordx4 v64, s[16:19], s42 offen offset:2048  lds
    v_mfma_f32_16x16x32_bf16 v[104:107], a[200:203], a[44:47], v[104:107]
    s_waitcnt lgkmcnt(6)
    ds_read_b64_tr_b16 a[220:221], v35 offset:40960
    ds_read_b64_tr_b16 a[222:223], v35 offset:45056
    v_mfma_f32_16x16x32_bf16 v[108:111], a[204:207], a[40:43], v[108:111]
    buffer_load_dwordx4 v65, s[16:19], s42 offen offset:3072  lds
    v_mfma_f32_16x16x32_bf16 v[112:115], a[204:207], a[44:47], v[112:115]
    s_waitcnt lgkmcnt(6)
    s_waitcnt vmcnt(20)
    s_barrier
    s_and_b32 s43, s48, 7
    s_lshl2_add_u32 s43, s43, s50
    s_lshl2_add_u32 s43, s43, s36
    s_lshl_b32 s43, s43, 13
    s_lshl_b32 s62, s51, 20
    s_add_u32 s62, s62, 0
    s_add_u32 s43, s43, s62
    v_lshlrev_b32 v6, 2, v16
    buffer_load_dword v7, v6, s[20:23], s43 offen
    ds_read_b64_tr_b16 a[192:193], v28 offset:49152
    ds_read_b64_tr_b16 a[194:195], v28 offset:53248
    v_mfma_f32_16x16x32_bf16 v[116:119], a[208:211], a[40:43], v[116:119]
    s_add_u32 m0, s37, 49152
    s_add_u32 s42, s39, 0
    v_mfma_f32_16x16x32_bf16 v[120:123], a[208:211], a[44:47], v[120:123]
    s_waitcnt lgkmcnt(6)
    ds_read_b64_tr_b16 a[196:197], v29 offset:49152
    ds_read_b64_tr_b16 a[198:199], v29 offset:53248
    v_mfma_f32_16x16x32_bf16 v[124:127], a[212:215], a[40:43], v[124:127]
    buffer_load_dwordx4 v56, s[8:11], s42 offen offset:0 nt lds
    v_mfma_f32_16x16x32_bf16 v[128:131], a[212:215], a[44:47], v[128:131]
    s_waitcnt lgkmcnt(6)
    ds_read_b64_tr_b16 a[200:201], v30 offset:49152
    ds_read_b64_tr_b16 a[202:203], v30 offset:53248
    v_mfma_f32_16x16x32_bf16 v[132:135], a[216:219], a[40:43], v[132:135]
    buffer_load_dwordx4 v57, s[8:11], s42 offen offset:1024 nt lds
    v_mfma_f32_16x16x32_bf16 v[136:139], a[216:219], a[44:47], v[136:139]
    s_waitcnt lgkmcnt(6)
    ds_read_b64_tr_b16 a[204:205], v31 offset:49152
    ds_read_b64_tr_b16 a[206:207], v31 offset:53248
    v_mfma_f32_16x16x32_bf16 v[140:143], a[220:223], a[40:43], v[140:143]
    buffer_load_dwordx4 v58, s[8:11], s42 offen offset:2048 nt lds
    v_mfma_f32_16x16x32_bf16 v[144:147], a[220:223], a[44:47], v[144:147]
    s_waitcnt lgkmcnt(6)
    ds_read_b64_tr_b16 a[208:209], v32 offset:49152
    ds_read_b64_tr_b16 a[210:211], v32 offset:53248
    v_mfma_f32_16x16x32_bf16 v[180:183], a[192:195], a[16:19], v[180:183]
    buffer_load_dwordx4 v59, s[8:11], s42 offen offset:3072 nt lds
    v_mfma_f32_16x16x32_bf16 v[184:187], a[192:195], a[20:23], v[184:187]
    s_waitcnt lgkmcnt(6)
    ds_read_b64_tr_b16 a[212:213], v33 offset:49152
    ds_read_b64_tr_b16 a[214:215], v33 offset:53248
    v_mfma_f32_16x16x32_bf16 v[188:191], a[196:199], a[16:19], v[188:191]
    s_add_u32 s42, s52, 1573120
    s_and_b32 s42, s42, 0x3fffff
    s_add_u32 m0, s37, 65536
    v_mfma_f32_16x16x32_bf16 v[192:195], a[196:199], a[20:23], v[192:195]
    s_waitcnt lgkmcnt(6)
    ds_read_b64_tr_b16 a[216:217], v34 offset:49152
    ds_read_b64_tr_b16 a[218:219], v34 offset:53248
    v_mfma_f32_16x16x32_bf16 v[196:199], a[200:203], a[16:19], v[196:199]
    s_add_u32 s42, s42, s40
    buffer_load_dwordx4 v62, s[16:19], s42 offen offset:0  lds
    v_mfma_f32_16x16x32_bf16 v[200:203], a[200:203], a[20:23], v[200:203]
    s_waitcnt lgkmcnt(6)
    ds_read_b64_tr_b16 a[220:221], v35 offset:49152
    ds_read_b64_tr_b16 a[222:223], v35 offset:53248
    v_mfma_f32_16x16x32_bf16 v[204:207], a[204:207], a[16:19], v[204:207]
    buffer_load_dwordx4 v63, s[16:19], s42 offen offset:1024  lds
    v_mfma_f32_16x16x32_bf16 v[208:211], a[204:207], a[20:23], v[208:211]
    s_waitcnt lgkmcnt(6)
    ds_read_b64_tr_b16 a[192:193], v28 offset:57344
    ds_read_b64_tr_b16 a[194:195], v28 offset:61440
    v_mfma_f32_16x16x32_bf16 v[212:215], a[208:211], a[16:19], v[212:215]
    buffer_load_dwordx4 v64, s[16:19], s42 offen offset:2048  lds
    v_mfma_f32_16x16x32_bf16 v[216:219], a[208:211], a[20:23], v[216:219]
    s_waitcnt lgkmcnt(6)
    ds_read_b64_tr_b16 a[196:197], v29 offset:57344
    ds_read_b64_tr_b16 a[198:199], v29 offset:61440
    v_mfma_f32_16x16x32_bf16 v[220:223], a[212:215], a[16:19], v[220:223]
    buffer_load_dwordx4 v65, s[16:19], s42 offen offset:3072  lds
    v_mfma_f32_16x16x32_bf16 v[224:227], a[212:215], a[20:23], v[224:227]
    s_waitcnt lgkmcnt(6)
    ds_read_b64_tr_b16 a[200:201], v30 offset:57344
    ds_read_b64_tr_b16 a[202:203], v30 offset:61440
    v_mfma_f32_16x16x32_bf16 v[228:231], a[216:219], a[16:19], v[228:231]
    s_add_u32 s42, s41, 640
    s_and_b32 s42, s42, 0x3ff
    s_add_u32 m0, s37, 81920
    v_mfma_f32_16x16x32_bf16 v[232:235], a[216:219], a[20:23], v[232:235]
    s_waitcnt lgkmcnt(6)
    ds_read_b64_tr_b16 a[204:205], v31 offset:57344
    ds_read_b64_tr_b16 a[206:207], v31 offset:61440
    v_mfma_f32_16x16x32_bf16 v[236:239], a[220:223], a[16:19], v[236:239]
    s_add_u32 s42, s42, s38
    buffer_load_dwordx4 v160, s[4:7], s42 offen offset:0  lds
    v_mfma_f32_16x16x32_bf16 v[240:243], a[220:223], a[20:23], v[240:243]
    s_waitcnt lgkmcnt(6)
    ds_read_b64_tr_b16 a[208:209], v32 offset:57344
    ds_read_b64_tr_b16 a[210:211], v32 offset:61440
    v_mfma_f32_16x16x32_bf16 v[180:183], a[192:195], a[24:27], v[180:183]
    buffer_load_dwordx4 v161, s[4:7], s42 offen offset:1024  lds
    v_mfma_f32_16x16x32_bf16 v[184:187], a[192:195], a[28:31], v[184:187]
    s_waitcnt lgkmcnt(6)
    ds_read_b64_tr_b16 a[212:213], v33 offset:57344
    ds_read_b64_tr_b16 a[214:215], v33 offset:61440
    v_mfma_f32_16x16x32_bf16 v[188:191], a[196:199], a[24:27], v[188:191]
    buffer_load_dwordx4 v162, s[4:7], s42 offen offset:2048  lds
    v_mfma_f32_16x16x32_bf16 v[192:195], a[196:199], a[28:31], v[192:195]
    s_waitcnt lgkmcnt(6)
    ds_read_b64_tr_b16 a[216:217], v34 offset:57344
    ds_read_b64_tr_b16 a[218:219], v34 offset:61440
    v_mfma_f32_16x16x32_bf16 v[196:199], a[200:203], a[24:27], v[196:199]
    buffer_load_dwordx4 v163, s[4:7], s42 offen offset:3072  lds
    v_mfma_f32_16x16x32_bf16 v[200:203], a[200:203], a[28:31], v[200:203]
    s_waitcnt lgkmcnt(6)
    ds_read_b64_tr_b16 a[220:221], v35 offset:57344
    ds_read_b64_tr_b16 a[222:223], v35 offset:61440
    v_mfma_f32_16x16x32_bf16 v[204:207], a[204:207], a[24:27], v[204:207]
    v_mfma_f32_16x16x32_bf16 v[208:211], a[204:207], a[28:31], v[208:211]
    s_waitcnt lgkmcnt(6)
    s_waitcnt vmcnt(25)
    s_barrier
    ds_read_b64 a[48:49], v156 offset:0
    ds_read_b64 a[50:51], v157 offset:0
    v_mfma_f32_16x16x32_bf16 v[212:215], a[208:211], a[24:27], v[212:215]
    s_add_u32 s42, s52, 2621440
    ds_read_b64 a[52:53], v156 offset:2048
    ds_read_b64 a[54:55], v157 offset:2048
    v_mfma_f32_16x16x32_bf16 v[216:219], a[208:211], a[28:31], v[216:219]
    s_waitcnt lgkmcnt(8)
    ds_read_b64_tr_b16 a[192:193], v36 offset:16384
    ds_read_b64_tr_b16 a[194:195], v36 offset:20480
    v_mfma_f32_16x16x32_bf16 v[220:223], a[212:215], a[24:27], v[220:223]
    s_and_b32 s42, s42, 0x3fffff
    ds_read_b64_tr_b16 a[196:197], v37 offset:16384
    ds_read_b64_tr_b16 a[198:199], v37 offset:20480
    v_mfma_f32_16x16x32_bf16 v[224:227], a[212:215], a[28:31], v[224:227]
    s_waitcnt lgkmcnt(10)
    ds_read_b64_tr_b16 a[200:201], v38 offset:16384
    ds_read_b64_tr_b16 a[202:203], v38 offset:20480
    v_mfma_f32_16x16x32_bf16 v[228:231], a[216:219], a[24:27], v[228:231]
    s_add_u32 m0, s37, 98304
    s_add_u32 s42, s42, s40
    v_mfma_f32_16x16x32_bf16 v[232:235], a[216:219], a[28:31], v[232:235]
    s_waitcnt lgkmcnt(10)
    ds_read_b64_tr_b16 a[204:205], v39 offset:16384
    ds_read_b64_tr_b16 a[206:207], v39 offset:20480
    v_mfma_f32_16x16x32_bf16 v[236:239], a[220:223], a[24:27], v[236:239]
    buffer_load_dwordx4 v62, s[16:19], s42 offen offset:0  lds
    v_mfma_f32_16x16x32_bf16 v[240:243], a[220:223], a[28:31], v[240:243]
    s_waitcnt lgkmcnt(6)
    ds_read_b64_tr_b16 a[208:209], v40 offset:16384
    ds_read_b64_tr_b16 a[210:211], v40 offset:20480
    v_mfma_f32_16x16x32_bf16 v[84:87], a[192:195], a[48:51], v[84:87]
    buffer_load_dwordx4 v63, s[16:19], s42 offen offset:1024  lds
    v_mfma_f32_16x16x32_bf16 v[88:91], a[192:195], a[52:55], v[88:91]
    s_waitcnt lgkmcnt(6)
    ds_read_b64_tr_b16 a[212:213], v41 offset:16384
    ds_read_b64_tr_b16 a[214:215], v41 offset:20480
    v_mfma_f32_16x16x32_bf16 v[92:95], a[196:199], a[48:51], v[92:95]
    buffer_load_dwordx4 v64, s[16:19], s42 offen offset:2048  lds
    v_mfma_f32_16x16x32_bf16 v[96:99], a[196:199], a[52:55], v[96:99]
    s_waitcnt lgkmcnt(6)
    ds_read_b64_tr_b16 a[216:217], v42 offset:16384
    ds_read_b64_tr_b16 a[218:219], v42 offset:20480
    v_mfma_f32_16x16x32_bf16 v[100:103], a[200:203], a[48:51], v[100:103]
    buffer_load_dwordx4 v65, s[16:19], s42 offen offset:3072  lds
    v_mfma_f32_16x16x32_bf16 v[104:107], a[200:203], a[52:55], v[104:107]
    s_waitcnt lgkmcnt(6)
    ds_read_b64_tr_b16 a[220:221], v43 offset:16384
    ds_read_b64_tr_b16 a[222:223], v43 offset:20480
    v_mfma_f32_16x16x32_bf16 v[108:111], a[204:207], a[48:51], v[108:111]
    v_mfma_f32_16x16x32_bf16 v[112:115], a[204:207], a[52:55], v[112:115]
    s_waitcnt lgkmcnt(6)
    ds_read_b64 a[56:57], v158 offset:0
    ds_read_b64 a[58:59], v159 offset:0
    v_mfma_f32_16x16x32_bf16 v[116:119], a[208:211], a[48:51], v[116:119]
    ds_read_b64 a[60:61], v158 offset:2048
    ds_read_b64 a[62:63], v159 offset:2048
    v_mfma_f32_16x16x32_bf16 v[120:123], a[208:211], a[52:55], v[120:123]
    s_waitcnt lgkmcnt(8)
    ds_read_b64_tr_b16 a[192:193], v36 offset:24576
    ds_read_b64_tr_b16 a[194:195], v36 offset:28672
    v_mfma_f32_16x16x32_bf16 v[124:127], a[212:215], a[48:51], v[124:127]
    ds_read_b64_tr_b16 a[196:197], v37 offset:24576
    ds_read_b64_tr_b16 a[198:199], v37 offset:28672
    v_mfma_f32_16x16x32_bf16 v[128:131], a[212:215], a[52:55], v[128:131]
    s_waitcnt lgkmcnt(10)
    ds_read_b64_tr_b16 a[200:201], v38 offset:24576
    ds_read_b64_tr_b16 a[202:203], v38 offset:28672
    v_mfma_f32_16x16x32_bf16 v[132:135], a[216:219], a[48:51], v[132:135]
    v_mfma_f32_16x16x32_bf16 v[136:139], a[216:219], a[52:55], v[136:139]
    s_waitcnt lgkmcnt(10)
    ds_read_b64_tr_b16 a[204:205], v39 offset:24576
    ds_read_b64_tr_b16 a[206:207], v39 offset:28672
    v_mfma_f32_16x16x32_bf16 v[140:143], a[220:223], a[48:51], v[140:143]
    v_mfma_f32_16x16x32_bf16 v[144:147], a[220:223], a[52:55], v[144:147]
    s_waitcnt lgkmcnt(6)
    ds_read_b64_tr_b16 a[208:209], v40 offset:24576
    ds_read_b64_tr_b16 a[210:211], v40 offset:28672
    v_mfma_f32_16x16x32_bf16 v[84:87], a[192:195], a[56:59], v[84:87]
    v_mfma_f32_16x16x32_bf16 v[88:91], a[192:195], a[60:63], v[88:91]
    s_waitcnt lgkmcnt(6)
    ds_read_b64_tr_b16 a[212:213], v41 offset:24576
    ds_read_b64_tr_b16 a[214:215], v41 offset:28672
    v_mfma_f32_16x16x32_bf16 v[92:95], a[196:199], a[56:59], v[92:95]
    v_mfma_f32_16x16x32_bf16 v[96:99], a[196:199], a[60:63], v[96:99]
    s_waitcnt lgkmcnt(6)
    ds_read_b64_tr_b16 a[216:217], v42 offset:24576
    ds_read_b64_tr_b16 a[218:219], v42 offset:28672
    v_mfma_f32_16x16x32_bf16 v[100:103], a[200:203], a[56:59], v[100:103]
    v_mfma_f32_16x16x32_bf16 v[104:107], a[200:203], a[60:63], v[104:107]
    s_waitcnt lgkmcnt(6)
    ds_read_b64_tr_b16 a[220:221], v43 offset:24576
    ds_read_b64_tr_b16 a[222:223], v43 offset:28672
    v_mfma_f32_16x16x32_bf16 v[108:111], a[204:207], a[56:59], v[108:111]
    v_mfma_f32_16x16x32_bf16 v[112:115], a[204:207], a[60:63], v[112:115]
    s_waitcnt lgkmcnt(6)
    s_waitcnt vmcnt(25)
    s_barrier
    ds_read_b64_tr_b16 a[192:193], v20 offset:0
    ds_read_b64_tr_b16 a[194:195], v20 offset:4096
    v_mfma_f32_16x16x32_bf16 v[116:119], a[208:211], a[56:59], v[116:119]
    s_add_u32 m0, s37, 114688
    s_add_u32 s42, s39, 16384
    v_mfma_f32_16x16x32_bf16 v[120:123], a[208:211], a[60:63], v[120:123]
    s_waitcnt lgkmcnt(6)
    ds_read_b64_tr_b16 a[196:197], v21 offset:0
    ds_read_b64_tr_b16 a[198:199], v21 offset:4096
    v_mfma_f32_16x16x32_bf16 v[124:127], a[212:215], a[56:59], v[124:127]
    buffer_load_dwordx4 v56, s[8:11], s42 offen offset:0 nt lds
    v_mfma_f32_16x16x32_bf16 v[128:131], a[212:215], a[60:63], v[128:131]
    s_waitcnt lgkmcnt(6)
    ds_read_b64_tr_b16 a[200:201], v22 offset:0
    ds_read_b64_tr_b16 a[202:203], v22 offset:4096
    v_mfma_f32_16x16x32_bf16 v[132:135], a[216:219], a[56:59], v[132:135]
    buffer_load_dwordx4 v57, s[8:11], s42 offen offset:1024 nt lds
    v_mfma_f32_16x16x32_bf16 v[136:139], a[216:219], a[60:63], v[136:139]
    s_waitcnt lgkmcnt(6)
    ds_read_b64_tr_b16 a[204:205], v23 offset:0
    ds_read_b64_tr_b16 a[206:207], v23 offset:4096
    v_mfma_f32_16x16x32_bf16 v[140:143], a[220:223], a[56:59], v[140:143]
    buffer_load_dwordx4 v58, s[8:11], s42 offen offset:2048 nt lds
    v_mfma_f32_16x16x32_bf16 v[144:147], a[220:223], a[60:63], v[144:147]
    s_waitcnt lgkmcnt(6)
    ds_read_b64_tr_b16 a[208:209], v24 offset:0
    ds_read_b64_tr_b16 a[210:211], v24 offset:4096
    v_mfma_f32_16x16x32_bf16 v[180:183], a[192:195], a[32:35], v[180:183]
    buffer_load_dwordx4 v59, s[8:11], s42 offen offset:3072 nt lds
    v_mfma_f32_16x16x32_bf16 v[184:187], a[192:195], a[36:39], v[184:187]
    s_waitcnt lgkmcnt(6)
    ds_read_b64_tr_b16 a[212:213], v25 offset:0
    ds_read_b64_tr_b16 a[214:215], v25 offset:4096
    v_mfma_f32_16x16x32_bf16 v[188:191], a[196:199], a[32:35], v[188:191]
    s_add_u32 s42, s52, 2097408
    s_and_b32 s42, s42, 0x3fffff
    s_add_u32 m0, s37, 131072
    v_mfma_f32_16x16x32_bf16 v[192:195], a[196:199], a[36:39], v[192:195]
    s_waitcnt lgkmcnt(6)
    ds_read_b64_tr_b16 a[216:217], v26 offset:0
    ds_read_b64_tr_b16 a[218:219], v26 offset:4096
    v_mfma_f32_16x16x32_bf16 v[196:199], a[200:203], a[32:35], v[196:199]
    s_add_u32 s42, s42, s40
    buffer_load_dwordx4 v62, s[16:19], s42 offen offset:0  lds
    v_mfma_f32_16x16x32_bf16 v[200:203], a[200:203], a[36:39], v[200:203]
    s_waitcnt lgkmcnt(6)
    ds_read_b64_tr_b16 a[220:221], v27 offset:0
    ds_read_b64_tr_b16 a[222:223], v27 offset:4096
    v_mfma_f32_16x16x32_bf16 v[204:207], a[204:207], a[32:35], v[204:207]
    buffer_load_dwordx4 v63, s[16:19], s42 offen offset:1024  lds
    v_mfma_f32_16x16x32_bf16 v[208:211], a[204:207], a[36:39], v[208:211]
    s_waitcnt lgkmcnt(6)
    ds_read_b64_tr_b16 a[192:193], v20 offset:8192
    ds_read_b64_tr_b16 a[194:195], v20 offset:12288
    v_mfma_f32_16x16x32_bf16 v[212:215], a[208:211], a[32:35], v[212:215]
    buffer_load_dwordx4 v64, s[16:19], s42 offen offset:2048  lds
    v_mfma_f32_16x16x32_bf16 v[216:219], a[208:211], a[36:39], v[216:219]
    s_waitcnt lgkmcnt(6)
    ds_read_b64_tr_b16 a[196:197], v21 offset:8192
    ds_read_b64_tr_b16 a[198:199], v21 offset:12288
    v_mfma_f32_16x16x32_bf16 v[220:223], a[212:215], a[32:35], v[220:223]
    buffer_load_dwordx4 v65, s[16:19], s42 offen offset:3072  lds
    v_mfma_f32_16x16x32_bf16 v[224:227], a[212:215], a[36:39], v[224:227]
    s_waitcnt lgkmcnt(6)
    ds_read_b64_tr_b16 a[200:201], v22 offset:8192
    ds_read_b64_tr_b16 a[202:203], v22 offset:12288
    v_mfma_f32_16x16x32_bf16 v[228:231], a[216:219], a[32:35], v[228:231]
    v_mfma_f32_16x16x32_bf16 v[232:235], a[216:219], a[36:39], v[232:235]
    s_waitcnt lgkmcnt(6)
    ds_read_b64_tr_b16 a[204:205], v23 offset:8192
    ds_read_b64_tr_b16 a[206:207], v23 offset:12288
    v_mfma_f32_16x16x32_bf16 v[236:239], a[220:223], a[32:35], v[236:239]
    v_mfma_f32_16x16x32_bf16 v[240:243], a[220:223], a[36:39], v[240:243]
    s_waitcnt lgkmcnt(6)
    ds_read_b64_tr_b16 a[208:209], v24 offset:8192
    ds_read_b64_tr_b16 a[210:211], v24 offset:12288
    v_mfma_f32_16x16x32_bf16 v[180:183], a[192:195], a[40:43], v[180:183]
    v_mfma_f32_16x16x32_bf16 v[184:187], a[192:195], a[44:47], v[184:187]
    s_waitcnt lgkmcnt(6)
    ds_read_b64_tr_b16 a[212:213], v25 offset:8192
    ds_read_b64_tr_b16 a[214:215], v25 offset:12288
    v_mfma_f32_16x16x32_bf16 v[188:191], a[196:199], a[40:43], v[188:191]
    v_mfma_f32_16x16x32_bf16 v[192:195], a[196:199], a[44:47], v[192:195]
    s_waitcnt lgkmcnt(6)
    ds_read_b64_tr_b16 a[216:217], v26 offset:8192
    ds_read_b64_tr_b16 a[218:219], v26 offset:12288
    v_mfma_f32_16x16x32_bf16 v[196:199], a[200:203], a[40:43], v[196:199]
    v_mfma_f32_16x16x32_bf16 v[200:203], a[200:203], a[44:47], v[200:203]
    s_waitcnt lgkmcnt(6)
    ds_read_b64_tr_b16 a[220:221], v27 offset:8192
    ds_read_b64_tr_b16 a[222:223], v27 offset:12288
    v_mfma_f32_16x16x32_bf16 v[204:207], a[204:207], a[40:43], v[204:207]
    v_mfma_f32_16x16x32_bf16 v[208:211], a[204:207], a[44:47], v[208:211]
    s_waitcnt lgkmcnt(6)
    s_waitcnt vmcnt(25)
    s_barrier
    ds_read_b64 a[64:65], v148 offset:16384
    ds_read_b64 a[66:67], v149 offset:16384
    v_mfma_f32_16x16x32_bf16 v[212:215], a[208:211], a[40:43], v[212:215]
    s_add_u32 s42, s41, 768
    ds_read_b64 a[68:69], v148 offset:18432
    ds_read_b64 a[70:71], v149 offset:18432
    v_mfma_f32_16x16x32_bf16 v[216:219], a[208:211], a[44:47], v[216:219]
    s_waitcnt lgkmcnt(8)
    ds_read_b64_tr_b16 a[192:193], v20 offset:32768
    ds_read_b64_tr_b16 a[194:195], v20 offset:36864
    v_mfma_f32_16x16x32_bf16 v[220:223], a[212:215], a[40:43], v[220:223]
    s_and_b32 s42, s42, 0x3ff
    ds_read_b64_tr_b16 a[196:197], v21 offset:32768
    ds_read_b64_tr_b16 a[198:199], v21 offset:36864
    v_mfma_f32_16x16x32_bf16 v[224:227], a[212:215], a[44:47], v[224:227]
    s_waitcnt lgkmcnt(10)
    ds_read_b64_tr_b16 a[200:201], v22 offset:32768
    ds_read_b64_tr_b16 a[202:203], v22 offset:36864
    v_mfma_f32_16x16x32_bf16 v[228:231], a[216:219], a[40:43], v[228:231]
    s_add_u32 m0, s37, 147456
    s_add_u32 s42, s42, s38
    v_mfma_f32_16x16x32_bf16 v[232:235], a[216:219], a[44:47], v[232:235]
    s_waitcnt lgkmcnt(10)
    ds_read_b64_tr_b16 a[204:205], v23 offset:32768
    ds_read_b64_tr_b16 a[206:207], v23 offset:36864
    v_mfma_f32_16x16x32_bf16 v[236:239], a[220:223], a[40:43], v[236:239]
    buffer_load_dwordx4 v160, s[4:7], s42 offen offset:0  lds
    v_mfma_f32_16x16x32_bf16 v[240:243], a[220:223], a[44:47], v[240:243]
    s_waitcnt lgkmcnt(6)
    ds_read_b64_tr_b16 a[208:209], v24 offset:32768
    ds_read_b64_tr_b16 a[210:211], v24 offset:36864
    v_mfma_f32_16x16x32_bf16 v[84:87], a[192:195], a[64:67], v[84:87]
    buffer_load_dwordx4 v161, s[4:7], s42 offen offset:1024  lds
    v_mfma_f32_16x16x32_bf16 v[88:91], a[192:195], a[68:71], v[88:91]
    s_waitcnt lgkmcnt(6)
    ds_read_b64_tr_b16 a[212:213], v25 offset:32768
    ds_read_b64_tr_b16 a[214:215], v25 offset:36864
    v_mfma_f32_16x16x32_bf16 v[92:95], a[196:199], a[64:67], v[92:95]
    buffer_load_dwordx4 v162, s[4:7], s42 offen offset:2048  lds
    v_mfma_f32_16x16x32_bf16 v[96:99], a[196:199], a[68:71], v[96:99]
    s_waitcnt lgkmcnt(6)
    ds_read_b64_tr_b16 a[216:217], v26 offset:32768
    ds_read_b64_tr_b16 a[218:219], v26 offset:36864
    v_mfma_f32_16x16x32_bf16 v[100:103], a[200:203], a[64:67], v[100:103]
    buffer_load_dwordx4 v163, s[4:7], s42 offen offset:3072  lds
    v_mfma_f32_16x16x32_bf16 v[104:107], a[200:203], a[68:71], v[104:107]
    s_waitcnt lgkmcnt(6)
    ds_read_b64_tr_b16 a[220:221], v27 offset:32768
    ds_read_b64_tr_b16 a[222:223], v27 offset:36864
    v_mfma_f32_16x16x32_bf16 v[108:111], a[204:207], a[64:67], v[108:111]
    v_mfma_f32_16x16x32_bf16 v[112:115], a[204:207], a[68:71], v[112:115]
    s_waitcnt lgkmcnt(6)
    ds_read_b64 a[72:73], v150 offset:16384
    ds_read_b64 a[74:75], v151 offset:16384
    v_mfma_f32_16x16x32_bf16 v[116:119], a[208:211], a[64:67], v[116:119]
    ds_read_b64 a[76:77], v150 offset:18432
    ds_read_b64 a[78:79], v151 offset:18432
    v_mfma_f32_16x16x32_bf16 v[120:123], a[208:211], a[68:71], v[120:123]
    s_waitcnt lgkmcnt(8)
    ds_read_b64_tr_b16 a[192:193], v20 offset:40960
    ds_read_b64_tr_b16 a[194:195], v20 offset:45056
    v_mfma_f32_16x16x32_bf16 v[124:127], a[212:215], a[64:67], v[124:127]
    ds_read_b64_tr_b16 a[196:197], v21 offset:40960
    ds_read_b64_tr_b16 a[198:199], v21 offset:45056
    v_mfma_f32_16x16x32_bf16 v[128:131], a[212:215], a[68:71], v[128:131]
    s_waitcnt lgkmcnt(10)
    ds_read_b64_tr_b16 a[200:201], v22 offset:40960
    ds_read_b64_tr_b16 a[202:203], v22 offset:45056
    v_mfma_f32_16x16x32_bf16 v[132:135], a[216:219], a[64:67], v[132:135]
    v_mfma_f32_16x16x32_bf16 v[136:139], a[216:219], a[68:71], v[136:139]
    s_waitcnt lgkmcnt(10)
    ds_read_b64_tr_b16 a[204:205], v23 offset:40960
    ds_read_b64_tr_b16 a[206:207], v23 offset:45056
    v_mfma_f32_16x16x32_bf16 v[140:143], a[220:223], a[64:67], v[140:143]
    v_mfma_f32_16x16x32_bf16 v[144:147], a[220:223], a[68:71], v[144:147]
    s_waitcnt lgkmcnt(6)
    ds_read_b64_tr_b16 a[208:209], v24 offset:40960
    ds_read_b64_tr_b16 a[210:211], v24 offset:45056
    v_mfma_f32_16x16x32_bf16 v[84:87], a[192:195], a[72:75], v[84:87]
    v_mfma_f32_16x16x32_bf16 v[88:91], a[192:195], a[76:79], v[88:91]
    s_waitcnt lgkmcnt(6)
    ds_read_b64_tr_b16 a[212:213], v25 offset:40960
    ds_read_b64_tr_b16 a[214:215], v25 offset:45056
    v_mfma_f32_16x16x32_bf16 v[92:95], a[196:199], a[72:75], v[92:95]
    v_mfma_f32_16x16x32_bf16 v[96:99], a[196:199], a[76:79], v[96:99]
    s_waitcnt lgkmcnt(6)
    ds_read_b64_tr_b16 a[216:217], v26 offset:40960
    ds_read_b64_tr_b16 a[218:219], v26 offset:45056
    v_mfma_f32_16x16x32_bf16 v[100:103], a[200:203], a[72:75], v[100:103]
    v_mfma_f32_16x16x32_bf16 v[104:107], a[200:203], a[76:79], v[104:107]
    s_waitcnt lgkmcnt(6)
    ds_read_b64_tr_b16 a[220:221], v27 offset:40960
    ds_read_b64_tr_b16 a[222:223], v27 offset:45056
    v_mfma_f32_16x16x32_bf16 v[108:111], a[204:207], a[72:75], v[108:111]
    v_mfma_f32_16x16x32_bf16 v[112:115], a[204:207], a[76:79], v[112:115]
    s_waitcnt lgkmcnt(6)
    s_waitcnt vmcnt(20)
    s_barrier
    s_and_b32 s43, s48, 7
    s_lshl2_add_u32 s43, s43, s50
    s_lshl2_add_u32 s43, s43, s36
    s_lshl_b32 s43, s43, 13
    s_lshl_b32 s62, s51, 20
    s_add_u32 s62, s62, 4096
    s_add_u32 s43, s43, s62
    v_lshlrev_b32 v6, 2, v16
    buffer_load_dword v7, v6, s[20:23], s43 offen
    ds_read_b64_tr_b16 a[192:193], v28 offset:0
    ds_read_b64_tr_b16 a[194:195], v28 offset:4096
    v_mfma_f32_16x16x32_bf16 v[116:119], a[208:211], a[72:75], v[116:119]
    s_add_u32 s42, s52, 3145728
    s_and_b32 s42, s42, 0x3fffff
    s_add_u32 m0, s37, 0
    v_mfma_f32_16x16x32_bf16 v[120:123], a[208:211], a[76:79], v[120:123]
    s_waitcnt lgkmcnt(6)
    ds_read_b64_tr_b16 a[196:197], v29 offset:0
    ds_read_b64_tr_b16 a[198:199], v29 offset:4096
    v_mfma_f32_16x16x32_bf16 v[124:127], a[212:215], a[72:75], v[124:127]
    s_add_u32 s42, s42, s40
    buffer_load_dwordx4 v62, s[16:19], s42 offen offset:0  lds
    v_mfma_f32_16x16x32_bf16 v[128:131], a[212:215], a[76:79], v[128:131]
    s_waitcnt lgkmcnt(6)
    ds_read_b64_tr_b16 a[200:201], v30 offset:0
    ds_read_b64_tr_b16 a[202:203], v30 offset:4096
    v_mfma_f32_16x16x32_bf16 v[132:135], a[216:219], a[72:75], v[132:135]
    buffer_load_dwordx4 v63, s[16:19], s42 offen offset:1024  lds
    v_mfma_f32_16x16x32_bf16 v[136:139], a[216:219], a[76:79], v[136:139]
    s_waitcnt lgkmcnt(6)
    ds_read_b64_tr_b16 a[204:205], v31 offset:0
    ds_read_b64_tr_b16 a[206:207], v31 offset:4096
    v_mfma_f32_16x16x32_bf16 v[140:143], a[220:223], a[72:75], v[140:143]
    buffer_load_dwordx4 v64, s[16:19], s42 offen offset:2048  lds
    v_mfma_f32_16x16x32_bf16 v[144:147], a[220:223], a[76:79], v[144:147]
    s_waitcnt lgkmcnt(6)
    ds_read_b64_tr_b16 a[208:209], v32 offset:0
    ds_read_b64_tr_b16 a[210:211], v32 offset:4096
    v_mfma_f32_16x16x32_bf16 v[180:183], a[192:195], a[48:51], v[180:183]
    buffer_load_dwordx4 v65, s[16:19], s42 offen offset:3072  lds
    v_mfma_f32_16x16x32_bf16 v[184:187], a[192:195], a[52:55], v[184:187]
    s_waitcnt lgkmcnt(6)
    ds_read_b64_tr_b16 a[212:213], v33 offset:0
    ds_read_b64_tr_b16 a[214:215], v33 offset:4096
    v_mfma_f32_16x16x32_bf16 v[188:191], a[196:199], a[48:51], v[188:191]
    s_add_u32 m0, s37, 16384
    s_add_u32 s42, s39, 0
    v_mfma_f32_16x16x32_bf16 v[192:195], a[196:199], a[52:55], v[192:195]
    s_waitcnt lgkmcnt(6)
    ds_read_b64_tr_b16 a[216:217], v34 offset:0
    ds_read_b64_tr_b16 a[218:219], v34 offset:4096
    v_mfma_f32_16x16x32_bf16 v[196:199], a[200:203], a[48:51], v[196:199]
    buffer_load_dwordx4 v60, s[12:15], s42 offen offset:0 nt lds
    v_mfma_f32_16x16x32_bf16 v[200:203], a[200:203], a[52:55], v[200:203]
    s_waitcnt lgkmcnt(6)
    ds_read_b64_tr_b16 a[220:221], v35 offset:0
    ds_read_b64_tr_b16 a[222:223], v35 offset:4096
    v_mfma_f32_16x16x32_bf16 v[204:207], a[204:207], a[48:51], v[204:207]
    buffer_load_dwordx4 v61, s[12:15], s42 offen offset:1024 nt lds
    v_mfma_f32_16x16x32_bf16 v[208:211], a[204:207], a[52:55], v[208:211]
    s_waitcnt lgkmcnt(6)
    ds_read_b64_tr_b16 a[192:193], v28 offset:8192
    ds_read_b64_tr_b16 a[194:195], v28 offset:12288
    v_mfma_f32_16x16x32_bf16 v[212:215], a[208:211], a[48:51], v[212:215]
    buffer_load_dwordx4 v60, s[12:15], s42 offen offset:2048 nt lds
    v_mfma_f32_16x16x32_bf16 v[216:219], a[208:211], a[52:55], v[216:219]
    s_waitcnt lgkmcnt(6)
    ds_read_b64_tr_b16 a[196:197], v29 offset:8192
    ds_read_b64_tr_b16 a[198:199], v29 offset:12288
    v_mfma_f32_16x16x32_bf16 v[220:223], a[212:215], a[48:51], v[220:223]
    buffer_load_dwordx4 v61, s[12:15], s42 offen offset:3072 nt lds
    v_mfma_f32_16x16x32_bf16 v[224:227], a[212:215], a[52:55], v[224:227]
    s_waitcnt lgkmcnt(6)
    ds_read_b64_tr_b16 a[200:201], v30 offset:8192
    ds_read_b64_tr_b16 a[202:203], v30 offset:12288
    v_mfma_f32_16x16x32_bf16 v[228:231], a[216:219], a[48:51], v[228:231]
    v_mfma_f32_16x16x32_bf16 v[232:235], a[216:219], a[52:55], v[232:235]
    s_waitcnt lgkmcnt(6)
    ds_read_b64_tr_b16 a[204:205], v31 offset:8192
    ds_read_b64_tr_b16 a[206:207], v31 offset:12288
    v_mfma_f32_16x16x32_bf16 v[236:239], a[220:223], a[48:51], v[236:239]
    v_mfma_f32_16x16x32_bf16 v[240:243], a[220:223], a[52:55], v[240:243]
    s_waitcnt lgkmcnt(6)
    ds_read_b64_tr_b16 a[208:209], v32 offset:8192
    ds_read_b64_tr_b16 a[210:211], v32 offset:12288
    v_mfma_f32_16x16x32_bf16 v[180:183], a[192:195], a[56:59], v[180:183]
    v_mfma_f32_16x16x32_bf16 v[184:187], a[192:195], a[60:63], v[184:187]
    s_waitcnt lgkmcnt(6)
    ds_read_b64_tr_b16 a[212:213], v33 offset:8192
    ds_read_b64_tr_b16 a[214:215], v33 offset:12288
    v_mfma_f32_16x16x32_bf16 v[188:191], a[196:199], a[56:59], v[188:191]
    v_mfma_f32_16x16x32_bf16 v[192:195], a[196:199], a[60:63], v[192:195]
    s_waitcnt lgkmcnt(6)
    ds_read_b64_tr_b16 a[216:217], v34 offset:8192
    ds_read_b64_tr_b16 a[218:219], v34 offset:12288
    v_mfma_f32_16x16x32_bf16 v[196:199], a[200:203], a[56:59], v[196:199]
    v_mfma_f32_16x16x32_bf16 v[200:203], a[200:203], a[60:63], v[200:203]
    s_waitcnt lgkmcnt(6)
    ds_read_b64_tr_b16 a[220:221], v35 offset:8192
    ds_read_b64_tr_b16 a[222:223], v35 offset:12288
    v_mfma_f32_16x16x32_bf16 v[204:207], a[204:207], a[56:59], v[204:207]
    v_mfma_f32_16x16x32_bf16 v[208:211], a[204:207], a[60:63], v[208:211]
    s_waitcnt lgkmcnt(6)
    s_waitcnt vmcnt(21)
    s_barrier
    ds_read_b64 a[80:81], v152 offset:16384
    ds_read_b64 a[82:83], v153 offset:16384
    v_mfma_f32_16x16x32_bf16 v[212:215], a[208:211], a[56:59], v[212:215]
    s_add_u32 s42, s52, 2621696
    ds_read_b64 a[84:85], v152 offset:18432
    ds_read_b64 a[86:87], v153 offset:18432
    v_mfma_f32_16x16x32_bf16 v[216:219], a[208:211], a[60:63], v[216:219]
    s_waitcnt lgkmcnt(8)
    ds_read_b64_tr_b16 a[192:193], v28 offset:32768
    ds_read_b64_tr_b16 a[194:195], v28 offset:36864
    v_mfma_f32_16x16x32_bf16 v[220:223], a[212:215], a[56:59], v[220:223]
    s_and_b32 s42, s42, 0x3fffff
    ds_read_b64_tr_b16 a[196:197], v29 offset:32768
    ds_read_b64_tr_b16 a[198:199], v29 offset:36864
    v_mfma_f32_16x16x32_bf16 v[224:227], a[212:215], a[60:63], v[224:227]
    s_waitcnt lgkmcnt(10)
    ds_read_b64_tr_b16 a[200:201], v30 offset:32768
    ds_read_b64_tr_b16 a[202:203], v30 offset:36864
    v_mfma_f32_16x16x32_bf16 v[228:231], a[216:219], a[56:59], v[228:231]
    s_add_u32 m0, s37, 32768
    s_add_u32 s42, s42, s40
    v_mfma_f32_16x16x32_bf16 v[232:235], a[216:219], a[60:63], v[232:235]
    s_waitcnt lgkmcnt(10)
    ds_read_b64_tr_b16 a[204:205], v31 offset:32768
    ds_read_b64_tr_b16 a[206:207], v31 offset:36864
    v_mfma_f32_16x16x32_bf16 v[236:239], a[220:223], a[56:59], v[236:239]
    buffer_load_dwordx4 v62, s[16:19], s42 offen offset:0  lds
    v_mfma_f32_16x16x32_bf16 v[240:243], a[220:223], a[60:63], v[240:243]
    s_waitcnt lgkmcnt(6)
    ds_read_b64_tr_b16 a[208:209], v32 offset:32768
    ds_read_b64_tr_b16 a[210:211], v32 offset:36864
    v_mfma_f32_16x16x32_bf16 v[84:87], a[192:195], a[80:83], v[84:87]
    buffer_load_dwordx4 v63, s[16:19], s42 offen offset:1024  lds
    v_mfma_f32_16x16x32_bf16 v[88:91], a[192:195], a[84:87], v[88:91]
    s_waitcnt lgkmcnt(6)
    ds_read_b64_tr_b16 a[212:213], v33 offset:32768
    ds_read_b64_tr_b16 a[214:215], v33 offset:36864
    v_mfma_f32_16x16x32_bf16 v[92:95], a[196:199], a[80:83], v[92:95]
    buffer_load_dwordx4 v64, s[16:19], s42 offen offset:2048  lds
    v_mfma_f32_16x16x32_bf16 v[96:99], a[196:199], a[84:87], v[96:99]
    s_waitcnt lgkmcnt(6)
    ds_read_b64_tr_b16 a[216:217], v34 offset:32768
    ds_read_b64_tr_b16 a[218:219], v34 offset:36864
    v_mfma_f32_16x16x32_bf16 v[100:103], a[200:203], a[80:83], v[100:103]
    buffer_load_dwordx4 v65, s[16:19], s42 offen offset:3072  lds
    v_mfma_f32_16x16x32_bf16 v[104:107], a[200:203], a[84:87], v[104:107]
    s_waitcnt lgkmcnt(6)
    ds_read_b64_tr_b16 a[220:221], v35 offset:32768
    ds_read_b64_tr_b16 a[222:223], v35 offset:36864
    v_mfma_f32_16x16x32_bf16 v[108:111], a[204:207], a[80:83], v[108:111]
    v_mfma_f32_16x16x32_bf16 v[112:115], a[204:207], a[84:87], v[112:115]
    s_waitcnt lgkmcnt(6)
    ds_read_b64 a[88:89], v154 offset:16384
    ds_read_b64 a[90:91], v155 offset:16384
    v_mfma_f32_16x16x32_bf16 v[116:119], a[208:211], a[80:83], v[116:119]
    ds_read_b64 a[92:93], v154 offset:18432
    ds_read_b64 a[94:95], v155 offset:18432
    v_mfma_f32_16x16x32_bf16 v[120:123], a[208:211], a[84:87], v[120:123]
    s_waitcnt lgkmcnt(8)
    ds_read_b64_tr_b16 a[192:193], v28 offset:40960
    ds_read_b64_tr_b16 a[194:195], v28 offset:45056
    v_mfma_f32_16x16x32_bf16 v[124:127], a[212:215], a[80:83], v[124:127]
    ds_read_b64_tr_b16 a[196:197], v29 offset:40960
    ds_read_b64_tr_b16 a[198:199], v29 offset:45056
    v_mfma_f32_16x16x32_bf16 v[128:131], a[212:215], a[84:87], v[128:131]
    s_waitcnt lgkmcnt(10)
    ds_read_b64_tr_b16 a[200:201], v30 offset:40960
    ds_read_b64_tr_b16 a[202:203], v30 offset:45056
    v_mfma_f32_16x16x32_bf16 v[132:135], a[216:219], a[80:83], v[132:135]
    v_mfma_f32_16x16x32_bf16 v[136:139], a[216:219], a[84:87], v[136:139]
    s_waitcnt lgkmcnt(10)
    ds_read_b64_tr_b16 a[204:205], v31 offset:40960
    ds_read_b64_tr_b16 a[206:207], v31 offset:45056
    v_mfma_f32_16x16x32_bf16 v[140:143], a[220:223], a[80:83], v[140:143]
    v_mfma_f32_16x16x32_bf16 v[144:147], a[220:223], a[84:87], v[144:147]
    s_waitcnt lgkmcnt(6)
    ds_read_b64_tr_b16 a[208:209], v32 offset:40960
    ds_read_b64_tr_b16 a[210:211], v32 offset:45056
    v_mfma_f32_16x16x32_bf16 v[84:87], a[192:195], a[88:91], v[84:87]
    v_mfma_f32_16x16x32_bf16 v[88:91], a[192:195], a[92:95], v[88:91]
    s_waitcnt lgkmcnt(6)
    ds_read_b64_tr_b16 a[212:213], v33 offset:40960
    ds_read_b64_tr_b16 a[214:215], v33 offset:45056
    v_mfma_f32_16x16x32_bf16 v[92:95], a[196:199], a[88:91], v[92:95]
    v_mfma_f32_16x16x32_bf16 v[96:99], a[196:199], a[92:95], v[96:99]
    s_waitcnt lgkmcnt(6)
    ds_read_b64_tr_b16 a[216:217], v34 offset:40960
    ds_read_b64_tr_b16 a[218:219], v34 offset:45056
    v_mfma_f32_16x16x32_bf16 v[100:103], a[200:203], a[88:91], v[100:103]
    v_mfma_f32_16x16x32_bf16 v[104:107], a[200:203], a[92:95], v[104:107]
    s_waitcnt lgkmcnt(6)
    ds_read_b64_tr_b16 a[220:221], v35 offset:40960
    ds_read_b64_tr_b16 a[222:223], v35 offset:45056
    v_mfma_f32_16x16x32_bf16 v[108:111], a[204:207], a[88:91], v[108:111]
    v_mfma_f32_16x16x32_bf16 v[112:115], a[204:207], a[92:95], v[112:115]
    s_waitcnt lgkmcnt(6)
    s_waitcnt vmcnt(17)
    s_barrier
    global_load_dword v7, v67, s[88:89]
    ds_read_b64_tr_b16 a[192:193], v36 offset:0
    ds_read_b64_tr_b16 a[194:195], v36 offset:4096
    v_mfma_f32_16x16x32_bf16 v[116:119], a[208:211], a[88:91], v[116:119]
    s_add_u32 s42, s41, 896
    s_and_b32 s42, s42, 0x3ff
    s_add_u32 m0, s37, 65536
    v_mfma_f32_16x16x32_bf16 v[120:123], a[208:211], a[92:95], v[120:123]
    s_waitcnt lgkmcnt(6)
    ds_read_b64_tr_b16 a[196:197], v37 offset:0
    ds_read_b64_tr_b16 a[198:199], v37 offset:4096
    v_mfma_f32_16x16x32_bf16 v[124:127], a[212:215], a[88:91], v[124:127]
    s_add_u32 s42, s42, s38
    buffer_load_dwordx4 v160, s[4:7], s42 offen offset:0  lds
    v_mfma_f32_16x16x32_bf16 v[128:131], a[212:215], a[92:95], v[128:131]
    s_waitcnt lgkmcnt(6)
    ds_read_b64_tr_b16 a[200:201], v38 offset:0
    ds_read_b64_tr_b16 a[202:203], v38 offset:4096
    v_mfma_f32_16x16x32_bf16 v[132:135], a[216:219], a[88:91], v[132:135]
    buffer_load_dwordx4 v161, s[4:7], s42 offen offset:1024  lds
    v_mfma_f32_16x16x32_bf16 v[136:139], a[216:219], a[92:95], v[136:139]
    s_waitcnt lgkmcnt(6)
    ds_read_b64_tr_b16 a[204:205], v39 offset:0
    ds_read_b64_tr_b16 a[206:207], v39 offset:4096
    v_mfma_f32_16x16x32_bf16 v[140:143], a[220:223], a[88:91], v[140:143]
    buffer_load_dwordx4 v162, s[4:7], s42 offen offset:2048  lds
    v_mfma_f32_16x16x32_bf16 v[144:147], a[220:223], a[92:95], v[144:147]
    s_waitcnt lgkmcnt(6)
    ds_read_b64_tr_b16 a[208:209], v40 offset:0
    ds_read_b64_tr_b16 a[210:211], v40 offset:4096
    v_mfma_f32_16x16x32_bf16 v[180:183], a[192:195], a[64:67], v[180:183]
    buffer_load_dwordx4 v163, s[4:7], s42 offen offset:3072  lds
    v_mfma_f32_16x16x32_bf16 v[184:187], a[192:195], a[68:71], v[184:187]
    s_waitcnt lgkmcnt(6)
    ds_read_b64_tr_b16 a[212:213], v41 offset:0
    ds_read_b64_tr_b16 a[214:215], v41 offset:4096
    v_mfma_f32_16x16x32_bf16 v[188:191], a[196:199], a[64:67], v[188:191]
    s_add_u32 m0, s37, 81920
    s_add_u32 s42, s39, 32768
    v_mfma_f32_16x16x32_bf16 v[192:195], a[196:199], a[68:71], v[192:195]
    s_waitcnt lgkmcnt(6)
    ds_read_b64_tr_b16 a[216:217], v42 offset:0
    ds_read_b64_tr_b16 a[218:219], v42 offset:4096
    v_mfma_f32_16x16x32_bf16 v[196:199], a[200:203], a[64:67], v[196:199]
    buffer_load_dwordx4 v56, s[8:11], s42 offen offset:0 nt lds
    v_mfma_f32_16x16x32_bf16 v[200:203], a[200:203], a[68:71], v[200:203]
    s_waitcnt lgkmcnt(6)
    ds_read_b64_tr_b16 a[220:221], v43 offset:0
    ds_read_b64_tr_b16 a[222:223], v43 offset:4096
    v_mfma_f32_16x16x32_bf16 v[204:207], a[204:207], a[64:67], v[204:207]
    buffer_load_dwordx4 v57, s[8:11], s42 offen offset:1024 nt lds
    v_mfma_f32_16x16x32_bf16 v[208:211], a[204:207], a[68:71], v[208:211]
    s_waitcnt lgkmcnt(6)
    ds_read_b64_tr_b16 a[192:193], v36 offset:8192
    ds_read_b64_tr_b16 a[194:195], v36 offset:12288
    v_mfma_f32_16x16x32_bf16 v[212:215], a[208:211], a[64:67], v[212:215]
    buffer_load_dwordx4 v58, s[8:11], s42 offen offset:2048 nt lds
    v_mfma_f32_16x16x32_bf16 v[216:219], a[208:211], a[68:71], v[216:219]
    s_waitcnt lgkmcnt(6)
    ds_read_b64_tr_b16 a[196:197], v37 offset:8192
    ds_read_b64_tr_b16 a[198:199], v37 offset:12288
    v_mfma_f32_16x16x32_bf16 v[220:223], a[212:215], a[64:67], v[220:223]
    buffer_load_dwordx4 v59, s[8:11], s42 offen offset:3072 nt lds
    v_mfma_f32_16x16x32_bf16 v[224:227], a[212:215], a[68:71], v[224:227]
    s_waitcnt lgkmcnt(6)
    ds_read_b64_tr_b16 a[200:201], v38 offset:8192
    ds_read_b64_tr_b16 a[202:203], v38 offset:12288
    v_mfma_f32_16x16x32_bf16 v[228:231], a[216:219], a[64:67], v[228:231]
    v_mfma_f32_16x16x32_bf16 v[232:235], a[216:219], a[68:71], v[232:235]
    s_waitcnt lgkmcnt(6)
    ds_read_b64_tr_b16 a[204:205], v39 offset:8192
    ds_read_b64_tr_b16 a[206:207], v39 offset:12288
    v_mfma_f32_16x16x32_bf16 v[236:239], a[220:223], a[64:67], v[236:239]
    v_mfma_f32_16x16x32_bf16 v[240:243], a[220:223], a[68:71], v[240:243]
    s_waitcnt lgkmcnt(6)
    ds_read_b64_tr_b16 a[208:209], v40 offset:8192
    ds_read_b64_tr_b16 a[210:211], v40 offset:12288
    v_mfma_f32_16x16x32_bf16 v[180:183], a[192:195], a[72:75], v[180:183]
    v_mfma_f32_16x16x32_bf16 v[184:187], a[192:195], a[76:79], v[184:187]
    s_waitcnt lgkmcnt(6)
    ds_read_b64_tr_b16 a[212:213], v41 offset:8192
    ds_read_b64_tr_b16 a[214:215], v41 offset:12288
    v_mfma_f32_16x16x32_bf16 v[188:191], a[196:199], a[72:75], v[188:191]
    v_mfma_f32_16x16x32_bf16 v[192:195], a[196:199], a[76:79], v[192:195]
    s_waitcnt lgkmcnt(6)
    ds_read_b64_tr_b16 a[216:217], v42 offset:8192
    ds_read_b64_tr_b16 a[218:219], v42 offset:12288
    v_mfma_f32_16x16x32_bf16 v[196:199], a[200:203], a[72:75], v[196:199]
    v_mfma_f32_16x16x32_bf16 v[200:203], a[200:203], a[76:79], v[200:203]
    s_waitcnt lgkmcnt(6)
    ds_read_b64_tr_b16 a[220:221], v43 offset:8192
    ds_read_b64_tr_b16 a[222:223], v43 offset:12288
    v_mfma_f32_16x16x32_bf16 v[204:207], a[204:207], a[72:75], v[204:207]
    v_mfma_f32_16x16x32_bf16 v[208:211], a[204:207], a[76:79], v[208:211]
    s_waitcnt lgkmcnt(6)
    s_waitcnt vmcnt(17)
    s_barrier
    ds_read_b64 a[96:97], v156 offset:16384
    ds_read_b64 a[98:99], v157 offset:16384
    v_mfma_f32_16x16x32_bf16 v[212:215], a[208:211], a[72:75], v[212:215]
    s_add_u32 s42, s52, 3670016
    ds_read_b64 a[100:101], v156 offset:18432
    ds_read_b64 a[102:103], v157 offset:18432
    v_mfma_f32_16x16x32_bf16 v[216:219], a[208:211], a[76:79], v[216:219]
    s_waitcnt lgkmcnt(8)
    ds_read_b64_tr_b16 a[192:193], v20 offset:0
    ds_read_b64_tr_b16 a[194:195], v20 offset:4096
    v_mfma_f32_16x16x32_bf16 v[220:223], a[212:215], a[72:75], v[220:223]
    s_and_b32 s42, s42, 0x3fffff
    ds_read_b64_tr_b16 a[196:197], v21 offset:0
    ds_read_b64_tr_b16 a[198:199], v21 offset:4096
    v_mfma_f32_16x16x32_bf16 v[224:227], a[212:215], a[76:79], v[224:227]
    s_waitcnt lgkmcnt(10)
    ds_read_b64_tr_b16 a[200:201], v22 offset:0
    ds_read_b64_tr_b16 a[202:203], v22 offset:4096
    v_mfma_f32_16x16x32_bf16 v[228:231], a[216:219], a[72:75], v[228:231]
    s_add_u32 m0, s37, 98304
    s_add_u32 s42, s42, s40
    v_mfma_f32_16x16x32_bf16 v[232:235], a[216:219], a[76:79], v[232:235]
    s_waitcnt lgkmcnt(10)
    ds_read_b64_tr_b16 a[204:205], v23 offset:0
    ds_read_b64_tr_b16 a[206:207], v23 offset:4096
    v_mfma_f32_16x16x32_bf16 v[236:239], a[220:223], a[72:75], v[236:239]
    buffer_load_dwordx4 v62, s[16:19], s42 offen offset:0  lds
    v_mfma_f32_16x16x32_bf16 v[240:243], a[220:223], a[76:79], v[240:243]
    s_waitcnt lgkmcnt(6)
    ds_read_b64_tr_b16 a[208:209], v24 offset:0
    ds_read_b64_tr_b16 a[210:211], v24 offset:4096
    v_mfma_f32_16x16x32_bf16 v[84:87], a[192:195], a[96:99], v[84:87]
    buffer_load_dwordx4 v63, s[16:19], s42 offen offset:1024  lds
    v_mfma_f32_16x16x32_bf16 v[88:91], a[192:195], a[100:103], v[88:91]
    s_waitcnt lgkmcnt(6)
    ds_read_b64_tr_b16 a[212:213], v25 offset:0
    ds_read_b64_tr_b16 a[214:215], v25 offset:4096
    v_mfma_f32_16x16x32_bf16 v[92:95], a[196:199], a[96:99], v[92:95]
    buffer_load_dwordx4 v64, s[16:19], s42 offen offset:2048  lds
    v_mfma_f32_16x16x32_bf16 v[96:99], a[196:199], a[100:103], v[96:99]
    s_waitcnt lgkmcnt(6)
    ds_read_b64_tr_b16 a[216:217], v26 offset:0
    ds_read_b64_tr_b16 a[218:219], v26 offset:4096
    v_mfma_f32_16x16x32_bf16 v[100:103], a[200:203], a[96:99], v[100:103]
    buffer_load_dwordx4 v65, s[16:19], s42 offen offset:3072  lds
    v_mfma_f32_16x16x32_bf16 v[104:107], a[200:203], a[100:103], v[104:107]
    s_waitcnt lgkmcnt(6)
    ds_read_b64_tr_b16 a[220:221], v27 offset:0
    ds_read_b64_tr_b16 a[222:223], v27 offset:4096
    v_mfma_f32_16x16x32_bf16 v[108:111], a[204:207], a[96:99], v[108:111]
    v_mfma_f32_16x16x32_bf16 v[112:115], a[204:207], a[100:103], v[112:115]
    s_waitcnt lgkmcnt(6)
    ds_read_b64 a[104:105], v158 offset:16384
    ds_read_b64 a[106:107], v159 offset:16384
    v_mfma_f32_16x16x32_bf16 v[116:119], a[208:211], a[96:99], v[116:119]
    ds_read_b64 a[108:109], v158 offset:18432
    ds_read_b64 a[110:111], v159 offset:18432
    v_mfma_f32_16x16x32_bf16 v[120:123], a[208:211], a[100:103], v[120:123]
    s_waitcnt lgkmcnt(8)
    ds_read_b64_tr_b16 a[192:193], v20 offset:8192
    ds_read_b64_tr_b16 a[194:195], v20 offset:12288
    v_mfma_f32_16x16x32_bf16 v[124:127], a[212:215], a[96:99], v[124:127]
    ds_read_b64_tr_b16 a[196:197], v21 offset:8192
    ds_read_b64_tr_b16 a[198:199], v21 offset:12288
    v_mfma_f32_16x16x32_bf16 v[128:131], a[212:215], a[100:103], v[128:131]
    s_waitcnt lgkmcnt(10)
    ds_read_b64_tr_b16 a[200:201], v22 offset:8192
    ds_read_b64_tr_b16 a[202:203], v22 offset:12288
    v_mfma_f32_16x16x32_bf16 v[132:135], a[216:219], a[96:99], v[132:135]
    v_mfma_f32_16x16x32_bf16 v[136:139], a[216:219], a[100:103], v[136:139]
    s_waitcnt lgkmcnt(10)
    ds_read_b64_tr_b16 a[204:205], v23 offset:8192
    ds_read_b64_tr_b16 a[206:207], v23 offset:12288
    v_mfma_f32_16x16x32_bf16 v[140:143], a[220:223], a[96:99], v[140:143]
    v_mfma_f32_16x16x32_bf16 v[144:147], a[220:223], a[100:103], v[144:147]
    s_waitcnt lgkmcnt(6)
    ds_read_b64_tr_b16 a[208:209], v24 offset:8192
    ds_read_b64_tr_b16 a[210:211], v24 offset:12288
    v_mfma_f32_16x16x32_bf16 v[84:87], a[192:195], a[104:107], v[84:87]
    v_mfma_f32_16x16x32_bf16 v[88:91], a[192:195], a[108:111], v[88:91]
    s_waitcnt lgkmcnt(6)
    ds_read_b64_tr_b16 a[212:213], v25 offset:8192
    ds_read_b64_tr_b16 a[214:215], v25 offset:12288
    v_mfma_f32_16x16x32_bf16 v[92:95], a[196:199], a[104:107], v[92:95]
    v_mfma_f32_16x16x32_bf16 v[96:99], a[196:199], a[108:111], v[96:99]
    s_waitcnt lgkmcnt(6)
    ds_read_b64_tr_b16 a[216:217], v26 offset:8192
    ds_read_b64_tr_b16 a[218:219], v26 offset:12288
    v_mfma_f32_16x16x32_bf16 v[100:103], a[200:203], a[104:107], v[100:103]
    v_mfma_f32_16x16x32_bf16 v[104:107], a[200:203], a[108:111], v[104:107]
    s_waitcnt lgkmcnt(6)
    ds_read_b64_tr_b16 a[220:221], v27 offset:8192
    ds_read_b64_tr_b16 a[222:223], v27 offset:12288
    v_mfma_f32_16x16x32_bf16 v[108:111], a[204:207], a[104:107], v[108:111]
    v_mfma_f32_16x16x32_bf16 v[112:115], a[204:207], a[108:111], v[112:115]
    s_waitcnt lgkmcnt(6)
    s_waitcnt vmcnt(13)
    s_barrier
    ds_read_b64_tr_b16 a[192:193], v20 offset:32768
    ds_read_b64_tr_b16 a[194:195], v20 offset:36864
    v_mfma_f32_16x16x32_bf16 v[116:119], a[208:211], a[104:107], v[116:119]
    s_add_u32 s42, s52, 3145984
    s_and_b32 s42, s42, 0x3fffff
    s_add_u32 m0, s37, 131072
    v_mfma_f32_16x16x32_bf16 v[120:123], a[208:211], a[108:111], v[120:123]
    s_waitcnt lgkmcnt(6)
    ds_read_b64_tr_b16 a[196:197], v21 offset:32768
    ds_read_b64_tr_b16 a[198:199], v21 offset:36864
    v_mfma_f32_16x16x32_bf16 v[124:127], a[212:215], a[104:107], v[124:127]
    s_add_u32 s42, s42, s40
    buffer_load_dwordx4 v62, s[16:19], s42 offen offset:0  lds
    v_mfma_f32_16x16x32_bf16 v[128:131], a[212:215], a[108:111], v[128:131]
    s_waitcnt lgkmcnt(6)
    ds_read_b64_tr_b16 a[200:201], v22 offset:32768
    ds_read_b64_tr_b16 a[202:203], v22 offset:36864
    v_mfma_f32_16x16x32_bf16 v[132:135], a[216:219], a[104:107], v[132:135]
    buffer_load_dwordx4 v63, s[16:19], s42 offen offset:1024  lds
    v_mfma_f32_16x16x32_bf16 v[136:139], a[216:219], a[108:111], v[136:139]
    s_waitcnt lgkmcnt(6)
    ds_read_b64_tr_b16 a[204:205], v23 offset:32768
    ds_read_b64_tr_b16 a[206:207], v23 offset:36864
    v_mfma_f32_16x16x32_bf16 v[140:143], a[220:223], a[104:107], v[140:143]
    buffer_load_dwordx4 v64, s[16:19], s42 offen offset:2048  lds
    v_mfma_f32_16x16x32_bf16 v[144:147], a[220:223], a[108:111], v[144:147]
    s_waitcnt lgkmcnt(6)
    ds_read_b64_tr_b16 a[208:209], v24 offset:32768
    ds_read_b64_tr_b16 a[210:211], v24 offset:36864
    v_mfma_f32_16x16x32_bf16 v[180:183], a[192:195], a[80:83], v[180:183]
    buffer_load_dwordx4 v65, s[16:19], s42 offen offset:3072  lds
    v_mfma_f32_16x16x32_bf16 v[184:187], a[192:195], a[84:87], v[184:187]
    s_waitcnt lgkmcnt(6)
    ds_read_b64_tr_b16 a[212:213], v25 offset:32768
    ds_read_b64_tr_b16 a[214:215], v25 offset:36864
    v_mfma_f32_16x16x32_bf16 v[188:191], a[196:199], a[80:83], v[188:191]
    s_add_u32 s42, s52, 3670272
    s_and_b32 s42, s42, 0x3fffff
    s_add_u32 m0, s37, 147456
    v_mfma_f32_16x16x32_bf16 v[192:195], a[196:199], a[84:87], v[192:195]
    s_waitcnt lgkmcnt(6)
    ds_read_b64_tr_b16 a[216:217], v26 offset:32768
    ds_read_b64_tr_b16 a[218:219], v26 offset:36864
    v_mfma_f32_16x16x32_bf16 v[196:199], a[200:203], a[80:83], v[196:199]
    s_add_u32 s42, s42, s40
    buffer_load_dwordx4 v62, s[16:19], s42 offen offset:0  lds
    v_mfma_f32_16x16x32_bf16 v[200:203], a[200:203], a[84:87], v[200:203]
    s_waitcnt lgkmcnt(6)
    ds_read_b64_tr_b16 a[220:221], v27 offset:32768
    ds_read_b64_tr_b16 a[222:223], v27 offset:36864
    v_mfma_f32_16x16x32_bf16 v[204:207], a[204:207], a[80:83], v[204:207]
    buffer_load_dwordx4 v63, s[16:19], s42 offen offset:1024  lds
    v_mfma_f32_16x16x32_bf16 v[208:211], a[204:207], a[84:87], v[208:211]
    s_waitcnt lgkmcnt(6)
    ds_read_b64_tr_b16 a[192:193], v20 offset:40960
    ds_read_b64_tr_b16 a[194:195], v20 offset:45056
    v_mfma_f32_16x16x32_bf16 v[212:215], a[208:211], a[80:83], v[212:215]
    buffer_load_dwordx4 v64, s[16:19], s42 offen offset:2048  lds
    v_mfma_f32_16x16x32_bf16 v[216:219], a[208:211], a[84:87], v[216:219]
    s_waitcnt lgkmcnt(6)
    ds_read_b64_tr_b16 a[196:197], v21 offset:40960
    ds_read_b64_tr_b16 a[198:199], v21 offset:45056
    v_mfma_f32_16x16x32_bf16 v[220:223], a[212:215], a[80:83], v[220:223]
    buffer_load_dwordx4 v65, s[16:19], s42 offen offset:3072  lds
    v_mfma_f32_16x16x32_bf16 v[224:227], a[212:215], a[84:87], v[224:227]
    s_waitcnt lgkmcnt(6)
    ds_read_b64_tr_b16 a[200:201], v22 offset:40960
    ds_read_b64_tr_b16 a[202:203], v22 offset:45056
    v_mfma_f32_16x16x32_bf16 v[228:231], a[216:219], a[80:83], v[228:231]
    v_mfma_f32_16x16x32_bf16 v[232:235], a[216:219], a[84:87], v[232:235]
    s_waitcnt lgkmcnt(6)
    ds_read_b64_tr_b16 a[204:205], v23 offset:40960
    ds_read_b64_tr_b16 a[206:207], v23 offset:45056
    v_mfma_f32_16x16x32_bf16 v[236:239], a[220:223], a[80:83], v[236:239]
    v_mfma_f32_16x16x32_bf16 v[240:243], a[220:223], a[84:87], v[240:243]
    s_waitcnt lgkmcnt(6)
    ds_read_b64_tr_b16 a[208:209], v24 offset:40960
    ds_read_b64_tr_b16 a[210:211], v24 offset:45056
    v_mfma_f32_16x16x32_bf16 v[180:183], a[192:195], a[88:91], v[180:183]
    v_mfma_f32_16x16x32_bf16 v[184:187], a[192:195], a[92:95], v[184:187]
    s_waitcnt lgkmcnt(6)
    ds_read_b64_tr_b16 a[212:213], v25 offset:40960
    ds_read_b64_tr_b16 a[214:215], v25 offset:45056
    v_mfma_f32_16x16x32_bf16 v[188:191], a[196:199], a[88:91], v[188:191]
    v_mfma_f32_16x16x32_bf16 v[192:195], a[196:199], a[92:95], v[192:195]
    s_waitcnt lgkmcnt(6)
    ds_read_b64_tr_b16 a[216:217], v26 offset:40960
    ds_read_b64_tr_b16 a[218:219], v26 offset:45056
    v_mfma_f32_16x16x32_bf16 v[196:199], a[200:203], a[88:91], v[196:199]
    v_mfma_f32_16x16x32_bf16 v[200:203], a[200:203], a[92:95], v[200:203]
    s_waitcnt lgkmcnt(6)
    ds_read_b64_tr_b16 a[220:221], v27 offset:40960
    ds_read_b64_tr_b16 a[222:223], v27 offset:45056
    v_mfma_f32_16x16x32_bf16 v[204:207], a[204:207], a[88:91], v[204:207]
    v_mfma_f32_16x16x32_bf16 v[208:211], a[204:207], a[92:95], v[208:211]
    s_waitcnt lgkmcnt(6)
    s_waitcnt vmcnt(8)
    s_barrier
    ds_read_b64 a[112:113], v152 offset:0
    ds_read_b64 a[114:115], v153 offset:0
    v_mfma_f32_16x16x32_bf16 v[212:215], a[208:211], a[88:91], v[212:215]
    s_add_u32 m0, s37, 0
    ds_read_b64 a[116:117], v152 offset:2048
    ds_read_b64 a[118:119], v153 offset:2048
    v_mfma_f32_16x16x32_bf16 v[216:219], a[208:211], a[92:95], v[216:219]
    s_waitcnt lgkmcnt(8)
    ds_read_b64_tr_b16 a[192:193], v28 offset:32768
    ds_read_b64_tr_b16 a[194:195], v28 offset:36864
    v_mfma_f32_16x16x32_bf16 v[220:223], a[212:215], a[88:91], v[220:223]
    s_add_u32 s42, s39, 16384
    ds_read_b64_tr_b16 a[196:197], v29 offset:32768
    ds_read_b64_tr_b16 a[198:199], v29 offset:36864
    v_mfma_f32_16x16x32_bf16 v[224:227], a[212:215], a[92:95], v[224:227]
    s_waitcnt lgkmcnt(10)
    ds_read_b64_tr_b16 a[200:201], v30 offset:32768
    ds_read_b64_tr_b16 a[202:203], v30 offset:36864
    v_mfma_f32_16x16x32_bf16 v[228:231], a[216:219], a[88:91], v[228:231]
    buffer_load_dwordx4 v60, s[12:15], s42 offen offset:0 nt lds
    v_mfma_f32_16x16x32_bf16 v[232:235], a[216:219], a[92:95], v[232:235]
    s_waitcnt lgkmcnt(10)
    ds_read_b64_tr_b16 a[204:205], v31 offset:32768
    ds_read_b64_tr_b16 a[206:207], v31 offset:36864
    v_mfma_f32_16x16x32_bf16 v[236:239], a[220:223], a[88:91], v[236:239]
    buffer_load_dwordx4 v61, s[12:15], s42 offen offset:1024 nt lds
    v_mfma_f32_16x16x32_bf16 v[240:243], a[220:223], a[92:95], v[240:243]
    s_waitcnt lgkmcnt(6)
    ds_read_b64_tr_b16 a[208:209], v32 offset:32768
    ds_read_b64_tr_b16 a[210:211], v32 offset:36864
    v_mfma_f32_16x16x32_bf16 v[84:87], a[192:195], a[112:115], v[84:87]
    buffer_load_dwordx4 v60, s[12:15], s42 offen offset:2048 nt lds
    v_mfma_f32_16x16x32_bf16 v[88:91], a[192:195], a[116:119], v[88:91]
    s_waitcnt lgkmcnt(6)
    ds_read_b64_tr_b16 a[212:213], v33 offset:32768
    ds_read_b64_tr_b16 a[214:215], v33 offset:36864
    v_mfma_f32_16x16x32_bf16 v[92:95], a[196:199], a[112:115], v[92:95]
    buffer_load_dwordx4 v61, s[12:15], s42 offen offset:3072 nt lds
    v_mfma_f32_16x16x32_bf16 v[96:99], a[196:199], a[116:119], v[96:99]
    s_waitcnt lgkmcnt(6)
    ds_read_b64_tr_b16 a[216:217], v34 offset:32768
    ds_read_b64_tr_b16 a[218:219], v34 offset:36864
    v_mfma_f32_16x16x32_bf16 v[100:103], a[200:203], a[112:115], v[100:103]
    v_mfma_f32_16x16x32_bf16 v[104:107], a[200:203], a[116:119], v[104:107]
    s_waitcnt lgkmcnt(6)
    ds_read_b64_tr_b16 a[220:221], v35 offset:32768
    ds_read_b64_tr_b16 a[222:223], v35 offset:36864
    v_mfma_f32_16x16x32_bf16 v[108:111], a[204:207], a[112:115], v[108:111]
    v_mfma_f32_16x16x32_bf16 v[112:115], a[204:207], a[116:119], v[112:115]
    s_waitcnt lgkmcnt(6)
    ds_read_b64 a[120:121], v154 offset:0
    ds_read_b64 a[122:123], v155 offset:0
    v_mfma_f32_16x16x32_bf16 v[116:119], a[208:211], a[112:115], v[116:119]
    ds_read_b64 a[124:125], v154 offset:2048
    ds_read_b64 a[126:127], v155 offset:2048
    v_mfma_f32_16x16x32_bf16 v[120:123], a[208:211], a[116:119], v[120:123]
    s_waitcnt lgkmcnt(8)
    ds_read_b64_tr_b16 a[192:193], v28 offset:40960
    ds_read_b64_tr_b16 a[194:195], v28 offset:45056
    v_mfma_f32_16x16x32_bf16 v[124:127], a[212:215], a[112:115], v[124:127]
    ds_read_b64_tr_b16 a[196:197], v29 offset:40960
    ds_read_b64_tr_b16 a[198:199], v29 offset:45056
    v_mfma_f32_16x16x32_bf16 v[128:131], a[212:215], a[116:119], v[128:131]
    s_waitcnt lgkmcnt(10)
    ds_read_b64_tr_b16 a[200:201], v30 offset:40960
    ds_read_b64_tr_b16 a[202:203], v30 offset:45056
    v_mfma_f32_16x16x32_bf16 v[132:135], a[216:219], a[112:115], v[132:135]
    v_mfma_f32_16x16x32_bf16 v[136:139], a[216:219], a[116:119], v[136:139]
    s_waitcnt lgkmcnt(10)
    ds_read_b64_tr_b16 a[204:205], v31 offset:40960
    ds_read_b64_tr_b16 a[206:207], v31 offset:45056
    v_mfma_f32_16x16x32_bf16 v[140:143], a[220:223], a[112:115], v[140:143]
    v_mfma_f32_16x16x32_bf16 v[144:147], a[220:223], a[116:119], v[144:147]
    s_waitcnt lgkmcnt(6)
    ds_read_b64_tr_b16 a[208:209], v32 offset:40960
    ds_read_b64_tr_b16 a[210:211], v32 offset:45056
    v_mfma_f32_16x16x32_bf16 v[84:87], a[192:195], a[120:123], v[84:87]
    v_mfma_f32_16x16x32_bf16 v[88:91], a[192:195], a[124:127], v[88:91]
    s_waitcnt lgkmcnt(6)
    ds_read_b64_tr_b16 a[212:213], v33 offset:40960
    ds_read_b64_tr_b16 a[214:215], v33 offset:45056
    v_mfma_f32_16x16x32_bf16 v[92:95], a[196:199], a[120:123], v[92:95]
    v_mfma_f32_16x16x32_bf16 v[96:99], a[196:199], a[124:127], v[96:99]
    s_waitcnt lgkmcnt(6)
    ds_read_b64_tr_b16 a[216:217], v34 offset:40960
    ds_read_b64_tr_b16 a[218:219], v34 offset:45056
    v_mfma_f32_16x16x32_bf16 v[100:103], a[200:203], a[120:123], v[100:103]
    v_mfma_f32_16x16x32_bf16 v[104:107], a[200:203], a[124:127], v[104:107]
    s_waitcnt lgkmcnt(6)
    ds_read_b64_tr_b16 a[220:221], v35 offset:40960
    ds_read_b64_tr_b16 a[222:223], v35 offset:45056
    v_mfma_f32_16x16x32_bf16 v[108:111], a[204:207], a[120:123], v[108:111]
    v_mul_f32 v84, s46, v84
    v_mul_f32 v85, s46, v85
    v_mfma_f32_16x16x32_bf16 v[112:115], a[204:207], a[124:127], v[112:115]
    s_waitcnt lgkmcnt(6)
    s_waitcnt vmcnt(8)
    s_barrier
    ds_read_b64_tr_b16 a[192:193], v36 offset:0
    ds_read_b64_tr_b16 a[194:195], v36 offset:4096
    v_mfma_f32_16x16x32_bf16 v[116:119], a[208:211], a[120:123], v[116:119]
    s_add_u32 m0, s37, 32768
    v_mul_f32 v86, s46, v86
    v_mul_f32 v87, s46, v87
    v_mfma_f32_16x16x32_bf16 v[120:123], a[208:211], a[124:127], v[120:123]
    s_waitcnt lgkmcnt(6)
    ds_read_b64_tr_b16 a[196:197], v37 offset:0
    ds_read_b64_tr_b16 a[198:199], v37 offset:4096
    v_mfma_f32_16x16x32_bf16 v[124:127], a[212:215], a[120:123], v[124:127]
    s_add_u32 s42, s39, 49152
    buffer_load_dwordx4 v56, s[8:11], s42 offen offset:0 nt lds
    v_mfma_f32_16x16x32_bf16 v[128:131], a[212:215], a[124:127], v[128:131]
    s_waitcnt lgkmcnt(6)
    ds_read_b64_tr_b16 a[200:201], v38 offset:0
    ds_read_b64_tr_b16 a[202:203], v38 offset:4096
    v_mfma_f32_16x16x32_bf16 v[132:135], a[216:219], a[120:123], v[132:135]
    buffer_load_dwordx4 v57, s[8:11], s42 offen offset:1024 nt lds
    v_mfma_f32_16x16x32_bf16 v[136:139], a[216:219], a[124:127], v[136:139]
    s_waitcnt lgkmcnt(6)
    ds_read_b64_tr_b16 a[204:205], v39 offset:0
    ds_read_b64_tr_b16 a[206:207], v39 offset:4096
    v_mfma_f32_16x16x32_bf16 v[140:143], a[220:223], a[120:123], v[140:143]
    buffer_load_dwordx4 v58, s[8:11], s42 offen offset:2048 nt lds
    v_mfma_f32_16x16x32_bf16 v[144:147], a[220:223], a[124:127], v[144:147]
    s_waitcnt lgkmcnt(6)
    ds_read_b64_tr_b16 a[208:209], v40 offset:0
    ds_read_b64_tr_b16 a[210:211], v40 offset:4096
    v_mfma_f32_16x16x32_bf16 v[180:183], a[192:195], a[96:99], v[180:183]
    buffer_load_dwordx4 v59, s[8:11], s42 offen offset:3072 nt lds
    v_mul_f32 v92, s46, v92
    v_mul_f32 v93, s46, v93
    v_mul_f32 v94, s46, v94
    v_mul_f32 v95, s46, v95
    v_mfma_f32_16x16x32_bf16 v[184:187], a[192:195], a[100:103], v[184:187]
    s_waitcnt lgkmcnt(6)
    ds_read_b64_tr_b16 a[212:213], v41 offset:0
    ds_read_b64_tr_b16 a[214:215], v41 offset:4096
    v_cvt_pk_bf16_f32 v148, v84, v85
    v_cvt_pk_bf16_f32 v149, v86, v87
    v_cvt_pk_bf16_f32 v150, v92, v93
    v_cvt_pk_bf16_f32 v151, v94, v95
    v_mfma_f32_16x16x32_bf16 v[188:191], a[196:199], a[96:99], v[188:191]
    v_mul_f32 v88, s46, v88
    v_mul_f32 v89, s46, v89
    v_mul_f32 v90, s46, v90
    v_mul_f32 v91, s46, v91
    v_mul_f32 v96, s46, v96
    v_mul_f32 v97, s46, v97
    v_mfma_f32_16x16x32_bf16 v[192:195], a[196:199], a[100:103], v[192:195]
    s_waitcnt lgkmcnt(6)
    ds_read_b64_tr_b16 a[216:217], v42 offset:0
    ds_read_b64_tr_b16 a[218:219], v42 offset:4096
    v_mul_f32 v98, s46, v98
    v_mul_f32 v99, s46, v99
    v_cvt_pk_bf16_f32 v152, v88, v89
    v_cvt_pk_bf16_f32 v153, v90, v91
    v_mfma_f32_16x16x32_bf16 v[196:199], a[200:203], a[96:99], v[196:199]
    v_cvt_pk_bf16_f32 v154, v96, v97
    v_cvt_pk_bf16_f32 v155, v98, v99
    v_permlane32_swap_b32 v148, v150
    v_permlane32_swap_b32 v149, v151
    v_permlane32_swap_b32 v152, v154
    v_permlane32_swap_b32 v153, v155
    v_mfma_f32_16x16x32_bf16 v[200:203], a[200:203], a[100:103], v[200:203]
    s_waitcnt lgkmcnt(6)
    ds_read_b64_tr_b16 a[220:221], v43 offset:0
    ds_read_b64_tr_b16 a[222:223], v43 offset:4096
    v_permlane16_swap_b32 v148, v150
    v_permlane16_swap_b32 v149, v151
    v_permlane16_swap_b32 v152, v154
    v_permlane16_swap_b32 v153, v155
    v_mfma_f32_16x16x32_bf16 v[204:207], a[204:207], a[96:99], v[204:207]
    v_mul_f32 v100, s46, v100
    v_mul_f32 v101, s46, v101
    v_mul_f32 v102, s46, v102
    v_mul_f32 v103, s46, v103
    v_mul_f32 v108, s46, v108
    v_mul_f32 v109, s46, v109
    v_mfma_f32_16x16x32_bf16 v[208:211], a[204:207], a[100:103], v[208:211]
    s_waitcnt lgkmcnt(6)
    ds_read_b64_tr_b16 a[192:193], v36 offset:8192
    ds_read_b64_tr_b16 a[194:195], v36 offset:12288
    v_mul_f32 v110, s46, v110
    v_mul_f32 v111, s46, v111
    v_cvt_pk_bf16_f32 v156, v100, v101
    v_cvt_pk_bf16_f32 v157, v102, v103
    v_mfma_f32_16x16x32_bf16 v[212:215], a[208:211], a[96:99], v[212:215]
    v_cvt_pk_bf16_f32 v158, v108, v109
    v_cvt_pk_bf16_f32 v159, v110, v111
    v_mul_f32 v104, s46, v104
    v_mul_f32 v105, s46, v105
    v_mul_f32 v106, s46, v106
    v_mul_f32 v107, s46, v107
    v_mfma_f32_16x16x32_bf16 v[216:219], a[208:211], a[100:103], v[216:219]
    s_waitcnt lgkmcnt(6)
    ds_read_b64_tr_b16 a[196:197], v37 offset:8192
    ds_read_b64_tr_b16 a[198:199], v37 offset:12288
    v_mul_f32 v112, s46, v112
    v_mul_f32 v113, s46, v113
    v_mul_f32 v114, s46, v114
    v_mul_f32 v115, s46, v115
    v_mfma_f32_16x16x32_bf16 v[220:223], a[212:215], a[96:99], v[220:223]
    v_cvt_pk_bf16_f32 v160, v104, v105
    v_cvt_pk_bf16_f32 v161, v106, v107
    v_cvt_pk_bf16_f32 v162, v112, v113
    v_cvt_pk_bf16_f32 v163, v114, v115
    v_permlane32_swap_b32 v156, v158
    v_permlane32_swap_b32 v157, v159
    v_mfma_f32_16x16x32_bf16 v[224:227], a[212:215], a[100:103], v[224:227]
    s_waitcnt lgkmcnt(6)
    ds_read_b64_tr_b16 a[200:201], v38 offset:8192
    ds_read_b64_tr_b16 a[202:203], v38 offset:12288
    v_permlane32_swap_b32 v160, v162
    v_permlane32_swap_b32 v161, v163
    v_permlane16_swap_b32 v156, v158
    v_permlane16_swap_b32 v157, v159
    v_mfma_f32_16x16x32_bf16 v[228:231], a[216:219], a[96:99], v[228:231]
    v_permlane16_swap_b32 v160, v162
    v_permlane16_swap_b32 v161, v163
    v_mul_f32 v116, s46, v116
    v_mul_f32 v117, s46, v117
    v_mul_f32 v118, s46, v118
    v_mul_f32 v119, s46, v119
    v_mfma_f32_16x16x32_bf16 v[232:235], a[216:219], a[100:103], v[232:235]
    s_waitcnt lgkmcnt(6)
    ds_read_b64_tr_b16 a[204:205], v39 offset:8192
    ds_read_b64_tr_b16 a[206:207], v39 offset:12288
    v_mul_f32 v124, s46, v124
    v_mul_f32 v125, s46, v125
    v_mul_f32 v126, s46, v126
    v_mul_f32 v127, s46, v127
    v_mfma_f32_16x16x32_bf16 v[236:239], a[220:223], a[96:99], v[236:239]
    v_cvt_pk_bf16_f32 v164, v116, v117
    v_cvt_pk_bf16_f32 v165, v118, v119
    v_cvt_pk_bf16_f32 v166, v124, v125
    v_cvt_pk_bf16_f32 v167, v126, v127
    v_mul_f32 v120, s46, v120
    v_mul_f32 v121, s46, v121
    v_mfma_f32_16x16x32_bf16 v[240:243], a[220:223], a[100:103], v[240:243]
    s_waitcnt lgkmcnt(6)
    ds_read_b64_tr_b16 a[208:209], v40 offset:8192
    ds_read_b64_tr_b16 a[210:211], v40 offset:12288
    v_mul_f32 v122, s46, v122
    v_mul_f32 v123, s46, v123
    v_mul_f32 v128, s46, v128
    v_mul_f32 v129, s46, v129
    v_mfma_f32_16x16x32_bf16 v[180:183], a[192:195], a[104:107], v[180:183]
    v_mul_f32 v130, s46, v130
    v_mul_f32 v131, s46, v131
    v_cvt_pk_bf16_f32 v168, v120, v121
    v_cvt_pk_bf16_f32 v169, v122, v123
    v_cvt_pk_bf16_f32 v170, v128, v129
    v_cvt_pk_bf16_f32 v171, v130, v131
    v_mfma_f32_16x16x32_bf16 v[184:187], a[192:195], a[108:111], v[184:187]
    s_waitcnt lgkmcnt(6)
    ds_read_b64_tr_b16 a[212:213], v41 offset:8192
    ds_read_b64_tr_b16 a[214:215], v41 offset:12288
    v_permlane32_swap_b32 v164, v166
    v_permlane32_swap_b32 v165, v167
    v_permlane32_swap_b32 v168, v170
    v_permlane32_swap_b32 v169, v171
    v_mfma_f32_16x16x32_bf16 v[188:191], a[196:199], a[104:107], v[188:191]
    v_permlane16_swap_b32 v164, v166
    v_permlane16_swap_b32 v165, v167
    v_permlane16_swap_b32 v168, v170
    v_permlane16_swap_b32 v169, v171
    v_mul_f32 v132, s46, v132
    v_mul_f32 v133, s46, v133
    v_mfma_f32_16x16x32_bf16 v[192:195], a[196:199], a[108:111], v[192:195]
    s_waitcnt lgkmcnt(6)
    ds_read_b64_tr_b16 a[216:217], v42 offset:8192
    ds_read_b64_tr_b16 a[218:219], v42 offset:12288
    v_mul_f32 v134, s46, v134
    v_mul_f32 v135, s46, v135
    v_mul_f32 v140, s46, v140
    v_mul_f32 v141, s46, v141
    v_mfma_f32_16x16x32_bf16 v[196:199], a[200:203], a[104:107], v[196:199]
    v_mul_f32 v142, s46, v142
    v_mul_f32 v143, s46, v143
    v_cvt_pk_bf16_f32 v172, v132, v133
    v_cvt_pk_bf16_f32 v173, v134, v135
    v_cvt_pk_bf16_f32 v174, v140, v141
    v_cvt_pk_bf16_f32 v175, v142, v143
    v_mfma_f32_16x16x32_bf16 v[200:203], a[200:203], a[108:111], v[200:203]
    s_waitcnt lgkmcnt(6)
    ds_read_b64_tr_b16 a[220:221], v43 offset:8192
    ds_read_b64_tr_b16 a[222:223], v43 offset:12288
    v_mul_f32 v136, s46, v136
    v_mul_f32 v137, s46, v137
    v_mul_f32 v138, s46, v138
    v_mul_f32 v139, s46, v139
    v_mfma_f32_16x16x32_bf16 v[204:207], a[204:207], a[104:107], v[204:207]
    v_mul_f32 v144, s46, v144
    v_mul_f32 v145, s46, v145
    v_mul_f32 v146, s46, v146
    v_mul_f32 v147, s46, v147
    v_cvt_pk_bf16_f32 v176, v136, v137
    v_cvt_pk_bf16_f32 v177, v138, v139
    v_mfma_f32_16x16x32_bf16 v[208:211], a[204:207], a[108:111], v[208:211]
    s_waitcnt lgkmcnt(6)
    s_barrier
    ds_read_b128 a[192:195], v44 offset:49152
    ds_read_b128 a[196:199], v45 offset:49152
    v_cvt_pk_bf16_f32 v178, v144, v145
    v_cvt_pk_bf16_f32 v179, v146, v147
    v_permlane32_swap_b32 v172, v174
    v_permlane32_swap_b32 v173, v175
    v_mfma_f32_16x16x32_bf16 v[212:215], a[208:211], a[104:107], v[212:215]
    s_add_u32 m0, s37, 65536
    v_permlane32_swap_b32 v176, v178
    v_permlane32_swap_b32 v177, v179
    v_permlane16_swap_b32 v172, v174
    v_permlane16_swap_b32 v173, v175
    v_permlane16_swap_b32 v176, v178
    v_permlane16_swap_b32 v177, v179
    v_mfma_f32_16x16x32_bf16 v[216:219], a[208:211], a[108:111], v[216:219]
    s_waitcnt lgkmcnt(6)
    s_add_u32 s42, s39, 32768
    buffer_load_dwordx4 v60, s[12:15], s42 offen offset:0 nt lds
    v_mfma_f32_16x16x32_bf16 v[220:223], a[212:215], a[104:107], v[220:223]
    buffer_load_dwordx4 v61, s[12:15], s42 offen offset:1024 nt lds
    v_mfma_f32_16x16x32_bf16 v[224:227], a[212:215], a[108:111], v[224:227]
    s_waitcnt lgkmcnt(4)
    ds_read_b128 a[200:203], v46 offset:49152
    ds_read_b128 a[204:207], v47 offset:49152
    buffer_load_dwordx4 v60, s[12:15], s42 offen offset:2048 nt lds
    v_mfma_f32_16x16x32_bf16 v[228:231], a[216:219], a[104:107], v[228:231]
    buffer_load_dwordx4 v61, s[12:15], s42 offen offset:3072 nt lds
    v_mfma_f32_16x16x32_bf16 v[232:235], a[216:219], a[108:111], v[232:235]
    s_waitcnt lgkmcnt(4)
    v_mfma_f32_16x16x32_bf16 v[236:239], a[220:223], a[104:107], v[236:239]
    v_mfma_f32_16x16x32_bf16 v[240:243], a[220:223], a[108:111], v[240:243]
    s_waitcnt lgkmcnt(3)
    ds_read_b128 a[208:211], v44 offset:53248
    ds_read_b128 a[212:215], v45 offset:53248
    v_mfma_f32_16x16x32_bf16 v[84:87], a[192:195], v[148:151], 0
    v_mfma_f32_16x16x32_bf16 v[88:91], a[192:195], v[152:155], 0
    s_waitcnt lgkmcnt(4)
    v_mfma_f32_16x16x32_bf16 v[84:87], a[196:199], v[156:159], v[84:87]
    v_mfma_f32_16x16x32_bf16 v[88:91], a[196:199], v[160:163], v[88:91]
    s_waitcnt lgkmcnt(3)
    v_mfma_f32_16x16x32_bf16 v[84:87], a[200:203], v[164:167], v[84:87]
    v_mfma_f32_16x16x32_bf16 v[88:91], a[200:203], v[168:171], v[88:91]
    s_waitcnt lgkmcnt(2)
    v_mfma_f32_16x16x32_bf16 v[84:87], a[204:207], v[172:175], v[84:87]
    v_mfma_f32_16x16x32_bf16 v[88:91], a[204:207], v[176:179], v[88:91]
    s_waitcnt lgkmcnt(1)
    v_mfma_f32_16x16x32_bf16 v[92:95], a[208:211], v[148:151], 0
    v_mfma_f32_16x16x32_bf16 v[96:99], a[208:211], v[152:155], 0
    s_waitcnt lgkmcnt(0)
    ds_read_b128 a[216:219], v46 offset:53248
    ds_read_b128 a[220:223], v47 offset:53248
    v_mfma_f32_16x16x32_bf16 v[92:95], a[212:215], v[156:159], v[92:95]
    v_mfma_f32_16x16x32_bf16 v[96:99], a[212:215], v[160:163], v[96:99]
    s_waitcnt lgkmcnt(1)
    v_mfma_f32_16x16x32_bf16 v[92:95], a[216:219], v[164:167], v[92:95]
    v_mfma_f32_16x16x32_bf16 v[96:99], a[216:219], v[168:171], v[96:99]
    s_waitcnt lgkmcnt(0)
    ds_read_b128 a[192:195], v44 offset:57344
    ds_read_b128 a[196:199], v45 offset:57344
    v_mfma_f32_16x16x32_bf16 v[92:95], a[220:223], v[172:175], v[92:95]
    v_mfma_f32_16x16x32_bf16 v[96:99], a[220:223], v[176:179], v[96:99]
    s_waitcnt lgkmcnt(1)
    v_mfma_f32_16x16x32_bf16 v[100:103], a[192:195], v[148:151], 0
    v_mfma_f32_16x16x32_bf16 v[104:107], a[192:195], v[152:155], 0
    s_waitcnt lgkmcnt(0)
    ds_read_b128 a[200:203], v46 offset:57344
    ds_read_b128 a[204:207], v47 offset:57344
    v_mfma_f32_16x16x32_bf16 v[100:103], a[196:199], v[156:159], v[100:103]
    v_mfma_f32_16x16x32_bf16 v[104:107], a[196:199], v[160:163], v[104:107]
    s_waitcnt lgkmcnt(1)
    v_mfma_f32_16x16x32_bf16 v[100:103], a[200:203], v[164:167], v[100:103]
    v_mfma_f32_16x16x32_bf16 v[104:107], a[200:203], v[168:171], v[104:107]
    s_waitcnt lgkmcnt(0)
    ds_read_b128 a[208:211], v44 offset:61440
    ds_read_b128 a[212:215], v45 offset:61440
    v_mfma_f32_16x16x32_bf16 v[100:103], a[204:207], v[172:175], v[100:103]
    v_mfma_f32_16x16x32_bf16 v[104:107], a[204:207], v[176:179], v[104:107]
    s_waitcnt lgkmcnt(1)
    v_mfma_f32_16x16x32_bf16 v[108:111], a[208:211], v[148:151], 0
    v_mfma_f32_16x16x32_bf16 v[112:115], a[208:211], v[152:155], 0
    s_waitcnt lgkmcnt(0)
    ds_read_b128 a[216:219], v46 offset:61440
    ds_read_b128 a[220:223], v47 offset:61440
    v_mfma_f32_16x16x32_bf16 v[108:111], a[212:215], v[156:159], v[108:111]
    v_mfma_f32_16x16x32_bf16 v[112:115], a[212:215], v[160:163], v[112:115]
    s_waitcnt lgkmcnt(1)
    v_mfma_f32_16x16x32_bf16 v[108:111], a[216:219], v[164:167], v[108:111]
    v_mfma_f32_16x16x32_bf16 v[112:115], a[216:219], v[168:171], v[112:115]
    s_waitcnt lgkmcnt(0)
    s_waitcnt vmcnt(12)
    s_barrier
    ds_read_b64_tr_b16 a[192:193], v36 offset:16384
    ds_read_b64_tr_b16 a[194:195], v36 offset:20480
    v_mfma_f32_16x16x32_bf16 v[108:111], a[220:223], v[172:175], v[108:111]
    s_add_u32 m0, s37, 98304
    s_add_u32 s42, s39, 65536
    v_mfma_f32_16x16x32_bf16 v[112:115], a[220:223], v[176:179], v[112:115]
    s_waitcnt lgkmcnt(0)
    ds_read_b64_tr_b16 a[196:197], v37 offset:16384
    ds_read_b64_tr_b16 a[198:199], v37 offset:20480
    v_mfma_f32_16x16x32_bf16 v[180:183], a[192:195], a[112:115], v[180:183]
    buffer_load_dwordx4 v56, s[8:11], s42 offen offset:0 nt lds
    v_mfma_f32_16x16x32_bf16 v[184:187], a[192:195], a[116:119], v[184:187]
    s_waitcnt lgkmcnt(0)
    ds_read_b64_tr_b16 a[200:201], v38 offset:16384
    ds_read_b64_tr_b16 a[202:203], v38 offset:20480
    v_mfma_f32_16x16x32_bf16 v[188:191], a[196:199], a[112:115], v[188:191]
    buffer_load_dwordx4 v57, s[8:11], s42 offen offset:1024 nt lds
    v_mfma_f32_16x16x32_bf16 v[192:195], a[196:199], a[116:119], v[192:195]
    s_waitcnt lgkmcnt(0)
    ds_read_b64_tr_b16 a[204:205], v39 offset:16384
    ds_read_b64_tr_b16 a[206:207], v39 offset:20480
    v_mfma_f32_16x16x32_bf16 v[196:199], a[200:203], a[112:115], v[196:199]
    buffer_load_dwordx4 v58, s[8:11], s42 offen offset:2048 nt lds
    v_mfma_f32_16x16x32_bf16 v[200:203], a[200:203], a[116:119], v[200:203]
    s_waitcnt lgkmcnt(0)
    ds_read_b64_tr_b16 a[208:209], v40 offset:16384
    ds_read_b64_tr_b16 a[210:211], v40 offset:20480
    v_mfma_f32_16x16x32_bf16 v[204:207], a[204:207], a[112:115], v[204:207]
    buffer_load_dwordx4 v59, s[8:11], s42 offen offset:3072 nt lds
    v_mfma_f32_16x16x32_bf16 v[208:211], a[204:207], a[116:119], v[208:211]
    s_waitcnt lgkmcnt(0)
    ds_read_b64_tr_b16 a[212:213], v41 offset:16384
    ds_read_b64_tr_b16 a[214:215], v41 offset:20480
    v_mfma_f32_16x16x32_bf16 v[212:215], a[208:211], a[112:115], v[212:215]
    v_max3_f32 v1, v84, v85, v86
    v_max3_f32 v3, v88, v89, v90
    v_mfma_f32_16x16x32_bf16 v[216:219], a[208:211], a[116:119], v[216:219]
    s_waitcnt lgkmcnt(0)
    ds_read_b64_tr_b16 a[216:217], v42 offset:16384
    ds_read_b64_tr_b16 a[218:219], v42 offset:20480
    v_mfma_f32_16x16x32_bf16 v[220:223], a[212:215], a[112:115], v[220:223]
    v_max3_f32 v1, v1, v87, v92
    v_max3_f32 v3, v3, v91, v96
    v_mfma_f32_16x16x32_bf16 v[224:227], a[212:215], a[116:119], v[224:227]
    s_waitcnt lgkmcnt(0)
    ds_read_b64_tr_b16 a[220:221], v43 offset:16384
    ds_read_b64_tr_b16 a[222:223], v43 offset:20480
    v_mfma_f32_16x16x32_bf16 v[228:231], a[216:219], a[112:115], v[228:231]
    v_max3_f32 v1, v1, v93, v94
    v_max3_f32 v3, v3, v97, v98
    v_mfma_f32_16x16x32_bf16 v[232:235], a[216:219], a[116:119], v[232:235]
    s_waitcnt lgkmcnt(0)
    ds_read_b64_tr_b16 a[192:193], v36 offset:24576
    ds_read_b64_tr_b16 a[194:195], v36 offset:28672
    v_mfma_f32_16x16x32_bf16 v[236:239], a[220:223], a[112:115], v[236:239]
    v_max3_f32 v1, v1, v95, v100
    v_max3_f32 v3, v3, v99, v104
    v_mfma_f32_16x16x32_bf16 v[240:243], a[220:223], a[116:119], v[240:243]
    s_waitcnt lgkmcnt(0)
    ds_read_b64_tr_b16 a[196:197], v37 offset:24576
    ds_read_b64_tr_b16 a[198:199], v37 offset:28672
    v_mfma_f32_16x16x32_bf16 v[180:183], a[192:195], a[120:123], v[180:183]
    v_max3_f32 v1, v1, v101, v102
    v_max3_f32 v3, v3, v105, v106
    v_mfma_f32_16x16x32_bf16 v[184:187], a[192:195], a[124:127], v[184:187]
    s_waitcnt lgkmcnt(0)
    ds_read_b64_tr_b16 a[200:201], v38 offset:24576
    ds_read_b64_tr_b16 a[202:203], v38 offset:28672
    v_mfma_f32_16x16x32_bf16 v[188:191], a[196:199], a[120:123], v[188:191]
    v_max3_f32 v1, v1, v103, v108
    v_max3_f32 v3, v3, v107, v112
    v_mfma_f32_16x16x32_bf16 v[192:195], a[196:199], a[124:127], v[192:195]
    s_waitcnt lgkmcnt(0)
    ds_read_b64_tr_b16 a[204:205], v39 offset:24576
    ds_read_b64_tr_b16 a[206:207], v39 offset:28672
    v_mfma_f32_16x16x32_bf16 v[196:199], a[200:203], a[120:123], v[196:199]
    v_max3_f32 v1, v1, v109, v110
    v_max3_f32 v3, v3, v113, v114
    v_mfma_f32_16x16x32_bf16 v[200:203], a[200:203], a[124:127], v[200:203]
    s_waitcnt lgkmcnt(0)
    ds_read_b64_tr_b16 a[208:209], v40 offset:24576
    ds_read_b64_tr_b16 a[210:211], v40 offset:28672
    v_mfma_f32_16x16x32_bf16 v[204:207], a[204:207], a[120:123], v[204:207]
    v_max_f32 v1, v1, v111
    v_max_f32 v3, v3, v115
    v_mfma_f32_16x16x32_bf16 v[208:211], a[204:207], a[124:127], v[208:211]
    s_waitcnt lgkmcnt(0)
    ds_read_b64_tr_b16 a[212:213], v41 offset:24576
    ds_read_b64_tr_b16 a[214:215], v41 offset:28672
    v_mfma_f32_16x16x32_bf16 v[212:215], a[208:211], a[120:123], v[212:215]
    v_mov_b32 v2, v1
    v_mov_b32 v4, v3
    v_mfma_f32_16x16x32_bf16 v[216:219], a[208:211], a[124:127], v[216:219]
    s_waitcnt lgkmcnt(0)
    ds_read_b64_tr_b16 a[216:217], v42 offset:24576
    ds_read_b64_tr_b16 a[218:219], v42 offset:28672
    v_mfma_f32_16x16x32_bf16 v[220:223], a[212:215], a[120:123], v[220:223]
    v_permlane32_swap_b32 v1, v2
    v_permlane32_swap_b32 v3, v4
    v_mfma_f32_16x16x32_bf16 v[224:227], a[212:215], a[124:127], v[224:227]
    s_waitcnt lgkmcnt(0)
    ds_read_b64_tr_b16 a[220:221], v43 offset:24576
    ds_read_b64_tr_b16 a[222:223], v43 offset:28672
    v_mfma_f32_16x16x32_bf16 v[228:231], a[216:219], a[120:123], v[228:231]
    v_max_f32 v1, v1, v2
    v_max_f32 v3, v3, v4
    v_mfma_f32_16x16x32_bf16 v[232:235], a[216:219], a[124:127], v[232:235]
    s_waitcnt lgkmcnt(0)
    s_barrier
    ds_read_b128 a[192:195], v48 offset:49152
    ds_read_b128 a[196:199], v49 offset:49152
    v_mfma_f32_16x16x32_bf16 v[236:239], a[220:223], a[120:123], v[236:239]
    s_add_u32 m0, s37, 131072
    v_mov_b32 v2, v1
    v_mov_b32 v4, v3
    v_mfma_f32_16x16x32_bf16 v[240:243], a[220:223], a[124:127], v[240:243]
    s_waitcnt lgkmcnt(1)
    v_permlane16_swap_b32 v1, v2
    v_permlane16_swap_b32 v3, v4
    v_max_f32 v1, v1, v2
    v_max_f32 v3, v3, v4
    v_sub_f32 v76, 0, v1
    v_sub_f32 v77, 0, v1
    v_sub_f32 v78, 0, v1
    v_sub_f32 v79, 0, v1
    v_sub_f32 v80, 0, v3
    v_sub_f32 v81, 0, v3
    v_sub_f32 v82, 0, v3
    v_sub_f32 v83, 0, v3
    v_mfma_f32_16x16x32_bf16 v[116:119], a[192:195], v[148:151], v[76:79]
    s_add_u32 s42, s39, 49152
    buffer_load_dwordx4 v60, s[12:15], s42 offen offset:0 nt lds
    v_mfma_f32_16x16x32_bf16 v[120:123], a[192:195], v[152:155], v[80:83]
    s_waitcnt lgkmcnt(0)
    ds_read_b128 a[200:203], v50 offset:49152
    ds_read_b128 a[204:207], v51 offset:49152
    v_mfma_f32_16x16x32_bf16 v[116:119], a[196:199], v[156:159], v[116:119]
    buffer_load_dwordx4 v61, s[12:15], s42 offen offset:1024 nt lds
    v_mfma_f32_16x16x32_bf16 v[120:123], a[196:199], v[160:163], v[120:123]
    s_waitcnt lgkmcnt(1)
    buffer_load_dwordx4 v60, s[12:15], s42 offen offset:2048 nt lds
    v_mfma_f32_16x16x32_bf16 v[116:119], a[200:203], v[164:167], v[116:119]
    buffer_load_dwordx4 v61, s[12:15], s42 offen offset:3072 nt lds
    v_mfma_f32_16x16x32_bf16 v[120:123], a[200:203], v[168:171], v[120:123]
    s_waitcnt lgkmcnt(0)
    ds_read_b128 a[208:211], v48 offset:53248
    ds_read_b128 a[212:215], v49 offset:53248
    v_mfma_f32_16x16x32_bf16 v[116:119], a[204:207], v[172:175], v[116:119]
    v_sub_f32 v84, v84, v1
    v_sub_f32 v85, v85, v1
    v_mfma_f32_16x16x32_bf16 v[120:123], a[204:207], v[176:179], v[120:123]
    s_waitcnt lgkmcnt(1)
    v_sub_f32 v86, v86, v1
    v_sub_f32 v87, v87, v1
    v_mfma_f32_16x16x32_bf16 v[124:127], a[208:211], v[148:151], v[76:79]
    v_sub_f32 v88, v88, v3
    v_sub_f32 v89, v89, v3
    v_mfma_f32_16x16x32_bf16 v[128:131], a[208:211], v[152:155], v[80:83]
    s_waitcnt lgkmcnt(0)
    ds_read_b128 a[216:219], v50 offset:53248
    ds_read_b128 a[220:223], v51 offset:53248
    v_mfma_f32_16x16x32_bf16 v[124:127], a[212:215], v[156:159], v[124:127]
    v_sub_f32 v90, v90, v3
    v_sub_f32 v91, v91, v3
    v_mfma_f32_16x16x32_bf16 v[128:131], a[212:215], v[160:163], v[128:131]
    s_waitcnt lgkmcnt(1)
    v_sub_f32 v92, v92, v1
    v_sub_f32 v93, v93, v1
    v_mfma_f32_16x16x32_bf16 v[124:127], a[216:219], v[164:167], v[124:127]
    v_sub_f32 v94, v94, v1
    v_sub_f32 v95, v95, v1
    v_mfma_f32_16x16x32_bf16 v[128:131], a[216:219], v[168:171], v[128:131]
    s_waitcnt lgkmcnt(0)
    ds_read_b128 a[192:195], v48 offset:57344
    ds_read_b128 a[196:199], v49 offset:57344
    v_mfma_f32_16x16x32_bf16 v[124:127], a[220:223], v[172:175], v[124:127]
    v_sub_f32 v96, v96, v3
    v_sub_f32 v97, v97, v3
    v_mfma_f32_16x16x32_bf16 v[128:131], a[220:223], v[176:179], v[128:131]
    s_waitcnt lgkmcnt(1)
    v_sub_f32 v98, v98, v3
    v_sub_f32 v99, v99, v3
    v_mfma_f32_16x16x32_bf16 v[132:135], a[192:195], v[148:151], v[76:79]
    v_sub_f32 v100, v100, v1
    v_sub_f32 v101, v101, v1
    v_mfma_f32_16x16x32_bf16 v[136:139], a[192:195], v[152:155], v[80:83]
    s_waitcnt lgkmcnt(0)
    ds_read_b128 a[200:203], v50 offset:57344
    ds_read_b128 a[204:207], v51 offset:57344
    v_mfma_f32_16x16x32_bf16 v[132:135], a[196:199], v[156:159], v[132:135]
    v_sub_f32 v102, v102, v1
    v_sub_f32 v103, v103, v1
    v_mfma_f32_16x16x32_bf16 v[136:139], a[196:199], v[160:163], v[136:139]
    s_waitcnt lgkmcnt(1)
    v_sub_f32 v104, v104, v3
    v_sub_f32 v105, v105, v3
    v_mfma_f32_16x16x32_bf16 v[132:135], a[200:203], v[164:167], v[132:135]
    v_sub_f32 v106, v106, v3
    v_sub_f32 v107, v107, v3
    v_mfma_f32_16x16x32_bf16 v[136:139], a[200:203], v[168:171], v[136:139]
    s_waitcnt lgkmcnt(0)
    ds_read_b128 a[208:211], v48 offset:61440
    ds_read_b128 a[212:215], v49 offset:61440
    v_mfma_f32_16x16x32_bf16 v[132:135], a[204:207], v[172:175], v[132:135]
    v_sub_f32 v108, v108, v1
    v_sub_f32 v109, v109, v1
    v_mfma_f32_16x16x32_bf16 v[136:139], a[204:207], v[176:179], v[136:139]
    s_waitcnt lgkmcnt(1)
    v_sub_f32 v110, v110, v1
    v_sub_f32 v111, v111, v1
    v_mfma_f32_16x16x32_bf16 v[140:143], a[208:211], v[148:151], v[76:79]
    v_sub_f32 v112, v112, v3
    v_sub_f32 v113, v113, v3
    v_mfma_f32_16x16x32_bf16 v[144:147], a[208:211], v[152:155], v[80:83]
    s_waitcnt lgkmcnt(0)
    ds_read_b128 a[216:219], v50 offset:61440
    ds_read_b128 a[220:223], v51 offset:61440
    v_mfma_f32_16x16x32_bf16 v[140:143], a[212:215], v[156:159], v[140:143]
    v_sub_f32 v114, v114, v3
    v_sub_f32 v115, v115, v3
    v_mfma_f32_16x16x32_bf16 v[144:147], a[212:215], v[160:163], v[144:147]
    s_waitcnt lgkmcnt(1)
    v_exp_f32 v84, v84
    v_mfma_f32_16x16x32_bf16 v[140:143], a[216:219], v[164:167], v[140:143]
    v_exp_f32 v85, v85
    v_mfma_f32_16x16x32_bf16 v[144:147], a[216:219], v[168:171], v[144:147]
    s_waitcnt lgkmcnt(0)
    v_exp_f32 v86, v86
    v_mfma_f32_16x16x32_bf16 v[140:143], a[220:223], v[172:175], v[140:143]
    v_exp_f32 v87, v87
    v_mfma_f32_16x16x32_bf16 v[144:147], a[220:223], v[176:179], v[144:147]
    s_barrier
    ds_read_b64_tr_b16 a[192:193], v20 offset:16384
    ds_read_b64_tr_b16 a[194:195], v20 offset:20480
    v_exp_f32 v92, v92
    v_exp_f32 v93, v93
    v_exp_f32 v94, v94
    v_exp_f32 v95, v95
    v_cvt_pk_bf16_f32 v84, v84, v85
    v_cvt_pk_bf16_f32 v85, v86, v87
    v_cvt_pk_bf16_f32 v86, v92, v93
    v_cvt_pk_bf16_f32 v87, v94, v95
    v_exp_f32 v88, v88
    v_exp_f32 v89, v89
    v_exp_f32 v90, v90
    v_exp_f32 v91, v91
    v_exp_f32 v96, v96
    v_exp_f32 v97, v97
    v_exp_f32 v98, v98
    v_exp_f32 v99, v99
    v_cvt_pk_bf16_f32 v88, v88, v89
    v_cvt_pk_bf16_f32 v89, v90, v91
    v_cvt_pk_bf16_f32 v90, v96, v97
    v_cvt_pk_bf16_f32 v91, v98, v99
    v_mfma_f32_16x16x32_bf16 v[68:71], a[224:227], v[84:87], 0
    s_add_u32 m0, s37, 49152
    v_exp_f32 v100, v100
    v_mfma_f32_16x16x32_bf16 v[72:75], a[224:227], v[88:91], 0
    s_waitcnt lgkmcnt(0)
    ds_read_b64_tr_b16 a[196:197], v21 offset:16384
    ds_read_b64_tr_b16 a[198:199], v21 offset:20480
    v_mfma_f32_16x16x32_bf16 a[128:131], a[192:195], v[84:87], 0
    s_add_u32 s42, s39, 81920
    buffer_load_dwordx4 v56, s[8:11], s42 offen offset:0 nt lds
    v_mfma_f32_16x16x32_bf16 a[132:135], a[192:195], v[88:91], 0
    s_waitcnt lgkmcnt(0)
    ds_read_b64_tr_b16 a[200:201], v22 offset:16384
    ds_read_b64_tr_b16 a[202:203], v22 offset:20480
    v_mfma_f32_16x16x32_bf16 a[136:139], a[196:199], v[84:87], 0
    buffer_load_dwordx4 v57, s[8:11], s42 offen offset:1024 nt lds
    v_mfma_f32_16x16x32_bf16 a[140:143], a[196:199], v[88:91], 0
    s_waitcnt lgkmcnt(0)
    ds_read_b64_tr_b16 a[204:205], v23 offset:16384
    ds_read_b64_tr_b16 a[206:207], v23 offset:20480
    v_mfma_f32_16x16x32_bf16 a[144:147], a[200:203], v[84:87], 0
    buffer_load_dwordx4 v58, s[8:11], s42 offen offset:2048 nt lds
    v_mfma_f32_16x16x32_bf16 a[148:151], a[200:203], v[88:91], 0
    s_waitcnt lgkmcnt(0)
    ds_read_b64_tr_b16 a[208:209], v24 offset:16384
    ds_read_b64_tr_b16 a[210:211], v24 offset:20480
    v_mfma_f32_16x16x32_bf16 a[152:155], a[204:207], v[84:87], 0
    buffer_load_dwordx4 v59, s[8:11], s42 offen offset:3072 nt lds
    v_mfma_f32_16x16x32_bf16 a[156:159], a[204:207], v[88:91], 0
    s_waitcnt lgkmcnt(0)
    ds_read_b64_tr_b16 a[212:213], v25 offset:16384
    ds_read_b64_tr_b16 a[214:215], v25 offset:20480
    v_mfma_f32_16x16x32_bf16 a[160:163], a[208:211], v[84:87], 0
    v_exp_f32 v101, v101
    v_mfma_f32_16x16x32_bf16 a[164:167], a[208:211], v[88:91], 0
    s_waitcnt lgkmcnt(0)
    ds_read_b64_tr_b16 a[216:217], v26 offset:16384
    ds_read_b64_tr_b16 a[218:219], v26 offset:20480
    v_mfma_f32_16x16x32_bf16 a[168:171], a[212:215], v[84:87], 0
    v_exp_f32 v102, v102
    v_mfma_f32_16x16x32_bf16 a[172:175], a[212:215], v[88:91], 0
    s_waitcnt lgkmcnt(0)
    ds_read_b64_tr_b16 a[220:221], v27 offset:16384
    ds_read_b64_tr_b16 a[222:223], v27 offset:20480
    v_mfma_f32_16x16x32_bf16 a[176:179], a[216:219], v[84:87], 0
    v_exp_f32 v103, v103
    v_mfma_f32_16x16x32_bf16 a[180:183], a[216:219], v[88:91], 0
    s_waitcnt lgkmcnt(0)
    v_exp_f32 v108, v108
    v_mfma_f32_16x16x32_bf16 a[184:187], a[220:223], v[84:87], 0
    v_exp_f32 v109, v109
    v_mfma_f32_16x16x32_bf16 a[188:191], a[220:223], v[88:91], 0
    ds_read_b64_tr_b16 a[192:193], v20 offset:24576
    ds_read_b64_tr_b16 a[194:195], v20 offset:28672
    v_exp_f32 v110, v110
    v_exp_f32 v111, v111
    v_cvt_pk_bf16_f32 v100, v100, v101
    v_cvt_pk_bf16_f32 v101, v102, v103
    v_cvt_pk_bf16_f32 v102, v108, v109
    v_cvt_pk_bf16_f32 v103, v110, v111
    v_exp_f32 v104, v104
    v_exp_f32 v105, v105
    v_exp_f32 v106, v106
    v_exp_f32 v107, v107
    v_exp_f32 v112, v112
    v_exp_f32 v113, v113
    v_exp_f32 v114, v114
    v_exp_f32 v115, v115
    v_cvt_pk_bf16_f32 v104, v104, v105
    v_cvt_pk_bf16_f32 v105, v106, v107
    v_cvt_pk_bf16_f32 v106, v112, v113
    v_cvt_pk_bf16_f32 v107, v114, v115
    v_mfma_f32_16x16x32_bf16 v[68:71], a[224:227], v[100:103], v[68:71]
    v_max3_f32 v19, v116, v117, v118
    v_max3_f32 v19, v19, v119, v120
    v_mfma_f32_16x16x32_bf16 v[72:75], a[224:227], v[104:107], v[72:75]
    s_waitcnt lgkmcnt(0)
    ds_read_b64_tr_b16 a[196:197], v21 offset:24576
    ds_read_b64_tr_b16 a[198:199], v21 offset:28672
    v_mfma_f32_16x16x32_bf16 a[128:131], a[192:195], v[100:103], a[128:131]
    v_max3_f32 v19, v19, v121, v122
    v_max3_f32 v19, v19, v123, v124
    v_mfma_f32_16x16x32_bf16 a[132:135], a[192:195], v[104:107], a[132:135]
    s_waitcnt lgkmcnt(0)
    ds_read_b64_tr_b16 a[200:201], v22 offset:24576
    ds_read_b64_tr_b16 a[202:203], v22 offset:28672
    v_mfma_f32_16x16x32_bf16 a[136:139], a[196:199], v[100:103], a[136:139]
    v_max3_f32 v19, v19, v125, v126
    v_max3_f32 v19, v19, v127, v128
    v_mfma_f32_16x16x32_bf16 a[140:143], a[196:199], v[104:107], a[140:143]
    s_waitcnt lgkmcnt(0)
    ds_read_b64_tr_b16 a[204:205], v23 offset:24576
    ds_read_b64_tr_b16 a[206:207], v23 offset:28672
    v_mfma_f32_16x16x32_bf16 a[144:147], a[200:203], v[100:103], a[144:147]
    v_max3_f32 v19, v19, v129, v130
    v_max3_f32 v19, v19, v131, v132
    v_mfma_f32_16x16x32_bf16 a[148:151], a[200:203], v[104:107], a[148:151]
    s_waitcnt lgkmcnt(0)
    ds_read_b64_tr_b16 a[208:209], v24 offset:24576
    ds_read_b64_tr_b16 a[210:211], v24 offset:28672
    v_mfma_f32_16x16x32_bf16 a[152:155], a[204:207], v[100:103], a[152:155]
    v_max3_f32 v19, v19, v133, v134
    v_max3_f32 v19, v19, v135, v136
    v_mfma_f32_16x16x32_bf16 a[156:159], a[204:207], v[104:107], a[156:159]
    s_waitcnt lgkmcnt(0)
    ds_read_b64_tr_b16 a[212:213], v25 offset:24576
    ds_read_b64_tr_b16 a[214:215], v25 offset:28672
    v_mfma_f32_16x16x32_bf16 a[160:163], a[208:211], v[100:103], a[160:163]
    v_max3_f32 v19, v19, v137, v138
    v_max3_f32 v19, v19, v139, v140
    v_mfma_f32_16x16x32_bf16 a[164:167], a[208:211], v[104:107], a[164:167]
    s_waitcnt lgkmcnt(0)
    ds_read_b64_tr_b16 a[216:217], v26 offset:24576
    ds_read_b64_tr_b16 a[218:219], v26 offset:28672
    v_mfma_f32_16x16x32_bf16 a[168:171], a[212:215], v[100:103], a[168:171]
    v_max3_f32 v19, v19, v141, v142
    v_max3_f32 v19, v19, v143, v144
    v_mfma_f32_16x16x32_bf16 a[172:175], a[212:215], v[104:107], a[172:175]
    s_waitcnt lgkmcnt(0)
    ds_read_b64_tr_b16 a[220:221], v27 offset:24576
    ds_read_b64_tr_b16 a[222:223], v27 offset:28672
    v_mfma_f32_16x16x32_bf16 a[176:179], a[216:219], v[100:103], a[176:179]
    v_max3_f32 v19, v19, v145, v146
    v_max_f32 v19, v19, v147
    v_mfma_f32_16x16x32_bf16 a[180:183], a[216:219], v[104:107], a[180:183]
    s_waitcnt lgkmcnt(0)
    s_barrier
    ds_read_b128 a[192:195], v48 offset:16384
    ds_read_b128 a[196:199], v49 offset:16384
    v_mfma_f32_16x16x32_bf16 a[184:187], a[220:223], v[100:103], a[184:187]
    s_add_u32 m0, s37, 147456
    v_cmp_lt_f32 vcc, s47, v19
    v_mul_f32 v180, s46, v180
    v_mfma_f32_16x16x32_bf16 a[188:191], a[220:223], v[104:107], a[188:191]
    s_cbranch_vccnz w2_t1_slow
w2_t1_back:
    s_waitcnt lgkmcnt(1)
    v_exp_f32 v116, v116
    v_mfma_f32_16x16x32_bf16 v[84:87], a[192:195], v[148:151], v[76:79]
    s_add_u32 s42, s39, 65536
    buffer_load_dwordx4 v60, s[12:15], s42 offen offset:0 nt lds
    v_mfma_f32_16x16x32_bf16 v[88:91], a[192:195], v[152:155], v[80:83]
    s_waitcnt lgkmcnt(0)
    ds_read_b128 a[200:203], v50 offset:16384
    ds_read_b128 a[204:207], v51 offset:16384
    v_mfma_f32_16x16x32_bf16 v[84:87], a[196:199], v[156:159], v[84:87]
    buffer_load_dwordx4 v61, s[12:15], s42 offen offset:1024 nt lds
    v_mfma_f32_16x16x32_bf16 v[88:91], a[196:199], v[160:163], v[88:91]
    s_waitcnt lgkmcnt(1)
    buffer_load_dwordx4 v60, s[12:15], s42 offen offset:2048 nt lds
    v_mfma_f32_16x16x32_bf16 v[84:87], a[200:203], v[164:167], v[84:87]
    buffer_load_dwordx4 v61, s[12:15], s42 offen offset:3072 nt lds
    v_mfma_f32_16x16x32_bf16 v[88:91], a[200:203], v[168:171], v[88:91]
    s_waitcnt lgkmcnt(0)
    ds_read_b128 a[208:211], v48 offset:20480
    ds_read_b128 a[212:215], v49 offset:20480
    v_mfma_f32_16x16x32_bf16 v[84:87], a[204:207], v[172:175], v[84:87]
    v_exp_f32 v117, v117
    v_mfma_f32_16x16x32_bf16 v[88:91], a[204:207], v[176:179], v[88:91]
    s_waitcnt lgkmcnt(1)
    v_exp_f32 v118, v118
    v_mfma_f32_16x16x32_bf16 v[92:95], a[208:211], v[148:151], v[76:79]
    v_exp_f32 v119, v119
    v_mfma_f32_16x16x32_bf16 v[96:99], a[208:211], v[152:155], v[80:83]
    s_waitcnt lgkmcnt(0)
    ds_read_b128 a[216:219], v50 offset:20480
    ds_read_b128 a[220:223], v51 offset:20480
    v_mfma_f32_16x16x32_bf16 v[92:95], a[212:215], v[156:159], v[92:95]
    v_exp_f32 v124, v124
    v_mfma_f32_16x16x32_bf16 v[96:99], a[212:215], v[160:163], v[96:99]
    s_waitcnt lgkmcnt(1)
    v_exp_f32 v125, v125
    v_mfma_f32_16x16x32_bf16 v[92:95], a[216:219], v[164:167], v[92:95]
    v_exp_f32 v126, v126
    v_mfma_f32_16x16x32_bf16 v[96:99], a[216:219], v[168:171], v[96:99]
    s_waitcnt lgkmcnt(0)
    ds_read_b128 a[192:195], v48 offset:24576
    ds_read_b128 a[196:199], v49 offset:24576
    v_mfma_f32_16x16x32_bf16 v[92:95], a[220:223], v[172:175], v[92:95]
    v_exp_f32 v127, v127
    v_mfma_f32_16x16x32_bf16 v[96:99], a[220:223], v[176:179], v[96:99]
    s_waitcnt lgkmcnt(1)
    v_cvt_pk_bf16_f32 v116, v116, v117
    v_cvt_pk_bf16_f32 v117, v118, v119
    v_mfma_f32_16x16x32_bf16 v[100:103], a[192:195], v[148:151], v[76:79]
    v_cvt_pk_bf16_f32 v118, v124, v125
    v_cvt_pk_bf16_f32 v119, v126, v127
    v_mfma_f32_16x16x32_bf16 v[104:107], a[192:195], v[152:155], v[80:83]
    s_waitcnt lgkmcnt(0)
    ds_read_b128 a[200:203], v50 offset:24576
    ds_read_b128 a[204:207], v51 offset:24576
    v_mfma_f32_16x16x32_bf16 v[100:103], a[196:199], v[156:159], v[100:103]
    v_exp_f32 v120, v120
    v_mfma_f32_16x16x32_bf16 v[104:107], a[196:199], v[160:163], v[104:107]
    s_waitcnt lgkmcnt(1)
    v_exp_f32 v121, v121
    v_mfma_f32_16x16x32_bf16 v[100:103], a[200:203], v[164:167], v[100:103]
    v_exp_f32 v122, v122
    v_mfma_f32_16x16x32_bf16 v[104:107], a[200:203], v[168:171], v[104:107]
    s_waitcnt lgkmcnt(0)
    ds_read_b128 a[208:211], v48 offset:28672
    ds_read_b128 a[212:215], v49 offset:28672
    v_mfma_f32_16x16x32_bf16 v[100:103], a[204:207], v[172:175], v[100:103]
    v_exp_f32 v123, v123
    v_mfma_f32_16x16x32_bf16 v[104:107], a[204:207], v[176:179], v[104:107]
    s_waitcnt lgkmcnt(1)
    v_exp_f32 v128, v128
    v_mfma_f32_16x16x32_bf16 v[108:111], a[208:211], v[148:151], v[76:79]
    v_exp_f32 v129, v129
    v_mfma_f32_16x16x32_bf16 v[112:115], a[208:211], v[152:155], v[80:83]
    s_waitcnt lgkmcnt(0)
    ds_read_b128 a[216:219], v50 offset:28672
    ds_read_b128 a[220:223], v51 offset:28672
    v_mfma_f32_16x16x32_bf16 v[108:111], a[212:215], v[156:159], v[108:111]
    v_exp_f32 v130, v130
    v_mfma_f32_16x16x32_bf16 v[112:115], a[212:215], v[160:163], v[112:115]
    s_waitcnt lgkmcnt(1)
    v_exp_f32 v131, v131
    v_mfma_f32_16x16x32_bf16 v[108:111], a[216:219], v[164:167], v[108:111]
    v_cvt_pk_bf16_f32 v120, v120, v121
    v_cvt_pk_bf16_f32 v121, v122, v123
    v_mfma_f32_16x16x32_bf16 v[112:115], a[216:219], v[168:171], v[112:115]
    s_waitcnt lgkmcnt(0)
    v_cvt_pk_bf16_f32 v122, v128, v129
    v_cvt_pk_bf16_f32 v123, v130, v131
    v_mfma_f32_16x16x32_bf16 v[108:111], a[220:223], v[172:175], v[108:111]
    v_exp_f32 v132, v132
    v_mfma_f32_16x16x32_bf16 v[112:115], a[220:223], v[176:179], v[112:115]
    s_waitcnt vmcnt(24)
    s_barrier
    global_load_dword v7, v67, s[88:89]
    ds_read_b64_tr_b16 a[192:193], v20 offset:0
    ds_read_b64_tr_b16 a[194:195], v20 offset:4096
    v_mfma_f32_16x16x32_bf16 v[68:71], a[224:227], v[116:119], v[68:71]
    s_add_u32 m0, s37, 114688
    v_exp_f32 v133, v133
    v_mfma_f32_16x16x32_bf16 v[72:75], a[224:227], v[120:123], v[72:75]
    s_waitcnt lgkmcnt(0)
    ds_read_b64_tr_b16 a[196:197], v21 offset:0
    ds_read_b64_tr_b16 a[198:199], v21 offset:4096
    v_mfma_f32_16x16x32_bf16 a[128:131], a[192:195], v[116:119], a[128:131]
    s_add_u32 s42, s39, 98304
    buffer_load_dwordx4 v56, s[8:11], s42 offen offset:0 nt lds
    v_mfma_f32_16x16x32_bf16 a[132:135], a[192:195], v[120:123], a[132:135]
    s_waitcnt lgkmcnt(0)
    ds_read_b64_tr_b16 a[200:201], v22 offset:0
    ds_read_b64_tr_b16 a[202:203], v22 offset:4096
    v_mfma_f32_16x16x32_bf16 a[136:139], a[196:199], v[116:119], a[136:139]
    buffer_load_dwordx4 v57, s[8:11], s42 offen offset:1024 nt lds
    v_mfma_f32_16x16x32_bf16 a[140:143], a[196:199], v[120:123], a[140:143]
    s_waitcnt lgkmcnt(0)
    ds_read_b64_tr_b16 a[204:205], v23 offset:0
    ds_read_b64_tr_b16 a[206:207], v23 offset:4096
    v_mfma_f32_16x16x32_bf16 a[144:147], a[200:203], v[116:119], a[144:147]
    buffer_load_dwordx4 v58, s[8:11], s42 offen offset:2048 nt lds
    v_mfma_f32_16x16x32_bf16 a[148:151], a[200:203], v[120:123], a[148:151]
    s_waitcnt lgkmcnt(0)
    ds_read_b64_tr_b16 a[208:209], v24 offset:0
    ds_read_b64_tr_b16 a[210:211], v24 offset:4096
    v_mfma_f32_16x16x32_bf16 a[152:155], a[204:207], v[116:119], a[152:155]
    buffer_load_dwordx4 v59, s[8:11], s42 offen offset:3072 nt lds
    v_mfma_f32_16x16x32_bf16 a[156:159], a[204:207], v[120:123], a[156:159]
    s_waitcnt lgkmcnt(0)
    ds_read_b64_tr_b16 a[212:213], v25 offset:0
    ds_read_b64_tr_b16 a[214:215], v25 offset:4096
    v_mfma_f32_16x16x32_bf16 a[160:163], a[208:211], v[116:119], a[160:163]
    v_exp_f32 v134, v134
    v_mfma_f32_16x16x32_bf16 a[164:167], a[208:211], v[120:123], a[164:167]
    s_waitcnt lgkmcnt(0)
    ds_read_b64_tr_b16 a[216:217], v26 offset:0
    ds_read_b64_tr_b16 a[218:219], v26 offset:4096
    v_mfma_f32_16x16x32_bf16 a[168:171], a[212:215], v[116:119], a[168:171]
    v_exp_f32 v135, v135
    v_mfma_f32_16x16x32_bf16 a[172:175], a[212:215], v[120:123], a[172:175]
    s_waitcnt lgkmcnt(0)
    ds_read_b64_tr_b16 a[220:221], v27 offset:0
    ds_read_b64_tr_b16 a[222:223], v27 offset:4096
    v_mfma_f32_16x16x32_bf16 a[176:179], a[216:219], v[116:119], a[176:179]
    v_exp_f32 v140, v140
    v_mfma_f32_16x16x32_bf16 a[180:183], a[216:219], v[120:123], a[180:183]
    s_waitcnt lgkmcnt(0)
    v_exp_f32 v141, v141
    v_mfma_f32_16x16x32_bf16 a[184:187], a[220:223], v[116:119], a[184:187]
    v_exp_f32 v142, v142
    v_mfma_f32_16x16x32_bf16 a[188:191], a[220:223], v[120:123], a[188:191]
    ds_read_b64_tr_b16 a[192:193], v20 offset:8192
    ds_read_b64_tr_b16 a[194:195], v20 offset:12288
    v_exp_f32 v143, v143
    v_cvt_pk_bf16_f32 v132, v132, v133
    v_cvt_pk_bf16_f32 v133, v134, v135
    v_cvt_pk_bf16_f32 v134, v140, v141
    v_cvt_pk_bf16_f32 v135, v142, v143
    v_exp_f32 v136, v136
    v_exp_f32 v137, v137
    v_exp_f32 v138, v138
    v_exp_f32 v139, v139
    v_exp_f32 v144, v144
    v_exp_f32 v145, v145
    v_exp_f32 v146, v146
    v_exp_f32 v147, v147
    v_cvt_pk_bf16_f32 v136, v136, v137
    v_cvt_pk_bf16_f32 v137, v138, v139
    v_cvt_pk_bf16_f32 v138, v144, v145
    v_cvt_pk_bf16_f32 v139, v146, v147
    v_mfma_f32_16x16x32_bf16 v[68:71], a[224:227], v[132:135], v[68:71]
    v_max3_f32 v19, v84, v85, v86
    v_max3_f32 v19, v19, v87, v88
    v_mfma_f32_16x16x32_bf16 v[72:75], a[224:227], v[136:139], v[72:75]
    s_waitcnt lgkmcnt(0)
    ds_read_b64_tr_b16 a[196:197], v21 offset:8192
    ds_read_b64_tr_b16 a[198:199], v21 offset:12288
    v_mfma_f32_16x16x32_bf16 a[128:131], a[192:195], v[132:135], a[128:131]
    v_max3_f32 v19, v19, v89, v90
    v_max3_f32 v19, v19, v91, v92
    v_mfma_f32_16x16x32_bf16 a[132:135], a[192:195], v[136:139], a[132:135]
    s_waitcnt lgkmcnt(0)
    ds_read_b64_tr_b16 a[200:201], v22 offset:8192
    ds_read_b64_tr_b16 a[202:203], v22 offset:12288
    v_mfma_f32_16x16x32_bf16 a[136:139], a[196:199], v[132:135], a[136:139]
    v_max3_f32 v19, v19, v93, v94
    v_max3_f32 v19, v19, v95, v96
    v_mfma_f32_16x16x32_bf16 a[140:143], a[196:199], v[136:139], a[140:143]
    s_waitcnt lgkmcnt(0)
    ds_read_b64_tr_b16 a[204:205], v23 offset:8192
    ds_read_b64_tr_b16 a[206:207], v23 offset:12288
    v_mfma_f32_16x16x32_bf16 a[144:147], a[200:203], v[132:135], a[144:147]
    v_max3_f32 v19, v19, v97, v98
    v_max3_f32 v19, v19, v99, v100
    v_mfma_f32_16x16x32_bf16 a[148:151], a[200:203], v[136:139], a[148:151]
    s_waitcnt lgkmcnt(0)
    ds_read_b64_tr_b16 a[208:209], v24 offset:8192
    ds_read_b64_tr_b16 a[210:211], v24 offset:12288
    v_mfma_f32_16x16x32_bf16 a[152:155], a[204:207], v[132:135], a[152:155]
    v_max3_f32 v19, v19, v101, v102
    v_max3_f32 v19, v19, v103, v104
    v_mfma_f32_16x16x32_bf16 a[156:159], a[204:207], v[136:139], a[156:159]
    s_waitcnt lgkmcnt(0)
    ds_read_b64_tr_b16 a[212:213], v25 offset:8192
    ds_read_b64_tr_b16 a[214:215], v25 offset:12288
    v_mfma_f32_16x16x32_bf16 a[160:163], a[208:211], v[132:135], a[160:163]
    v_max3_f32 v19, v19, v105, v106
    v_max3_f32 v19, v19, v107, v108
    v_mfma_f32_16x16x32_bf16 a[164:167], a[208:211], v[136:139], a[164:167]
    s_waitcnt lgkmcnt(0)
    ds_read_b64_tr_b16 a[216:217], v26 offset:8192
    ds_read_b64_tr_b16 a[218:219], v26 offset:12288
    v_mfma_f32_16x16x32_bf16 a[168:171], a[212:215], v[132:135], a[168:171]
    v_max3_f32 v19, v19, v109, v110
    v_max3_f32 v19, v19, v111, v112
    v_mfma_f32_16x16x32_bf16 a[172:175], a[212:215], v[136:139], a[172:175]
    s_waitcnt lgkmcnt(0)
    ds_read_b64_tr_b16 a[220:221], v27 offset:8192
    ds_read_b64_tr_b16 a[222:223], v27 offset:12288
    v_mfma_f32_16x16x32_bf16 a[176:179], a[216:219], v[132:135], a[176:179]
    v_max3_f32 v19, v19, v113, v114
    v_max_f32 v19, v19, v115
    v_mfma_f32_16x16x32_bf16 a[180:183], a[216:219], v[136:139], a[180:183]
    s_waitcnt lgkmcnt(0)
    s_waitcnt vmcnt(25)
    s_barrier
    ds_read_b128 a[192:195], v44 offset:32768
    ds_read_b128 a[196:199], v45 offset:32768
    v_mfma_f32_16x16x32_bf16 a[184:187], a[220:223], v[132:135], a[184:187]
    s_add_u32 m0, s37, 16384
    v_cmp_lt_f32 vcc, s47, v19
    v_mul_f32 v181, s46, v181
    v_mfma_f32_16x16x32_bf16 a[188:191], a[220:223], v[136:139], a[188:191]
    s_cbranch_vccnz w2_t2_slow
w2_t2_back:
    s_waitcnt lgkmcnt(1)
    v_exp_f32 v84, v84
    v_mul_f32 v182, s46, v182
    v_mul_f32 v183, s46, v183
    v_mul_f32 v188, s46, v188
    v_mul_f32 v189, s46, v189
    v_mul_f32 v190, s46, v190
    v_mul_f32 v191, s46, v191
    v_cvt_pk_bf16_f32 v180, v180, v181
    v_cvt_pk_bf16_f32 v181, v182, v183
    v_cvt_pk_bf16_f32 v182, v188, v189
    v_cvt_pk_bf16_f32 v183, v190, v191
    v_mul_f32 v184, s46, v184
    v_mul_f32 v185, s46, v185
    v_mul_f32 v186, s46, v186
    v_mul_f32 v187, s46, v187
    v_mul_f32 v192, s46, v192
    v_mul_f32 v193, s46, v193
    v_mul_f32 v194, s46, v194
    v_mul_f32 v195, s46, v195
    v_cvt_pk_bf16_f32 v184, v184, v185
    v_cvt_pk_bf16_f32 v185, v186, v187
    v_cvt_pk_bf16_f32 v186, v192, v193
    v_cvt_pk_bf16_f32 v187, v194, v195
    v_permlane32_swap_b32 v180, v182
    v_permlane32_swap_b32 v181, v183
    v_permlane32_swap_b32 v184, v186
    v_permlane32_swap_b32 v185, v187
    v_permlane16_swap_b32 v180, v182
    v_permlane16_swap_b32 v181, v183
    v_permlane16_swap_b32 v184, v186
    v_permlane16_swap_b32 v185, v187
    v_mfma_f32_16x16x32_bf16 v[116:119], a[192:195], v[148:151], v[76:79]
    s_add_u32 s42, s39, 81920
    ds_read_b128 a[200:203], v46 offset:32768
    ds_read_b128 a[204:207], v47 offset:32768
    v_mfma_f32_16x16x32_bf16 v[120:123], a[192:195], v[152:155], v[80:83]
    s_waitcnt lgkmcnt(2)
    buffer_load_dwordx4 v60, s[12:15], s42 offen offset:0 nt lds
    v_mfma_f32_16x16x32_bf16 v[116:119], a[196:199], v[156:159], v[116:119]
    buffer_load_dwordx4 v61, s[12:15], s42 offen offset:1024 nt lds
    v_mfma_f32_16x16x32_bf16 v[120:123], a[196:199], v[160:163], v[120:123]
    s_waitcnt lgkmcnt(1)
    buffer_load_dwordx4 v60, s[12:15], s42 offen offset:2048 nt lds
    v_mfma_f32_16x16x32_bf16 v[116:119], a[200:203], v[164:167], v[116:119]
    ds_read_b128 a[208:211], v44 offset:36864
    ds_read_b128 a[212:215], v45 offset:36864
    v_mfma_f32_16x16x32_bf16 v[120:123], a[200:203], v[168:171], v[120:123]
    s_waitcnt lgkmcnt(2)
    buffer_load_dwordx4 v61, s[12:15], s42 offen offset:3072 nt lds
    v_mfma_f32_16x16x32_bf16 v[116:119], a[204:207], v[172:175], v[116:119]
    v_exp_f32 v85, v85
    v_mfma_f32_16x16x32_bf16 v[120:123], a[204:207], v[176:179], v[120:123]
    s_waitcnt lgkmcnt(1)
    v_exp_f32 v86, v86
    v_mfma_f32_16x16x32_bf16 v[124:127], a[208:211], v[148:151], v[76:79]
    ds_read_b128 a[216:219], v46 offset:36864
    ds_read_b128 a[220:223], v47 offset:36864
    v_mfma_f32_16x16x32_bf16 v[128:131], a[208:211], v[152:155], v[80:83]
    s_waitcnt lgkmcnt(2)
    v_exp_f32 v87, v87
    v_mfma_f32_16x16x32_bf16 v[124:127], a[212:215], v[156:159], v[124:127]
    v_exp_f32 v92, v92
    v_mfma_f32_16x16x32_bf16 v[128:131], a[212:215], v[160:163], v[128:131]
    s_waitcnt lgkmcnt(1)
    v_exp_f32 v93, v93
    v_mfma_f32_16x16x32_bf16 v[124:127], a[216:219], v[164:167], v[124:127]
    ds_read_b128 a[192:195], v44 offset:40960
    ds_read_b128 a[196:199], v45 offset:40960
    v_mfma_f32_16x16x32_bf16 v[128:131], a[216:219], v[168:171], v[128:131]
    s_waitcnt lgkmcnt(2)
    v_exp_f32 v94, v94
    v_mfma_f32_16x16x32_bf16 v[124:127], a[220:223], v[172:175], v[124:127]
    v_exp_f32 v95, v95
    v_mfma_f32_16x16x32_bf16 v[128:131], a[220:223], v[176:179], v[128:131]
    s_waitcnt lgkmcnt(1)
    v_cvt_pk_bf16_f32 v84, v84, v85
    v_cvt_pk_bf16_f32 v85, v86, v87
    v_mfma_f32_16x16x32_bf16 v[132:135], a[192:195], v[148:151], v[76:79]
    ds_read_b128 a[200:203], v46 offset:40960
    ds_read_b128 a[204:207], v47 offset:40960
    v_mfma_f32_16x16x32_bf16 v[136:139], a[192:195], v[152:155], v[80:83]
    s_waitcnt lgkmcnt(2)
    v_cvt_pk_bf16_f32 v86, v92, v93
    v_cvt_pk_bf16_f32 v87, v94, v95
    v_mfma_f32_16x16x32_bf16 v[132:135], a[196:199], v[156:159], v[132:135]
    v_exp_f32 v88, v88
    v_mfma_f32_16x16x32_bf16 v[136:139], a[196:199], v[160:163], v[136:139]
    s_waitcnt lgkmcnt(1)
    v_exp_f32 v89, v89
    v_mfma_f32_16x16x32_bf16 v[132:135], a[200:203], v[164:167], v[132:135]
    ds_read_b128 a[208:211], v44 offset:45056
    ds_read_b128 a[212:215], v45 offset:45056
    v_mfma_f32_16x16x32_bf16 v[136:139], a[200:203], v[168:171], v[136:139]
    s_waitcnt lgkmcnt(2)
    v_exp_f32 v90, v90
    v_mfma_f32_16x16x32_bf16 v[132:135], a[204:207], v[172:175], v[132:135]
    v_exp_f32 v91, v91
    v_mfma_f32_16x16x32_bf16 v[136:139], a[204:207], v[176:179], v[136:139]
    s_waitcnt lgkmcnt(1)
    v_exp_f32 v96, v96
    v_mfma_f32_16x16x32_bf16 v[140:143], a[208:211], v[148:151], v[76:79]
    ds_read_b128 a[216:219], v46 offset:45056
    ds_read_b128 a[220:223], v47 offset:45056
    v_mfma_f32_16x16x32_bf16 v[144:147], a[208:211], v[152:155], v[80:83]
    s_waitcnt lgkmcnt(2)
    v_exp_f32 v97, v97
    v_mfma_f32_16x16x32_bf16 v[140:143], a[212:215], v[156:159], v[140:143]
    v_exp_f32 v98, v98
    v_mfma_f32_16x16x32_bf16 v[144:147], a[212:215], v[160:163], v[144:147]
    s_waitcnt lgkmcnt(1)
    v_exp_f32 v99, v99
    v_mfma_f32_16x16x32_bf16 v[140:143], a[216:219], v[164:167], v[140:143]
    v_cvt_pk_bf16_f32 v88, v88, v89
    v_cvt_pk_bf16_f32 v89, v90, v91
    v_mfma_f32_16x16x32_bf16 v[144:147], a[216:219], v[168:171], v[144:147]
    s_waitcnt lgkmcnt(0)
    v_cvt_pk_bf16_f32 v90, v96, v97
    v_cvt_pk_bf16_f32 v91, v98, v99
    v_mfma_f32_16x16x32_bf16 v[140:143], a[220:223], v[172:175], v[140:143]
    s_waitcnt vmcnt(25)
    s_barrier
    ds_read_b64_tr_b16 a[192:193], v28 offset:0
    ds_read_b64_tr_b16 a[194:195], v28 offset:4096
    v_mfma_f32_16x16x32_bf16 v[144:147], a[220:223], v[176:179], v[144:147]
    s_add_u32 m0, s37, 81920
    v_exp_f32 v100, v100
    v_mfma_f32_16x16x32_bf16 v[68:71], a[224:227], v[84:87], v[68:71]
    s_add_u32 s42, s39, 114688
    buffer_load_dwordx4 v56, s[8:11], s42 offen offset:0 nt lds
    v_mfma_f32_16x16x32_bf16 v[72:75], a[224:227], v[88:91], v[72:75]
    s_waitcnt lgkmcnt(0)
    ds_read_b64_tr_b16 a[196:197], v29 offset:0
    ds_read_b64_tr_b16 a[198:199], v29 offset:4096
    v_mfma_f32_16x16x32_bf16 a[128:131], a[192:195], v[84:87], a[128:131]
    buffer_load_dwordx4 v57, s[8:11], s42 offen offset:1024 nt lds
    v_mfma_f32_16x16x32_bf16 a[132:135], a[192:195], v[88:91], a[132:135]
    s_waitcnt lgkmcnt(0)
    ds_read_b64_tr_b16 a[200:201], v30 offset:0
    ds_read_b64_tr_b16 a[202:203], v30 offset:4096
    v_mfma_f32_16x16x32_bf16 a[136:139], a[196:199], v[84:87], a[136:139]
    buffer_load_dwordx4 v58, s[8:11], s42 offen offset:2048 nt lds
    v_mfma_f32_16x16x32_bf16 a[140:143], a[196:199], v[88:91], a[140:143]
    s_waitcnt lgkmcnt(0)
    ds_read_b64_tr_b16 a[204:205], v31 offset:0
    ds_read_b64_tr_b16 a[206:207], v31 offset:4096
    v_mfma_f32_16x16x32_bf16 a[144:147], a[200:203], v[84:87], a[144:147]
    buffer_load_dwordx4 v59, s[8:11], s42 offen offset:3072 nt lds
    v_mfma_f32_16x16x32_bf16 a[148:151], a[200:203], v[88:91], a[148:151]
    s_waitcnt lgkmcnt(0)
    ds_read_b64_tr_b16 a[208:209], v32 offset:0
    ds_read_b64_tr_b16 a[210:211], v32 offset:4096
    v_mfma_f32_16x16x32_bf16 a[152:155], a[204:207], v[84:87], a[152:155]
    v_exp_f32 v101, v101
    v_mfma_f32_16x16x32_bf16 a[156:159], a[204:207], v[88:91], a[156:159]
    s_waitcnt lgkmcnt(0)
    ds_read_b64_tr_b16 a[212:213], v33 offset:0
    ds_read_b64_tr_b16 a[214:215], v33 offset:4096
    v_mfma_f32_16x16x32_bf16 a[160:163], a[208:211], v[84:87], a[160:163]
    v_exp_f32 v102, v102
    v_mfma_f32_16x16x32_bf16 a[164:167], a[208:211], v[88:91], a[164:167]
    s_waitcnt lgkmcnt(0)
    ds_read_b64_tr_b16 a[216:217], v34 offset:0
    ds_read_b64_tr_b16 a[218:219], v34 offset:4096
    v_mfma_f32_16x16x32_bf16 a[168:171], a[212:215], v[84:87], a[168:171]
    v_exp_f32 v103, v103
    v_mfma_f32_16x16x32_bf16 a[172:175], a[212:215], v[88:91], a[172:175]
    s_waitcnt lgkmcnt(0)
    ds_read_b64_tr_b16 a[220:221], v35 offset:0
    ds_read_b64_tr_b16 a[222:223], v35 offset:4096
    v_mfma_f32_16x16x32_bf16 a[176:179], a[216:219], v[84:87], a[176:179]
    v_exp_f32 v108, v108
    v_mfma_f32_16x16x32_bf16 a[180:183], a[216:219], v[88:91], a[180:183]
    s_waitcnt lgkmcnt(0)
    v_exp_f32 v109, v109
    v_mfma_f32_16x16x32_bf16 a[184:187], a[220:223], v[84:87], a[184:187]
    v_exp_f32 v110, v110
    v_mfma_f32_16x16x32_bf16 a[188:191], a[220:223], v[88:91], a[188:191]
    ds_read_b64_tr_b16 a[192:193], v28 offset:8192
    ds_read_b64_tr_b16 a[194:195], v28 offset:12288
    v_exp_f32 v111, v111
    v_cvt_pk_bf16_f32 v100, v100, v101
    v_cvt_pk_bf16_f32 v101, v102, v103
    v_cvt_pk_bf16_f32 v102, v108, v109
    v_cvt_pk_bf16_f32 v103, v110, v111
    v_exp_f32 v104, v104
    v_exp_f32 v105, v105
    v_exp_f32 v106, v106
    v_exp_f32 v107, v107
    v_exp_f32 v112, v112
    v_exp_f32 v113, v113
    v_exp_f32 v114, v114
    v_exp_f32 v115, v115
    v_cvt_pk_bf16_f32 v104, v104, v105
    v_cvt_pk_bf16_f32 v105, v106, v107
    v_cvt_pk_bf16_f32 v106, v112, v113
    v_cvt_pk_bf16_f32 v107, v114, v115
    v_mfma_f32_16x16x32_bf16 v[68:71], a[224:227], v[100:103], v[68:71]
    v_max3_f32 v19, v116, v117, v118
    v_max3_f32 v19, v19, v119, v120
    v_mfma_f32_16x16x32_bf16 v[72:75], a[224:227], v[104:107], v[72:75]
    s_waitcnt lgkmcnt(0)
    ds_read_b64_tr_b16 a[196:197], v29 offset:8192
    ds_read_b64_tr_b16 a[198:199], v29 offset:12288
    v_mfma_f32_16x16x32_bf16 a[128:131], a[192:195], v[100:103], a[128:131]
    v_max3_f32 v19, v19, v121, v122
    v_max3_f32 v19, v19, v123, v124
    v_mfma_f32_16x16x32_bf16 a[132:135], a[192:195], v[104:107], a[132:135]
    s_waitcnt lgkmcnt(0)
    ds_read_b64_tr_b16 a[200:201], v30 offset:8192
    ds_read_b64_tr_b16 a[202:203], v30 offset:12288
    v_mfma_f32_16x16x32_bf16 a[136:139], a[196:199], v[100:103], a[136:139]
    v_max3_f32 v19, v19, v125, v126
    v_max3_f32 v19, v19, v127, v128
    v_mfma_f32_16x16x32_bf16 a[140:143], a[196:199], v[104:107], a[140:143]
    s_waitcnt lgkmcnt(0)
    ds_read_b64_tr_b16 a[204:205], v31 offset:8192
    ds_read_b64_tr_b16 a[206:207], v31 offset:12288
    v_mfma_f32_16x16x32_bf16 a[144:147], a[200:203], v[100:103], a[144:147]
    v_max3_f32 v19, v19, v129, v130
    v_max3_f32 v19, v19, v131, v132
    v_mfma_f32_16x16x32_bf16 a[148:151], a[200:203], v[104:107], a[148:151]
    s_waitcnt lgkmcnt(0)
    ds_read_b64_tr_b16 a[208:209], v32 offset:8192
    ds_read_b64_tr_b16 a[210:211], v32 offset:12288
    v_mfma_f32_16x16x32_bf16 a[152:155], a[204:207], v[100:103], a[152:155]
    v_max3_f32 v19, v19, v133, v134
    v_max3_f32 v19, v19, v135, v136
    v_mfma_f32_16x16x32_bf16 a[156:159], a[204:207], v[104:107], a[156:159]
    s_waitcnt lgkmcnt(0)
    ds_read_b64_tr_b16 a[212:213], v33 offset:8192
    ds_read_b64_tr_b16 a[214:215], v33 offset:12288
    v_mfma_f32_16x16x32_bf16 a[160:163], a[208:211], v[100:103], a[160:163]
    v_max3_f32 v19, v19, v137, v138
    v_max3_f32 v19, v19, v139, v140
    v_mfma_f32_16x16x32_bf16 a[164:167], a[208:211], v[104:107], a[164:167]
    s_waitcnt lgkmcnt(0)
    ds_read_b64_tr_b16 a[216:217], v34 offset:8192
    ds_read_b64_tr_b16 a[218:219], v34 offset:12288
    v_mfma_f32_16x16x32_bf16 a[168:171], a[212:215], v[100:103], a[168:171]
    v_max3_f32 v19, v19, v141, v142
    v_max3_f32 v19, v19, v143, v144
    v_mfma_f32_16x16x32_bf16 a[172:175], a[212:215], v[104:107], a[172:175]
    s_waitcnt lgkmcnt(0)
    ds_read_b64_tr_b16 a[220:221], v35 offset:8192
    ds_read_b64_tr_b16 a[222:223], v35 offset:12288
    v_mfma_f32_16x16x32_bf16 a[176:179], a[216:219], v[100:103], a[176:179]
    v_max3_f32 v19, v19, v145, v146
    v_max_f32 v19, v19, v147
    v_mfma_f32_16x16x32_bf16 a[180:183], a[216:219], v[104:107], a[180:183]
    s_waitcnt lgkmcnt(0)
    s_waitcnt vmcnt(25)
    s_barrier
    ds_read_b128 a[192:195], v48 offset:32768
    ds_read_b128 a[196:199], v49 offset:32768
    v_mfma_f32_16x16x32_bf16 a[184:187], a[220:223], v[100:103], a[184:187]
    v_cmp_lt_f32 vcc, s47, v19
    v_mul_f32 v196, s46, v196
    v_mfma_f32_16x16x32_bf16 a[188:191], a[220:223], v[104:107], a[188:191]
    s_cbranch_vccnz w2_t3_slow
w2_t3_back:
    s_waitcnt lgkmcnt(1)
    v_exp_f32 v116, v116
    v_mul_f32 v197, s46, v197
    v_mul_f32 v198, s46, v198
    v_mul_f32 v199, s46, v199
    v_mul_f32 v204, s46, v204
    v_mul_f32 v205, s46, v205
    v_mul_f32 v206, s46, v206
    v_mul_f32 v207, s46, v207
    v_cvt_pk_bf16_f32 v196, v196, v197
    v_cvt_pk_bf16_f32 v197, v198, v199
    v_cvt_pk_bf16_f32 v198, v204, v205
    v_cvt_pk_bf16_f32 v199, v206, v207
    v_mul_f32 v200, s46, v200
    v_mul_f32 v201, s46, v201
    v_mul_f32 v202, s46, v202
    v_mul_f32 v203, s46, v203
    v_mul_f32 v208, s46, v208
    v_mul_f32 v209, s46, v209
    v_mul_f32 v210, s46, v210
    v_mul_f32 v211, s46, v211
    v_cvt_pk_bf16_f32 v200, v200, v201
    v_cvt_pk_bf16_f32 v201, v202, v203
    v_cvt_pk_bf16_f32 v202, v208, v209
    v_cvt_pk_bf16_f32 v203, v210, v211
    v_permlane32_swap_b32 v196, v198
    v_permlane32_swap_b32 v197, v199
    v_permlane32_swap_b32 v200, v202
    v_permlane32_swap_b32 v201, v203
    v_permlane16_swap_b32 v196, v198
    v_permlane16_swap_b32 v197, v199
    v_permlane16_swap_b32 v200, v202
    v_permlane16_swap_b32 v201, v203
    v_mfma_f32_16x16x32_bf16 v[84:87], a[192:195], v[148:151], v[76:79]
    ds_read_b128 a[200:203], v50 offset:32768
    ds_read_b128 a[204:207], v51 offset:32768
    v_mfma_f32_16x16x32_bf16 v[88:91], a[192:195], v[152:155], v[80:83]
    s_waitcnt lgkmcnt(2)
    v_exp_f32 v117, v117
    v_mfma_f32_16x16x32_bf16 v[84:87], a[196:199], v[156:159], v[84:87]
    v_exp_f32 v118, v118
    v_mfma_f32_16x16x32_bf16 v[88:91], a[196:199], v[160:163], v[88:91]
    s_waitcnt lgkmcnt(1)
    v_exp_f32 v119, v119
    v_mfma_f32_16x16x32_bf16 v[84:87], a[200:203], v[164:167], v[84:87]
    ds_read_b128 a[208:211], v48 offset:36864
    ds_read_b128 a[212:215], v49 offset:36864
    v_mfma_f32_16x16x32_bf16 v[88:91], a[200:203], v[168:171], v[88:91]
    s_waitcnt lgkmcnt(2)
    v_exp_f32 v124, v124
    v_mfma_f32_16x16x32_bf16 v[84:87], a[204:207], v[172:175], v[84:87]
    v_exp_f32 v125, v125
    v_mfma_f32_16x16x32_bf16 v[88:91], a[204:207], v[176:179], v[88:91]
    s_waitcnt lgkmcnt(1)
    v_exp_f32 v126, v126
    v_mfma_f32_16x16x32_bf16 v[92:95], a[208:211], v[148:151], v[76:79]
    ds_read_b128 a[216:219], v50 offset:36864
    ds_read_b128 a[220:223], v51 offset:36864
    v_mfma_f32_16x16x32_bf16 v[96:99], a[208:211], v[152:155], v[80:83]
    s_waitcnt lgkmcnt(2)
    v_exp_f32 v127, v127
    v_mfma_f32_16x16x32_bf16 v[92:95], a[212:215], v[156:159], v[92:95]
    v_cvt_pk_bf16_f32 v116, v116, v117
    v_cvt_pk_bf16_f32 v117, v118, v119
    v_mfma_f32_16x16x32_bf16 v[96:99], a[212:215], v[160:163], v[96:99]
    s_waitcnt lgkmcnt(1)
    v_cvt_pk_bf16_f32 v118, v124, v125
    v_cvt_pk_bf16_f32 v119, v126, v127
    v_mfma_f32_16x16x32_bf16 v[92:95], a[216:219], v[164:167], v[92:95]
    ds_read_b128 a[192:195], v48 offset:40960
    ds_read_b128 a[196:199], v49 offset:40960
    v_mfma_f32_16x16x32_bf16 v[96:99], a[216:219], v[168:171], v[96:99]
    s_waitcnt lgkmcnt(2)
    v_exp_f32 v120, v120
    v_mfma_f32_16x16x32_bf16 v[92:95], a[220:223], v[172:175], v[92:95]
    v_exp_f32 v121, v121
    v_mfma_f32_16x16x32_bf16 v[96:99], a[220:223], v[176:179], v[96:99]
    s_waitcnt lgkmcnt(1)
    v_exp_f32 v122, v122
    v_mfma_f32_16x16x32_bf16 v[100:103], a[192:195], v[148:151], v[76:79]
    ds_read_b128 a[200:203], v50 offset:40960
    ds_read_b128 a[204:207], v51 offset:40960
    v_mfma_f32_16x16x32_bf16 v[104:107], a[192:195], v[152:155], v[80:83]
    s_waitcnt lgkmcnt(2)
    v_exp_f32 v123, v123
    v_mfma_f32_16x16x32_bf16 v[100:103], a[196:199], v[156:159], v[100:103]
    v_exp_f32 v128, v128
    v_mfma_f32_16x16x32_bf16 v[104:107], a[196:199], v[160:163], v[104:107]
    s_waitcnt lgkmcnt(1)
    v_exp_f32 v129, v129
    v_mfma_f32_16x16x32_bf16 v[100:103], a[200:203], v[164:167], v[100:103]
    ds_read_b128 a[208:211], v48 offset:45056
    ds_read_b128 a[212:215], v49 offset:45056
    v_mfma_f32_16x16x32_bf16 v[104:107], a[200:203], v[168:171], v[104:107]
    s_waitcnt lgkmcnt(2)
    v_exp_f32 v130, v130
    v_mfma_f32_16x16x32_bf16 v[100:103], a[204:207], v[172:175], v[100:103]
    v_exp_f32 v131, v131
    v_mfma_f32_16x16x32_bf16 v[104:107], a[204:207], v[176:179], v[104:107]
    s_waitcnt lgkmcnt(1)
    v_cvt_pk_bf16_f32 v120, v120, v121
    v_cvt_pk_bf16_f32 v121, v122, v123
    v_mfma_f32_16x16x32_bf16 v[108:111], a[208:211], v[148:151], v[76:79]
    ds_read_b128 a[216:219], v50 offset:45056
    ds_read_b128 a[220:223], v51 offset:45056
    v_mfma_f32_16x16x32_bf16 v[112:115], a[208:211], v[152:155], v[80:83]
    s_waitcnt lgkmcnt(2)
    v_cvt_pk_bf16_f32 v122, v128, v129
    v_cvt_pk_bf16_f32 v123, v130, v131
    v_mfma_f32_16x16x32_bf16 v[108:111], a[212:215], v[156:159], v[108:111]
    v_exp_f32 v132, v132
    v_mfma_f32_16x16x32_bf16 v[112:115], a[212:215], v[160:163], v[112:115]
    s_waitcnt lgkmcnt(1)
    v_exp_f32 v133, v133
    v_mfma_f32_16x16x32_bf16 v[108:111], a[216:219], v[164:167], v[108:111]
    v_exp_f32 v134, v134
    v_mfma_f32_16x16x32_bf16 v[112:115], a[216:219], v[168:171], v[112:115]
    s_waitcnt lgkmcnt(0)
    v_exp_f32 v135, v135
    v_mfma_f32_16x16x32_bf16 v[108:111], a[220:223], v[172:175], v[108:111]
    s_waitcnt vmcnt(21)
    s_barrier
    ds_read_b64_tr_b16 a[192:193], v36 offset:0
    ds_read_b64_tr_b16 a[194:195], v36 offset:4096
    v_mfma_f32_16x16x32_bf16 v[112:115], a[220:223], v[176:179], v[112:115]
    s_add_u32 m0, s37, 0
    v_exp_f32 v140, v140
    v_mfma_f32_16x16x32_bf16 v[68:71], a[224:227], v[116:119], v[68:71]
    s_add_u32 s42, s39, 98304
    buffer_load_dwordx4 v60, s[12:15], s42 offen offset:0 nt lds
    v_mfma_f32_16x16x32_bf16 v[72:75], a[224:227], v[120:123], v[72:75]
    s_waitcnt lgkmcnt(0)
    ds_read_b64_tr_b16 a[196:197], v37 offset:0
    ds_read_b64_tr_b16 a[198:199], v37 offset:4096
    v_mfma_f32_16x16x32_bf16 a[128:131], a[192:195], v[116:119], a[128:131]
    buffer_load_dwordx4 v61, s[12:15], s42 offen offset:1024 nt lds
    v_mfma_f32_16x16x32_bf16 a[132:135], a[192:195], v[120:123], a[132:135]
    s_waitcnt lgkmcnt(0)
    ds_read_b64_tr_b16 a[200:201], v38 offset:0
    ds_read_b64_tr_b16 a[202:203], v38 offset:4096
    v_mfma_f32_16x16x32_bf16 a[136:139], a[196:199], v[116:119], a[136:139]
    buffer_load_dwordx4 v60, s[12:15], s42 offen offset:2048 nt lds
    v_mfma_f32_16x16x32_bf16 a[140:143], a[196:199], v[120:123], a[140:143]
    s_waitcnt lgkmcnt(0)
    ds_read_b64_tr_b16 a[204:205], v39 offset:0
    ds_read_b64_tr_b16 a[206:207], v39 offset:4096
    v_mfma_f32_16x16x32_bf16 a[144:147], a[200:203], v[116:119], a[144:147]
    buffer_load_dwordx4 v61, s[12:15], s42 offen offset:3072 nt lds
    v_mfma_f32_16x16x32_bf16 a[148:151], a[200:203], v[120:123], a[148:151]
    s_waitcnt lgkmcnt(0)
    ds_read_b64_tr_b16 a[208:209], v40 offset:0
    ds_read_b64_tr_b16 a[210:211], v40 offset:4096
    v_mfma_f32_16x16x32_bf16 a[152:155], a[204:207], v[116:119], a[152:155]
    v_exp_f32 v141, v141
    v_mfma_f32_16x16x32_bf16 a[156:159], a[204:207], v[120:123], a[156:159]
    s_waitcnt lgkmcnt(0)
    ds_read_b64_tr_b16 a[212:213], v41 offset:0
    ds_read_b64_tr_b16 a[214:215], v41 offset:4096
    v_mfma_f32_16x16x32_bf16 a[160:163], a[208:211], v[116:119], a[160:163]
    v_exp_f32 v142, v142
    v_mfma_f32_16x16x32_bf16 a[164:167], a[208:211], v[120:123], a[164:167]
    s_waitcnt lgkmcnt(0)
    ds_read_b64_tr_b16 a[216:217], v42 offset:0
    ds_read_b64_tr_b16 a[218:219], v42 offset:4096
    v_mfma_f32_16x16x32_bf16 a[168:171], a[212:215], v[116:119], a[168:171]
    v_exp_f32 v143, v143
    v_mfma_f32_16x16x32_bf16 a[172:175], a[212:215], v[120:123], a[172:175]
    s_waitcnt lgkmcnt(0)
    ds_read_b64_tr_b16 a[220:221], v43 offset:0
    ds_read_b64_tr_b16 a[222:223], v43 offset:4096
    v_mfma_f32_16x16x32_bf16 a[176:179], a[216:219], v[116:119], a[176:179]
    v_cvt_pk_bf16_f32 v132, v132, v133
    v_cvt_pk_bf16_f32 v133, v134, v135
    v_mfma_f32_16x16x32_bf16 a[180:183], a[216:219], v[120:123], a[180:183]
    s_waitcnt lgkmcnt(0)
    v_cvt_pk_bf16_f32 v134, v140, v141
    v_cvt_pk_bf16_f32 v135, v142, v143
    v_mfma_f32_16x16x32_bf16 a[184:187], a[220:223], v[116:119], a[184:187]
    v_exp_f32 v136, v136
    v_mfma_f32_16x16x32_bf16 a[188:191], a[220:223], v[120:123], a[188:191]
    ds_read_b64_tr_b16 a[192:193], v36 offset:8192
    ds_read_b64_tr_b16 a[194:195], v36 offset:12288
    v_exp_f32 v137, v137
    v_exp_f32 v138, v138
    v_exp_f32 v139, v139
    v_exp_f32 v144, v144
    v_exp_f32 v145, v145
    v_exp_f32 v146, v146
    v_exp_f32 v147, v147
    v_cvt_pk_bf16_f32 v136, v136, v137
    v_cvt_pk_bf16_f32 v137, v138, v139
    v_cvt_pk_bf16_f32 v138, v144, v145
    v_cvt_pk_bf16_f32 v139, v146, v147
    v_mfma_f32_16x16x32_bf16 v[68:71], a[224:227], v[132:135], v[68:71]
    v_max3_f32 v19, v84, v85, v86
    v_max3_f32 v19, v19, v87, v88
    v_mfma_f32_16x16x32_bf16 v[72:75], a[224:227], v[136:139], v[72:75]
    s_waitcnt lgkmcnt(0)
    ds_read_b64_tr_b16 a[196:197], v37 offset:8192
    ds_read_b64_tr_b16 a[198:199], v37 offset:12288
    v_mfma_f32_16x16x32_bf16 a[128:131], a[192:195], v[132:135], a[128:131]
    v_max3_f32 v19, v19, v89, v90
    v_max3_f32 v19, v19, v91, v92
    v_mfma_f32_16x16x32_bf16 a[132:135], a[192:195], v[136:139], a[132:135]
    s_waitcnt lgkmcnt(0)
    ds_read_b64_tr_b16 a[200:201], v38 offset:8192
    ds_read_b64_tr_b16 a[202:203], v38 offset:12288
    v_mfma_f32_16x16x32_bf16 a[136:139], a[196:199], v[132:135], a[136:139]
    v_max3_f32 v19, v19, v93, v94
    v_max3_f32 v19, v19, v95, v96
    v_mfma_f32_16x16x32_bf16 a[140:143], a[196:199], v[136:139], a[140:143]
    s_waitcnt lgkmcnt(0)
    ds_read_b64_tr_b16 a[204:205], v39 offset:8192
    ds_read_b64_tr_b16 a[206:207], v39 offset:12288
    v_mfma_f32_16x16x32_bf16 a[144:147], a[200:203], v[132:135], a[144:147]
    v_max3_f32 v19, v19, v97, v98
    v_max3_f32 v19, v19, v99, v100
    v_mfma_f32_16x16x32_bf16 a[148:151], a[200:203], v[136:139], a[148:151]
    s_waitcnt lgkmcnt(0)
    ds_read_b64_tr_b16 a[208:209], v40 offset:8192
    ds_read_b64_tr_b16 a[210:211], v40 offset:12288
    v_mfma_f32_16x16x32_bf16 a[152:155], a[204:207], v[132:135], a[152:155]
    v_max3_f32 v19, v19, v101, v102
    v_max3_f32 v19, v19, v103, v104
    v_mfma_f32_16x16x32_bf16 a[156:159], a[204:207], v[136:139], a[156:159]
    s_waitcnt lgkmcnt(0)
    ds_read_b64_tr_b16 a[212:213], v41 offset:8192
    ds_read_b64_tr_b16 a[214:215], v41 offset:12288
    v_mfma_f32_16x16x32_bf16 a[160:163], a[208:211], v[132:135], a[160:163]
    v_max3_f32 v19, v19, v105, v106
    v_max3_f32 v19, v19, v107, v108
    v_mfma_f32_16x16x32_bf16 a[164:167], a[208:211], v[136:139], a[164:167]
    s_waitcnt lgkmcnt(0)
    ds_read_b64_tr_b16 a[216:217], v42 offset:8192
    ds_read_b64_tr_b16 a[218:219], v42 offset:12288
    v_mfma_f32_16x16x32_bf16 a[168:171], a[212:215], v[132:135], a[168:171]
    v_max3_f32 v19, v19, v109, v110
    v_max3_f32 v19, v19, v111, v112
    v_mfma_f32_16x16x32_bf16 a[172:175], a[212:215], v[136:139], a[172:175]
    s_waitcnt lgkmcnt(0)
    ds_read_b64_tr_b16 a[220:221], v43 offset:8192
    ds_read_b64_tr_b16 a[222:223], v43 offset:12288
    v_mfma_f32_16x16x32_bf16 a[176:179], a[216:219], v[132:135], a[176:179]
    v_max3_f32 v19, v19, v113, v114
    v_max_f32 v19, v19, v115
    v_mfma_f32_16x16x32_bf16 a[180:183], a[216:219], v[136:139], a[180:183]
    s_waitcnt lgkmcnt(0)
    s_waitcnt vmcnt(21)
    s_barrier
    ds_read_b128 a[192:195], v44 offset:49152
    ds_read_b128 a[196:199], v45 offset:49152
    v_mfma_f32_16x16x32_bf16 a[184:187], a[220:223], v[132:135], a[184:187]
    s_add_u32 m0, s37, 32768
    v_cmp_lt_f32 vcc, s47, v19
    v_mul_f32 v212, s46, v212
    v_mfma_f32_16x16x32_bf16 a[188:191], a[220:223], v[136:139], a[188:191]
    s_cbranch_vccnz w2_t4_slow
w2_t4_back:
    s_waitcnt lgkmcnt(1)
    v_exp_f32 v84, v84
    v_mul_f32 v213, s46, v213
    v_mul_f32 v214, s46, v214
    v_mul_f32 v215, s46, v215
    v_mul_f32 v220, s46, v220
    v_mul_f32 v221, s46, v221
    v_mul_f32 v222, s46, v222
    v_mul_f32 v223, s46, v223
    v_cvt_pk_bf16_f32 v212, v212, v213
    v_cvt_pk_bf16_f32 v213, v214, v215
    v_cvt_pk_bf16_f32 v214, v220, v221
    v_cvt_pk_bf16_f32 v215, v222, v223
    v_mul_f32 v216, s46, v216
    v_mul_f32 v217, s46, v217
    v_mul_f32 v218, s46, v218
    v_mul_f32 v219, s46, v219
    v_mul_f32 v224, s46, v224
    v_mul_f32 v225, s46, v225
    v_mul_f32 v226, s46, v226
    v_mul_f32 v227, s46, v227
    v_cvt_pk_bf16_f32 v216, v216, v217
    v_cvt_pk_bf16_f32 v217, v218, v219
    v_cvt_pk_bf16_f32 v218, v224, v225
    v_cvt_pk_bf16_f32 v219, v226, v227
    v_permlane32_swap_b32 v212, v214
    v_permlane32_swap_b32 v213, v215
    v_permlane32_swap_b32 v216, v218
    v_permlane32_swap_b32 v217, v219
    v_permlane16_swap_b32 v212, v214
    v_permlane16_swap_b32 v213, v215
    v_permlane16_swap_b32 v216, v218
    v_permlane16_swap_b32 v217, v219
    v_mfma_f32_16x16x32_bf16 v[116:119], a[192:195], v[148:151], v[76:79]
    s_add_u32 s42, s39, 131072
    ds_read_b128 a[200:203], v46 offset:49152
    ds_read_b128 a[204:207], v47 offset:49152
    v_mfma_f32_16x16x32_bf16 v[120:123], a[192:195], v[152:155], v[80:83]
    s_waitcnt lgkmcnt(2)
    buffer_load_dwordx4 v56, s[8:11], s42 offen offset:0 nt lds
    v_mfma_f32_16x16x32_bf16 v[116:119], a[196:199], v[156:159], v[116:119]
    buffer_load_dwordx4 v57, s[8:11], s42 offen offset:1024 nt lds
    v_mfma_f32_16x16x32_bf16 v[120:123], a[196:199], v[160:163], v[120:123]
    s_waitcnt lgkmcnt(1)
    buffer_load_dwordx4 v58, s[8:11], s42 offen offset:2048 nt lds
    v_mfma_f32_16x16x32_bf16 v[116:119], a[200:203], v[164:167], v[116:119]
    ds_read_b128 a[208:211], v44 offset:53248
    ds_read_b128 a[212:215], v45 offset:53248
    v_mfma_f32_16x16x32_bf16 v[120:123], a[200:203], v[168:171], v[120:123]
    s_waitcnt lgkmcnt(2)
    buffer_load_dwordx4 v59, s[8:11], s42 offen offset:3072 nt lds
    v_mfma_f32_16x16x32_bf16 v[116:119], a[204:207], v[172:175], v[116:119]
    v_exp_f32 v85, v85
    v_mfma_f32_16x16x32_bf16 v[120:123], a[204:207], v[176:179], v[120:123]
    s_waitcnt lgkmcnt(1)
    v_exp_f32 v86, v86
    v_mfma_f32_16x16x32_bf16 v[124:127], a[208:211], v[148:151], v[76:79]
    ds_read_b128 a[216:219], v46 offset:53248
    ds_read_b128 a[220:223], v47 offset:53248
    v_mfma_f32_16x16x32_bf16 v[128:131], a[208:211], v[152:155], v[80:83]
    s_waitcnt lgkmcnt(2)
    v_exp_f32 v87, v87
    v_mfma_f32_16x16x32_bf16 v[124:127], a[212:215], v[156:159], v[124:127]
    v_exp_f32 v92, v92
    v_mfma_f32_16x16x32_bf16 v[128:131], a[212:215], v[160:163], v[128:131]
    s_waitcnt lgkmcnt(1)
    v_exp_f32 v93, v93
    v_mfma_f32_16x16x32_bf16 v[124:127], a[216:219], v[164:167], v[124:127]
    ds_read_b128 a[192:195], v44 offset:57344
    ds_read_b128 a[196:199], v45 offset:57344
    v_mfma_f32_16x16x32_bf16 v[128:131], a[216:219], v[168:171], v[128:131]
    s_waitcnt lgkmcnt(2)
    v_exp_f32 v94, v94
    v_mfma_f32_16x16x32_bf16 v[124:127], a[220:223], v[172:175], v[124:127]
    v_exp_f32 v95, v95
    v_mfma_f32_16x16x32_bf16 v[128:131], a[220:223], v[176:179], v[128:131]
    s_waitcnt lgkmcnt(1)
    v_cvt_pk_bf16_f32 v84, v84, v85
    v_cvt_pk_bf16_f32 v85, v86, v87
    v_mfma_f32_16x16x32_bf16 v[132:135], a[192:195], v[148:151], v[76:79]
    ds_read_b128 a[200:203], v46 offset:57344
    ds_read_b128 a[204:207], v47 offset:57344
    v_mfma_f32_16x16x32_bf16 v[136:139], a[192:195], v[152:155], v[80:83]
    s_waitcnt lgkmcnt(2)
    v_cvt_pk_bf16_f32 v86, v92, v93
    v_cvt_pk_bf16_f32 v87, v94, v95
    v_mfma_f32_16x16x32_bf16 v[132:135], a[196:199], v[156:159], v[132:135]
    v_exp_f32 v88, v88
    v_mfma_f32_16x16x32_bf16 v[136:139], a[196:199], v[160:163], v[136:139]
    s_waitcnt lgkmcnt(1)
    v_exp_f32 v89, v89
    v_mfma_f32_16x16x32_bf16 v[132:135], a[200:203], v[164:167], v[132:135]
    ds_read_b128 a[208:211], v44 offset:61440
    ds_read_b128 a[212:215], v45 offset:61440
    v_mfma_f32_16x16x32_bf16 v[136:139], a[200:203], v[168:171], v[136:139]
    s_waitcnt lgkmcnt(2)
    v_exp_f32 v90, v90
    v_mfma_f32_16x16x32_bf16 v[132:135], a[204:207], v[172:175], v[132:135]
    v_exp_f32 v91, v91
    v_mfma_f32_16x16x32_bf16 v[136:139], a[204:207], v[176:179], v[136:139]
    s_waitcnt lgkmcnt(1)
    v_exp_f32 v96, v96
    v_mfma_f32_16x16x32_bf16 v[140:143], a[208:211], v[148:151], v[76:79]
    ds_read_b128 a[216:219], v46 offset:61440
    ds_read_b128 a[220:223], v47 offset:61440
    v_mfma_f32_16x16x32_bf16 v[144:147], a[208:211], v[152:155], v[80:83]
    s_waitcnt lgkmcnt(2)
    v_exp_f32 v97, v97
    v_mfma_f32_16x16x32_bf16 v[140:143], a[212:215], v[156:159], v[140:143]
    v_exp_f32 v98, v98
    v_mfma_f32_16x16x32_bf16 v[144:147], a[212:215], v[160:163], v[144:147]
    s_waitcnt lgkmcnt(1)
    v_exp_f32 v99, v99
    v_mfma_f32_16x16x32_bf16 v[140:143], a[216:219], v[164:167], v[140:143]
    v_cvt_pk_bf16_f32 v88, v88, v89
    v_cvt_pk_bf16_f32 v89, v90, v91
    v_mfma_f32_16x16x32_bf16 v[144:147], a[216:219], v[168:171], v[144:147]
    s_waitcnt lgkmcnt(0)
    v_cvt_pk_bf16_f32 v90, v96, v97
    v_cvt_pk_bf16_f32 v91, v98, v99
    v_mfma_f32_16x16x32_bf16 v[140:143], a[220:223], v[172:175], v[140:143]
    s_waitcnt vmcnt(21)
    s_barrier
    ds_read_b64_tr_b16 a[192:193], v36 offset:16384
    ds_read_b64_tr_b16 a[194:195], v36 offset:20480
    v_mfma_f32_16x16x32_bf16 v[144:147], a[220:223], v[176:179], v[144:147]
    s_add_u32 m0, s37, 65536
    v_exp_f32 v100, v100
    v_mfma_f32_16x16x32_bf16 v[68:71], a[224:227], v[84:87], v[68:71]
    s_add_u32 s42, s39, 114688
    buffer_load_dwordx4 v60, s[12:15], s42 offen offset:0 nt lds
    v_mfma_f32_16x16x32_bf16 v[72:75], a[224:227], v[88:91], v[72:75]
    s_waitcnt lgkmcnt(0)
    ds_read_b64_tr_b16 a[196:197], v37 offset:16384
    ds_read_b64_tr_b16 a[198:199], v37 offset:20480
    v_mfma_f32_16x16x32_bf16 a[128:131], a[192:195], v[84:87], a[128:131]
    buffer_load_dwordx4 v61, s[12:15], s42 offen offset:1024 nt lds
    v_mfma_f32_16x16x32_bf16 a[132:135], a[192:195], v[88:91], a[132:135]
    s_waitcnt lgkmcnt(0)
    ds_read_b64_tr_b16 a[200:201], v38 offset:16384
    ds_read_b64_tr_b16 a[202:203], v38 offset:20480
    v_mfma_f32_16x16x32_bf16 a[136:139], a[196:199], v[84:87], a[136:139]
    buffer_load_dwordx4 v60, s[12:15], s42 offen offset:2048 nt lds
    v_mfma_f32_16x16x32_bf16 a[140:143], a[196:199], v[88:91], a[140:143]
    s_waitcnt lgkmcnt(0)
    ds_read_b64_tr_b16 a[204:205], v39 offset:16384
    ds_read_b64_tr_b16 a[206:207], v39 offset:20480
    v_mfma_f32_16x16x32_bf16 a[144:147], a[200:203], v[84:87], a[144:147]
    buffer_load_dwordx4 v61, s[12:15], s42 offen offset:3072 nt lds
    v_mfma_f32_16x16x32_bf16 a[148:151], a[200:203], v[88:91], a[148:151]
    s_waitcnt lgkmcnt(0)
    ds_read_b64_tr_b16 a[208:209], v40 offset:16384
    ds_read_b64_tr_b16 a[210:211], v40 offset:20480
    v_mfma_f32_16x16x32_bf16 a[152:155], a[204:207], v[84:87], a[152:155]
    v_exp_f32 v101, v101
    v_mfma_f32_16x16x32_bf16 a[156:159], a[204:207], v[88:91], a[156:159]
    s_waitcnt lgkmcnt(0)
    ds_read_b64_tr_b16 a[212:213], v41 offset:16384
    ds_read_b64_tr_b16 a[214:215], v41 offset:20480
    v_mfma_f32_16x16x32_bf16 a[160:163], a[208:211], v[84:87], a[160:163]
    v_exp_f32 v102, v102
    v_mfma_f32_16x16x32_bf16 a[164:167], a[208:211], v[88:91], a[164:167]
    s_waitcnt lgkmcnt(0)
    ds_read_b64_tr_b16 a[216:217], v42 offset:16384
    ds_read_b64_tr_b16 a[218:219], v42 offset:20480
    v_mfma_f32_16x16x32_bf16 a[168:171], a[212:215], v[84:87], a[168:171]
    v_exp_f32 v103, v103
    v_mfma_f32_16x16x32_bf16 a[172:175], a[212:215], v[88:91], a[172:175]
    s_waitcnt lgkmcnt(0)
    ds_read_b64_tr_b16 a[220:221], v43 offset:16384
    ds_read_b64_tr_b16 a[222:223], v43 offset:20480
    v_mfma_f32_16x16x32_bf16 a[176:179], a[216:219], v[84:87], a[176:179]
    v_exp_f32 v108, v108
    v_mfma_f32_16x16x32_bf16 a[180:183], a[216:219], v[88:91], a[180:183]
    s_waitcnt lgkmcnt(0)
    v_exp_f32 v109, v109
    v_mfma_f32_16x16x32_bf16 a[184:187], a[220:223], v[84:87], a[184:187]
    v_exp_f32 v110, v110
    v_mfma_f32_16x16x32_bf16 a[188:191], a[220:223], v[88:91], a[188:191]
    ds_read_b64_tr_b16 a[192:193], v36 offset:24576
    ds_read_b64_tr_b16 a[194:195], v36 offset:28672
    v_exp_f32 v111, v111
    v_cvt_pk_bf16_f32 v100, v100, v101
    v_cvt_pk_bf16_f32 v101, v102, v103
    v_cvt_pk_bf16_f32 v102, v108, v109
    v_cvt_pk_bf16_f32 v103, v110, v111
    v_exp_f32 v104, v104
    v_exp_f32 v105, v105
    v_exp_f32 v106, v106
    v_exp_f32 v107, v107
    v_exp_f32 v112, v112
    v_exp_f32 v113, v113
    v_exp_f32 v114, v114
    v_exp_f32 v115, v115
    v_cvt_pk_bf16_f32 v104, v104, v105
    v_cvt_pk_bf16_f32 v105, v106, v107
    v_cvt_pk_bf16_f32 v106, v112, v113
    v_cvt_pk_bf16_f32 v107, v114, v115
    v_mfma_f32_16x16x32_bf16 v[68:71], a[224:227], v[100:103], v[68:71]
    v_max3_f32 v19, v116, v117, v118
    v_max3_f32 v19, v19, v119, v120
    v_mfma_f32_16x16x32_bf16 v[72:75], a[224:227], v[104:107], v[72:75]
    s_waitcnt lgkmcnt(0)
    ds_read_b64_tr_b16 a[196:197], v37 offset:24576
    ds_read_b64_tr_b16 a[198:199], v37 offset:28672
    v_mfma_f32_16x16x32_bf16 a[128:131], a[192:195], v[100:103], a[128:131]
    v_max3_f32 v19, v19, v121, v122
    v_max3_f32 v19, v19, v123, v124
    v_mfma_f32_16x16x32_bf16 a[132:135], a[192:195], v[104:107], a[132:135]
    s_waitcnt lgkmcnt(0)
    ds_read_b64_tr_b16 a[200:201], v38 offset:24576
    ds_read_b64_tr_b16 a[202:203], v38 offset:28672
    v_mfma_f32_16x16x32_bf16 a[136:139], a[196:199], v[100:103], a[136:139]
    v_max3_f32 v19, v19, v125, v126
    v_max3_f32 v19, v19, v127, v128
    v_mfma_f32_16x16x32_bf16 a[140:143], a[196:199], v[104:107], a[140:143]
    s_waitcnt lgkmcnt(0)
    ds_read_b64_tr_b16 a[204:205], v39 offset:24576
    ds_read_b64_tr_b16 a[206:207], v39 offset:28672
    v_mfma_f32_16x16x32_bf16 a[144:147], a[200:203], v[100:103], a[144:147]
    v_max3_f32 v19, v19, v129, v130
    v_max3_f32 v19, v19, v131, v132
    v_mfma_f32_16x16x32_bf16 a[148:151], a[200:203], v[104:107], a[148:151]
    s_waitcnt lgkmcnt(0)
    ds_read_b64_tr_b16 a[208:209], v40 offset:24576
    ds_read_b64_tr_b16 a[210:211], v40 offset:28672
    v_mfma_f32_16x16x32_bf16 a[152:155], a[204:207], v[100:103], a[152:155]
    v_max3_f32 v19, v19, v133, v134
    v_max3_f32 v19, v19, v135, v136
    v_mfma_f32_16x16x32_bf16 a[156:159], a[204:207], v[104:107], a[156:159]
    s_waitcnt lgkmcnt(0)
    ds_read_b64_tr_b16 a[212:213], v41 offset:24576
    ds_read_b64_tr_b16 a[214:215], v41 offset:28672
    v_mfma_f32_16x16x32_bf16 a[160:163], a[208:211], v[100:103], a[160:163]
    v_max3_f32 v19, v19, v137, v138
    v_max3_f32 v19, v19, v139, v140
    v_mfma_f32_16x16x32_bf16 a[164:167], a[208:211], v[104:107], a[164:167]
    s_waitcnt lgkmcnt(0)
    ds_read_b64_tr_b16 a[216:217], v42 offset:24576
    ds_read_b64_tr_b16 a[218:219], v42 offset:28672
    v_mfma_f32_16x16x32_bf16 a[168:171], a[212:215], v[100:103], a[168:171]
    v_max3_f32 v19, v19, v141, v142
    v_max3_f32 v19, v19, v143, v144
    v_mfma_f32_16x16x32_bf16 a[172:175], a[212:215], v[104:107], a[172:175]
    s_waitcnt lgkmcnt(0)
    ds_read_b64_tr_b16 a[220:221], v43 offset:24576
    ds_read_b64_tr_b16 a[222:223], v43 offset:28672
    v_mfma_f32_16x16x32_bf16 a[176:179], a[216:219], v[100:103], a[176:179]
    v_max3_f32 v19, v19, v145, v146
    v_max_f32 v19, v19, v147
    v_mfma_f32_16x16x32_bf16 a[180:183], a[216:219], v[104:107], a[180:183]
    s_waitcnt lgkmcnt(0)
    s_waitcnt vmcnt(20)
    s_barrier
    ds_read_b128 a[192:195], v48 offset:49152
    ds_read_b128 a[196:199], v49 offset:49152
    v_mfma_f32_16x16x32_bf16 a[184:187], a[220:223], v[100:103], a[184:187]
    s_add_u32 m0, s37, 98304
    v_cmp_lt_f32 vcc, s47, v19
    v_mul_f32 v228, s46, v228
    v_mfma_f32_16x16x32_bf16 a[188:191], a[220:223], v[104:107], a[188:191]
    s_cbranch_vccnz w2_t5_slow
w2_t5_back:
    s_waitcnt lgkmcnt(1)
    v_exp_f32 v116, v116
    v_mul_f32 v229, s46, v229
    v_mul_f32 v230, s46, v230
    v_mul_f32 v231, s46, v231
    v_mul_f32 v236, s46, v236
    v_mul_f32 v237, s46, v237
    v_mul_f32 v238, s46, v238
    v_mul_f32 v239, s46, v239
    v_cvt_pk_bf16_f32 v228, v228, v229
    v_cvt_pk_bf16_f32 v229, v230, v231
    v_cvt_pk_bf16_f32 v230, v236, v237
    v_cvt_pk_bf16_f32 v231, v238, v239
    v_mul_f32 v232, s46, v232
    v_mul_f32 v233, s46, v233
    v_mul_f32 v234, s46, v234
    v_mul_f32 v235, s46, v235
    v_mul_f32 v240, s46, v240
    v_mul_f32 v241, s46, v241
    v_mul_f32 v242, s46, v242
    v_mul_f32 v243, s46, v243
    v_cvt_pk_bf16_f32 v232, v232, v233
    v_cvt_pk_bf16_f32 v233, v234, v235
    v_cvt_pk_bf16_f32 v234, v240, v241
    v_cvt_pk_bf16_f32 v235, v242, v243
    v_permlane32_swap_b32 v228, v230
    v_permlane32_swap_b32 v229, v231
    v_permlane32_swap_b32 v232, v234
    v_permlane32_swap_b32 v233, v235
    v_permlane16_swap_b32 v228, v230
    v_permlane16_swap_b32 v229, v231
    v_permlane16_swap_b32 v232, v234
    v_permlane16_swap_b32 v233, v235
    v_mfma_f32_16x16x32_bf16 v[84:87], a[192:195], v[148:151], v[76:79]
    s_add_u32 s42, s39, 147456
    ds_read_b128 a[200:203], v50 offset:49152
    ds_read_b128 a[204:207], v51 offset:49152
    v_mfma_f32_16x16x32_bf16 v[88:91], a[192:195], v[152:155], v[80:83]
    s_waitcnt lgkmcnt(2)
    buffer_load_dwordx4 v56, s[8:11], s42 offen offset:0 nt lds
    v_mfma_f32_16x16x32_bf16 v[84:87], a[196:199], v[156:159], v[84:87]
    buffer_load_dwordx4 v57, s[8:11], s42 offen offset:1024 nt lds
    v_mfma_f32_16x16x32_bf16 v[88:91], a[196:199], v[160:163], v[88:91]
    s_waitcnt lgkmcnt(1)
    buffer_load_dwordx4 v58, s[8:11], s42 offen offset:2048 nt lds
    v_mfma_f32_16x16x32_bf16 v[84:87], a[200:203], v[164:167], v[84:87]
    ds_read_b128 a[208:211], v48 offset:53248
    ds_read_b128 a[212:215], v49 offset:53248
    v_mfma_f32_16x16x32_bf16 v[88:91], a[200:203], v[168:171], v[88:91]
    s_waitcnt lgkmcnt(2)
    buffer_load_dwordx4 v59, s[8:11], s42 offen offset:3072 nt lds
    v_mfma_f32_16x16x32_bf16 v[84:87], a[204:207], v[172:175], v[84:87]
    v_exp_f32 v117, v117
    v_mfma_f32_16x16x32_bf16 v[88:91], a[204:207], v[176:179], v[88:91]
    s_waitcnt lgkmcnt(1)
    v_exp_f32 v118, v118
    v_mfma_f32_16x16x32_bf16 v[92:95], a[208:211], v[148:151], v[76:79]
    ds_read_b128 a[216:219], v50 offset:53248
    ds_read_b128 a[220:223], v51 offset:53248
    v_mfma_f32_16x16x32_bf16 v[96:99], a[208:211], v[152:155], v[80:83]
    s_waitcnt lgkmcnt(2)
    v_exp_f32 v119, v119
    v_mfma_f32_16x16x32_bf16 v[92:95], a[212:215], v[156:159], v[92:95]
    v_exp_f32 v124, v124
    v_mfma_f32_16x16x32_bf16 v[96:99], a[212:215], v[160:163], v[96:99]
    s_waitcnt lgkmcnt(1)
    v_exp_f32 v125, v125
    v_mfma_f32_16x16x32_bf16 v[92:95], a[216:219], v[164:167], v[92:95]
    ds_read_b128 a[192:195], v48 offset:57344
    ds_read_b128 a[196:199], v49 offset:57344
    v_mfma_f32_16x16x32_bf16 v[96:99], a[216:219], v[168:171], v[96:99]
    s_waitcnt lgkmcnt(2)
    v_exp_f32 v126, v126
    v_mfma_f32_16x16x32_bf16 v[92:95], a[220:223], v[172:175], v[92:95]
    v_exp_f32 v127, v127
    v_mfma_f32_16x16x32_bf16 v[96:99], a[220:223], v[176:179], v[96:99]
    s_waitcnt lgkmcnt(1)
    v_cvt_pk_bf16_f32 v116, v116, v117
    v_cvt_pk_bf16_f32 v117, v118, v119
    v_mfma_f32_16x16x32_bf16 v[100:103], a[192:195], v[148:151], v[76:79]
    ds_read_b128 a[200:203], v50 offset:57344
    ds_read_b128 a[204:207], v51 offset:57344
    v_mfma_f32_16x16x32_bf16 v[104:107], a[192:195], v[152:155], v[80:83]
    s_waitcnt lgkmcnt(2)
    v_cvt_pk_bf16_f32 v118, v124, v125
    v_cvt_pk_bf16_f32 v119, v126, v127
    v_mfma_f32_16x16x32_bf16 v[100:103], a[196:199], v[156:159], v[100:103]
    v_exp_f32 v120, v120
    v_mfma_f32_16x16x32_bf16 v[104:107], a[196:199], v[160:163], v[104:107]
    s_waitcnt lgkmcnt(1)
    v_exp_f32 v121, v121
    v_mfma_f32_16x16x32_bf16 v[100:103], a[200:203], v[164:167], v[100:103]
    ds_read_b128 a[208:211], v48 offset:61440
    ds_read_b128 a[212:215], v49 offset:61440
    v_mfma_f32_16x16x32_bf16 v[104:107], a[200:203], v[168:171], v[104:107]
    s_waitcnt lgkmcnt(2)
    v_exp_f32 v122, v122
    v_mfma_f32_16x16x32_bf16 v[100:103], a[204:207], v[172:175], v[100:103]
    v_exp_f32 v123, v123
    v_mfma_f32_16x16x32_bf16 v[104:107], a[204:207], v[176:179], v[104:107]
    s_waitcnt lgkmcnt(1)
    v_exp_f32 v128, v128
    v_mfma_f32_16x16x32_bf16 v[108:111], a[208:211], v[148:151], v[76:79]
    ds_read_b128 a[216:219], v50 offset:61440
    ds_read_b128 a[220:223], v51 offset:61440
    v_mfma_f32_16x16x32_bf16 v[112:115], a[208:211], v[152:155], v[80:83]
    s_waitcnt lgkmcnt(2)
    v_exp_f32 v129, v129
    v_mfma_f32_16x16x32_bf16 v[108:111], a[212:215], v[156:159], v[108:111]
    v_exp_f32 v130, v130
    v_mfma_f32_16x16x32_bf16 v[112:115], a[212:215], v[160:163], v[112:115]
    s_waitcnt lgkmcnt(1)
    v_exp_f32 v131, v131
    v_mfma_f32_16x16x32_bf16 v[108:111], a[216:219], v[164:167], v[108:111]
    v_cvt_pk_bf16_f32 v120, v120, v121
    v_cvt_pk_bf16_f32 v121, v122, v123
    v_mfma_f32_16x16x32_bf16 v[112:115], a[216:219], v[168:171], v[112:115]
    s_waitcnt lgkmcnt(0)
    v_cvt_pk_bf16_f32 v122, v128, v129
    v_cvt_pk_bf16_f32 v123, v130, v131
    v_mfma_f32_16x16x32_bf16 v[108:111], a[220:223], v[172:175], v[108:111]
    s_waitcnt vmcnt(20)
    s_barrier
    ds_read_b64_tr_b16 a[192:193], v20 offset:16384
    ds_read_b64_tr_b16 a[194:195], v20 offset:20480
    v_mfma_f32_16x16x32_bf16 v[112:115], a[220:223], v[176:179], v[112:115]
    s_add_u32 m0, s37, 131072
    v_exp_f32 v132, v132
    v_mfma_f32_16x16x32_bf16 v[68:71], a[224:227], v[116:119], v[68:71]
    s_add_u32 s42, s39, 131072
    buffer_load_dwordx4 v60, s[12:15], s42 offen offset:0 nt lds
    v_mfma_f32_16x16x32_bf16 v[72:75], a[224:227], v[120:123], v[72:75]
    s_waitcnt lgkmcnt(0)
    ds_read_b64_tr_b16 a[196:197], v21 offset:16384
    ds_read_b64_tr_b16 a[198:199], v21 offset:20480
    v_mfma_f32_16x16x32_bf16 a[128:131], a[192:195], v[116:119], a[128:131]
    buffer_load_dwordx4 v61, s[12:15], s42 offen offset:1024 nt lds
    v_mfma_f32_16x16x32_bf16 a[132:135], a[192:195], v[120:123], a[132:135]
    s_waitcnt lgkmcnt(0)
    ds_read_b64_tr_b16 a[200:201], v22 offset:16384
    ds_read_b64_tr_b16 a[202:203], v22 offset:20480
    v_mfma_f32_16x16x32_bf16 a[136:139], a[196:199], v[116:119], a[136:139]
    buffer_load_dwordx4 v60, s[12:15], s42 offen offset:2048 nt lds
    v_mfma_f32_16x16x32_bf16 a[140:143], a[196:199], v[120:123], a[140:143]
    s_waitcnt lgkmcnt(0)
    ds_read_b64_tr_b16 a[204:205], v23 offset:16384
    ds_read_b64_tr_b16 a[206:207], v23 offset:20480
    v_mfma_f32_16x16x32_bf16 a[144:147], a[200:203], v[116:119], a[144:147]
    buffer_load_dwordx4 v61, s[12:15], s42 offen offset:3072 nt lds
    v_mfma_f32_16x16x32_bf16 a[148:151], a[200:203], v[120:123], a[148:151]
    s_waitcnt lgkmcnt(0)
    ds_read_b64_tr_b16 a[208:209], v24 offset:16384
    ds_read_b64_tr_b16 a[210:211], v24 offset:20480
    v_mfma_f32_16x16x32_bf16 a[152:155], a[204:207], v[116:119], a[152:155]
    v_exp_f32 v133, v133
    v_mfma_f32_16x16x32_bf16 a[156:159], a[204:207], v[120:123], a[156:159]
    s_waitcnt lgkmcnt(0)
    ds_read_b64_tr_b16 a[212:213], v25 offset:16384
    ds_read_b64_tr_b16 a[214:215], v25 offset:20480
    v_mfma_f32_16x16x32_bf16 a[160:163], a[208:211], v[116:119], a[160:163]
    v_exp_f32 v134, v134
    v_mfma_f32_16x16x32_bf16 a[164:167], a[208:211], v[120:123], a[164:167]
    s_waitcnt lgkmcnt(0)
    ds_read_b64_tr_b16 a[216:217], v26 offset:16384
    ds_read_b64_tr_b16 a[218:219], v26 offset:20480
    v_mfma_f32_16x16x32_bf16 a[168:171], a[212:215], v[116:119], a[168:171]
    v_exp_f32 v135, v135
    v_mfma_f32_16x16x32_bf16 a[172:175], a[212:215], v[120:123], a[172:175]
    s_waitcnt lgkmcnt(0)
    ds_read_b64_tr_b16 a[220:221], v27 offset:16384
    ds_read_b64_tr_b16 a[222:223], v27 offset:20480
    v_mfma_f32_16x16x32_bf16 a[176:179], a[216:219], v[116:119], a[176:179]
    v_exp_f32 v140, v140
    v_mfma_f32_16x16x32_bf16 a[180:183], a[216:219], v[120:123], a[180:183]
    s_waitcnt lgkmcnt(0)
    v_exp_f32 v141, v141
    v_mfma_f32_16x16x32_bf16 a[184:187], a[220:223], v[116:119], a[184:187]
    v_exp_f32 v142, v142
    v_mfma_f32_16x16x32_bf16 a[188:191], a[220:223], v[120:123], a[188:191]
    ds_read_b64_tr_b16 a[192:193], v20 offset:24576
    ds_read_b64_tr_b16 a[194:195], v20 offset:28672
    v_exp_f32 v143, v143
    v_cvt_pk_bf16_f32 v132, v132, v133
    v_cvt_pk_bf16_f32 v133, v134, v135
    v_cvt_pk_bf16_f32 v134, v140, v141
    v_cvt_pk_bf16_f32 v135, v142, v143
    v_exp_f32 v136, v136
    v_exp_f32 v137, v137
    v_exp_f32 v138, v138
    v_exp_f32 v139, v139
    v_exp_f32 v144, v144
    v_exp_f32 v145, v145
    v_exp_f32 v146, v146
    v_exp_f32 v147, v147
    v_cvt_pk_bf16_f32 v136, v136, v137
    v_cvt_pk_bf16_f32 v137, v138, v139
    v_cvt_pk_bf16_f32 v138, v144, v145
    v_cvt_pk_bf16_f32 v139, v146, v147
    v_mfma_f32_16x16x32_bf16 v[68:71], a[224:227], v[132:135], v[68:71]
    v_max3_f32 v19, v84, v85, v86
    v_max3_f32 v19, v19, v87, v88
    v_mfma_f32_16x16x32_bf16 v[72:75], a[224:227], v[136:139], v[72:75]
    s_waitcnt lgkmcnt(0)
    ds_read_b64_tr_b16 a[196:197], v21 offset:24576
    ds_read_b64_tr_b16 a[198:199], v21 offset:28672
    v_mfma_f32_16x16x32_bf16 a[128:131], a[192:195], v[132:135], a[128:131]
    v_max3_f32 v19, v19, v89, v90
    v_max3_f32 v19, v19, v91, v92
    v_mfma_f32_16x16x32_bf16 a[132:135], a[192:195], v[136:139], a[132:135]
    s_waitcnt lgkmcnt(0)
    ds_read_b64_tr_b16 a[200:201], v22 offset:24576
    ds_read_b64_tr_b16 a[202:203], v22 offset:28672
    v_mfma_f32_16x16x32_bf16 a[136:139], a[196:199], v[132:135], a[136:139]
    v_max3_f32 v19, v19, v93, v94
    v_max3_f32 v19, v19, v95, v96
    v_mfma_f32_16x16x32_bf16 a[140:143], a[196:199], v[136:139], a[140:143]
    s_waitcnt lgkmcnt(0)
    ds_read_b64_tr_b16 a[204:205], v23 offset:24576
    ds_read_b64_tr_b16 a[206:207], v23 offset:28672
    v_mfma_f32_16x16x32_bf16 a[144:147], a[200:203], v[132:135], a[144:147]
    v_max3_f32 v19, v19, v97, v98
    v_max3_f32 v19, v19, v99, v100
    v_mfma_f32_16x16x32_bf16 a[148:151], a[200:203], v[136:139], a[148:151]
    s_waitcnt lgkmcnt(0)
    ds_read_b64_tr_b16 a[208:209], v24 offset:24576
    ds_read_b64_tr_b16 a[210:211], v24 offset:28672
    v_mfma_f32_16x16x32_bf16 a[152:155], a[204:207], v[132:135], a[152:155]
    v_max3_f32 v19, v19, v101, v102
    v_max3_f32 v19, v19, v103, v104
    v_mfma_f32_16x16x32_bf16 a[156:159], a[204:207], v[136:139], a[156:159]
    s_waitcnt lgkmcnt(0)
    ds_read_b64_tr_b16 a[212:213], v25 offset:24576
    ds_read_b64_tr_b16 a[214:215], v25 offset:28672
    v_mfma_f32_16x16x32_bf16 a[160:163], a[208:211], v[132:135], a[160:163]
    v_max3_f32 v19, v19, v105, v106
    v_max3_f32 v19, v19, v107, v108
    v_mfma_f32_16x16x32_bf16 a[164:167], a[208:211], v[136:139], a[164:167]
    s_waitcnt lgkmcnt(0)
    ds_read_b64_tr_b16 a[216:217], v26 offset:24576
    ds_read_b64_tr_b16 a[218:219], v26 offset:28672
    v_mfma_f32_16x16x32_bf16 a[168:171], a[212:215], v[132:135], a[168:171]
    v_max3_f32 v19, v19, v109, v110
    v_max3_f32 v19, v19, v111, v112
    v_mfma_f32_16x16x32_bf16 a[172:175], a[212:215], v[136:139], a[172:175]
    s_waitcnt lgkmcnt(0)
    ds_read_b64_tr_b16 a[220:221], v27 offset:24576
    ds_read_b64_tr_b16 a[222:223], v27 offset:28672
    v_mfma_f32_16x16x32_bf16 a[176:179], a[216:219], v[132:135], a[176:179]
    v_max3_f32 v19, v19, v113, v114
    v_max_f32 v19, v19, v115
    v_mfma_f32_16x16x32_bf16 a[180:183], a[216:219], v[136:139], a[180:183]
    s_waitcnt lgkmcnt(0)
    s_waitcnt vmcnt(20)
    s_barrier
    ds_read_b128 a[192:195], v48 offset:16384
    ds_read_b128 a[196:199], v49 offset:16384
    v_mfma_f32_16x16x32_bf16 a[184:187], a[220:223], v[132:135], a[184:187]
    v_cmp_lt_f32 vcc, s47, v19
    v_mfma_f32_16x16x32_bf16 a[188:191], a[220:223], v[136:139], a[188:191]
    s_cbranch_vccnz w2_t6_slow
w2_t6_back:
    s_waitcnt lgkmcnt(1)
    v_exp_f32 v84, v84
    v_mfma_f32_16x16x32_bf16 v[116:119], a[192:195], v[148:151], v[76:79]
    v_exp_f32 v85, v85
    v_mfma_f32_16x16x32_bf16 v[120:123], a[192:195], v[152:155], v[80:83]
    s_waitcnt lgkmcnt(0)
    ds_read_b128 a[200:203], v50 offset:16384
    ds_read_b128 a[204:207], v51 offset:16384
    v_mfma_f32_16x16x32_bf16 v[116:119], a[196:199], v[156:159], v[116:119]
    v_exp_f32 v86, v86
    v_mfma_f32_16x16x32_bf16 v[120:123], a[196:199], v[160:163], v[120:123]
    s_waitcnt lgkmcnt(1)
    v_exp_f32 v87, v87
    v_mfma_f32_16x16x32_bf16 v[116:119], a[200:203], v[164:167], v[116:119]
    v_exp_f32 v92, v92
    v_mfma_f32_16x16x32_bf16 v[120:123], a[200:203], v[168:171], v[120:123]
    s_waitcnt lgkmcnt(0)
    ds_read_b128 a[208:211], v48 offset:20480
    ds_read_b128 a[212:215], v49 offset:20480
    v_mfma_f32_16x16x32_bf16 v[116:119], a[204:207], v[172:175], v[116:119]
    v_exp_f32 v93, v93
    v_mfma_f32_16x16x32_bf16 v[120:123], a[204:207], v[176:179], v[120:123]
    s_waitcnt lgkmcnt(1)
    v_exp_f32 v94, v94
    v_mfma_f32_16x16x32_bf16 v[124:127], a[208:211], v[148:151], v[76:79]
    v_exp_f32 v95, v95
    v_mfma_f32_16x16x32_bf16 v[128:131], a[208:211], v[152:155], v[80:83]
    s_waitcnt lgkmcnt(0)
    ds_read_b128 a[216:219], v50 offset:20480
    ds_read_b128 a[220:223], v51 offset:20480
    v_mfma_f32_16x16x32_bf16 v[124:127], a[212:215], v[156:159], v[124:127]
    v_cvt_pk_bf16_f32 v84, v84, v85
    v_cvt_pk_bf16_f32 v85, v86, v87
    v_mfma_f32_16x16x32_bf16 v[128:131], a[212:215], v[160:163], v[128:131]
    s_waitcnt lgkmcnt(1)
    v_cvt_pk_bf16_f32 v86, v92, v93
    v_cvt_pk_bf16_f32 v87, v94, v95
    v_mfma_f32_16x16x32_bf16 v[124:127], a[216:219], v[164:167], v[124:127]
    v_exp_f32 v88, v88
    v_mfma_f32_16x16x32_bf16 v[128:131], a[216:219], v[168:171], v[128:131]
    s_waitcnt lgkmcnt(0)
    ds_read_b128 a[192:195], v48 offset:24576
    ds_read_b128 a[196:199], v49 offset:24576
    v_mfma_f32_16x16x32_bf16 v[124:127], a[220:223], v[172:175], v[124:127]
    v_exp_f32 v89, v89
    v_mfma_f32_16x16x32_bf16 v[128:131], a[220:223], v[176:179], v[128:131]
    s_waitcnt lgkmcnt(1)
    v_exp_f32 v90, v90
    v_mfma_f32_16x16x32_bf16 v[132:135], a[192:195], v[148:151], v[76:79]
    v_exp_f32 v91, v91
    v_mfma_f32_16x16x32_bf16 v[136:139], a[192:195], v[152:155], v[80:83]
    s_waitcnt lgkmcnt(0)
    ds_read_b128 a[200:203], v50 offset:24576
    ds_read_b128 a[204:207], v51 offset:24576
    v_mfma_f32_16x16x32_bf16 v[132:135], a[196:199], v[156:159], v[132:135]
    v_exp_f32 v96, v96
    v_mfma_f32_16x16x32_bf16 v[136:139], a[196:199], v[160:163], v[136:139]
    s_waitcnt lgkmcnt(1)
    v_exp_f32 v97, v97
    v_mfma_f32_16x16x32_bf16 v[132:135], a[200:203], v[164:167], v[132:135]
    v_exp_f32 v98, v98
    v_mfma_f32_16x16x32_bf16 v[136:139], a[200:203], v[168:171], v[136:139]
    s_waitcnt lgkmcnt(0)
    ds_read_b128 a[208:211], v48 offset:28672
    ds_read_b128 a[212:215], v49 offset:28672
    v_mfma_f32_16x16x32_bf16 v[132:135], a[204:207], v[172:175], v[132:135]
    v_exp_f32 v99, v99
    v_mfma_f32_16x16x32_bf16 v[136:139], a[204:207], v[176:179], v[136:139]
    s_waitcnt lgkmcnt(1)
    v_cvt_pk_bf16_f32 v88, v88, v89
    v_cvt_pk_bf16_f32 v89, v90, v91
    v_mfma_f32_16x16x32_bf16 v[140:143], a[208:211], v[148:151], v[76:79]
    v_cvt_pk_bf16_f32 v90, v96, v97
    v_cvt_pk_bf16_f32 v91, v98, v99
    v_mfma_f32_16x16x32_bf16 v[144:147], a[208:211], v[152:155], v[80:83]
    s_waitcnt lgkmcnt(0)
    ds_read_b128 a[216:219], v50 offset:28672
    ds_read_b128 a[220:223], v51 offset:28672
    v_mfma_f32_16x16x32_bf16 v[140:143], a[212:215], v[156:159], v[140:143]
    v_exp_f32 v100, v100
    v_mfma_f32_16x16x32_bf16 v[144:147], a[212:215], v[160:163], v[144:147]
    s_waitcnt lgkmcnt(1)
    v_exp_f32 v101, v101
    v_mfma_f32_16x16x32_bf16 v[140:143], a[216:219], v[164:167], v[140:143]
    v_exp_f32 v102, v102
    v_mfma_f32_16x16x32_bf16 v[144:147], a[216:219], v[168:171], v[144:147]
    s_waitcnt lgkmcnt(0)
    v_exp_f32 v103, v103
    v_mfma_f32_16x16x32_bf16 v[140:143], a[220:223], v[172:175], v[140:143]
    v_exp_f32 v108, v108
    v_mfma_f32_16x16x32_bf16 v[144:147], a[220:223], v[176:179], v[144:147]
    s_waitcnt vmcnt(16)
    s_barrier
    global_load_dword v7, v67, s[88:89]
    ds_read_b64_tr_b16 a[192:193], v20 offset:0
    ds_read_b64_tr_b16 a[194:195], v20 offset:4096
    v_mfma_f32_16x16x32_bf16 v[68:71], a[224:227], v[84:87], v[68:71]
    s_add_u32 m0, s37, 49152
    v_exp_f32 v109, v109
    v_mfma_f32_16x16x32_bf16 v[72:75], a[224:227], v[88:91], v[72:75]
    s_waitcnt lgkmcnt(0)
    ds_read_b64_tr_b16 a[196:197], v21 offset:0
    ds_read_b64_tr_b16 a[198:199], v21 offset:4096
    v_mfma_f32_16x16x32_bf16 a[128:131], a[192:195], v[84:87], a[128:131]
    s_add_u32 s42, s39, 163840
    buffer_load_dwordx4 v56, s[8:11], s42 offen offset:0 nt lds
    v_mfma_f32_16x16x32_bf16 a[132:135], a[192:195], v[88:91], a[132:135]
    s_waitcnt lgkmcnt(0)
    ds_read_b64_tr_b16 a[200:201], v22 offset:0
    ds_read_b64_tr_b16 a[202:203], v22 offset:4096
    v_mfma_f32_16x16x32_bf16 a[136:139], a[196:199], v[84:87], a[136:139]
    buffer_load_dwordx4 v57, s[8:11], s42 offen offset:1024 nt lds
    v_mfma_f32_16x16x32_bf16 a[140:143], a[196:199], v[88:91], a[140:143]
    s_waitcnt lgkmcnt(0)
    ds_read_b64_tr_b16 a[204:205], v23 offset:0
    ds_read_b64_tr_b16 a[206:207], v23 offset:4096
    v_mfma_f32_16x16x32_bf16 a[144:147], a[200:203], v[84:87], a[144:147]
    buffer_load_dwordx4 v58, s[8:11], s42 offen offset:2048 nt lds
    v_mfma_f32_16x16x32_bf16 a[148:151], a[200:203], v[88:91], a[148:151]
    s_waitcnt lgkmcnt(0)
    ds_read_b64_tr_b16 a[208:209], v24 offset:0
    ds_read_b64_tr_b16 a[210:211], v24 offset:4096
    v_mfma_f32_16x16x32_bf16 a[152:155], a[204:207], v[84:87], a[152:155]
    buffer_load_dwordx4 v59, s[8:11], s42 offen offset:3072 nt lds
    v_mfma_f32_16x16x32_bf16 a[156:159], a[204:207], v[88:91], a[156:159]
    s_waitcnt lgkmcnt(0)
    ds_read_b64_tr_b16 a[212:213], v25 offset:0
    ds_read_b64_tr_b16 a[214:215], v25 offset:4096
    v_mfma_f32_16x16x32_bf16 a[160:163], a[208:211], v[84:87], a[160:163]
    v_exp_f32 v110, v110
    v_mfma_f32_16x16x32_bf16 a[164:167], a[208:211], v[88:91], a[164:167]
    s_waitcnt lgkmcnt(0)
    ds_read_b64_tr_b16 a[216:217], v26 offset:0
    ds_read_b64_tr_b16 a[218:219], v26 offset:4096
    v_mfma_f32_16x16x32_bf16 a[168:171], a[212:215], v[84:87], a[168:171]
    v_exp_f32 v111, v111
    v_mfma_f32_16x16x32_bf16 a[172:175], a[212:215], v[88:91], a[172:175]
    s_waitcnt lgkmcnt(0)
    ds_read_b64_tr_b16 a[220:221], v27 offset:0
    ds_read_b64_tr_b16 a[222:223], v27 offset:4096
    v_mfma_f32_16x16x32_bf16 a[176:179], a[216:219], v[84:87], a[176:179]
    v_cvt_pk_bf16_f32 v100, v100, v101
    v_cvt_pk_bf16_f32 v101, v102, v103
    v_mfma_f32_16x16x32_bf16 a[180:183], a[216:219], v[88:91], a[180:183]
    s_waitcnt lgkmcnt(0)
    v_cvt_pk_bf16_f32 v102, v108, v109
    v_cvt_pk_bf16_f32 v103, v110, v111
    v_mfma_f32_16x16x32_bf16 a[184:187], a[220:223], v[84:87], a[184:187]
    v_exp_f32 v104, v104
    v_mfma_f32_16x16x32_bf16 a[188:191], a[220:223], v[88:91], a[188:191]
    ds_read_b64_tr_b16 a[192:193], v20 offset:8192
    ds_read_b64_tr_b16 a[194:195], v20 offset:12288
    v_exp_f32 v105, v105
    v_exp_f32 v106, v106
    v_exp_f32 v107, v107
    v_exp_f32 v112, v112
    v_exp_f32 v113, v113
    v_exp_f32 v114, v114
    v_exp_f32 v115, v115
    v_cvt_pk_bf16_f32 v104, v104, v105
    v_cvt_pk_bf16_f32 v105, v106, v107
    v_cvt_pk_bf16_f32 v106, v112, v113
    v_cvt_pk_bf16_f32 v107, v114, v115
    v_mfma_f32_16x16x32_bf16 v[68:71], a[224:227], v[100:103], v[68:71]
    v_max3_f32 v19, v116, v117, v118
    v_max3_f32 v19, v19, v119, v120
    v_mfma_f32_16x16x32_bf16 v[72:75], a[224:227], v[104:107], v[72:75]
    s_waitcnt lgkmcnt(0)
    ds_read_b64_tr_b16 a[196:197], v21 offset:8192
    ds_read_b64_tr_b16 a[198:199], v21 offset:12288
    v_mfma_f32_16x16x32_bf16 a[128:131], a[192:195], v[100:103], a[128:131]
    v_max3_f32 v19, v19, v121, v122
    v_max3_f32 v19, v19, v123, v124
    v_mfma_f32_16x16x32_bf16 a[132:135], a[192:195], v[104:107], a[132:135]
    s_waitcnt lgkmcnt(0)
    ds_read_b64_tr_b16 a[200:201], v22 offset:8192
    ds_read_b64_tr_b16 a[202:203], v22 offset:12288
    v_mfma_f32_16x16x32_bf16 a[136:139], a[196:199], v[100:103], a[136:139]
    v_max3_f32 v19, v19, v125, v126
    v_max3_f32 v19, v19, v127, v128
    v_mfma_f32_16x16x32_bf16 a[140:143], a[196:199], v[104:107], a[140:143]
    s_waitcnt lgkmcnt(0)
    ds_read_b64_tr_b16 a[204:205], v23 offset:8192
    ds_read_b64_tr_b16 a[206:207], v23 offset:12288
    v_mfma_f32_16x16x32_bf16 a[144:147], a[200:203], v[100:103], a[144:147]
    v_max3_f32 v19, v19, v129, v130
    v_max3_f32 v19, v19, v131, v132
    v_mfma_f32_16x16x32_bf16 a[148:151], a[200:203], v[104:107], a[148:151]
    s_waitcnt lgkmcnt(0)
    ds_read_b64_tr_b16 a[208:209], v24 offset:8192
    ds_read_b64_tr_b16 a[210:211], v24 offset:12288
    v_mfma_f32_16x16x32_bf16 a[152:155], a[204:207], v[100:103], a[152:155]
    v_max3_f32 v19, v19, v133, v134
    v_max3_f32 v19, v19, v135, v136
    v_mfma_f32_16x16x32_bf16 a[156:159], a[204:207], v[104:107], a[156:159]
    s_waitcnt lgkmcnt(0)
    ds_read_b64_tr_b16 a[212:213], v25 offset:8192
    ds_read_b64_tr_b16 a[214:215], v25 offset:12288
    v_mfma_f32_16x16x32_bf16 a[160:163], a[208:211], v[100:103], a[160:163]
    v_max3_f32 v19, v19, v137, v138
    v_max3_f32 v19, v19, v139, v140
    v_mfma_f32_16x16x32_bf16 a[164:167], a[208:211], v[104:107], a[164:167]
    s_waitcnt lgkmcnt(0)
    ds_read_b64_tr_b16 a[216:217], v26 offset:8192
    ds_read_b64_tr_b16 a[218:219], v26 offset:12288
    v_mfma_f32_16x16x32_bf16 a[168:171], a[212:215], v[100:103], a[168:171]
    v_max3_f32 v19, v19, v141, v142
    v_max3_f32 v19, v19, v143, v144
    v_mfma_f32_16x16x32_bf16 a[172:175], a[212:215], v[104:107], a[172:175]
    s_waitcnt lgkmcnt(0)
    ds_read_b64_tr_b16 a[220:221], v27 offset:8192
    ds_read_b64_tr_b16 a[222:223], v27 offset:12288
    v_mfma_f32_16x16x32_bf16 a[176:179], a[216:219], v[100:103], a[176:179]
    v_max3_f32 v19, v19, v145, v146
    v_max_f32 v19, v19, v147
    v_mfma_f32_16x16x32_bf16 a[180:183], a[216:219], v[104:107], a[180:183]
    s_waitcnt lgkmcnt(0)
    s_waitcnt vmcnt(17)
    s_barrier
    ds_read_b128 a[192:195], v44 offset:32768
    ds_read_b128 a[196:199], v45 offset:32768
    v_mfma_f32_16x16x32_bf16 a[184:187], a[220:223], v[100:103], a[184:187]
    s_add_u32 m0, s37, 147456
    v_cmp_lt_f32 vcc, s47, v19
    v_mfma_f32_16x16x32_bf16 a[188:191], a[220:223], v[104:107], a[188:191]
    s_cbranch_vccnz w2_t7_slow
w2_t7_back:
    s_waitcnt lgkmcnt(1)
    v_exp_f32 v116, v116
    v_mfma_f32_16x16x32_bf16 v[84:87], a[192:195], v[180:183], 0
    s_add_u32 s42, s39, 147456
    buffer_load_dwordx4 v60, s[12:15], s42 offen offset:0 nt lds
    v_mfma_f32_16x16x32_bf16 v[88:91], a[192:195], v[184:187], 0
    s_waitcnt lgkmcnt(0)
    ds_read_b128 a[200:203], v46 offset:32768
    ds_read_b128 a[204:207], v47 offset:32768
    v_mfma_f32_16x16x32_bf16 v[84:87], a[196:199], v[196:199], v[84:87]
    buffer_load_dwordx4 v61, s[12:15], s42 offen offset:1024 nt lds
    v_mfma_f32_16x16x32_bf16 v[88:91], a[196:199], v[200:203], v[88:91]
    s_waitcnt lgkmcnt(1)
    buffer_load_dwordx4 v60, s[12:15], s42 offen offset:2048 nt lds
    v_mfma_f32_16x16x32_bf16 v[84:87], a[200:203], v[212:215], v[84:87]
    buffer_load_dwordx4 v61, s[12:15], s42 offen offset:3072 nt lds
    v_mfma_f32_16x16x32_bf16 v[88:91], a[200:203], v[216:219], v[88:91]
    s_waitcnt lgkmcnt(0)
    ds_read_b128 a[208:211], v44 offset:36864
    ds_read_b128 a[212:215], v45 offset:36864
    v_mfma_f32_16x16x32_bf16 v[84:87], a[204:207], v[228:231], v[84:87]
    v_exp_f32 v117, v117
    v_mfma_f32_16x16x32_bf16 v[88:91], a[204:207], v[232:235], v[88:91]
    s_waitcnt lgkmcnt(1)
    v_exp_f32 v118, v118
    v_mfma_f32_16x16x32_bf16 v[92:95], a[208:211], v[180:183], 0
    v_exp_f32 v119, v119
    v_mfma_f32_16x16x32_bf16 v[96:99], a[208:211], v[184:187], 0
    s_waitcnt lgkmcnt(0)
    ds_read_b128 a[216:219], v46 offset:36864
    ds_read_b128 a[220:223], v47 offset:36864
    v_mfma_f32_16x16x32_bf16 v[92:95], a[212:215], v[196:199], v[92:95]
    v_exp_f32 v124, v124
    v_mfma_f32_16x16x32_bf16 v[96:99], a[212:215], v[200:203], v[96:99]
    s_waitcnt lgkmcnt(1)
    v_exp_f32 v125, v125
    v_mfma_f32_16x16x32_bf16 v[92:95], a[216:219], v[212:215], v[92:95]
    v_exp_f32 v126, v126
    v_mfma_f32_16x16x32_bf16 v[96:99], a[216:219], v[216:219], v[96:99]
    s_waitcnt lgkmcnt(0)
    ds_read_b128 a[192:195], v44 offset:40960
    ds_read_b128 a[196:199], v45 offset:40960
    v_mfma_f32_16x16x32_bf16 v[92:95], a[220:223], v[228:231], v[92:95]
    v_exp_f32 v127, v127
    v_mfma_f32_16x16x32_bf16 v[96:99], a[220:223], v[232:235], v[96:99]
    s_waitcnt lgkmcnt(1)
    v_cvt_pk_bf16_f32 v116, v116, v117
    v_cvt_pk_bf16_f32 v117, v118, v119
    v_mfma_f32_16x16x32_bf16 v[100:103], a[192:195], v[180:183], 0
    v_cvt_pk_bf16_f32 v118, v124, v125
    v_cvt_pk_bf16_f32 v119, v126, v127
    v_mfma_f32_16x16x32_bf16 v[104:107], a[192:195], v[184:187], 0
    s_waitcnt lgkmcnt(0)
    ds_read_b128 a[200:203], v46 offset:40960
    ds_read_b128 a[204:207], v47 offset:40960
    v_mfma_f32_16x16x32_bf16 v[100:103], a[196:199], v[196:199], v[100:103]
    v_exp_f32 v120, v120
    v_mfma_f32_16x16x32_bf16 v[104:107], a[196:199], v[200:203], v[104:107]
    s_waitcnt lgkmcnt(1)
    v_exp_f32 v121, v121
    v_mfma_f32_16x16x32_bf16 v[100:103], a[200:203], v[212:215], v[100:103]
    v_exp_f32 v122, v122
    v_mfma_f32_16x16x32_bf16 v[104:107], a[200:203], v[216:219], v[104:107]
    s_waitcnt lgkmcnt(0)
    ds_read_b128 a[208:211], v44 offset:45056
    ds_read_b128 a[212:215], v45 offset:45056
    v_mfma_f32_16x16x32_bf16 v[100:103], a[204:207], v[228:231], v[100:103]
    v_exp_f32 v123, v123
    v_mfma_f32_16x16x32_bf16 v[104:107], a[204:207], v[232:235], v[104:107]
    s_waitcnt lgkmcnt(1)
    v_exp_f32 v128, v128
    v_mfma_f32_16x16x32_bf16 v[108:111], a[208:211], v[180:183], 0
    v_exp_f32 v129, v129
    v_mfma_f32_16x16x32_bf16 v[112:115], a[208:211], v[184:187], 0
    s_waitcnt lgkmcnt(0)
    ds_read_b128 a[216:219], v46 offset:45056
    ds_read_b128 a[220:223], v47 offset:45056
    v_mfma_f32_16x16x32_bf16 v[108:111], a[212:215], v[196:199], v[108:111]
    v_exp_f32 v130, v130
    v_mfma_f32_16x16x32_bf16 v[112:115], a[212:215], v[200:203], v[112:115]
    s_waitcnt lgkmcnt(1)
    v_exp_f32 v131, v131
    v_mfma_f32_16x16x32_bf16 v[108:111], a[216:219], v[212:215], v[108:111]
    v_cvt_pk_bf16_f32 v120, v120, v121
    v_cvt_pk_bf16_f32 v121, v122, v123
    v_mfma_f32_16x16x32_bf16 v[112:115], a[216:219], v[216:219], v[112:115]
    s_waitcnt lgkmcnt(0)
    v_cvt_pk_bf16_f32 v122, v128, v129
    v_cvt_pk_bf16_f32 v123, v130, v131
    v_mfma_f32_16x16x32_bf16 v[108:111], a[220:223], v[228:231], v[108:111]
    v_exp_f32 v132, v132
    v_mfma_f32_16x16x32_bf16 v[112:115], a[220:223], v[232:235], v[112:115]
    s_waitcnt vmcnt(17)
    s_barrier
    ds_read_b64_tr_b16 a[192:193], v28 offset:0
    ds_read_b64_tr_b16 a[194:195], v28 offset:4096
    v_mfma_f32_16x16x32_bf16 v[68:71], a[224:227], v[116:119], v[68:71]
    s_add_u32 m0, s37, 114688
    ds_read_b64_tr_b16 a[196:197], v29 offset:0
    ds_read_b64_tr_b16 a[198:199], v29 offset:4096
    v_mfma_f32_16x16x32_bf16 v[72:75], a[224:227], v[120:123], v[72:75]
    s_waitcnt lgkmcnt(2)
    v_exp_f32 v133, v133
    v_mfma_f32_16x16x32_bf16 a[128:131], a[192:195], v[116:119], a[128:131]
    s_add_u32 s42, s39, 180224
    ds_read_b64_tr_b16 a[200:201], v30 offset:0
    ds_read_b64_tr_b16 a[202:203], v30 offset:4096
    v_mfma_f32_16x16x32_bf16 a[132:135], a[192:195], v[120:123], a[132:135]
    s_waitcnt lgkmcnt(2)
    buffer_load_dwordx4 v56, s[8:11], s42 offen offset:0 nt lds
    v_mfma_f32_16x16x32_bf16 a[136:139], a[196:199], v[116:119], a[136:139]
    ds_read_b64_tr_b16 a[204:205], v31 offset:0
    ds_read_b64_tr_b16 a[206:207], v31 offset:4096
    v_mfma_f32_16x16x32_bf16 a[140:143], a[196:199], v[120:123], a[140:143]
    s_waitcnt lgkmcnt(2)
    buffer_load_dwordx4 v57, s[8:11], s42 offen offset:1024 nt lds
    v_mfma_f32_16x16x32_bf16 a[144:147], a[200:203], v[116:119], a[144:147]
    ds_read_b64_tr_b16 a[208:209], v32 offset:0
    ds_read_b64_tr_b16 a[210:211], v32 offset:4096
    v_mfma_f32_16x16x32_bf16 a[148:151], a[200:203], v[120:123], a[148:151]
    s_waitcnt lgkmcnt(2)
    buffer_load_dwordx4 v58, s[8:11], s42 offen offset:2048 nt lds
    v_mfma_f32_16x16x32_bf16 a[152:155], a[204:207], v[116:119], a[152:155]
    ds_read_b64_tr_b16 a[212:213], v33 offset:0
    ds_read_b64_tr_b16 a[214:215], v33 offset:4096
    v_mfma_f32_16x16x32_bf16 a[156:159], a[204:207], v[120:123], a[156:159]
    s_waitcnt lgkmcnt(2)
    buffer_load_dwordx4 v59, s[8:11], s42 offen offset:3072 nt lds
    v_mfma_f32_16x16x32_bf16 a[160:163], a[208:211], v[116:119], a[160:163]
    ds_read_b64_tr_b16 a[216:217], v34 offset:0
    ds_read_b64_tr_b16 a[218:219], v34 offset:4096
    v_mfma_f32_16x16x32_bf16 a[164:167], a[208:211], v[120:123], a[164:167]
    s_waitcnt lgkmcnt(2)
    v_exp_f32 v134, v134
    v_mfma_f32_16x16x32_bf16 a[168:171], a[212:215], v[116:119], a[168:171]
    ds_read_b64_tr_b16 a[220:221], v35 offset:0
    ds_read_b64_tr_b16 a[222:223], v35 offset:4096
    v_mfma_f32_16x16x32_bf16 a[172:175], a[212:215], v[120:123], a[172:175]
    s_waitcnt lgkmcnt(2)
    v_exp_f32 v135, v135
    v_mfma_f32_16x16x32_bf16 a[176:179], a[216:219], v[116:119], a[176:179]
    v_exp_f32 v140, v140
    v_mfma_f32_16x16x32_bf16 a[180:183], a[216:219], v[120:123], a[180:183]
    s_waitcnt lgkmcnt(0)
    v_exp_f32 v141, v141
    v_mfma_f32_16x16x32_bf16 a[184:187], a[220:223], v[116:119], a[184:187]
    ds_read_b64_tr_b16 a[192:193], v28 offset:8192
    ds_read_b64_tr_b16 a[194:195], v28 offset:12288
    v_mfma_f32_16x16x32_bf16 a[188:191], a[220:223], v[120:123], a[188:191]
    v_exp_f32 v142, v142
    v_exp_f32 v143, v143
    v_cvt_pk_bf16_f32 v132, v132, v133
    v_cvt_pk_bf16_f32 v133, v134, v135
    v_cvt_pk_bf16_f32 v134, v140, v141
    v_cvt_pk_bf16_f32 v135, v142, v143
    v_exp_f32 v136, v136
    v_exp_f32 v137, v137
    v_exp_f32 v138, v138
    v_exp_f32 v139, v139
    v_exp_f32 v144, v144
    v_exp_f32 v145, v145
    v_exp_f32 v146, v146
    v_exp_f32 v147, v147
    v_cvt_pk_bf16_f32 v136, v136, v137
    v_cvt_pk_bf16_f32 v137, v138, v139
    v_cvt_pk_bf16_f32 v138, v144, v145
    v_cvt_pk_bf16_f32 v139, v146, v147
    v_mfma_f32_16x16x32_bf16 v[68:71], a[224:227], v[132:135], v[68:71]
    ds_read_b64_tr_b16 a[196:197], v29 offset:8192
    ds_read_b64_tr_b16 a[198:199], v29 offset:12288
    v_mfma_f32_16x16x32_bf16 v[72:75], a[224:227], v[136:139], v[72:75]
    s_waitcnt lgkmcnt(2)
    v_max3_f32 v1, v84, v85, v86
    v_max3_f32 v3, v88, v89, v90
    v_mfma_f32_16x16x32_bf16 a[128:131], a[192:195], v[132:135], a[128:131]
    ds_read_b64_tr_b16 a[200:201], v30 offset:8192
    ds_read_b64_tr_b16 a[202:203], v30 offset:12288
    v_mfma_f32_16x16x32_bf16 a[132:135], a[192:195], v[136:139], a[132:135]
    s_waitcnt lgkmcnt(2)
    v_max3_f32 v1, v1, v87, v92
    v_max3_f32 v3, v3, v91, v96
    v_mfma_f32_16x16x32_bf16 a[136:139], a[196:199], v[132:135], a[136:139]
    ds_read_b64_tr_b16 a[204:205], v31 offset:8192
    ds_read_b64_tr_b16 a[206:207], v31 offset:12288
    v_mfma_f32_16x16x32_bf16 a[140:143], a[196:199], v[136:139], a[140:143]
    s_waitcnt lgkmcnt(2)
    v_max3_f32 v1, v1, v93, v94
    v_max3_f32 v3, v3, v97, v98
    v_mfma_f32_16x16x32_bf16 a[144:147], a[200:203], v[132:135], a[144:147]
    ds_read_b64_tr_b16 a[208:209], v32 offset:8192
    ds_read_b64_tr_b16 a[210:211], v32 offset:12288
    v_mfma_f32_16x16x32_bf16 a[148:151], a[200:203], v[136:139], a[148:151]
    s_waitcnt lgkmcnt(2)
    v_max3_f32 v1, v1, v95, v100
    v_max3_f32 v3, v3, v99, v104
    v_mfma_f32_16x16x32_bf16 a[152:155], a[204:207], v[132:135], a[152:155]
    ds_read_b64_tr_b16 a[212:213], v33 offset:8192
    ds_read_b64_tr_b16 a[214:215], v33 offset:12288
    v_mfma_f32_16x16x32_bf16 a[156:159], a[204:207], v[136:139], a[156:159]
    s_waitcnt lgkmcnt(2)
    v_max3_f32 v1, v1, v101, v102
    v_max3_f32 v3, v3, v105, v106
    v_mfma_f32_16x16x32_bf16 a[160:163], a[208:211], v[132:135], a[160:163]
    ds_read_b64_tr_b16 a[216:217], v34 offset:8192
    ds_read_b64_tr_b16 a[218:219], v34 offset:12288
    v_mfma_f32_16x16x32_bf16 a[164:167], a[208:211], v[136:139], a[164:167]
    s_waitcnt lgkmcnt(2)
    v_max3_f32 v1, v1, v103, v108
    v_max3_f32 v3, v3, v107, v112
    v_mfma_f32_16x16x32_bf16 a[168:171], a[212:215], v[132:135], a[168:171]
    ds_read_b64_tr_b16 a[220:221], v35 offset:8192
    ds_read_b64_tr_b16 a[222:223], v35 offset:12288
    v_mfma_f32_16x16x32_bf16 a[172:175], a[212:215], v[136:139], a[172:175]
    s_waitcnt lgkmcnt(2)
    v_max3_f32 v1, v1, v109, v110
    v_max3_f32 v3, v3, v113, v114
    v_mfma_f32_16x16x32_bf16 a[176:179], a[216:219], v[132:135], a[176:179]
    s_waitcnt vmcnt(17)
    s_barrier
    ds_read_b128 a[192:195], v48 offset:32768
    ds_read_b128 a[196:199], v49 offset:32768
    v_mfma_f32_16x16x32_bf16 a[180:183], a[216:219], v[136:139], a[180:183]
    s_waitcnt lgkmcnt(2)
    v_max_f32 v1, v1, v111
    v_max_f32 v3, v3, v115
    v_mfma_f32_16x16x32_bf16 a[184:187], a[220:223], v[132:135], a[184:187]
    s_add_u32 m0, s37, 16384
    v_mov_b32 v2, v1
    v_mov_b32 v4, v3
    v_mfma_f32_16x16x32_bf16 a[188:191], a[220:223], v[136:139], a[188:191]
    s_waitcnt lgkmcnt(1)
    v_permlane32_swap_b32 v1, v2
    v_permlane32_swap_b32 v3, v4
    v_max_f32 v1, v1, v2
    v_max_f32 v3, v3, v4
    v_mov_b32 v2, v1
    v_mov_b32 v4, v3
    s_nop 0
    v_permlane16_swap_b32 v1, v2
    v_permlane16_swap_b32 v3, v4
    v_max_f32 v1, v1, v2
    v_max_f32 v3, v3, v4
    v_sub_f32 v76, 0, v1
    v_sub_f32 v77, 0, v1
    v_sub_f32 v78, 0, v1
    v_sub_f32 v79, 0, v1
    v_sub_f32 v80, 0, v3
    v_sub_f32 v81, 0, v3
    v_sub_f32 v82, 0, v3
    v_sub_f32 v83, 0, v3
    v_mfma_f32_16x16x32_bf16 v[116:119], a[192:195], v[180:183], v[76:79]
    s_add_u32 s42, s39, 163840
    buffer_load_dwordx4 v60, s[12:15], s42 offen offset:0 nt lds
    v_mfma_f32_16x16x32_bf16 v[120:123], a[192:195], v[184:187], v[80:83]
    s_waitcnt lgkmcnt(0)
    ds_read_b128 a[200:203], v50 offset:32768
    ds_read_b128 a[204:207], v51 offset:32768
    v_mfma_f32_16x16x32_bf16 v[116:119], a[196:199], v[196:199], v[116:119]
    buffer_load_dwordx4 v61, s[12:15], s42 offen offset:1024 nt lds
    v_mfma_f32_16x16x32_bf16 v[120:123], a[196:199], v[200:203], v[120:123]
    s_waitcnt lgkmcnt(1)
    buffer_load_dwordx4 v60, s[12:15], s42 offen offset:2048 nt lds
    v_mfma_f32_16x16x32_bf16 v[116:119], a[200:203], v[212:215], v[116:119]
    buffer_load_dwordx4 v61, s[12:15], s42 offen offset:3072 nt lds
    v_mfma_f32_16x16x32_bf16 v[120:123], a[200:203], v[216:219], v[120:123]
    s_waitcnt lgkmcnt(0)
    ds_read_b128 a[208:211], v48 offset:36864
    ds_read_b128 a[212:215], v49 offset:36864
    v_mfma_f32_16x16x32_bf16 v[116:119], a[204:207], v[228:231], v[116:119]
    v_sub_f32 v84, v84, v1
    v_sub_f32 v85, v85, v1
    v_mfma_f32_16x16x32_bf16 v[120:123], a[204:207], v[232:235], v[120:123]
    s_waitcnt lgkmcnt(1)
    v_sub_f32 v86, v86, v1
    v_sub_f32 v87, v87, v1
    v_mfma_f32_16x16x32_bf16 v[124:127], a[208:211], v[180:183], v[76:79]
    v_sub_f32 v88, v88, v3
    v_sub_f32 v89, v89, v3
    v_mfma_f32_16x16x32_bf16 v[128:131], a[208:211], v[184:187], v[80:83]
    s_waitcnt lgkmcnt(0)
    ds_read_b128 a[216:219], v50 offset:36864
    ds_read_b128 a[220:223], v51 offset:36864
    v_mfma_f32_16x16x32_bf16 v[124:127], a[212:215], v[196:199], v[124:127]
    v_sub_f32 v90, v90, v3
    v_sub_f32 v91, v91, v3
    v_mfma_f32_16x16x32_bf16 v[128:131], a[212:215], v[200:203], v[128:131]
    s_waitcnt lgkmcnt(1)
    v_sub_f32 v92, v92, v1
    v_sub_f32 v93, v93, v1
    v_mfma_f32_16x16x32_bf16 v[124:127], a[216:219], v[212:215], v[124:127]
    v_sub_f32 v94, v94, v1
    v_sub_f32 v95, v95, v1
    v_mfma_f32_16x16x32_bf16 v[128:131], a[216:219], v[216:219], v[128:131]
    s_waitcnt lgkmcnt(0)
    ds_read_b128 a[192:195], v48 offset:40960
    ds_read_b128 a[196:199], v49 offset:40960
    v_mfma_f32_16x16x32_bf16 v[124:127], a[220:223], v[228:231], v[124:127]
    v_sub_f32 v96, v96, v3
    v_sub_f32 v97, v97, v3
    v_mfma_f32_16x16x32_bf16 v[128:131], a[220:223], v[232:235], v[128:131]
    s_waitcnt lgkmcnt(1)
    v_sub_f32 v98, v98, v3
    v_sub_f32 v99, v99, v3
    v_mfma_f32_16x16x32_bf16 v[132:135], a[192:195], v[180:183], v[76:79]
    v_sub_f32 v100, v100, v1
    v_sub_f32 v101, v101, v1
    v_mfma_f32_16x16x32_bf16 v[136:139], a[192:195], v[184:187], v[80:83]
    s_waitcnt lgkmcnt(0)
    ds_read_b128 a[200:203], v50 offset:40960
    ds_read_b128 a[204:207], v51 offset:40960
    v_mfma_f32_16x16x32_bf16 v[132:135], a[196:199], v[196:199], v[132:135]
    v_sub_f32 v102, v102, v1
    v_sub_f32 v103, v103, v1
    v_mfma_f32_16x16x32_bf16 v[136:139], a[196:199], v[200:203], v[136:139]
    s_waitcnt lgkmcnt(1)
    v_sub_f32 v104, v104, v3
    v_sub_f32 v105, v105, v3
    v_mfma_f32_16x16x32_bf16 v[132:135], a[200:203], v[212:215], v[132:135]
    v_sub_f32 v106, v106, v3
    v_sub_f32 v107, v107, v3
    v_mfma_f32_16x16x32_bf16 v[136:139], a[200:203], v[216:219], v[136:139]
    s_waitcnt lgkmcnt(0)
    ds_read_b128 a[208:211], v48 offset:45056
    ds_read_b128 a[212:215], v49 offset:45056
    v_mfma_f32_16x16x32_bf16 v[132:135], a[204:207], v[228:231], v[132:135]
    v_sub_f32 v108, v108, v1
    v_sub_f32 v109, v109, v1
    v_mfma_f32_16x16x32_bf16 v[136:139], a[204:207], v[232:235], v[136:139]
    s_waitcnt lgkmcnt(1)
    v_sub_f32 v110, v110, v1
    v_sub_f32 v111, v111, v1
    v_mfma_f32_16x16x32_bf16 v[140:143], a[208:211], v[180:183], v[76:79]
    v_sub_f32 v112, v112, v3
    v_sub_f32 v113, v113, v3
    v_mfma_f32_16x16x32_bf16 v[144:147], a[208:211], v[184:187], v[80:83]
    s_waitcnt lgkmcnt(0)
    ds_read_b128 a[216:219], v50 offset:45056
    ds_read_b128 a[220:223], v51 offset:45056
    v_mfma_f32_16x16x32_bf16 v[140:143], a[212:215], v[196:199], v[140:143]
    v_sub_f32 v114, v114, v3
    v_sub_f32 v115, v115, v3
    v_mfma_f32_16x16x32_bf16 v[144:147], a[212:215], v[200:203], v[144:147]
    s_waitcnt lgkmcnt(1)
    v_exp_f32 v84, v84
    v_mfma_f32_16x16x32_bf16 v[140:143], a[216:219], v[212:215], v[140:143]
    v_exp_f32 v85, v85
    v_mfma_f32_16x16x32_bf16 v[144:147], a[216:219], v[216:219], v[144:147]
    s_waitcnt lgkmcnt(0)
    v_exp_f32 v86, v86
    v_mfma_f32_16x16x32_bf16 v[140:143], a[220:223], v[228:231], v[140:143]
    v_exp_f32 v87, v87
    v_mfma_f32_16x16x32_bf16 v[144:147], a[220:223], v[232:235], v[144:147]
    s_waitcnt vmcnt(17)
    s_barrier
    ds_read_b64_tr_b16 a[192:193], v36 offset:0
    ds_read_b64_tr_b16 a[194:195], v36 offset:4096
    v_exp_f32 v92, v92
    v_exp_f32 v93, v93
    v_exp_f32 v94, v94
    v_exp_f32 v95, v95
    v_cvt_pk_bf16_f32 v84, v84, v85
    v_cvt_pk_bf16_f32 v85, v86, v87
    v_cvt_pk_bf16_f32 v86, v92, v93
    v_cvt_pk_bf16_f32 v87, v94, v95
    v_exp_f32 v88, v88
    v_exp_f32 v89, v89
    v_exp_f32 v90, v90
    v_exp_f32 v91, v91
    v_exp_f32 v96, v96
    v_exp_f32 v97, v97
    v_exp_f32 v98, v98
    v_exp_f32 v99, v99
    v_cvt_pk_bf16_f32 v88, v88, v89
    v_cvt_pk_bf16_f32 v89, v90, v91
    v_cvt_pk_bf16_f32 v90, v96, v97
    v_cvt_pk_bf16_f32 v91, v98, v99
    v_rcp_f32 v17, v68
    v_rcp_f32 v18, v72
    v_mfma_f32_16x16x32_bf16 v[68:71], a[224:227], v[84:87], 0
    ds_read_b64_tr_b16 a[196:197], v37 offset:0
    ds_read_b64_tr_b16 a[198:199], v37 offset:4096
    v_mfma_f32_16x16x32_bf16 v[72:75], a[224:227], v[88:91], 0
    s_waitcnt lgkmcnt(2)
    v_exp_f32 v100, v100
    v_mfma_f32_16x16x32_bf16 v[148:151], a[192:195], v[84:87], 0
    ds_read_b64_tr_b16 a[200:201], v38 offset:0
    ds_read_b64_tr_b16 a[202:203], v38 offset:4096
    v_mfma_f32_16x16x32_bf16 v[152:155], a[192:195], v[88:91], 0
    s_waitcnt lgkmcnt(2)
    v_exp_f32 v101, v101
    v_mfma_f32_16x16x32_bf16 v[188:191], a[196:199], v[84:87], 0
    ds_read_b64_tr_b16 a[204:205], v39 offset:0
    ds_read_b64_tr_b16 a[206:207], v39 offset:4096
    v_mfma_f32_16x16x32_bf16 v[192:195], a[196:199], v[88:91], 0
    s_waitcnt lgkmcnt(2)
    v_exp_f32 v102, v102
    v_mfma_f32_16x16x32_bf16 v[156:159], a[200:203], v[84:87], 0
    ds_read_b64_tr_b16 a[208:209], v40 offset:0
    ds_read_b64_tr_b16 a[210:211], v40 offset:4096
    v_mfma_f32_16x16x32_bf16 v[160:163], a[200:203], v[88:91], 0
    s_waitcnt lgkmcnt(2)
    v_exp_f32 v103, v103
    v_mfma_f32_16x16x32_bf16 v[204:207], a[204:207], v[84:87], 0
    ds_read_b64_tr_b16 a[212:213], v41 offset:0
    ds_read_b64_tr_b16 a[214:215], v41 offset:4096
    v_mfma_f32_16x16x32_bf16 v[208:211], a[204:207], v[88:91], 0
    s_waitcnt lgkmcnt(2)
    v_exp_f32 v108, v108
    v_mfma_f32_16x16x32_bf16 v[164:167], a[208:211], v[84:87], 0
    ds_read_b64_tr_b16 a[216:217], v42 offset:0
    ds_read_b64_tr_b16 a[218:219], v42 offset:4096
    v_mfma_f32_16x16x32_bf16 v[168:171], a[208:211], v[88:91], 0
    s_waitcnt lgkmcnt(2)
    v_exp_f32 v109, v109
    v_mfma_f32_16x16x32_bf16 v[220:223], a[212:215], v[84:87], 0
    ds_read_b64_tr_b16 a[220:221], v43 offset:0
    ds_read_b64_tr_b16 a[222:223], v43 offset:4096
    v_mfma_f32_16x16x32_bf16 v[224:227], a[212:215], v[88:91], 0
    s_waitcnt lgkmcnt(2)
    v_exp_f32 v110, v110
    v_mfma_f32_16x16x32_bf16 v[172:175], a[216:219], v[84:87], 0
    v_exp_f32 v111, v111
    v_mfma_f32_16x16x32_bf16 v[176:179], a[216:219], v[88:91], 0
    s_waitcnt lgkmcnt(0)
    v_cvt_pk_bf16_f32 v100, v100, v101
    v_cvt_pk_bf16_f32 v101, v102, v103
    v_mfma_f32_16x16x32_bf16 v[236:239], a[220:223], v[84:87], 0
    ds_read_b64_tr_b16 a[192:193], v36 offset:8192
    ds_read_b64_tr_b16 a[194:195], v36 offset:12288
    v_mfma_f32_16x16x32_bf16 v[240:243], a[220:223], v[88:91], 0
    v_cvt_pk_bf16_f32 v102, v108, v109
    v_cvt_pk_bf16_f32 v103, v110, v111
    v_exp_f32 v104, v104
    v_exp_f32 v105, v105
    v_exp_f32 v106, v106
    v_exp_f32 v107, v107
    v_exp_f32 v112, v112
    v_exp_f32 v113, v113
    v_exp_f32 v114, v114
    v_exp_f32 v115, v115
    v_cvt_pk_bf16_f32 v104, v104, v105
    v_cvt_pk_bf16_f32 v105, v106, v107
    v_cvt_pk_bf16_f32 v106, v112, v113
    v_cvt_pk_bf16_f32 v107, v114, v115
    v_mfma_f32_16x16x32_bf16 v[68:71], a[224:227], v[100:103], v[68:71]
    ds_read_b64_tr_b16 a[196:197], v37 offset:8192
    ds_read_b64_tr_b16 a[198:199], v37 offset:12288
    v_mfma_f32_16x16x32_bf16 v[72:75], a[224:227], v[104:107], v[72:75]
    s_waitcnt lgkmcnt(2)
    v_max3_f32 v19, v116, v117, v118
    v_max3_f32 v19, v19, v119, v120
    v_mfma_f32_16x16x32_bf16 v[148:151], a[192:195], v[100:103], v[148:151]
    ds_read_b64_tr_b16 a[200:201], v38 offset:8192
    ds_read_b64_tr_b16 a[202:203], v38 offset:12288
    v_mfma_f32_16x16x32_bf16 v[152:155], a[192:195], v[104:107], v[152:155]
    s_waitcnt lgkmcnt(2)
    v_max3_f32 v19, v19, v121, v122
    v_max3_f32 v19, v19, v123, v124
    v_mfma_f32_16x16x32_bf16 v[188:191], a[196:199], v[100:103], v[188:191]
    ds_read_b64_tr_b16 a[204:205], v39 offset:8192
    ds_read_b64_tr_b16 a[206:207], v39 offset:12288
    v_mfma_f32_16x16x32_bf16 v[192:195], a[196:199], v[104:107], v[192:195]
    s_waitcnt lgkmcnt(2)
    v_max3_f32 v19, v19, v125, v126
    v_max3_f32 v19, v19, v127, v128
    v_mfma_f32_16x16x32_bf16 v[156:159], a[200:203], v[100:103], v[156:159]
    ds_read_b64_tr_b16 a[208:209], v40 offset:8192
    ds_read_b64_tr_b16 a[210:211], v40 offset:12288
    v_mfma_f32_16x16x32_bf16 v[160:163], a[200:203], v[104:107], v[160:163]
    s_waitcnt lgkmcnt(2)
    v_max3_f32 v19, v19, v129, v130
    v_max3_f32 v19, v19, v131, v132
    v_mfma_f32_16x16x32_bf16 v[204:207], a[204:207], v[100:103], v[204:207]
    ds_read_b64_tr_b16 a[212:213], v41 offset:8192
    ds_read_b64_tr_b16 a[214:215], v41 offset:12288
    v_mfma_f32_16x16x32_bf16 v[208:211], a[204:207], v[104:107], v[208:211]
    s_waitcnt lgkmcnt(2)
    v_max3_f32 v19, v19, v133, v134
    v_max3_f32 v19, v19, v135, v136
    v_mfma_f32_16x16x32_bf16 v[164:167], a[208:211], v[100:103], v[164:167]
    ds_read_b64_tr_b16 a[216:217], v42 offset:8192
    ds_read_b64_tr_b16 a[218:219], v42 offset:12288
    v_mfma_f32_16x16x32_bf16 v[168:171], a[208:211], v[104:107], v[168:171]
    s_waitcnt lgkmcnt(2)
    v_max3_f32 v19, v19, v137, v138
    v_max3_f32 v19, v19, v139, v140
    v_mfma_f32_16x16x32_bf16 v[220:223], a[212:215], v[100:103], v[220:223]
    ds_read_b64_tr_b16 a[220:221], v43 offset:8192
    ds_read_b64_tr_b16 a[222:223], v43 offset:12288
    v_mfma_f32_16x16x32_bf16 v[224:227], a[212:215], v[104:107], v[224:227]
    s_waitcnt lgkmcnt(2)
    v_max3_f32 v19, v19, v141, v142
    v_max3_f32 v19, v19, v143, v144
    v_mfma_f32_16x16x32_bf16 v[172:175], a[216:219], v[100:103], v[172:175]
    s_waitcnt vmcnt(12)
    s_barrier
    ds_read_b128 a[192:195], v44 offset:49152
    ds_read_b128 a[196:199], v45 offset:49152
    v_mfma_f32_16x16x32_bf16 v[176:179], a[216:219], v[104:107], v[176:179]
    s_waitcnt lgkmcnt(2)
    v_max3_f32 v19, v19, v145, v146
    v_max_f32 v19, v19, v147
    v_mfma_f32_16x16x32_bf16 v[236:239], a[220:223], v[100:103], v[236:239]
    s_add_u32 s42, s51, 1
    v_cmp_lt_f32 vcc, s47, v19
    v_accvgpr_read_b32 v244, a128
    v_mfma_f32_16x16x32_bf16 v[240:243], a[220:223], v[104:107], v[240:243]
    s_cbranch_vccnz w2_t9_slow
w2_t9_back:
    s_waitcnt lgkmcnt(1)
    v_exp_f32 v116, v116
    v_accvgpr_read_b32 v245, a129
    v_accvgpr_read_b32 v246, a130
    v_accvgpr_read_b32 v247, a131
    v_accvgpr_read_b32 v248, a136
    v_accvgpr_read_b32 v249, a137
    v_accvgpr_read_b32 v250, a138
    v_accvgpr_read_b32 v251, a139
    v_mul_f32 v244, v17, v244
    v_mul_f32 v245, v17, v245
    v_mul_f32 v246, v17, v246
    v_mul_f32 v247, v17, v247
    v_mul_f32 v248, v17, v248
    v_mul_f32 v249, v17, v249
    v_mul_f32 v250, v17, v250
    v_mul_f32 v251, v17, v251
    v_cvt_pk_bf16_f32 v244, v244, v245
    v_cvt_pk_bf16_f32 v245, v246, v247
    v_cvt_pk_bf16_f32 v246, v248, v249
    v_cvt_pk_bf16_f32 v247, v250, v251
    v_accvgpr_write_b32 a0, v244
    v_accvgpr_write_b32 a1, v245
    v_accvgpr_write_b32 a2, v246
    v_accvgpr_write_b32 a3, v247
    v_mfma_f32_16x16x32_bf16 v[84:87], a[192:195], v[180:183], v[76:79]
    s_lshl_b32 s42, s42, 6
    ds_read_b128 a[200:203], v46 offset:49152
    ds_read_b128 a[204:207], v47 offset:49152
    v_mfma_f32_16x16x32_bf16 v[88:91], a[192:195], v[184:187], v[80:83]
    s_waitcnt lgkmcnt(2)
    v_add_u32 v8, s42, v60
    v_and_b32 v8, 0xff, v8
    v_mfma_f32_16x16x32_bf16 v[84:87], a[196:199], v[196:199], v[84:87]
    v_and_b32 v9, 0x300, v60
    v_lshl_add_u32 v8, v9, 2, v8
    v_mfma_f32_16x16x32_bf16 v[88:91], a[196:199], v[200:203], v[88:91]
    s_waitcnt lgkmcnt(1)
    v_add_u32 v62, 0, v8
    v_add_u32 v64, 6144, v8
    v_mfma_f32_16x16x32_bf16 v[84:87], a[200:203], v[212:215], v[84:87]
    ds_read_b128 a[208:211], v44 offset:53248
    ds_read_b128 a[212:215], v45 offset:53248
    v_mfma_f32_16x16x32_bf16 v[88:91], a[200:203], v[216:219], v[88:91]
    s_waitcnt lgkmcnt(2)
    v_add_u32 v8, s42, v61
    v_and_b32 v8, 0xff, v8
    v_mfma_f32_16x16x32_bf16 v[84:87], a[204:207], v[228:231], v[84:87]
    v_and_b32 v9, 0x300, v61
    v_lshl_add_u32 v8, v9, 2, v8
    v_mfma_f32_16x16x32_bf16 v[88:91], a[204:207], v[232:235], v[88:91]
    s_waitcnt lgkmcnt(1)
    v_add_u32 v63, 3072, v8
    v_add_u32 v65, 9216, v8
    v_mfma_f32_16x16x32_bf16 v[92:95], a[208:211], v[180:183], v[76:79]
    s_add_u32 m0, s37, 81920
    ds_read_b128 a[216:219], v46 offset:53248
    ds_read_b128 a[220:223], v47 offset:53248
    v_mfma_f32_16x16x32_bf16 v[96:99], a[208:211], v[184:187], v[80:83]
    s_waitcnt lgkmcnt(2)
    v_exp_f32 v117, v117
    v_mfma_f32_16x16x32_bf16 v[92:95], a[212:215], v[196:199], v[92:95]
    s_add_u32 s42, s80, 0
    buffer_load_dwordx4 v62, s[20:23], s42 offen offset:0  lds
    v_mfma_f32_16x16x32_bf16 v[96:99], a[212:215], v[200:203], v[96:99]
    s_waitcnt lgkmcnt(1)
    buffer_load_dwordx4 v63, s[20:23], s42 offen offset:1024  lds
    v_mfma_f32_16x16x32_bf16 v[92:95], a[216:219], v[212:215], v[92:95]
    ds_read_b128 a[192:195], v44 offset:57344
    ds_read_b128 a[196:199], v45 offset:57344
    v_mfma_f32_16x16x32_bf16 v[96:99], a[216:219], v[216:219], v[96:99]
    s_waitcnt lgkmcnt(2)
    buffer_load_dwordx4 v64, s[20:23], s42 offen offset:2048  lds
    v_mfma_f32_16x16x32_bf16 v[92:95], a[220:223], v[228:231], v[92:95]
    buffer_load_dwordx4 v65, s[20:23], s42 offen offset:3072  lds
    v_mfma_f32_16x16x32_bf16 v[96:99], a[220:223], v[232:235], v[96:99]
    s_waitcnt lgkmcnt(1)
    v_exp_f32 v118, v118
    v_mfma_f32_16x16x32_bf16 v[100:103], a[192:195], v[180:183], v[76:79]
    s_add_u32 m0, s37, 0
    ds_read_b128 a[200:203], v46 offset:57344
    ds_read_b128 a[204:207], v47 offset:57344
    v_mfma_f32_16x16x32_bf16 v[104:107], a[192:195], v[184:187], v[80:83]
    s_waitcnt lgkmcnt(2)
    v_exp_f32 v119, v119
    v_mfma_f32_16x16x32_bf16 v[100:103], a[196:199], v[196:199], v[100:103]
    s_add_u32 s42, s39, 196608
    buffer_load_dwordx4 v56, s[8:11], s42 offen offset:0 nt lds
    v_mfma_f32_16x16x32_bf16 v[104:107], a[196:199], v[200:203], v[104:107]
    s_waitcnt lgkmcnt(1)
    buffer_load_dwordx4 v57, s[8:11], s42 offen offset:1024 nt lds
    v_mfma_f32_16x16x32_bf16 v[100:103], a[200:203], v[212:215], v[100:103]
    ds_read_b128 a[208:211], v44 offset:61440
    ds_read_b128 a[212:215], v45 offset:61440
    v_mfma_f32_16x16x32_bf16 v[104:107], a[200:203], v[216:219], v[104:107]
    s_waitcnt lgkmcnt(2)
    buffer_load_dwordx4 v58, s[8:11], s42 offen offset:2048 nt lds
    v_mfma_f32_16x16x32_bf16 v[100:103], a[204:207], v[228:231], v[100:103]
    buffer_load_dwordx4 v59, s[8:11], s42 offen offset:3072 nt lds
    v_mfma_f32_16x16x32_bf16 v[104:107], a[204:207], v[232:235], v[104:107]
    s_waitcnt lgkmcnt(1)
    v_exp_f32 v124, v124
    v_mfma_f32_16x16x32_bf16 v[108:111], a[208:211], v[180:183], v[76:79]
    ds_read_b128 a[216:219], v46 offset:61440
    ds_read_b128 a[220:223], v47 offset:61440
    v_mfma_f32_16x16x32_bf16 v[112:115], a[208:211], v[184:187], v[80:83]
    s_waitcnt lgkmcnt(2)
    v_exp_f32 v125, v125
    v_mfma_f32_16x16x32_bf16 v[108:111], a[212:215], v[196:199], v[108:111]
    v_exp_f32 v126, v126
    v_mfma_f32_16x16x32_bf16 v[112:115], a[212:215], v[200:203], v[112:115]
    s_waitcnt lgkmcnt(1)
    v_exp_f32 v127, v127
    v_mfma_f32_16x16x32_bf16 v[108:111], a[216:219], v[212:215], v[108:111]
    v_cvt_pk_bf16_f32 v116, v116, v117
    v_cvt_pk_bf16_f32 v117, v118, v119
    v_mfma_f32_16x16x32_bf16 v[112:115], a[216:219], v[216:219], v[112:115]
    s_waitcnt lgkmcnt(0)
    v_cvt_pk_bf16_f32 v118, v124, v125
    v_cvt_pk_bf16_f32 v119, v126, v127
    v_mfma_f32_16x16x32_bf16 v[108:111], a[220:223], v[228:231], v[108:111]
    s_waitcnt vmcnt(16)
    s_barrier
    ds_read_b64_tr_b16 a[192:193], v36 offset:16384
    ds_read_b64_tr_b16 a[194:195], v36 offset:20480
    v_mfma_f32_16x16x32_bf16 v[112:115], a[220:223], v[232:235], v[112:115]
    s_add_u32 m0, s37, 32768
    v_exp_f32 v120, v120
    v_exp_f32 v121, v121
    v_exp_f32 v122, v122
    v_exp_f32 v123, v123
    v_exp_f32 v128, v128
    v_exp_f32 v129, v129
    v_exp_f32 v130, v130
    v_exp_f32 v131, v131
    v_cvt_pk_bf16_f32 v120, v120, v121
    v_cvt_pk_bf16_f32 v121, v122, v123
    v_cvt_pk_bf16_f32 v122, v128, v129
    v_cvt_pk_bf16_f32 v123, v130, v131
    v_accvgpr_read_b32 v244, a132
    v_accvgpr_read_b32 v245, a133
    v_accvgpr_read_b32 v246, a134
    v_accvgpr_read_b32 v247, a135
    v_accvgpr_read_b32 v248, a140
    v_accvgpr_read_b32 v249, a141
    v_accvgpr_read_b32 v250, a142
    v_accvgpr_read_b32 v251, a143
    v_mul_f32 v244, v18, v244
    v_mul_f32 v245, v18, v245
    v_mul_f32 v246, v18, v246
    v_mul_f32 v247, v18, v247
    v_mul_f32 v248, v18, v248
    v_mul_f32 v249, v18, v249
    v_mul_f32 v250, v18, v250
    v_mul_f32 v251, v18, v251
    v_cvt_pk_bf16_f32 v244, v244, v245
    v_cvt_pk_bf16_f32 v245, v246, v247
    v_cvt_pk_bf16_f32 v246, v248, v249
    v_cvt_pk_bf16_f32 v247, v250, v251
    v_accvgpr_write_b32 a4, v244
    v_accvgpr_write_b32 a5, v245
    v_accvgpr_write_b32 a6, v246
    v_accvgpr_write_b32 a7, v247
    v_mfma_f32_16x16x32_bf16 v[68:71], a[224:227], v[116:119], v[68:71]
    s_add_u32 s42, s39, 180224
    ds_read_b64_tr_b16 a[196:197], v37 offset:16384
    ds_read_b64_tr_b16 a[198:199], v37 offset:20480
    v_mfma_f32_16x16x32_bf16 v[72:75], a[224:227], v[120:123], v[72:75]
    s_waitcnt lgkmcnt(2)
    buffer_load_dwordx4 v60, s[12:15], s42 offen offset:0 nt lds
    v_mfma_f32_16x16x32_bf16 v[148:151], a[192:195], v[116:119], v[148:151]
    ds_read_b64_tr_b16 a[200:201], v38 offset:16384
    ds_read_b64_tr_b16 a[202:203], v38 offset:20480
    v_mfma_f32_16x16x32_bf16 v[152:155], a[192:195], v[120:123], v[152:155]
    s_waitcnt lgkmcnt(2)
    buffer_load_dwordx4 v61, s[12:15], s42 offen offset:1024 nt lds
    v_mfma_f32_16x16x32_bf16 v[188:191], a[196:199], v[116:119], v[188:191]
    ds_read_b64_tr_b16 a[204:205], v39 offset:16384
    ds_read_b64_tr_b16 a[206:207], v39 offset:20480
    v_mfma_f32_16x16x32_bf16 v[192:195], a[196:199], v[120:123], v[192:195]
    s_waitcnt lgkmcnt(2)
    buffer_load_dwordx4 v60, s[12:15], s42 offen offset:2048 nt lds
    v_mfma_f32_16x16x32_bf16 v[156:159], a[200:203], v[116:119], v[156:159]
    ds_read_b64_tr_b16 a[208:209], v40 offset:16384
    ds_read_b64_tr_b16 a[210:211], v40 offset:20480
    v_mfma_f32_16x16x32_bf16 v[160:163], a[200:203], v[120:123], v[160:163]
    s_waitcnt lgkmcnt(2)
    buffer_load_dwordx4 v61, s[12:15], s42 offen offset:3072 nt lds
    v_mfma_f32_16x16x32_bf16 v[204:207], a[204:207], v[116:119], v[204:207]
    ds_read_b64_tr_b16 a[212:213], v41 offset:16384
    ds_read_b64_tr_b16 a[214:215], v41 offset:20480
    v_mfma_f32_16x16x32_bf16 v[208:211], a[204:207], v[120:123], v[208:211]
    s_waitcnt lgkmcnt(2)
    v_exp_f32 v132, v132
    v_mfma_f32_16x16x32_bf16 v[164:167], a[208:211], v[116:119], v[164:167]
    ds_read_b64_tr_b16 a[216:217], v42 offset:16384
    ds_read_b64_tr_b16 a[218:219], v42 offset:20480
    v_mfma_f32_16x16x32_bf16 v[168:171], a[208:211], v[120:123], v[168:171]
    s_waitcnt lgkmcnt(2)
    v_exp_f32 v133, v133
    v_mfma_f32_16x16x32_bf16 v[220:223], a[212:215], v[116:119], v[220:223]
    ds_read_b64_tr_b16 a[220:221], v43 offset:16384
    ds_read_b64_tr_b16 a[222:223], v43 offset:20480
    v_mfma_f32_16x16x32_bf16 v[224:227], a[212:215], v[120:123], v[224:227]
    s_waitcnt lgkmcnt(2)
    v_exp_f32 v134, v134
    v_mfma_f32_16x16x32_bf16 v[172:175], a[216:219], v[116:119], v[172:175]
    v_exp_f32 v135, v135
    v_mfma_f32_16x16x32_bf16 v[176:179], a[216:219], v[120:123], v[176:179]
    s_waitcnt lgkmcnt(0)
    v_exp_f32 v140, v140
    v_mfma_f32_16x16x32_bf16 v[236:239], a[220:223], v[116:119], v[236:239]
    ds_read_b64_tr_b16 a[192:193], v36 offset:24576
    ds_read_b64_tr_b16 a[194:195], v36 offset:28672
    v_mfma_f32_16x16x32_bf16 v[240:243], a[220:223], v[120:123], v[240:243]
    v_exp_f32 v141, v141
    v_exp_f32 v142, v142
    v_exp_f32 v143, v143
    v_cvt_pk_bf16_f32 v132, v132, v133
    v_cvt_pk_bf16_f32 v133, v134, v135
    v_cvt_pk_bf16_f32 v134, v140, v141
    v_cvt_pk_bf16_f32 v135, v142, v143
    v_exp_f32 v136, v136
    v_exp_f32 v137, v137
    v_exp_f32 v138, v138
    v_exp_f32 v139, v139
    v_exp_f32 v144, v144
    v_exp_f32 v145, v145
    v_exp_f32 v146, v146
    v_exp_f32 v147, v147
    v_cvt_pk_bf16_f32 v136, v136, v137
    v_cvt_pk_bf16_f32 v137, v138, v139
    v_cvt_pk_bf16_f32 v138, v144, v145
    v_cvt_pk_bf16_f32 v139, v146, v147
    v_mfma_f32_16x16x32_bf16 v[68:71], a[224:227], v[132:135], v[68:71]
    ds_read_b64_tr_b16 a[196:197], v37 offset:24576
    ds_read_b64_tr_b16 a[198:199], v37 offset:28672
    v_mfma_f32_16x16x32_bf16 v[72:75], a[224:227], v[136:139], v[72:75]
    s_waitcnt lgkmcnt(2)
    v_max3_f32 v19, v84, v85, v86
    v_max3_f32 v19, v19, v87, v88
    v_mfma_f32_16x16x32_bf16 v[148:151], a[192:195], v[132:135], v[148:151]
    ds_read_b64_tr_b16 a[200:201], v38 offset:24576
    ds_read_b64_tr_b16 a[202:203], v38 offset:28672
    v_mfma_f32_16x16x32_bf16 v[152:155], a[192:195], v[136:139], v[152:155]
    s_waitcnt lgkmcnt(2)
    v_max3_f32 v19, v19, v89, v90
    v_max3_f32 v19, v19, v91, v92
    v_mfma_f32_16x16x32_bf16 v[188:191], a[196:199], v[132:135], v[188:191]
    ds_read_b64_tr_b16 a[204:205], v39 offset:24576
    ds_read_b64_tr_b16 a[206:207], v39 offset:28672
    v_mfma_f32_16x16x32_bf16 v[192:195], a[196:199], v[136:139], v[192:195]
    s_waitcnt lgkmcnt(2)
    v_max3_f32 v19, v19, v93, v94
    v_max3_f32 v19, v19, v95, v96
    v_mfma_f32_16x16x32_bf16 v[156:159], a[200:203], v[132:135], v[156:159]
    ds_read_b64_tr_b16 a[208:209], v40 offset:24576
    ds_read_b64_tr_b16 a[210:211], v40 offset:28672
    v_mfma_f32_16x16x32_bf16 v[160:163], a[200:203], v[136:139], v[160:163]
    s_waitcnt lgkmcnt(2)
    v_max3_f32 v19, v19, v97, v98
    v_max3_f32 v19, v19, v99, v100
    v_mfma_f32_16x16x32_bf16 v[204:207], a[204:207], v[132:135], v[204:207]
    ds_read_b64_tr_b16 a[212:213], v41 offset:24576
    ds_read_b64_tr_b16 a[214:215], v41 offset:28672
    v_mfma_f32_16x16x32_bf16 v[208:211], a[204:207], v[136:139], v[208:211]
    s_waitcnt lgkmcnt(2)
    v_max3_f32 v19, v19, v101, v102
    v_max3_f32 v19, v19, v103, v104
    v_mfma_f32_16x16x32_bf16 v[164:167], a[208:211], v[132:135], v[164:167]
    ds_read_b64_tr_b16 a[216:217], v42 offset:24576
    ds_read_b64_tr_b16 a[218:219], v42 offset:28672
    v_mfma_f32_16x16x32_bf16 v[168:171], a[208:211], v[136:139], v[168:171]
    s_waitcnt lgkmcnt(2)
    v_max3_f32 v19, v19, v105, v106
    v_max3_f32 v19, v19, v107, v108
    v_mfma_f32_16x16x32_bf16 v[220:223], a[212:215], v[132:135], v[220:223]
    ds_read_b64_tr_b16 a[220:221], v43 offset:24576
    ds_read_b64_tr_b16 a[222:223], v43 offset:28672
    v_mfma_f32_16x16x32_bf16 v[224:227], a[212:215], v[136:139], v[224:227]
    s_waitcnt lgkmcnt(2)
    v_max3_f32 v19, v19, v109, v110
    v_max3_f32 v19, v19, v111, v112
    v_mfma_f32_16x16x32_bf16 v[172:175], a[216:219], v[132:135], v[172:175]
    s_waitcnt vmcnt(16)
    s_barrier
    ds_read_b128 a[192:195], v48 offset:49152
    ds_read_b128 a[196:199], v49 offset:49152
    v_mfma_f32_16x16x32_bf16 v[176:179], a[216:219], v[136:139], v[176:179]
    s_waitcnt lgkmcnt(2)
    v_max3_f32 v19, v19, v113, v114
    v_max_f32 v19, v19, v115
    v_mfma_f32_16x16x32_bf16 v[236:239], a[220:223], v[132:135], v[236:239]
    s_add_u32 m0, s37, 65536
    v_cmp_lt_f32 vcc, s47, v19
    v_accvgpr_read_b32 v244, a144
    v_mfma_f32_16x16x32_bf16 v[240:243], a[220:223], v[136:139], v[240:243]
    s_cbranch_vccnz w2_t10_slow
w2_t10_back:
    s_waitcnt lgkmcnt(1)
    v_exp_f32 v84, v84
    v_accvgpr_read_b32 v245, a145
    v_accvgpr_read_b32 v246, a146
    v_accvgpr_read_b32 v247, a147
    v_accvgpr_read_b32 v248, a152
    v_accvgpr_read_b32 v249, a153
    v_accvgpr_read_b32 v250, a154
    v_accvgpr_read_b32 v251, a155
    v_mul_f32 v244, v17, v244
    v_mul_f32 v245, v17, v245
    v_mul_f32 v246, v17, v246
    v_mul_f32 v247, v17, v247
    v_mul_f32 v248, v17, v248
    v_mul_f32 v249, v17, v249
    v_mul_f32 v250, v17, v250
    v_mul_f32 v251, v17, v251
    v_cvt_pk_bf16_f32 v244, v244, v245
    v_cvt_pk_bf16_f32 v245, v246, v247
    v_cvt_pk_bf16_f32 v246, v248, v249
    v_cvt_pk_bf16_f32 v247, v250, v251
    v_accvgpr_write_b32 a8, v244
    v_accvgpr_write_b32 a9, v245
    v_accvgpr_write_b32 a10, v246
    v_accvgpr_write_b32 a11, v247
    v_mfma_f32_16x16x32_bf16 v[116:119], a[192:195], v[180:183], v[76:79]
    s_add_u32 s42, s80, 65536
    ds_read_b128 a[200:203], v50 offset:49152
    ds_read_b128 a[204:207], v51 offset:49152
    v_mfma_f32_16x16x32_bf16 v[120:123], a[192:195], v[184:187], v[80:83]
    s_waitcnt lgkmcnt(2)
    buffer_load_dwordx4 v62, s[20:23], s42 offen offset:0  lds
    v_mfma_f32_16x16x32_bf16 v[116:119], a[196:199], v[196:199], v[116:119]
    buffer_load_dwordx4 v63, s[20:23], s42 offen offset:1024  lds
    v_mfma_f32_16x16x32_bf16 v[120:123], a[196:199], v[200:203], v[120:123]
    s_waitcnt lgkmcnt(1)
    buffer_load_dwordx4 v64, s[20:23], s42 offen offset:2048  lds
    v_mfma_f32_16x16x32_bf16 v[116:119], a[200:203], v[212:215], v[116:119]
    ds_read_b128 a[208:211], v48 offset:53248
    ds_read_b128 a[212:215], v49 offset:53248
    v_mfma_f32_16x16x32_bf16 v[120:123], a[200:203], v[216:219], v[120:123]
    s_waitcnt lgkmcnt(2)
    buffer_load_dwordx4 v65, s[20:23], s42 offen offset:3072  lds
    v_mfma_f32_16x16x32_bf16 v[116:119], a[204:207], v[228:231], v[116:119]
    s_add_u32 m0, s37, 98304
    v_exp_f32 v85, v85
    v_mfma_f32_16x16x32_bf16 v[120:123], a[204:207], v[232:235], v[120:123]
    s_waitcnt lgkmcnt(1)
    v_exp_f32 v86, v86
    v_mfma_f32_16x16x32_bf16 v[124:127], a[208:211], v[180:183], v[76:79]
    s_add_u32 s42, s39, 212992
    ds_read_b128 a[216:219], v50 offset:53248
    ds_read_b128 a[220:223], v51 offset:53248
    v_mfma_f32_16x16x32_bf16 v[128:131], a[208:211], v[184:187], v[80:83]
    s_waitcnt lgkmcnt(2)
    buffer_load_dwordx4 v56, s[8:11], s42 offen offset:0 nt lds
    v_mfma_f32_16x16x32_bf16 v[124:127], a[212:215], v[196:199], v[124:127]
    buffer_load_dwordx4 v57, s[8:11], s42 offen offset:1024 nt lds
    v_mfma_f32_16x16x32_bf16 v[128:131], a[212:215], v[200:203], v[128:131]
    s_waitcnt lgkmcnt(1)
    buffer_load_dwordx4 v58, s[8:11], s42 offen offset:2048 nt lds
    v_mfma_f32_16x16x32_bf16 v[124:127], a[216:219], v[212:215], v[124:127]
    ds_read_b128 a[192:195], v48 offset:57344
    ds_read_b128 a[196:199], v49 offset:57344
    v_mfma_f32_16x16x32_bf16 v[128:131], a[216:219], v[216:219], v[128:131]
    s_waitcnt lgkmcnt(2)
    buffer_load_dwordx4 v59, s[8:11], s42 offen offset:3072 nt lds
    v_mfma_f32_16x16x32_bf16 v[124:127], a[220:223], v[228:231], v[124:127]
    v_exp_f32 v87, v87
    v_mfma_f32_16x16x32_bf16 v[128:131], a[220:223], v[232:235], v[128:131]
    s_waitcnt lgkmcnt(1)
    v_exp_f32 v92, v92
    v_mfma_f32_16x16x32_bf16 v[132:135], a[192:195], v[180:183], v[76:79]
    ds_read_b128 a[200:203], v50 offset:57344
    ds_read_b128 a[204:207], v51 offset:57344
    v_mfma_f32_16x16x32_bf16 v[136:139], a[192:195], v[184:187], v[80:83]
    s_waitcnt lgkmcnt(2)
    v_exp_f32 v93, v93
    v_mfma_f32_16x16x32_bf16 v[132:135], a[196:199], v[196:199], v[132:135]
    v_exp_f32 v94, v94
    v_mfma_f32_16x16x32_bf16 v[136:139], a[196:199], v[200:203], v[136:139]
    s_waitcnt lgkmcnt(1)
    v_exp_f32 v95, v95
    v_mfma_f32_16x16x32_bf16 v[132:135], a[200:203], v[212:215], v[132:135]
    ds_read_b128 a[208:211], v48 offset:61440
    ds_read_b128 a[212:215], v49 offset:61440
    v_mfma_f32_16x16x32_bf16 v[136:139], a[200:203], v[216:219], v[136:139]
    s_waitcnt lgkmcnt(2)
    v_cvt_pk_bf16_f32 v84, v84, v85
    v_cvt_pk_bf16_f32 v85, v86, v87
    v_mfma_f32_16x16x32_bf16 v[132:135], a[204:207], v[228:231], v[132:135]
    v_cvt_pk_bf16_f32 v86, v92, v93
    v_cvt_pk_bf16_f32 v87, v94, v95
    v_mfma_f32_16x16x32_bf16 v[136:139], a[204:207], v[232:235], v[136:139]
    s_waitcnt lgkmcnt(1)
    v_exp_f32 v88, v88
    v_mfma_f32_16x16x32_bf16 v[140:143], a[208:211], v[180:183], v[76:79]
    ds_read_b128 a[216:219], v50 offset:61440
    ds_read_b128 a[220:223], v51 offset:61440
    v_mfma_f32_16x16x32_bf16 v[144:147], a[208:211], v[184:187], v[80:83]
    s_waitcnt lgkmcnt(2)
    v_exp_f32 v89, v89
    v_mfma_f32_16x16x32_bf16 v[140:143], a[212:215], v[196:199], v[140:143]
    v_exp_f32 v90, v90
    v_mfma_f32_16x16x32_bf16 v[144:147], a[212:215], v[200:203], v[144:147]
    s_waitcnt lgkmcnt(1)
    v_exp_f32 v91, v91
    v_mfma_f32_16x16x32_bf16 v[140:143], a[216:219], v[212:215], v[140:143]
    v_exp_f32 v96, v96
    v_mfma_f32_16x16x32_bf16 v[144:147], a[216:219], v[216:219], v[144:147]
    s_waitcnt lgkmcnt(0)
    v_exp_f32 v97, v97
    v_mfma_f32_16x16x32_bf16 v[140:143], a[220:223], v[228:231], v[140:143]
    s_waitcnt vmcnt(20)
    s_barrier
    ds_read_b64_tr_b16 a[192:193], v20 offset:16384
    ds_read_b64_tr_b16 a[194:195], v20 offset:20480
    v_mfma_f32_16x16x32_bf16 v[144:147], a[220:223], v[232:235], v[144:147]
    s_add_u32 m0, s37, 131072
    v_exp_f32 v98, v98
    v_exp_f32 v99, v99
    v_cvt_pk_bf16_f32 v88, v88, v89
    v_cvt_pk_bf16_f32 v89, v90, v91
    v_cvt_pk_bf16_f32 v90, v96, v97
    v_cvt_pk_bf16_f32 v91, v98, v99
    v_accvgpr_read_b32 v244, a148
    v_accvgpr_read_b32 v245, a149
    v_accvgpr_read_b32 v246, a150
    v_accvgpr_read_b32 v247, a151
    v_accvgpr_read_b32 v248, a156
    v_accvgpr_read_b32 v249, a157
    v_accvgpr_read_b32 v250, a158
    v_accvgpr_read_b32 v251, a159
    v_mul_f32 v244, v18, v244
    v_mul_f32 v245, v18, v245
    v_mul_f32 v246, v18, v246
    v_mul_f32 v247, v18, v247
    v_mul_f32 v248, v18, v248
    v_mul_f32 v249, v18, v249
    v_mul_f32 v250, v18, v250
    v_mul_f32 v251, v18, v251
    v_cvt_pk_bf16_f32 v244, v244, v245
    v_cvt_pk_bf16_f32 v245, v246, v247
    v_cvt_pk_bf16_f32 v246, v248, v249
    v_cvt_pk_bf16_f32 v247, v250, v251
    v_accvgpr_write_b32 a12, v244
    v_accvgpr_write_b32 a13, v245
    v_accvgpr_write_b32 a14, v246
    v_accvgpr_write_b32 a15, v247
    v_mfma_f32_16x16x32_bf16 v[68:71], a[224:227], v[84:87], v[68:71]
    s_add_u32 s42, s39, 196608
    ds_read_b64_tr_b16 a[196:197], v21 offset:16384
    ds_read_b64_tr_b16 a[198:199], v21 offset:20480
    v_mfma_f32_16x16x32_bf16 v[72:75], a[224:227], v[88:91], v[72:75]
    s_waitcnt lgkmcnt(2)
    buffer_load_dwordx4 v60, s[12:15], s42 offen offset:0 nt lds
    v_mfma_f32_16x16x32_bf16 v[148:151], a[192:195], v[84:87], v[148:151]
    ds_read_b64_tr_b16 a[200:201], v22 offset:16384
    ds_read_b64_tr_b16 a[202:203], v22 offset:20480
    v_mfma_f32_16x16x32_bf16 v[152:155], a[192:195], v[88:91], v[152:155]
    s_waitcnt lgkmcnt(2)
    buffer_load_dwordx4 v61, s[12:15], s42 offen offset:1024 nt lds
    v_mfma_f32_16x16x32_bf16 v[188:191], a[196:199], v[84:87], v[188:191]
    ds_read_b64_tr_b16 a[204:205], v23 offset:16384
    ds_read_b64_tr_b16 a[206:207], v23 offset:20480
    v_mfma_f32_16x16x32_bf16 v[192:195], a[196:199], v[88:91], v[192:195]
    s_waitcnt lgkmcnt(2)
    buffer_load_dwordx4 v60, s[12:15], s42 offen offset:2048 nt lds
    v_mfma_f32_16x16x32_bf16 v[156:159], a[200:203], v[84:87], v[156:159]
    ds_read_b64_tr_b16 a[208:209], v24 offset:16384
    ds_read_b64_tr_b16 a[210:211], v24 offset:20480
    v_mfma_f32_16x16x32_bf16 v[160:163], a[200:203], v[88:91], v[160:163]
    s_waitcnt lgkmcnt(2)
    buffer_load_dwordx4 v61, s[12:15], s42 offen offset:3072 nt lds
    v_mfma_f32_16x16x32_bf16 v[204:207], a[204:207], v[84:87], v[204:207]
    ds_read_b64_tr_b16 a[212:213], v25 offset:16384
    ds_read_b64_tr_b16 a[214:215], v25 offset:20480
    v_mfma_f32_16x16x32_bf16 v[208:211], a[204:207], v[88:91], v[208:211]
    s_waitcnt lgkmcnt(2)
    v_exp_f32 v100, v100
    v_mfma_f32_16x16x32_bf16 v[164:167], a[208:211], v[84:87], v[164:167]
    ds_read_b64_tr_b16 a[216:217], v26 offset:16384
    ds_read_b64_tr_b16 a[218:219], v26 offset:20480
    v_mfma_f32_16x16x32_bf16 v[168:171], a[208:211], v[88:91], v[168:171]
    s_waitcnt lgkmcnt(2)
    v_exp_f32 v101, v101
    v_mfma_f32_16x16x32_bf16 v[220:223], a[212:215], v[84:87], v[220:223]
    ds_read_b64_tr_b16 a[220:221], v27 offset:16384
    ds_read_b64_tr_b16 a[222:223], v27 offset:20480
    v_mfma_f32_16x16x32_bf16 v[224:227], a[212:215], v[88:91], v[224:227]
    s_waitcnt lgkmcnt(2)
    v_exp_f32 v102, v102
    v_mfma_f32_16x16x32_bf16 v[172:175], a[216:219], v[84:87], v[172:175]
    v_exp_f32 v103, v103
    v_mfma_f32_16x16x32_bf16 v[176:179], a[216:219], v[88:91], v[176:179]
    s_waitcnt lgkmcnt(0)
    v_exp_f32 v108, v108
    v_mfma_f32_16x16x32_bf16 v[236:239], a[220:223], v[84:87], v[236:239]
    ds_read_b64_tr_b16 a[192:193], v20 offset:24576
    ds_read_b64_tr_b16 a[194:195], v20 offset:28672
    v_mfma_f32_16x16x32_bf16 v[240:243], a[220:223], v[88:91], v[240:243]
    v_exp_f32 v109, v109
    v_exp_f32 v110, v110
    v_exp_f32 v111, v111
    v_cvt_pk_bf16_f32 v100, v100, v101
    v_cvt_pk_bf16_f32 v101, v102, v103
    v_cvt_pk_bf16_f32 v102, v108, v109
    v_cvt_pk_bf16_f32 v103, v110, v111
    v_exp_f32 v104, v104
    v_exp_f32 v105, v105
    v_exp_f32 v106, v106
    v_exp_f32 v107, v107
    v_exp_f32 v112, v112
    v_exp_f32 v113, v113
    v_exp_f32 v114, v114
    v_exp_f32 v115, v115
    v_cvt_pk_bf16_f32 v104, v104, v105
    v_cvt_pk_bf16_f32 v105, v106, v107
    v_cvt_pk_bf16_f32 v106, v112, v113
    v_cvt_pk_bf16_f32 v107, v114, v115
    v_mfma_f32_16x16x32_bf16 v[68:71], a[224:227], v[100:103], v[68:71]
    ds_read_b64_tr_b16 a[196:197], v21 offset:24576
    ds_read_b64_tr_b16 a[198:199], v21 offset:28672
    v_mfma_f32_16x16x32_bf16 v[72:75], a[224:227], v[104:107], v[72:75]
    s_waitcnt lgkmcnt(2)
    v_max3_f32 v19, v116, v117, v118
    v_max3_f32 v19, v19, v119, v120
    v_mfma_f32_16x16x32_bf16 v[148:151], a[192:195], v[100:103], v[148:151]
    ds_read_b64_tr_b16 a[200:201], v22 offset:24576
    ds_read_b64_tr_b16 a[202:203], v22 offset:28672
    v_mfma_f32_16x16x32_bf16 v[152:155], a[192:195], v[104:107], v[152:155]
    s_waitcnt lgkmcnt(2)
    v_max3_f32 v19, v19, v121, v122
    v_max3_f32 v19, v19, v123, v124
    v_mfma_f32_16x16x32_bf16 v[188:191], a[196:199], v[100:103], v[188:191]
    ds_read_b64_tr_b16 a[204:205], v23 offset:24576
    ds_read_b64_tr_b16 a[206:207], v23 offset:28672
    v_mfma_f32_16x16x32_bf16 v[192:195], a[196:199], v[104:107], v[192:195]
    s_waitcnt lgkmcnt(2)
    v_max3_f32 v19, v19, v125, v126
    v_max3_f32 v19, v19, v127, v128
    v_mfma_f32_16x16x32_bf16 v[156:159], a[200:203], v[100:103], v[156:159]
    ds_read_b64_tr_b16 a[208:209], v24 offset:24576
    ds_read_b64_tr_b16 a[210:211], v24 offset:28672
    v_mfma_f32_16x16x32_bf16 v[160:163], a[200:203], v[104:107], v[160:163]
    s_waitcnt lgkmcnt(2)
    v_max3_f32 v19, v19, v129, v130
    v_max3_f32 v19, v19, v131, v132
    v_mfma_f32_16x16x32_bf16 v[204:207], a[204:207], v[100:103], v[204:207]
    ds_read_b64_tr_b16 a[212:213], v25 offset:24576
    ds_read_b64_tr_b16 a[214:215], v25 offset:28672
    v_mfma_f32_16x16x32_bf16 v[208:211], a[204:207], v[104:107], v[208:211]
    s_waitcnt lgkmcnt(2)
    v_max3_f32 v19, v19, v133, v134
    v_max3_f32 v19, v19, v135, v136
    v_mfma_f32_16x16x32_bf16 v[164:167], a[208:211], v[100:103], v[164:167]
    ds_read_b64_tr_b16 a[216:217], v26 offset:24576
    ds_read_b64_tr_b16 a[218:219], v26 offset:28672
    v_mfma_f32_16x16x32_bf16 v[168:171], a[208:211], v[104:107], v[168:171]
    s_waitcnt lgkmcnt(2)
    v_max3_f32 v19, v19, v137, v138
    v_max3_f32 v19, v19, v139, v140
    v_mfma_f32_16x16x32_bf16 v[220:223], a[212:215], v[100:103], v[220:223]
    ds_read_b64_tr_b16 a[220:221], v27 offset:24576
    ds_read_b64_tr_b16 a[222:223], v27 offset:28672
    v_mfma_f32_16x16x32_bf16 v[224:227], a[212:215], v[104:107], v[224:227]
    s_waitcnt lgkmcnt(2)
    v_max3_f32 v19, v19, v141, v142
    v_max3_f32 v19, v19, v143, v144
    v_mfma_f32_16x16x32_bf16 v[172:175], a[216:219], v[100:103], v[172:175]
    s_waitcnt vmcnt(16)
    s_barrier
    ds_read_b128 a[192:195], v44 offset:0
    ds_read_b128 a[196:199], v45 offset:0
    v_mfma_f32_16x16x32_bf16 v[176:179], a[216:219], v[104:107], v[176:179]
    s_waitcnt lgkmcnt(2)
    v_max3_f32 v19, v19, v145, v146
    v_max_f32 v19, v19, v147
    v_mfma_f32_16x16x32_bf16 v[236:239], a[220:223], v[100:103], v[236:239]
    s_add_u32 m0, s37, 49152
    v_cmp_lt_f32 vcc, s47, v19
    v_accvgpr_read_b32 v244, a160
    v_mfma_f32_16x16x32_bf16 v[240:243], a[220:223], v[104:107], v[240:243]
    s_cbranch_vccnz w2_t11_slow
w2_t11_back:
    s_waitcnt lgkmcnt(1)
    v_exp_f32 v116, v116
    v_accvgpr_read_b32 v245, a161
    v_accvgpr_read_b32 v246, a162
    v_accvgpr_read_b32 v247, a163
    v_accvgpr_read_b32 v248, a168
    v_accvgpr_read_b32 v249, a169
    v_accvgpr_read_b32 v250, a170
    v_accvgpr_read_b32 v251, a171
    v_mul_f32 v244, v17, v244
    v_mul_f32 v245, v17, v245
    v_mul_f32 v246, v17, v246
    v_mul_f32 v247, v17, v247
    v_mul_f32 v248, v17, v248
    v_mul_f32 v249, v17, v249
    v_mul_f32 v250, v17, v250
    v_mul_f32 v251, v17, v251
    v_cvt_pk_bf16_f32 v244, v244, v245
    v_cvt_pk_bf16_f32 v245, v246, v247
    v_cvt_pk_bf16_f32 v246, v248, v249
    v_cvt_pk_bf16_f32 v247, v250, v251
    v_accvgpr_write_b32 a16, v244
    v_accvgpr_write_b32 a17, v245
    v_accvgpr_write_b32 a18, v246
    v_accvgpr_write_b32 a19, v247
    v_mfma_f32_16x16x32_bf16 v[84:87], a[192:195], v[180:183], v[76:79]
    s_add_u32 s42, s80, 131072
    ds_read_b128 a[200:203], v46 offset:0
    ds_read_b128 a[204:207], v47 offset:0
    v_mfma_f32_16x16x32_bf16 v[88:91], a[192:195], v[184:187], v[80:83]
    s_waitcnt lgkmcnt(2)
    buffer_load_dwordx4 v62, s[20:23], s42 offen offset:0  lds
    v_mfma_f32_16x16x32_bf16 v[84:87], a[196:199], v[196:199], v[84:87]
    buffer_load_dwordx4 v63, s[20:23], s42 offen offset:1024  lds
    v_mfma_f32_16x16x32_bf16 v[88:91], a[196:199], v[200:203], v[88:91]
    s_waitcnt lgkmcnt(1)
    buffer_load_dwordx4 v64, s[20:23], s42 offen offset:2048  lds
    v_mfma_f32_16x16x32_bf16 v[84:87], a[200:203], v[212:215], v[84:87]
    ds_read_b128 a[208:211], v44 offset:4096
    ds_read_b128 a[212:215], v45 offset:4096
    v_mfma_f32_16x16x32_bf16 v[88:91], a[200:203], v[216:219], v[88:91]
    s_waitcnt lgkmcnt(2)
    buffer_load_dwordx4 v65, s[20:23], s42 offen offset:3072  lds
    v_mfma_f32_16x16x32_bf16 v[84:87], a[204:207], v[228:231], v[84:87]
    s_add_u32 m0, s37, 147456
    v_exp_f32 v117, v117
    v_mfma_f32_16x16x32_bf16 v[88:91], a[204:207], v[232:235], v[88:91]
    s_waitcnt lgkmcnt(1)
    v_exp_f32 v118, v118
    v_mfma_f32_16x16x32_bf16 v[92:95], a[208:211], v[180:183], v[76:79]
    s_add_u32 s42, s39, 229376
    ds_read_b128 a[216:219], v46 offset:4096
    ds_read_b128 a[220:223], v47 offset:4096
    v_mfma_f32_16x16x32_bf16 v[96:99], a[208:211], v[184:187], v[80:83]
    s_waitcnt lgkmcnt(2)
    buffer_load_dwordx4 v56, s[8:11], s42 offen offset:0 nt lds
    v_mfma_f32_16x16x32_bf16 v[92:95], a[212:215], v[196:199], v[92:95]
    buffer_load_dwordx4 v57, s[8:11], s42 offen offset:1024 nt lds
    v_mfma_f32_16x16x32_bf16 v[96:99], a[212:215], v[200:203], v[96:99]
    s_waitcnt lgkmcnt(1)
    buffer_load_dwordx4 v58, s[8:11], s42 offen offset:2048 nt lds
    v_mfma_f32_16x16x32_bf16 v[92:95], a[216:219], v[212:215], v[92:95]
    ds_read_b128 a[192:195], v44 offset:8192
    ds_read_b128 a[196:199], v45 offset:8192
    v_mfma_f32_16x16x32_bf16 v[96:99], a[216:219], v[216:219], v[96:99]
    s_waitcnt lgkmcnt(2)
    buffer_load_dwordx4 v59, s[8:11], s42 offen offset:3072 nt lds
    v_mfma_f32_16x16x32_bf16 v[92:95], a[220:223], v[228:231], v[92:95]
    v_exp_f32 v119, v119
    v_mfma_f32_16x16x32_bf16 v[96:99], a[220:223], v[232:235], v[96:99]
    s_waitcnt lgkmcnt(1)
    v_exp_f32 v124, v124
    v_mfma_f32_16x16x32_bf16 v[100:103], a[192:195], v[180:183], v[76:79]
    ds_read_b128 a[200:203], v46 offset:8192
    ds_read_b128 a[204:207], v47 offset:8192
    v_mfma_f32_16x16x32_bf16 v[104:107], a[192:195], v[184:187], v[80:83]
    s_waitcnt lgkmcnt(2)
    v_exp_f32 v125, v125
    v_mfma_f32_16x16x32_bf16 v[100:103], a[196:199], v[196:199], v[100:103]
    v_exp_f32 v126, v126
    v_mfma_f32_16x16x32_bf16 v[104:107], a[196:199], v[200:203], v[104:107]
    s_waitcnt lgkmcnt(1)
    v_exp_f32 v127, v127
    v_mfma_f32_16x16x32_bf16 v[100:103], a[200:203], v[212:215], v[100:103]
    ds_read_b128 a[208:211], v44 offset:12288
    ds_read_b128 a[212:215], v45 offset:12288
    v_mfma_f32_16x16x32_bf16 v[104:107], a[200:203], v[216:219], v[104:107]
    s_waitcnt lgkmcnt(2)
    v_cvt_pk_bf16_f32 v116, v116, v117
    v_cvt_pk_bf16_f32 v117, v118, v119
    v_mfma_f32_16x16x32_bf16 v[100:103], a[204:207], v[228:231], v[100:103]
    v_cvt_pk_bf16_f32 v118, v124, v125
    v_cvt_pk_bf16_f32 v119, v126, v127
    v_mfma_f32_16x16x32_bf16 v[104:107], a[204:207], v[232:235], v[104:107]
    s_waitcnt lgkmcnt(1)
    v_exp_f32 v120, v120
    v_mfma_f32_16x16x32_bf16 v[108:111], a[208:211], v[180:183], v[76:79]
    ds_read_b128 a[216:219], v46 offset:12288
    ds_read_b128 a[220:223], v47 offset:12288
    v_mfma_f32_16x16x32_bf16 v[112:115], a[208:211], v[184:187], v[80:83]
    s_waitcnt lgkmcnt(2)
    v_exp_f32 v121, v121
    v_mfma_f32_16x16x32_bf16 v[108:111], a[212:215], v[196:199], v[108:111]
    v_exp_f32 v122, v122
    v_mfma_f32_16x16x32_bf16 v[112:115], a[212:215], v[200:203], v[112:115]
    s_waitcnt lgkmcnt(1)
    v_exp_f32 v123, v123
    v_mfma_f32_16x16x32_bf16 v[108:111], a[216:219], v[212:215], v[108:111]
    v_exp_f32 v128, v128
    v_mfma_f32_16x16x32_bf16 v[112:115], a[216:219], v[216:219], v[112:115]
    s_waitcnt lgkmcnt(0)
    v_exp_f32 v129, v129
    v_mfma_f32_16x16x32_bf16 v[108:111], a[220:223], v[228:231], v[108:111]
    s_waitcnt vmcnt(20)
    s_barrier
    global_load_dword v7, v67, s[88:89]
    ds_read_b64_tr_b16 a[192:193], v20 offset:32768
    ds_read_b64_tr_b16 a[194:195], v20 offset:36864
    v_mfma_f32_16x16x32_bf16 v[112:115], a[220:223], v[232:235], v[112:115]
    v_exp_f32 v130, v130
    v_exp_f32 v131, v131
    v_cvt_pk_bf16_f32 v120, v120, v121
    v_cvt_pk_bf16_f32 v121, v122, v123
    v_cvt_pk_bf16_f32 v122, v128, v129
    v_cvt_pk_bf16_f32 v123, v130, v131
    v_accvgpr_read_b32 v244, a164
    v_accvgpr_read_b32 v245, a165
    v_accvgpr_read_b32 v246, a166
    v_accvgpr_read_b32 v247, a167
    v_accvgpr_read_b32 v248, a172
    v_accvgpr_read_b32 v249, a173
    v_accvgpr_read_b32 v250, a174
    v_accvgpr_read_b32 v251, a175
    v_mul_f32 v244, v18, v244
    v_mul_f32 v245, v18, v245
    v_mul_f32 v246, v18, v246
    v_mul_f32 v247, v18, v247
    v_mul_f32 v248, v18, v248
    v_mul_f32 v249, v18, v249
    v_mul_f32 v250, v18, v250
    v_mul_f32 v251, v18, v251
    v_cvt_pk_bf16_f32 v244, v244, v245
    v_cvt_pk_bf16_f32 v245, v246, v247
    v_cvt_pk_bf16_f32 v246, v248, v249
    v_cvt_pk_bf16_f32 v247, v250, v251
    v_accvgpr_write_b32 a20, v244
    v_accvgpr_write_b32 a21, v245
    v_accvgpr_write_b32 a22, v246
    v_accvgpr_write_b32 a23, v247
    v_mfma_f32_16x16x32_bf16 v[68:71], a[224:227], v[116:119], v[68:71]
    ds_read_b64_tr_b16 a[196:197], v21 offset:32768
    ds_read_b64_tr_b16 a[198:199], v21 offset:36864
    v_mfma_f32_16x16x32_bf16 v[72:75], a[224:227], v[120:123], v[72:75]
    s_waitcnt lgkmcnt(2)
    v_exp_f32 v132, v132
    v_mfma_f32_16x16x32_bf16 v[148:151], a[192:195], v[116:119], v[148:151]
    ds_read_b64_tr_b16 a[200:201], v22 offset:32768
    ds_read_b64_tr_b16 a[202:203], v22 offset:36864
    v_mfma_f32_16x16x32_bf16 v[152:155], a[192:195], v[120:123], v[152:155]
    s_waitcnt lgkmcnt(2)
    v_exp_f32 v133, v133
    v_mfma_f32_16x16x32_bf16 v[188:191], a[196:199], v[116:119], v[188:191]
    ds_read_b64_tr_b16 a[204:205], v23 offset:32768
    ds_read_b64_tr_b16 a[206:207], v23 offset:36864
    v_mfma_f32_16x16x32_bf16 v[192:195], a[196:199], v[120:123], v[192:195]
    s_waitcnt lgkmcnt(2)
    v_exp_f32 v134, v134
    v_mfma_f32_16x16x32_bf16 v[156:159], a[200:203], v[116:119], v[156:159]
    ds_read_b64_tr_b16 a[208:209], v24 offset:32768
    ds_read_b64_tr_b16 a[210:211], v24 offset:36864
    v_mfma_f32_16x16x32_bf16 v[160:163], a[200:203], v[120:123], v[160:163]
    s_waitcnt lgkmcnt(2)
    v_exp_f32 v135, v135
    v_mfma_f32_16x16x32_bf16 v[204:207], a[204:207], v[116:119], v[204:207]
    ds_read_b64_tr_b16 a[212:213], v25 offset:32768
    ds_read_b64_tr_b16 a[214:215], v25 offset:36864
    v_mfma_f32_16x16x32_bf16 v[208:211], a[204:207], v[120:123], v[208:211]
    s_waitcnt lgkmcnt(2)
    v_exp_f32 v140, v140
    v_mfma_f32_16x16x32_bf16 v[164:167], a[208:211], v[116:119], v[164:167]
    ds_read_b64_tr_b16 a[216:217], v26 offset:32768
    ds_read_b64_tr_b16 a[218:219], v26 offset:36864
    v_mfma_f32_16x16x32_bf16 v[168:171], a[208:211], v[120:123], v[168:171]
    s_waitcnt lgkmcnt(2)
    v_exp_f32 v141, v141
    v_mfma_f32_16x16x32_bf16 v[220:223], a[212:215], v[116:119], v[220:223]
    ds_read_b64_tr_b16 a[220:221], v27 offset:32768
    ds_read_b64_tr_b16 a[222:223], v27 offset:36864
    v_mfma_f32_16x16x32_bf16 v[224:227], a[212:215], v[120:123], v[224:227]
    s_waitcnt lgkmcnt(2)
    v_exp_f32 v142, v142
    v_mfma_f32_16x16x32_bf16 v[172:175], a[216:219], v[116:119], v[172:175]
    v_exp_f32 v143, v143
    v_mfma_f32_16x16x32_bf16 v[176:179], a[216:219], v[120:123], v[176:179]
    s_waitcnt lgkmcnt(0)
    v_cvt_pk_bf16_f32 v132, v132, v133
    v_cvt_pk_bf16_f32 v133, v134, v135
    v_mfma_f32_16x16x32_bf16 v[236:239], a[220:223], v[116:119], v[236:239]
    ds_read_b64_tr_b16 a[192:193], v20 offset:40960
    ds_read_b64_tr_b16 a[194:195], v20 offset:45056
    v_mfma_f32_16x16x32_bf16 v[240:243], a[220:223], v[120:123], v[240:243]
    v_cvt_pk_bf16_f32 v134, v140, v141
    v_cvt_pk_bf16_f32 v135, v142, v143
    v_exp_f32 v136, v136
    v_exp_f32 v137, v137
    v_exp_f32 v138, v138
    v_exp_f32 v139, v139
    v_exp_f32 v144, v144
    v_exp_f32 v145, v145
    v_exp_f32 v146, v146
    v_exp_f32 v147, v147
    v_cvt_pk_bf16_f32 v136, v136, v137
    v_cvt_pk_bf16_f32 v137, v138, v139
    v_cvt_pk_bf16_f32 v138, v144, v145
    v_cvt_pk_bf16_f32 v139, v146, v147
    v_mfma_f32_16x16x32_bf16 v[68:71], a[224:227], v[132:135], v[68:71]
    ds_read_b64_tr_b16 a[196:197], v21 offset:40960
    ds_read_b64_tr_b16 a[198:199], v21 offset:45056
    v_mfma_f32_16x16x32_bf16 v[72:75], a[224:227], v[136:139], v[72:75]
    s_waitcnt lgkmcnt(2)
    v_max3_f32 v19, v84, v85, v86
    v_max3_f32 v19, v19, v87, v88
    v_mfma_f32_16x16x32_bf16 v[148:151], a[192:195], v[132:135], v[148:151]
    ds_read_b64_tr_b16 a[200:201], v22 offset:40960
    ds_read_b64_tr_b16 a[202:203], v22 offset:45056
    v_mfma_f32_16x16x32_bf16 v[152:155], a[192:195], v[136:139], v[152:155]
    s_waitcnt lgkmcnt(2)
    v_max3_f32 v19, v19, v89, v90
    v_max3_f32 v19, v19, v91, v92
    v_mfma_f32_16x16x32_bf16 v[188:191], a[196:199], v[132:135], v[188:191]
    ds_read_b64_tr_b16 a[204:205], v23 offset:40960
    ds_read_b64_tr_b16 a[206:207], v23 offset:45056
    v_mfma_f32_16x16x32_bf16 v[192:195], a[196:199], v[136:139], v[192:195]
    s_waitcnt lgkmcnt(2)
    v_max3_f32 v19, v19, v93, v94
    v_max3_f32 v19, v19, v95, v96
    v_mfma_f32_16x16x32_bf16 v[156:159], a[200:203], v[132:135], v[156:159]
    ds_read_b64_tr_b16 a[208:209], v24 offset:40960
    ds_read_b64_tr_b16 a[210:211], v24 offset:45056
    v_mfma_f32_16x16x32_bf16 v[160:163], a[200:203], v[136:139], v[160:163]
    s_waitcnt lgkmcnt(2)
    v_max3_f32 v19, v19, v97, v98
    v_max3_f32 v19, v19, v99, v100
    v_mfma_f32_16x16x32_bf16 v[204:207], a[204:207], v[132:135], v[204:207]
    ds_read_b64_tr_b16 a[212:213], v25 offset:40960
    ds_read_b64_tr_b16 a[214:215], v25 offset:45056
    v_mfma_f32_16x16x32_bf16 v[208:211], a[204:207], v[136:139], v[208:211]
    s_waitcnt lgkmcnt(2)
    v_max3_f32 v19, v19, v101, v102
    v_max3_f32 v19, v19, v103, v104
    v_mfma_f32_16x16x32_bf16 v[164:167], a[208:211], v[132:135], v[164:167]
    ds_read_b64_tr_b16 a[216:217], v26 offset:40960
    ds_read_b64_tr_b16 a[218:219], v26 offset:45056
    v_mfma_f32_16x16x32_bf16 v[168:171], a[208:211], v[136:139], v[168:171]
    s_waitcnt lgkmcnt(2)
    v_max3_f32 v19, v19, v105, v106
    v_max3_f32 v19, v19, v107, v108
    v_mfma_f32_16x16x32_bf16 v[220:223], a[212:215], v[132:135], v[220:223]
    ds_read_b64_tr_b16 a[220:221], v27 offset:40960
    ds_read_b64_tr_b16 a[222:223], v27 offset:45056
    v_mfma_f32_16x16x32_bf16 v[224:227], a[212:215], v[136:139], v[224:227]
    s_waitcnt lgkmcnt(2)
    v_max3_f32 v19, v19, v109, v110
    v_max3_f32 v19, v19, v111, v112
    v_mfma_f32_16x16x32_bf16 v[172:175], a[216:219], v[132:135], v[172:175]
    s_waitcnt vmcnt(13)
    s_barrier
    s_lshl_b32 s43, s48, 2
    buffer_load_dword v10, off, s[32:35], s43 sc1
    ds_read_b128 a[192:195], v48 offset:32768
    ds_read_b128 a[196:199], v49 offset:32768
    v_mfma_f32_16x16x32_bf16 v[176:179], a[216:219], v[136:139], v[176:179]
    s_waitcnt lgkmcnt(2)
    v_max3_f32 v19, v19, v113, v114
    v_max_f32 v19, v19, v115
    v_mfma_f32_16x16x32_bf16 v[236:239], a[220:223], v[132:135], v[236:239]
    s_add_u32 m0, s37, 114688
    v_cmp_lt_f32 vcc, s47, v19
    v_accvgpr_read_b32 v244, a176
    v_mfma_f32_16x16x32_bf16 v[240:243], a[220:223], v[136:139], v[240:243]
    s_cbranch_vccnz w2_t12_slow
w2_t12_back:
    s_waitcnt lgkmcnt(1)
    v_exp_f32 v84, v84
    v_accvgpr_read_b32 v245, a177
    v_accvgpr_read_b32 v246, a178
    v_accvgpr_read_b32 v247, a179
    v_accvgpr_read_b32 v248, a184
    v_accvgpr_read_b32 v249, a185
    v_accvgpr_read_b32 v250, a186
    v_accvgpr_read_b32 v251, a187
    v_mul_f32 v244, v17, v244
    v_mul_f32 v245, v17, v245
    v_mul_f32 v246, v17, v246
    v_mul_f32 v247, v17, v247
    v_mul_f32 v248, v17, v248
    v_mul_f32 v249, v17, v249
    v_mul_f32 v250, v17, v250
    v_mul_f32 v251, v17, v251
    v_cvt_pk_bf16_f32 v244, v244, v245
    v_cvt_pk_bf16_f32 v245, v246, v247
    v_cvt_pk_bf16_f32 v246, v248, v249
    v_cvt_pk_bf16_f32 v247, v250, v251
    v_accvgpr_write_b32 a24, v244
    v_accvgpr_write_b32 a25, v245
    v_accvgpr_write_b32 a26, v246
    v_accvgpr_write_b32 a27, v247
    v_mfma_f32_16x16x32_bf16 v[116:119], a[192:195], v[180:183], v[76:79]
    s_add_u32 s42, s39, 212992
    ds_read_b128 a[200:203], v50 offset:32768
    ds_read_b128 a[204:207], v51 offset:32768
    v_mfma_f32_16x16x32_bf16 v[120:123], a[192:195], v[184:187], v[80:83]
    s_waitcnt lgkmcnt(2)
    buffer_load_dwordx4 v60, s[12:15], s42 offen offset:0 nt lds
    v_mfma_f32_16x16x32_bf16 v[116:119], a[196:199], v[196:199], v[116:119]
    buffer_load_dwordx4 v61, s[12:15], s42 offen offset:1024 nt lds
    v_mfma_f32_16x16x32_bf16 v[120:123], a[196:199], v[200:203], v[120:123]
    s_waitcnt lgkmcnt(1)
    buffer_load_dwordx4 v60, s[12:15], s42 offen offset:2048 nt lds
    v_mfma_f32_16x16x32_bf16 v[116:119], a[200:203], v[212:215], v[116:119]
    ds_read_b128 a[208:211], v48 offset:36864
    ds_read_b128 a[212:215], v49 offset:36864
    v_mfma_f32_16x16x32_bf16 v[120:123], a[200:203], v[216:219], v[120:123]
    s_waitcnt lgkmcnt(2)
    buffer_load_dwordx4 v61, s[12:15], s42 offen offset:3072 nt lds
    v_mfma_f32_16x16x32_bf16 v[116:119], a[204:207], v[228:231], v[116:119]
    v_exp_f32 v85, v85
    v_mfma_f32_16x16x32_bf16 v[120:123], a[204:207], v[232:235], v[120:123]
    s_waitcnt lgkmcnt(1)
    v_exp_f32 v86, v86
    v_mfma_f32_16x16x32_bf16 v[124:127], a[208:211], v[180:183], v[76:79]
    ds_read_b128 a[216:219], v50 offset:36864
    ds_read_b128 a[220:223], v51 offset:36864
    v_mfma_f32_16x16x32_bf16 v[128:131], a[208:211], v[184:187], v[80:83]
    s_waitcnt lgkmcnt(2)
    v_exp_f32 v87, v87
    v_mfma_f32_16x16x32_bf16 v[124:127], a[212:215], v[196:199], v[124:127]
    v_exp_f32 v92, v92
    v_mfma_f32_16x16x32_bf16 v[128:131], a[212:215], v[200:203], v[128:131]
    s_waitcnt lgkmcnt(1)
    v_exp_f32 v93, v93
    v_mfma_f32_16x16x32_bf16 v[124:127], a[216:219], v[212:215], v[124:127]
    ds_read_b128 a[192:195], v48 offset:40960
    ds_read_b128 a[196:199], v49 offset:40960
    v_mfma_f32_16x16x32_bf16 v[128:131], a[216:219], v[216:219], v[128:131]
    s_waitcnt lgkmcnt(2)
    v_exp_f32 v94, v94
    v_mfma_f32_16x16x32_bf16 v[124:127], a[220:223], v[228:231], v[124:127]
    v_exp_f32 v95, v95
    v_mfma_f32_16x16x32_bf16 v[128:131], a[220:223], v[232:235], v[128:131]
    s_waitcnt lgkmcnt(1)
    v_cvt_pk_bf16_f32 v84, v84, v85
    v_cvt_pk_bf16_f32 v85, v86, v87
    v_mfma_f32_16x16x32_bf16 v[132:135], a[192:195], v[180:183], v[76:79]
    ds_read_b128 a[200:203], v50 offset:40960
    ds_read_b128 a[204:207], v51 offset:40960
    v_mfma_f32_16x16x32_bf16 v[136:139], a[192:195], v[184:187], v[80:83]
    s_waitcnt lgkmcnt(2)
    v_cvt_pk_bf16_f32 v86, v92, v93
    v_cvt_pk_bf16_f32 v87, v94, v95
    v_mfma_f32_16x16x32_bf16 v[132:135], a[196:199], v[196:199], v[132:135]
    v_exp_f32 v88, v88
    v_mfma_f32_16x16x32_bf16 v[136:139], a[196:199], v[200:203], v[136:139]
    s_waitcnt lgkmcnt(1)
    v_exp_f32 v89, v89
    v_mfma_f32_16x16x32_bf16 v[132:135], a[200:203], v[212:215], v[132:135]
    ds_read_b128 a[208:211], v48 offset:45056
    ds_read_b128 a[212:215], v49 offset:45056
    v_mfma_f32_16x16x32_bf16 v[136:139], a[200:203], v[216:219], v[136:139]
    s_waitcnt lgkmcnt(2)
    v_exp_f32 v90, v90
    v_mfma_f32_16x16x32_bf16 v[132:135], a[204:207], v[228:231], v[132:135]
    v_exp_f32 v91, v91
    v_mfma_f32_16x16x32_bf16 v[136:139], a[204:207], v[232:235], v[136:139]
    s_waitcnt lgkmcnt(1)
    v_exp_f32 v96, v96
    v_mfma_f32_16x16x32_bf16 v[140:143], a[208:211], v[180:183], v[76:79]
    ds_read_b128 a[216:219], v50 offset:45056
    ds_read_b128 a[220:223], v51 offset:45056
    v_mfma_f32_16x16x32_bf16 v[144:147], a[208:211], v[184:187], v[80:83]
    s_waitcnt lgkmcnt(2)
    v_exp_f32 v97, v97
    v_mfma_f32_16x16x32_bf16 v[140:143], a[212:215], v[196:199], v[140:143]
    v_exp_f32 v98, v98
    v_mfma_f32_16x16x32_bf16 v[144:147], a[212:215], v[200:203], v[144:147]
    s_waitcnt lgkmcnt(1)
    v_exp_f32 v99, v99
    v_mfma_f32_16x16x32_bf16 v[140:143], a[216:219], v[212:215], v[140:143]
    v_cvt_pk_bf16_f32 v88, v88, v89
    v_cvt_pk_bf16_f32 v89, v90, v91
    v_mfma_f32_16x16x32_bf16 v[144:147], a[216:219], v[216:219], v[144:147]
    s_waitcnt lgkmcnt(0)
    v_cvt_pk_bf16_f32 v90, v96, v97
    v_cvt_pk_bf16_f32 v91, v98, v99
    v_mfma_f32_16x16x32_bf16 v[140:143], a[220:223], v[228:231], v[140:143]
    s_waitcnt vmcnt(14)
    s_barrier
    ds_read_b64_tr_b16 a[192:193], v36 offset:0
    ds_read_b64_tr_b16 a[194:195], v36 offset:4096
    v_mfma_f32_16x16x32_bf16 v[144:147], a[220:223], v[232:235], v[144:147]
    s_add_u32 m0, s37, 16384
    v_exp_f32 v100, v100
    v_accvgpr_read_b32 v244, a180
    v_accvgpr_read_b32 v245, a181
    v_accvgpr_read_b32 v246, a182
    v_accvgpr_read_b32 v247, a183
    v_accvgpr_read_b32 v248, a188
    v_accvgpr_read_b32 v249, a189
    v_accvgpr_read_b32 v250, a190
    v_accvgpr_read_b32 v251, a191
    v_mul_f32 v244, v18, v244
    v_mul_f32 v245, v18, v245
    v_mul_f32 v246, v18, v246
    v_mul_f32 v247, v18, v247
    v_mul_f32 v248, v18, v248
    v_mul_f32 v249, v18, v249
    v_mul_f32 v250, v18, v250
    v_mul_f32 v251, v18, v251
    v_cvt_pk_bf16_f32 v244, v244, v245
    v_cvt_pk_bf16_f32 v245, v246, v247
    v_cvt_pk_bf16_f32 v246, v248, v249
    v_cvt_pk_bf16_f32 v247, v250, v251
    v_accvgpr_write_b32 a28, v244
    v_accvgpr_write_b32 a29, v245
    v_accvgpr_write_b32 a30, v246
    v_accvgpr_write_b32 a31, v247
    v_mfma_f32_16x16x32_bf16 v[68:71], a[224:227], v[84:87], v[68:71]
    s_add_u32 s42, s80, 196608
    ds_read_b64_tr_b16 a[196:197], v37 offset:0
    ds_read_b64_tr_b16 a[198:199], v37 offset:4096
    v_mfma_f32_16x16x32_bf16 v[72:75], a[224:227], v[88:91], v[72:75]
    s_waitcnt lgkmcnt(2)
    buffer_load_dwordx4 v62, s[20:23], s42 offen offset:0  lds
    v_mfma_f32_16x16x32_bf16 v[148:151], a[192:195], v[84:87], v[148:151]
    ds_read_b64_tr_b16 a[200:201], v38 offset:0
    ds_read_b64_tr_b16 a[202:203], v38 offset:4096
    v_mfma_f32_16x16x32_bf16 v[152:155], a[192:195], v[88:91], v[152:155]
    s_waitcnt lgkmcnt(2)
    buffer_load_dwordx4 v63, s[20:23], s42 offen offset:1024  lds
    v_mfma_f32_16x16x32_bf16 v[188:191], a[196:199], v[84:87], v[188:191]
    ds_read_b64_tr_b16 a[204:205], v39 offset:0
    ds_read_b64_tr_b16 a[206:207], v39 offset:4096
    v_mfma_f32_16x16x32_bf16 v[192:195], a[196:199], v[88:91], v[192:195]
    s_waitcnt lgkmcnt(2)
    buffer_load_dwordx4 v64, s[20:23], s42 offen offset:2048  lds
    v_mfma_f32_16x16x32_bf16 v[156:159], a[200:203], v[84:87], v[156:159]
    ds_read_b64_tr_b16 a[208:209], v40 offset:0
    ds_read_b64_tr_b16 a[210:211], v40 offset:4096
    v_mfma_f32_16x16x32_bf16 v[160:163], a[200:203], v[88:91], v[160:163]
    s_waitcnt lgkmcnt(2)
    buffer_load_dwordx4 v65, s[20:23], s42 offen offset:3072  lds
    v_mfma_f32_16x16x32_bf16 v[204:207], a[204:207], v[84:87], v[204:207]
    s_add_u32 m0, s37, 0
    ds_read_b64_tr_b16 a[212:213], v41 offset:0
    ds_read_b64_tr_b16 a[214:215], v41 offset:4096
    v_mfma_f32_16x16x32_bf16 v[208:211], a[204:207], v[88:91], v[208:211]
    s_waitcnt lgkmcnt(2)
    v_exp_f32 v101, v101
    v_mfma_f32_16x16x32_bf16 v[164:167], a[208:211], v[84:87], v[164:167]
    s_add_u32 s42, s39, 245760
    ds_read_b64_tr_b16 a[216:217], v42 offset:0
    ds_read_b64_tr_b16 a[218:219], v42 offset:4096
    v_mfma_f32_16x16x32_bf16 v[168:171], a[208:211], v[88:91], v[168:171]
    s_waitcnt lgkmcnt(2)
    buffer_load_dwordx4 v56, s[8:11], s42 offen offset:0 nt lds
    v_mfma_f32_16x16x32_bf16 v[220:223], a[212:215], v[84:87], v[220:223]
    ds_read_b64_tr_b16 a[220:221], v43 offset:0
    ds_read_b64_tr_b16 a[222:223], v43 offset:4096
    v_mfma_f32_16x16x32_bf16 v[224:227], a[212:215], v[88:91], v[224:227]
    s_waitcnt lgkmcnt(2)
    buffer_load_dwordx4 v57, s[8:11], s42 offen offset:1024 nt lds
    v_mfma_f32_16x16x32_bf16 v[172:175], a[216:219], v[84:87], v[172:175]
    buffer_load_dwordx4 v58, s[8:11], s42 offen offset:2048 nt lds
    v_mfma_f32_16x16x32_bf16 v[176:179], a[216:219], v[88:91], v[176:179]
    s_waitcnt lgkmcnt(0)
    buffer_load_dwordx4 v59, s[8:11], s42 offen offset:3072 nt lds
    v_mfma_f32_16x16x32_bf16 v[236:239], a[220:223], v[84:87], v[236:239]
    ds_read_b64_tr_b16 a[192:193], v36 offset:8192
    ds_read_b64_tr_b16 a[194:195], v36 offset:12288
    v_mfma_f32_16x16x32_bf16 v[240:243], a[220:223], v[88:91], v[240:243]
    v_exp_f32 v102, v102
    v_exp_f32 v103, v103
    v_exp_f32 v108, v108
    v_exp_f32 v109, v109
    v_exp_f32 v110, v110
    v_exp_f32 v111, v111
    v_cvt_pk_bf16_f32 v100, v100, v101
    v_cvt_pk_bf16_f32 v101, v102, v103
    v_cvt_pk_bf16_f32 v102, v108, v109
    v_cvt_pk_bf16_f32 v103, v110, v111
    v_exp_f32 v104, v104
    v_exp_f32 v105, v105
    v_exp_f32 v106, v106
    v_exp_f32 v107, v107
    v_exp_f32 v112, v112
    v_exp_f32 v113, v113
    v_exp_f32 v114, v114
    v_exp_f32 v115, v115
    v_cvt_pk_bf16_f32 v104, v104, v105
    v_cvt_pk_bf16_f32 v105, v106, v107
    v_cvt_pk_bf16_f32 v106, v112, v113
    v_cvt_pk_bf16_f32 v107, v114, v115
    v_mfma_f32_16x16x32_bf16 v[68:71], a[224:227], v[100:103], v[68:71]
    ds_read_b64_tr_b16 a[196:197], v37 offset:8192
    ds_read_b64_tr_b16 a[198:199], v37 offset:12288
    v_mfma_f32_16x16x32_bf16 v[72:75], a[224:227], v[104:107], v[72:75]
    s_waitcnt lgkmcnt(2)
    v_max3_f32 v19, v116, v117, v118
    v_max3_f32 v19, v19, v119, v120
    v_mfma_f32_16x16x32_bf16 v[148:151], a[192:195], v[100:103], v[148:151]
    ds_read_b64_tr_b16 a[200:201], v38 offset:8192
    ds_read_b64_tr_b16 a[202:203], v38 offset:12288
    v_mfma_f32_16x16x32_bf16 v[152:155], a[192:195], v[104:107], v[152:155]
    s_waitcnt lgkmcnt(2)
    v_max3_f32 v19, v19, v121, v122
    v_max3_f32 v19, v19, v123, v124
    v_mfma_f32_16x16x32_bf16 v[188:191], a[196:199], v[100:103], v[188:191]
    ds_read_b64_tr_b16 a[204:205], v39 offset:8192
    ds_read_b64_tr_b16 a[206:207], v39 offset:12288
    v_mfma_f32_16x16x32_bf16 v[192:195], a[196:199], v[104:107], v[192:195]
    s_waitcnt lgkmcnt(2)
    v_max3_f32 v19, v19, v125, v126
    v_max3_f32 v19, v19, v127, v128
    v_mfma_f32_16x16x32_bf16 v[156:159], a[200:203], v[100:103], v[156:159]
    ds_read_b64_tr_b16 a[208:209], v40 offset:8192
    ds_read_b64_tr_b16 a[210:211], v40 offset:12288
    v_mfma_f32_16x16x32_bf16 v[160:163], a[200:203], v[104:107], v[160:163]
    s_waitcnt lgkmcnt(2)
    v_max3_f32 v19, v19, v129, v130
    v_max3_f32 v19, v19, v131, v132
    v_mfma_f32_16x16x32_bf16 v[204:207], a[204:207], v[100:103], v[204:207]
    ds_read_b64_tr_b16 a[212:213], v41 offset:8192
    ds_read_b64_tr_b16 a[214:215], v41 offset:12288
    v_mfma_f32_16x16x32_bf16 v[208:211], a[204:207], v[104:107], v[208:211]
    s_waitcnt lgkmcnt(2)
    v_max3_f32 v19, v19, v133, v134
    v_max3_f32 v19, v19, v135, v136
    v_mfma_f32_16x16x32_bf16 v[164:167], a[208:211], v[100:103], v[164:167]
    ds_read_b64_tr_b16 a[216:217], v42 offset:8192
    ds_read_b64_tr_b16 a[218:219], v42 offset:12288
    v_mfma_f32_16x16x32_bf16 v[168:171], a[208:211], v[104:107], v[168:171]
    s_waitcnt lgkmcnt(2)
    v_max3_f32 v19, v19, v137, v138
    v_max3_f32 v19, v19, v139, v140
    v_mfma_f32_16x16x32_bf16 v[220:223], a[212:215], v[100:103], v[220:223]
    ds_read_b64_tr_b16 a[220:221], v43 offset:8192
    ds_read_b64_tr_b16 a[222:223], v43 offset:12288
    v_mfma_f32_16x16x32_bf16 v[224:227], a[212:215], v[104:107], v[224:227]
    s_waitcnt lgkmcnt(2)
    v_max3_f32 v19, v19, v141, v142
    v_max3_f32 v19, v19, v143, v144
    v_mfma_f32_16x16x32_bf16 v[172:175], a[216:219], v[100:103], v[172:175]
    s_waitcnt vmcnt(14)
    s_barrier
    ds_read_b128 a[192:195], v52 offset:16384
    ds_read_b128 a[196:199], v53 offset:16384
    v_mfma_f32_16x16x32_bf16 v[176:179], a[216:219], v[104:107], v[176:179]
    s_waitcnt lgkmcnt(2)
    v_max3_f32 v19, v19, v145, v146
    v_max_f32 v19, v19, v147
    v_mfma_f32_16x16x32_bf16 v[236:239], a[220:223], v[100:103], v[236:239]
    s_add_u32 m0, s37, 32768
    v_cmp_lt_f32 vcc, s47, v19
    v_mfma_f32_16x16x32_bf16 v[240:243], a[220:223], v[104:107], v[240:243]
    s_cbranch_vccnz w2_t13_slow
w2_t13_back:
    s_waitcnt lgkmcnt(1)
    v_exp_f32 v116, v116
    v_mfma_f32_16x16x32_bf16 v[84:87], a[192:195], v[180:183], v[76:79]
    s_add_u32 s42, s39, 229376
    ds_read_b128 a[200:203], v54 offset:16384
    ds_read_b128 a[204:207], v55 offset:16384
    v_mfma_f32_16x16x32_bf16 v[88:91], a[192:195], v[184:187], v[80:83]
    s_waitcnt lgkmcnt(2)
    buffer_load_dwordx4 v60, s[12:15], s42 offen offset:0 nt lds
    v_mfma_f32_16x16x32_bf16 v[84:87], a[196:199], v[196:199], v[84:87]
    buffer_load_dwordx4 v61, s[12:15], s42 offen offset:1024 nt lds
    v_mfma_f32_16x16x32_bf16 v[88:91], a[196:199], v[200:203], v[88:91]
    s_waitcnt lgkmcnt(1)
    buffer_load_dwordx4 v60, s[12:15], s42 offen offset:2048 nt lds
    v_mfma_f32_16x16x32_bf16 v[84:87], a[200:203], v[212:215], v[84:87]
    ds_read_b128 a[208:211], v52 offset:20480
    ds_read_b128 a[212:215], v53 offset:20480
    v_mfma_f32_16x16x32_bf16 v[88:91], a[200:203], v[216:219], v[88:91]
    s_waitcnt lgkmcnt(2)
    buffer_load_dwordx4 v61, s[12:15], s42 offen offset:3072 nt lds
    v_mfma_f32_16x16x32_bf16 v[84:87], a[204:207], v[228:231], v[84:87]
    v_exp_f32 v117, v117
    v_mfma_f32_16x16x32_bf16 v[88:91], a[204:207], v[232:235], v[88:91]
    s_waitcnt lgkmcnt(1)
    v_exp_f32 v118, v118
    v_mfma_f32_16x16x32_bf16 v[92:95], a[208:211], v[180:183], v[76:79]
    ds_read_b128 a[216:219], v54 offset:20480
    ds_read_b128 a[220:223], v55 offset:20480
    v_mfma_f32_16x16x32_bf16 v[96:99], a[208:211], v[184:187], v[80:83]
    s_waitcnt lgkmcnt(2)
    v_exp_f32 v119, v119
    v_mfma_f32_16x16x32_bf16 v[92:95], a[212:215], v[196:199], v[92:95]
    v_exp_f32 v124, v124
    v_mfma_f32_16x16x32_bf16 v[96:99], a[212:215], v[200:203], v[96:99]
    s_waitcnt lgkmcnt(1)
    v_exp_f32 v125, v125
    v_mfma_f32_16x16x32_bf16 v[92:95], a[216:219], v[212:215], v[92:95]
    ds_read_b128 a[192:195], v52 offset:24576
    ds_read_b128 a[196:199], v53 offset:24576
    v_mfma_f32_16x16x32_bf16 v[96:99], a[216:219], v[216:219], v[96:99]
    s_waitcnt lgkmcnt(2)
    v_exp_f32 v126, v126
    v_mfma_f32_16x16x32_bf16 v[92:95], a[220:223], v[228:231], v[92:95]
    v_exp_f32 v127, v127
    v_mfma_f32_16x16x32_bf16 v[96:99], a[220:223], v[232:235], v[96:99]
    s_waitcnt lgkmcnt(1)
    v_cvt_pk_bf16_f32 v116, v116, v117
    v_cvt_pk_bf16_f32 v117, v118, v119
    v_mfma_f32_16x16x32_bf16 v[100:103], a[192:195], v[180:183], v[76:79]
    ds_read_b128 a[200:203], v54 offset:24576
    ds_read_b128 a[204:207], v55 offset:24576
    v_mfma_f32_16x16x32_bf16 v[104:107], a[192:195], v[184:187], v[80:83]
    s_waitcnt lgkmcnt(2)
    v_cvt_pk_bf16_f32 v118, v124, v125
    v_cvt_pk_bf16_f32 v119, v126, v127
    v_mfma_f32_16x16x32_bf16 v[100:103], a[196:199], v[196:199], v[100:103]
    v_exp_f32 v120, v120
    v_mfma_f32_16x16x32_bf16 v[104:107], a[196:199], v[200:203], v[104:107]
    s_waitcnt lgkmcnt(1)
    v_exp_f32 v121, v121
    v_mfma_f32_16x16x32_bf16 v[100:103], a[200:203], v[212:215], v[100:103]
    ds_read_b128 a[208:211], v52 offset:28672
    ds_read_b128 a[212:215], v53 offset:28672
    v_mfma_f32_16x16x32_bf16 v[104:107], a[200:203], v[216:219], v[104:107]
    s_waitcnt lgkmcnt(2)
    v_exp_f32 v122, v122
    v_mfma_f32_16x16x32_bf16 v[100:103], a[204:207], v[228:231], v[100:103]
    v_exp_f32 v123, v123
    v_mfma_f32_16x16x32_bf16 v[104:107], a[204:207], v[232:235], v[104:107]
    s_waitcnt lgkmcnt(1)
    v_exp_f32 v128, v128
    v_mfma_f32_16x16x32_bf16 v[108:111], a[208:211], v[180:183], v[76:79]
    ds_read_b128 a[216:219], v54 offset:28672
    ds_read_b128 a[220:223], v55 offset:28672
    v_mfma_f32_16x16x32_bf16 v[112:115], a[208:211], v[184:187], v[80:83]
    s_waitcnt lgkmcnt(2)
    v_exp_f32 v129, v129
    v_mfma_f32_16x16x32_bf16 v[108:111], a[212:215], v[196:199], v[108:111]
    v_exp_f32 v130, v130
    v_mfma_f32_16x16x32_bf16 v[112:115], a[212:215], v[200:203], v[112:115]
    s_waitcnt lgkmcnt(1)
    v_exp_f32 v131, v131
    v_mfma_f32_16x16x32_bf16 v[108:111], a[216:219], v[212:215], v[108:111]
    v_cvt_pk_bf16_f32 v120, v120, v121
    v_cvt_pk_bf16_f32 v121, v122, v123
    v_mfma_f32_16x16x32_bf16 v[112:115], a[216:219], v[216:219], v[112:115]
    s_waitcnt lgkmcnt(0)
    v_cvt_pk_bf16_f32 v122, v128, v129
    v_cvt_pk_bf16_f32 v123, v130, v131
    v_mfma_f32_16x16x32_bf16 v[108:111], a[220:223], v[228:231], v[108:111]
    s_waitcnt vmcnt(12)
    s_barrier
    v_cmp_gt_u32 s[62:63], 3, v10
    s_nop 0
    s_cmp_lg_u64 s[62:63], 0
    s_cbranch_scc1 w2_pcnt_spin
w2_pcnt_back:
    ds_read_b64_tr_b16 a[192:193], v28 offset:49152
    ds_read_b64_tr_b16 a[194:195], v28 offset:53248
    v_mfma_f32_16x16x32_bf16 v[112:115], a[220:223], v[232:235], v[112:115]
    s_add_u32 m0, s37, 98304
    v_exp_f32 v132, v132
    v_mfma_f32_16x16x32_bf16 v[68:71], a[224:227], v[116:119], v[68:71]
    s_add_u32 s42, s39, 245760
    ds_read_b64_tr_b16 a[196:197], v29 offset:49152
    ds_read_b64_tr_b16 a[198:199], v29 offset:53248
    v_mfma_f32_16x16x32_bf16 v[72:75], a[224:227], v[120:123], v[72:75]
    s_waitcnt lgkmcnt(2)
    ds_read_b64_tr_b16 a[200:201], v30 offset:49152
    ds_read_b64_tr_b16 a[202:203], v30 offset:53248
    v_mfma_f32_16x16x32_bf16 v[148:151], a[192:195], v[116:119], v[148:151]
    ds_read_b64_tr_b16 a[204:205], v31 offset:49152
    ds_read_b64_tr_b16 a[206:207], v31 offset:53248
    v_mfma_f32_16x16x32_bf16 v[152:155], a[192:195], v[120:123], v[152:155]
    s_waitcnt lgkmcnt(4)
    ds_read_b64_tr_b16 a[208:209], v32 offset:49152
    ds_read_b64_tr_b16 a[210:211], v32 offset:53248
    v_mfma_f32_16x16x32_bf16 v[188:191], a[196:199], v[116:119], v[188:191]
    ds_read_b64_tr_b16 a[212:213], v33 offset:49152
    ds_read_b64_tr_b16 a[214:215], v33 offset:53248
    v_mfma_f32_16x16x32_bf16 v[192:195], a[196:199], v[120:123], v[192:195]
    s_waitcnt lgkmcnt(6)
    ds_read_b64_tr_b16 a[216:217], v34 offset:49152
    ds_read_b64_tr_b16 a[218:219], v34 offset:53248
    v_mfma_f32_16x16x32_bf16 v[156:159], a[200:203], v[116:119], v[156:159]
    buffer_load_dwordx4 v60, s[12:15], s42 offen offset:0 nt lds
    v_mfma_f32_16x16x32_bf16 v[160:163], a[200:203], v[120:123], v[160:163]
    s_waitcnt lgkmcnt(6)
    ds_read_b64_tr_b16 a[220:221], v35 offset:49152
    ds_read_b64_tr_b16 a[222:223], v35 offset:53248
    v_mfma_f32_16x16x32_bf16 v[204:207], a[204:207], v[116:119], v[204:207]
    buffer_load_dwordx4 v61, s[12:15], s42 offen offset:1024 nt lds
    v_mfma_f32_16x16x32_bf16 v[208:211], a[204:207], v[120:123], v[208:211]
    s_waitcnt lgkmcnt(6)
    buffer_load_dwordx4 v60, s[12:15], s42 offen offset:2048 nt lds
    v_mfma_f32_16x16x32_bf16 v[164:167], a[208:211], v[116:119], v[164:167]
    buffer_load_dwordx4 v61, s[12:15], s42 offen offset:3072 nt lds
    v_mfma_f32_16x16x32_bf16 v[168:171], a[208:211], v[120:123], v[168:171]
    s_waitcnt lgkmcnt(4)
    ds_read_b64_tr_b16 a[192:193], v28 offset:57344
    ds_read_b64_tr_b16 a[194:195], v28 offset:61440
    v_mfma_f32_16x16x32_bf16 v[220:223], a[212:215], v[116:119], v[220:223]
    v_exp_f32 v133, v133
    v_mfma_f32_16x16x32_bf16 v[224:227], a[212:215], v[120:123], v[224:227]
    s_waitcnt lgkmcnt(4)
    ds_read_b64_tr_b16 a[196:197], v29 offset:57344
    ds_read_b64_tr_b16 a[198:199], v29 offset:61440
    v_mfma_f32_16x16x32_bf16 v[172:175], a[216:219], v[116:119], v[172:175]
    v_exp_f32 v134, v134
    v_mfma_f32_16x16x32_bf16 v[176:179], a[216:219], v[120:123], v[176:179]
    s_waitcnt lgkmcnt(4)
    ds_read_b64_tr_b16 a[200:201], v30 offset:57344
    ds_read_b64_tr_b16 a[202:203], v30 offset:61440
    v_mfma_f32_16x16x32_bf16 v[236:239], a[220:223], v[116:119], v[236:239]
    v_exp_f32 v135, v135
    v_mfma_f32_16x16x32_bf16 v[240:243], a[220:223], v[120:123], v[240:243]
    ds_read_b64_tr_b16 a[204:205], v31 offset:57344
    ds_read_b64_tr_b16 a[206:207], v31 offset:61440
    v_exp_f32 v140, v140
    v_exp_f32 v141, v141
    v_exp_f32 v142, v142
    v_exp_f32 v143, v143
    v_cvt_pk_bf16_f32 v132, v132, v133
    v_cvt_pk_bf16_f32 v133, v134, v135
    v_cvt_pk_bf16_f32 v134, v140, v141
    v_cvt_pk_bf16_f32 v135, v142, v143
    v_exp_f32 v136, v136
    v_exp_f32 v137, v137
    v_exp_f32 v138, v138
    v_exp_f32 v139, v139
    v_exp_f32 v144, v144
    v_exp_f32 v145, v145
    v_exp_f32 v146, v146
    v_exp_f32 v147, v147
    v_cvt_pk_bf16_f32 v136, v136, v137
    v_cvt_pk_bf16_f32 v137, v138, v139
    v_cvt_pk_bf16_f32 v138, v144, v145
    v_cvt_pk_bf16_f32 v139, v146, v147
    v_mfma_f32_16x16x32_bf16 v[68:71], a[224:227], v[132:135], v[68:71]
    v_max3_f32 v19, v84, v85, v86
    v_max3_f32 v19, v19, v87, v88
    v_mfma_f32_16x16x32_bf16 v[72:75], a[224:227], v[136:139], v[72:75]
    s_waitcnt lgkmcnt(6)
    ds_read_b64_tr_b16 a[208:209], v32 offset:57344
    ds_read_b64_tr_b16 a[210:211], v32 offset:61440
    v_mfma_f32_16x16x32_bf16 v[148:151], a[192:195], v[132:135], v[148:151]
    v_max3_f32 v19, v19, v89, v90
    v_max3_f32 v19, v19, v91, v92
    v_mfma_f32_16x16x32_bf16 v[152:155], a[192:195], v[136:139], v[152:155]
    s_waitcnt lgkmcnt(6)
    ds_read_b64_tr_b16 a[212:213], v33 offset:57344
    ds_read_b64_tr_b16 a[214:215], v33 offset:61440
    v_mfma_f32_16x16x32_bf16 v[188:191], a[196:199], v[132:135], v[188:191]
    v_max3_f32 v19, v19, v93, v94
    v_max3_f32 v19, v19, v95, v96
    v_mfma_f32_16x16x32_bf16 v[192:195], a[196:199], v[136:139], v[192:195]
    s_waitcnt lgkmcnt(6)
    ds_read_b64_tr_b16 a[216:217], v34 offset:57344
    ds_read_b64_tr_b16 a[218:219], v34 offset:61440
    v_mfma_f32_16x16x32_bf16 v[156:159], a[200:203], v[132:135], v[156:159]
    v_max3_f32 v19, v19, v97, v98
    v_max3_f32 v19, v19, v99, v100
    v_mfma_f32_16x16x32_bf16 v[160:163], a[200:203], v[136:139], v[160:163]
    s_waitcnt lgkmcnt(6)
    ds_read_b64_tr_b16 a[220:221], v35 offset:57344
    ds_read_b64_tr_b16 a[222:223], v35 offset:61440
    v_mfma_f32_16x16x32_bf16 v[204:207], a[204:207], v[132:135], v[204:207]
    v_max3_f32 v19, v19, v101, v102
    v_max3_f32 v19, v19, v103, v104
    v_mfma_f32_16x16x32_bf16 v[208:211], a[204:207], v[136:139], v[208:211]
    s_waitcnt lgkmcnt(6)
    s_waitcnt vmcnt(8)
    s_barrier
    ds_read_b128 a[192:195], v44 offset:0
    ds_read_b128 a[196:199], v45 offset:0
    v_mfma_f32_16x16x32_bf16 v[164:167], a[208:211], v[132:135], v[164:167]
    s_add_u32 s42, s84, 0
    buffer_store_dwordx4 a[0:3], v16, s[24:27], s42 offen offset:0 sc1
    v_mfma_f32_16x16x32_bf16 v[168:171], a[208:211], v[136:139], v[168:171]
    s_waitcnt lgkmcnt(6)
    buffer_store_dwordx4 a[4:7], v16, s[24:27], s42 offen offset:2048 sc1
    v_mfma_f32_16x16x32_bf16 v[220:223], a[212:215], v[132:135], v[220:223]
    buffer_store_dwordx4 a[8:11], v16, s[24:27], s42 offen offset:1024 sc1
    v_mfma_f32_16x16x32_bf16 v[224:227], a[212:215], v[136:139], v[224:227]
    s_waitcnt lgkmcnt(4)
    ds_read_b128 a[200:203], v46 offset:0
    ds_read_b128 a[204:207], v47 offset:0
    v_mfma_f32_16x16x32_bf16 v[172:175], a[216:219], v[132:135], v[172:175]
    buffer_store_dwordx4 a[12:15], v16, s[24:27], s42 offen offset:3072 sc1
    v_mfma_f32_16x16x32_bf16 v[176:179], a[216:219], v[136:139], v[176:179]
    s_waitcnt lgkmcnt(4)
    v_max3_f32 v19, v19, v105, v106
    v_max3_f32 v19, v19, v107, v108
    v_mfma_f32_16x16x32_bf16 v[236:239], a[220:223], v[132:135], v[236:239]
    v_max3_f32 v19, v19, v109, v110
    v_max3_f32 v19, v19, v111, v112
    v_mfma_f32_16x16x32_bf16 v[240:243], a[220:223], v[136:139], v[240:243]
    v_max3_f32 v19, v19, v113, v114
    v_max_f32 v19, v19, v115
    v_cmp_lt_f32 vcc, s47, v19
    s_cbranch_vccnz w2_t14_slow
w2_t14_back:
    s_waitcnt lgkmcnt(3)
    ds_read_b128 a[208:211], v44 offset:4096
    ds_read_b128 a[212:215], v45 offset:4096
    v_mfma_f32_16x16x32_bf16 v[116:119], a[192:195], v[180:183], v[76:79]
    v_exp_f32 v84, v84
    v_mfma_f32_16x16x32_bf16 v[120:123], a[192:195], v[184:187], v[80:83]
    s_waitcnt lgkmcnt(4)
    v_exp_f32 v85, v85
    v_mfma_f32_16x16x32_bf16 v[116:119], a[196:199], v[196:199], v[116:119]
    v_exp_f32 v86, v86
    v_mfma_f32_16x16x32_bf16 v[120:123], a[196:199], v[200:203], v[120:123]
    s_waitcnt lgkmcnt(3)
    ds_read_b128 a[216:219], v46 offset:4096
    ds_read_b128 a[220:223], v47 offset:4096
    v_mfma_f32_16x16x32_bf16 v[116:119], a[200:203], v[212:215], v[116:119]
    v_exp_f32 v87, v87
    v_mfma_f32_16x16x32_bf16 v[120:123], a[200:203], v[216:219], v[120:123]
    s_waitcnt lgkmcnt(4)
    v_exp_f32 v92, v92
    v_mfma_f32_16x16x32_bf16 v[116:119], a[204:207], v[228:231], v[116:119]
    v_exp_f32 v93, v93
    v_mfma_f32_16x16x32_bf16 v[120:123], a[204:207], v[232:235], v[120:123]
    s_waitcnt lgkmcnt(3)
    ds_read_b128 a[192:195], v44 offset:8192
    ds_read_b128 a[196:199], v45 offset:8192
    v_mfma_f32_16x16x32_bf16 v[124:127], a[208:211], v[180:183], v[76:79]
    v_exp_f32 v94, v94
    v_mfma_f32_16x16x32_bf16 v[128:131], a[208:211], v[184:187], v[80:83]
    s_waitcnt lgkmcnt(4)
    v_exp_f32 v95, v95
    v_mfma_f32_16x16x32_bf16 v[124:127], a[212:215], v[196:199], v[124:127]
    v_cvt_pk_bf16_f32 v84, v84, v85
    v_cvt_pk_bf16_f32 v85, v86, v87
    v_mfma_f32_16x16x32_bf16 v[128:131], a[212:215], v[200:203], v[128:131]
    s_waitcnt lgkmcnt(3)
    ds_read_b128 a[200:203], v46 offset:8192
    ds_read_b128 a[204:207], v47 offset:8192
    v_mfma_f32_16x16x32_bf16 v[124:127], a[216:219], v[212:215], v[124:127]
    v_cvt_pk_bf16_f32 v86, v92, v93
    v_cvt_pk_bf16_f32 v87, v94, v95
    v_mfma_f32_16x16x32_bf16 v[128:131], a[216:219], v[216:219], v[128:131]
    s_waitcnt lgkmcnt(4)
    v_exp_f32 v88, v88
    v_mfma_f32_16x16x32_bf16 v[124:127], a[220:223], v[228:231], v[124:127]
    v_exp_f32 v89, v89
    v_mfma_f32_16x16x32_bf16 v[128:131], a[220:223], v[232:235], v[128:131]
    s_waitcnt lgkmcnt(3)
    ds_read_b128 a[208:211], v44 offset:12288
    ds_read_b128 a[212:215], v45 offset:12288
    v_mfma_f32_16x16x32_bf16 v[132:135], a[192:195], v[180:183], v[76:79]
    v_exp_f32 v90, v90
    v_mfma_f32_16x16x32_bf16 v[136:139], a[192:195], v[184:187], v[80:83]
    s_waitcnt lgkmcnt(4)
    v_exp_f32 v91, v91
    v_mfma_f32_16x16x32_bf16 v[132:135], a[196:199], v[196:199], v[132:135]
    v_exp_f32 v96, v96
    v_mfma_f32_16x16x32_bf16 v[136:139], a[196:199], v[200:203], v[136:139]
    s_waitcnt lgkmcnt(3)
    ds_read_b128 a[216:219], v46 offset:12288
    ds_read_b128 a[220:223], v47 offset:12288
    v_mfma_f32_16x16x32_bf16 v[132:135], a[200:203], v[212:215], v[132:135]
    v_exp_f32 v97, v97
    v_mfma_f32_16x16x32_bf16 v[136:139], a[200:203], v[216:219], v[136:139]
    s_waitcnt lgkmcnt(4)
    v_exp_f32 v98, v98
    v_mfma_f32_16x16x32_bf16 v[132:135], a[204:207], v[228:231], v[132:135]
    v_exp_f32 v99, v99
    v_mfma_f32_16x16x32_bf16 v[136:139], a[204:207], v[232:235], v[136:139]
    s_waitcnt lgkmcnt(3)
    v_cvt_pk_bf16_f32 v88, v88, v89
    v_cvt_pk_bf16_f32 v89, v90, v91
    v_mfma_f32_16x16x32_bf16 v[140:143], a[208:211], v[180:183], v[76:79]
    v_cvt_pk_bf16_f32 v90, v96, v97
    v_cvt_pk_bf16_f32 v91, v98, v99
    v_mfma_f32_16x16x32_bf16 v[144:147], a[208:211], v[184:187], v[80:83]
    s_waitcnt lgkmcnt(2)
    s_waitcnt vmcnt(8)
    s_barrier
    ds_read_b64_tr_b16 a[192:193], v20 offset:32768
    ds_read_b64_tr_b16 a[194:195], v20 offset:36864
    v_mfma_f32_16x16x32_bf16 v[140:143], a[212:215], v[196:199], v[140:143]
    s_add_u32 s42, s84, 3670016
    buffer_store_dwordx4 a[16:19], v16, s[24:27], s42 offen offset:0 sc1
    v_mfma_f32_16x16x32_bf16 v[144:147], a[212:215], v[200:203], v[144:147]
    s_waitcnt lgkmcnt(3)
    ds_read_b64_tr_b16 a[196:197], v21 offset:32768
    ds_read_b64_tr_b16 a[198:199], v21 offset:36864
    v_mfma_f32_16x16x32_bf16 v[140:143], a[216:219], v[212:215], v[140:143]
    buffer_store_dwordx4 a[20:23], v16, s[24:27], s42 offen offset:2048 sc1
    v_mfma_f32_16x16x32_bf16 v[144:147], a[216:219], v[216:219], v[144:147]
    s_waitcnt lgkmcnt(4)
    ds_read_b64_tr_b16 a[200:201], v22 offset:32768
    ds_read_b64_tr_b16 a[202:203], v22 offset:36864
    v_mfma_f32_16x16x32_bf16 v[140:143], a[220:223], v[228:231], v[140:143]
    buffer_store_dwordx4 a[24:27], v16, s[24:27], s42 offen offset:1024 sc1
    v_mfma_f32_16x16x32_bf16 v[144:147], a[220:223], v[232:235], v[144:147]
    ds_read_b64_tr_b16 a[204:205], v23 offset:32768
    ds_read_b64_tr_b16 a[206:207], v23 offset:36864
    v_mfma_f32_16x16x32_bf16 v[68:71], a[224:227], v[84:87], v[68:71]
    buffer_store_dwordx4 a[28:31], v16, s[24:27], s42 offen offset:3072 sc1
    v_mfma_f32_16x16x32_bf16 v[72:75], a[224:227], v[88:91], v[72:75]
    s_waitcnt lgkmcnt(6)
    ds_read_b64_tr_b16 a[208:209], v24 offset:32768
    ds_read_b64_tr_b16 a[210:211], v24 offset:36864
    v_mfma_f32_16x16x32_bf16 v[148:151], a[192:195], v[84:87], v[148:151]
    s_add_u32 m0, s37, 131072
    v_exp_f32 v100, v100
    v_mfma_f32_16x16x32_bf16 v[152:155], a[192:195], v[88:91], v[152:155]
    s_waitcnt lgkmcnt(6)
    ds_read_b64_tr_b16 a[212:213], v25 offset:32768
    ds_read_b64_tr_b16 a[214:215], v25 offset:36864
    v_mfma_f32_16x16x32_bf16 v[188:191], a[196:199], v[84:87], v[188:191]
    s_add_u32 s42, s81, 0
    buffer_load_dwordx4 v62, s[20:23], s42 offen offset:0  lds
    v_mfma_f32_16x16x32_bf16 v[192:195], a[196:199], v[88:91], v[192:195]
    s_waitcnt lgkmcnt(6)
    ds_read_b64_tr_b16 a[216:217], v26 offset:32768
    ds_read_b64_tr_b16 a[218:219], v26 offset:36864
    v_mfma_f32_16x16x32_bf16 v[156:159], a[200:203], v[84:87], v[156:159]
    buffer_load_dwordx4 v63, s[20:23], s42 offen offset:1024  lds
    v_mfma_f32_16x16x32_bf16 v[160:163], a[200:203], v[88:91], v[160:163]
    s_waitcnt lgkmcnt(6)
    ds_read_b64_tr_b16 a[220:221], v27 offset:32768
    ds_read_b64_tr_b16 a[222:223], v27 offset:36864
    v_mfma_f32_16x16x32_bf16 v[204:207], a[204:207], v[84:87], v[204:207]
    buffer_load_dwordx4 v64, s[20:23], s42 offen offset:2048  lds
    v_mfma_f32_16x16x32_bf16 v[208:211], a[204:207], v[88:91], v[208:211]
    s_waitcnt lgkmcnt(6)
    buffer_load_dwordx4 v65, s[20:23], s42 offen offset:3072  lds
    v_mfma_f32_16x16x32_bf16 v[164:167], a[208:211], v[84:87], v[164:167]
    v_exp_f32 v101, v101
    v_mfma_f32_16x16x32_bf16 v[168:171], a[208:211], v[88:91], v[168:171]
    s_waitcnt lgkmcnt(4)
    ds_read_b64_tr_b16 a[192:193], v20 offset:40960
    ds_read_b64_tr_b16 a[194:195], v20 offset:45056
    v_mfma_f32_16x16x32_bf16 v[220:223], a[212:215], v[84:87], v[220:223]
    v_exp_f32 v102, v102
    v_mfma_f32_16x16x32_bf16 v[224:227], a[212:215], v[88:91], v[224:227]
    s_waitcnt lgkmcnt(4)
    ds_read_b64_tr_b16 a[196:197], v21 offset:40960
    ds_read_b64_tr_b16 a[198:199], v21 offset:45056
    v_mfma_f32_16x16x32_bf16 v[172:175], a[216:219], v[84:87], v[172:175]
    v_exp_f32 v103, v103
    v_mfma_f32_16x16x32_bf16 v[176:179], a[216:219], v[88:91], v[176:179]
    s_waitcnt lgkmcnt(4)
    ds_read_b64_tr_b16 a[200:201], v22 offset:40960
    ds_read_b64_tr_b16 a[202:203], v22 offset:45056
    v_mfma_f32_16x16x32_bf16 v[236:239], a[220:223], v[84:87], v[236:239]
    v_exp_f32 v108, v108
    v_mfma_f32_16x16x32_bf16 v[240:243], a[220:223], v[88:91], v[240:243]
    ds_read_b64_tr_b16 a[204:205], v23 offset:40960
    ds_read_b64_tr_b16 a[206:207], v23 offset:45056
    v_exp_f32 v109, v109
    v_exp_f32 v110, v110
    v_exp_f32 v111, v111
    v_cvt_pk_bf16_f32 v100, v100, v101
    v_cvt_pk_bf16_f32 v101, v102, v103
    v_cvt_pk_bf16_f32 v102, v108, v109
    v_cvt_pk_bf16_f32 v103, v110, v111
    v_exp_f32 v104, v104
    v_exp_f32 v105, v105
    v_exp_f32 v106, v106
    v_exp_f32 v107, v107
    v_exp_f32 v112, v112
    v_exp_f32 v113, v113
    v_exp_f32 v114, v114
    v_exp_f32 v115, v115
    v_cvt_pk_bf16_f32 v104, v104, v105
    v_cvt_pk_bf16_f32 v105, v106, v107
    v_cvt_pk_bf16_f32 v106, v112, v113
    v_cvt_pk_bf16_f32 v107, v114, v115
    v_mfma_f32_16x16x32_bf16 v[68:71], a[224:227], v[100:103], v[68:71]
    v_max3_f32 v19, v116, v117, v118
    v_max3_f32 v19, v19, v119, v120
    v_mfma_f32_16x16x32_bf16 v[72:75], a[224:227], v[104:107], v[72:75]
    s_waitcnt lgkmcnt(6)
    ds_read_b64_tr_b16 a[208:209], v24 offset:40960
    ds_read_b64_tr_b16 a[210:211], v24 offset:45056
    v_mfma_f32_16x16x32_bf16 v[148:151], a[192:195], v[100:103], v[148:151]
    v_max3_f32 v19, v19, v121, v122
    v_max3_f32 v19, v19, v123, v124
    v_mfma_f32_16x16x32_bf16 v[152:155], a[192:195], v[104:107], v[152:155]
    s_waitcnt lgkmcnt(6)
    ds_read_b64_tr_b16 a[212:213], v25 offset:40960
    ds_read_b64_tr_b16 a[214:215], v25 offset:45056
    v_mfma_f32_16x16x32_bf16 v[188:191], a[196:199], v[100:103], v[188:191]
    v_max3_f32 v19, v19, v125, v126
    v_max3_f32 v19, v19, v127, v128
    v_mfma_f32_16x16x32_bf16 v[192:195], a[196:199], v[104:107], v[192:195]
    s_waitcnt lgkmcnt(6)
    ds_read_b64_tr_b16 a[216:217], v26 offset:40960
    ds_read_b64_tr_b16 a[218:219], v26 offset:45056
    v_mfma_f32_16x16x32_bf16 v[156:159], a[200:203], v[100:103], v[156:159]
    v_max3_f32 v19, v19, v129, v130
    v_max3_f32 v19, v19, v131, v132
    v_mfma_f32_16x16x32_bf16 v[160:163], a[200:203], v[104:107], v[160:163]
    s_waitcnt lgkmcnt(6)
    ds_read_b64_tr_b16 a[220:221], v27 offset:40960
    ds_read_b64_tr_b16 a[222:223], v27 offset:45056
    v_mfma_f32_16x16x32_bf16 v[204:207], a[204:207], v[100:103], v[204:207]
    v_max3_f32 v19, v19, v133, v134
    v_max3_f32 v19, v19, v135, v136
    v_mfma_f32_16x16x32_bf16 v[208:211], a[204:207], v[104:107], v[208:211]
    s_waitcnt lgkmcnt(6)
    s_barrier
    ds_read_b64_tr_b16 a[192:193], v28 offset:16384
    ds_read_b64_tr_b16 a[194:195], v28 offset:20480
    v_mfma_f32_16x16x32_bf16 v[164:167], a[208:211], v[100:103], v[164:167]
    s_add_u32 m0, s37, 147456
    v_max3_f32 v19, v19, v137, v138
    v_max3_f32 v19, v19, v139, v140
    v_mfma_f32_16x16x32_bf16 v[168:171], a[208:211], v[104:107], v[168:171]
    s_waitcnt lgkmcnt(6)
    ds_read_b64_tr_b16 a[196:197], v29 offset:16384
    ds_read_b64_tr_b16 a[198:199], v29 offset:20480
    v_mfma_f32_16x16x32_bf16 v[220:223], a[212:215], v[100:103], v[220:223]
    s_add_u32 s42, s82, 0
    buffer_load_dwordx4 v62, s[20:23], s42 offen offset:0  lds
    v_mfma_f32_16x16x32_bf16 v[224:227], a[212:215], v[104:107], v[224:227]
    s_waitcnt lgkmcnt(6)
    ds_read_b64_tr_b16 a[200:201], v30 offset:16384
    ds_read_b64_tr_b16 a[202:203], v30 offset:20480
    v_mfma_f32_16x16x32_bf16 v[172:175], a[216:219], v[100:103], v[172:175]
    buffer_load_dwordx4 v63, s[20:23], s42 offen offset:1024  lds
    v_mfma_f32_16x16x32_bf16 v[176:179], a[216:219], v[104:107], v[176:179]
    s_waitcnt lgkmcnt(6)
    ds_read_b64_tr_b16 a[204:205], v31 offset:16384
    ds_read_b64_tr_b16 a[206:207], v31 offset:20480
    v_mfma_f32_16x16x32_bf16 v[236:239], a[220:223], v[100:103], v[236:239]
    buffer_load_dwordx4 v64, s[20:23], s42 offen offset:2048  lds
    v_mfma_f32_16x16x32_bf16 v[240:243], a[220:223], v[104:107], v[240:243]
    v_max3_f32 v19, v19, v141, v142
    v_max3_f32 v19, v19, v143, v144
    v_max3_f32 v19, v19, v145, v146
    v_max_f32 v19, v19, v147
    v_cmp_lt_f32 vcc, s47, v19
    s_cbranch_vccnz w2_t15_slow
w2_t15_back:
    s_waitcnt lgkmcnt(6)
    ds_read_b64_tr_b16 a[208:209], v32 offset:16384
    ds_read_b64_tr_b16 a[210:211], v32 offset:20480
    v_mfma_f32_16x16x32_bf16 v[180:183], a[192:195], a[0:3], 0
    buffer_load_dwordx4 v65, s[20:23], s42 offen offset:3072  lds
    v_mfma_f32_16x16x32_bf16 v[184:187], a[192:195], a[4:7], 0
    s_waitcnt lgkmcnt(6)
    ds_read_b64_tr_b16 a[212:213], v33 offset:16384
    ds_read_b64_tr_b16 a[214:215], v33 offset:20480
    v_mfma_f32_16x16x32_bf16 v[84:87], a[196:199], a[0:3], 0
    v_exp_f32 v116, v116
    v_mfma_f32_16x16x32_bf16 v[88:91], a[196:199], a[4:7], 0
    s_waitcnt lgkmcnt(6)
    ds_read_b64_tr_b16 a[216:217], v34 offset:16384
    ds_read_b64_tr_b16 a[218:219], v34 offset:20480
    v_mfma_f32_16x16x32_bf16 v[196:199], a[200:203], a[0:3], 0
    v_exp_f32 v117, v117
    v_mfma_f32_16x16x32_bf16 v[200:203], a[200:203], a[4:7], 0
    s_waitcnt lgkmcnt(6)
    ds_read_b64_tr_b16 a[220:221], v35 offset:16384
    ds_read_b64_tr_b16 a[222:223], v35 offset:20480
    v_mfma_f32_16x16x32_bf16 v[92:95], a[204:207], a[0:3], 0
    v_exp_f32 v118, v118
    v_mfma_f32_16x16x32_bf16 v[96:99], a[204:207], a[4:7], 0
    s_waitcnt lgkmcnt(6)
    ds_read_b64_tr_b16 a[192:193], v28 offset:24576
    ds_read_b64_tr_b16 a[194:195], v28 offset:28672
    v_mfma_f32_16x16x32_bf16 v[212:215], a[208:211], a[0:3], 0
    v_exp_f32 v119, v119
    v_mfma_f32_16x16x32_bf16 v[216:219], a[208:211], a[4:7], 0
    s_waitcnt lgkmcnt(6)
    ds_read_b64_tr_b16 a[196:197], v29 offset:24576
    ds_read_b64_tr_b16 a[198:199], v29 offset:28672
    v_mfma_f32_16x16x32_bf16 v[100:103], a[212:215], a[0:3], 0
    v_exp_f32 v124, v124
    v_mfma_f32_16x16x32_bf16 v[104:107], a[212:215], a[4:7], 0
    s_waitcnt lgkmcnt(6)
    ds_read_b64_tr_b16 a[200:201], v30 offset:24576
    ds_read_b64_tr_b16 a[202:203], v30 offset:28672
    v_mfma_f32_16x16x32_bf16 v[228:231], a[216:219], a[0:3], 0
    v_exp_f32 v125, v125
    v_mfma_f32_16x16x32_bf16 v[232:235], a[216:219], a[4:7], 0
    s_waitcnt lgkmcnt(6)
    ds_read_b64_tr_b16 a[204:205], v31 offset:24576
    ds_read_b64_tr_b16 a[206:207], v31 offset:28672
    v_mfma_f32_16x16x32_bf16 v[108:111], a[220:223], a[0:3], 0
    v_exp_f32 v126, v126
    v_mfma_f32_16x16x32_bf16 v[112:115], a[220:223], a[4:7], 0
    s_waitcnt lgkmcnt(6)
    ds_read_b64_tr_b16 a[208:209], v32 offset:24576
    ds_read_b64_tr_b16 a[210:211], v32 offset:28672
    v_mfma_f32_16x16x32_bf16 v[180:183], a[192:195], a[8:11], v[180:183]
    v_exp_f32 v127, v127
    v_mfma_f32_16x16x32_bf16 v[184:187], a[192:195], a[12:15], v[184:187]
    s_waitcnt lgkmcnt(6)
    ds_read_b64_tr_b16 a[212:213], v33 offset:24576
    ds_read_b64_tr_b16 a[214:215], v33 offset:28672
    v_mfma_f32_16x16x32_bf16 v[84:87], a[196:199], a[8:11], v[84:87]
    v_cvt_pk_bf16_f32 v116, v116, v117
    v_cvt_pk_bf16_f32 v117, v118, v119
    v_mfma_f32_16x16x32_bf16 v[88:91], a[196:199], a[12:15], v[88:91]
    s_waitcnt lgkmcnt(6)
    ds_read_b64_tr_b16 a[216:217], v34 offset:24576
    ds_read_b64_tr_b16 a[218:219], v34 offset:28672
    v_mfma_f32_16x16x32_bf16 v[196:199], a[200:203], a[8:11], v[196:199]
    v_cvt_pk_bf16_f32 v118, v124, v125
    v_cvt_pk_bf16_f32 v119, v126, v127
    v_mfma_f32_16x16x32_bf16 v[200:203], a[200:203], a[12:15], v[200:203]
    s_waitcnt lgkmcnt(6)
    ds_read_b64_tr_b16 a[220:221], v35 offset:24576
    ds_read_b64_tr_b16 a[222:223], v35 offset:28672
    v_mfma_f32_16x16x32_bf16 v[92:95], a[204:207], a[8:11], v[92:95]
    v_exp_f32 v120, v120
    v_mfma_f32_16x16x32_bf16 v[96:99], a[204:207], a[12:15], v[96:99]
    s_waitcnt lgkmcnt(6)
    s_barrier
    s_waitcnt vmcnt(8)
    s_add_u32 s43, s53, 0
    buffer_store_dword v13, v14, s[24:27], s43 offen sc1
    ds_read_b64_tr_b16 a[192:193], v28 offset:0
    ds_read_b64_tr_b16 a[194:195], v28 offset:4096
    v_mfma_f32_16x16x32_bf16 v[212:215], a[208:211], a[8:11], v[212:215]
    s_add_u32 m0, s37, 114688
    v_exp_f32 v121, v121
    v_mfma_f32_16x16x32_bf16 v[216:219], a[208:211], a[12:15], v[216:219]
    s_waitcnt lgkmcnt(6)
    ds_read_b64_tr_b16 a[196:197], v29 offset:0
    ds_read_b64_tr_b16 a[198:199], v29 offset:4096
    v_mfma_f32_16x16x32_bf16 v[100:103], a[212:215], a[8:11], v[100:103]
    s_add_u32 s42, s83, 0
    buffer_load_dwordx4 v62, s[20:23], s42 offen offset:0  lds
    v_mfma_f32_16x16x32_bf16 v[104:107], a[212:215], a[12:15], v[104:107]
    s_waitcnt lgkmcnt(6)
    ds_read_b64_tr_b16 a[200:201], v30 offset:0
    ds_read_b64_tr_b16 a[202:203], v30 offset:4096
    v_mfma_f32_16x16x32_bf16 v[228:231], a[216:219], a[8:11], v[228:231]
    buffer_load_dwordx4 v63, s[20:23], s42 offen offset:1024  lds
    v_mfma_f32_16x16x32_bf16 v[232:235], a[216:219], a[12:15], v[232:235]
    s_waitcnt lgkmcnt(6)
    ds_read_b64_tr_b16 a[204:205], v31 offset:0
    ds_read_b64_tr_b16 a[206:207], v31 offset:4096
    v_mfma_f32_16x16x32_bf16 v[108:111], a[220:223], a[8:11], v[108:111]
    buffer_load_dwordx4 v64, s[20:23], s42 offen offset:2048  lds
    v_mfma_f32_16x16x32_bf16 v[112:115], a[220:223], a[12:15], v[112:115]
    s_waitcnt lgkmcnt(6)
    ds_read_b64_tr_b16 a[208:209], v32 offset:0
    ds_read_b64_tr_b16 a[210:211], v32 offset:4096
    v_mfma_f32_16x16x32_bf16 v[180:183], a[192:195], a[16:19], v[180:183]
    buffer_load_dwordx4 v65, s[20:23], s42 offen offset:3072  lds
    v_mfma_f32_16x16x32_bf16 v[184:187], a[192:195], a[20:23], v[184:187]
    s_waitcnt lgkmcnt(6)
    ds_read_b64_tr_b16 a[212:213], v33 offset:0
    ds_read_b64_tr_b16 a[214:215], v33 offset:4096
    v_mfma_f32_16x16x32_bf16 v[84:87], a[196:199], a[16:19], v[84:87]
    v_exp_f32 v122, v122
    v_mfma_f32_16x16x32_bf16 v[88:91], a[196:199], a[20:23], v[88:91]
    s_waitcnt lgkmcnt(6)
    ds_read_b64_tr_b16 a[216:217], v34 offset:0
    ds_read_b64_tr_b16 a[218:219], v34 offset:4096
    v_mfma_f32_16x16x32_bf16 v[196:199], a[200:203], a[16:19], v[196:199]
    v_exp_f32 v123, v123
    v_mfma_f32_16x16x32_bf16 v[200:203], a[200:203], a[20:23], v[200:203]
    s_waitcnt lgkmcnt(6)
    ds_read_b64_tr_b16 a[220:221], v35 offset:0
    ds_read_b64_tr_b16 a[222:223], v35 offset:4096
    v_mfma_f32_16x16x32_bf16 v[92:95], a[204:207], a[16:19], v[92:95]
    v_exp_f32 v128, v128
    v_mfma_f32_16x16x32_bf16 v[96:99], a[204:207], a[20:23], v[96:99]
    s_waitcnt lgkmcnt(6)
    ds_read_b64_tr_b16 a[192:193], v28 offset:8192
    ds_read_b64_tr_b16 a[194:195], v28 offset:12288
    v_mfma_f32_16x16x32_bf16 v[212:215], a[208:211], a[16:19], v[212:215]
    v_exp_f32 v129, v129
    v_mfma_f32_16x16x32_bf16 v[216:219], a[208:211], a[20:23], v[216:219]
    s_waitcnt lgkmcnt(6)
    ds_read_b64_tr_b16 a[196:197], v29 offset:8192
    ds_read_b64_tr_b16 a[198:199], v29 offset:12288
    v_mfma_f32_16x16x32_bf16 v[100:103], a[212:215], a[16:19], v[100:103]
    v_exp_f32 v130, v130
    v_mfma_f32_16x16x32_bf16 v[104:107], a[212:215], a[20:23], v[104:107]
    s_waitcnt lgkmcnt(6)
    ds_read_b64_tr_b16 a[200:201], v30 offset:8192
    ds_read_b64_tr_b16 a[202:203], v30 offset:12288
    v_mfma_f32_16x16x32_bf16 v[228:231], a[216:219], a[16:19], v[228:231]
    v_exp_f32 v131, v131
    v_mfma_f32_16x16x32_bf16 v[232:235], a[216:219], a[20:23], v[232:235]
    s_waitcnt lgkmcnt(6)
    ds_read_b64_tr_b16 a[204:205], v31 offset:8192
    ds_read_b64_tr_b16 a[206:207], v31 offset:12288
    v_mfma_f32_16x16x32_bf16 v[108:111], a[220:223], a[16:19], v[108:111]
    v_cvt_pk_bf16_f32 v120, v120, v121
    v_cvt_pk_bf16_f32 v121, v122, v123
    v_mfma_f32_16x16x32_bf16 v[112:115], a[220:223], a[20:23], v[112:115]
    s_waitcnt lgkmcnt(6)
    ds_read_b64_tr_b16 a[208:209], v32 offset:8192
    ds_read_b64_tr_b16 a[210:211], v32 offset:12288
    v_mfma_f32_16x16x32_bf16 v[180:183], a[192:195], a[24:27], v[180:183]
    v_cvt_pk_bf16_f32 v122, v128, v129
    v_cvt_pk_bf16_f32 v123, v130, v131
    v_mfma_f32_16x16x32_bf16 v[184:187], a[192:195], a[28:31], v[184:187]
    s_waitcnt lgkmcnt(6)
    ds_read_b64_tr_b16 a[212:213], v33 offset:8192
    ds_read_b64_tr_b16 a[214:215], v33 offset:12288
    v_mfma_f32_16x16x32_bf16 v[84:87], a[196:199], a[24:27], v[84:87]
    v_exp_f32 v132, v132
    v_mfma_f32_16x16x32_bf16 v[88:91], a[196:199], a[28:31], v[88:91]
    s_waitcnt lgkmcnt(6)
    ds_read_b64_tr_b16 a[216:217], v34 offset:8192
    ds_read_b64_tr_b16 a[218:219], v34 offset:12288
    v_mfma_f32_16x16x32_bf16 v[196:199], a[200:203], a[24:27], v[196:199]
    v_exp_f32 v133, v133
    v_mfma_f32_16x16x32_bf16 v[200:203], a[200:203], a[28:31], v[200:203]
    s_waitcnt lgkmcnt(6)
    ds_read_b64_tr_b16 a[220:221], v35 offset:8192
    ds_read_b64_tr_b16 a[222:223], v35 offset:12288
    v_mfma_f32_16x16x32_bf16 v[92:95], a[204:207], a[24:27], v[92:95]
    v_exp_f32 v134, v134
    v_mfma_f32_16x16x32_bf16 v[96:99], a[204:207], a[28:31], v[96:99]
    s_waitcnt lgkmcnt(6)
    v_exp_f32 v135, v135
    v_mfma_f32_16x16x32_bf16 v[212:215], a[208:211], a[24:27], v[212:215]
    v_exp_f32 v140, v140
    v_mfma_f32_16x16x32_bf16 v[216:219], a[208:211], a[28:31], v[216:219]
    s_waitcnt lgkmcnt(4)
    s_barrier
    s_add_u32 s43, s54, 0
    buffer_load_dword v10, v11, s[24:27], s43 offen sc1
    ds_read_b64_tr_b16 a[192:193], v28 offset:32768
    ds_read_b64_tr_b16 a[194:195], v28 offset:36864
    v_mfma_f32_16x16x32_bf16 v[100:103], a[212:215], a[24:27], v[100:103]
    s_add_u32 m0, s37, 0
    v_exp_f32 v141, v141
    v_mfma_f32_16x16x32_bf16 v[104:107], a[212:215], a[28:31], v[104:107]
    s_waitcnt lgkmcnt(4)
    ds_read_b64_tr_b16 a[196:197], v29 offset:32768
    ds_read_b64_tr_b16 a[198:199], v29 offset:36864
    v_mfma_f32_16x16x32_bf16 v[228:231], a[216:219], a[24:27], v[228:231]
    s_add_u32 s42, s81, 65536
    buffer_load_dwordx4 v62, s[20:23], s42 offen offset:0  lds
    v_mfma_f32_16x16x32_bf16 v[232:235], a[216:219], a[28:31], v[232:235]
    s_waitcnt lgkmcnt(4)
    ds_read_b64_tr_b16 a[200:201], v30 offset:32768
    ds_read_b64_tr_b16 a[202:203], v30 offset:36864
    v_mfma_f32_16x16x32_bf16 v[108:111], a[220:223], a[24:27], v[108:111]
    buffer_load_dwordx4 v63, s[20:23], s42 offen offset:1024  lds
    v_mfma_f32_16x16x32_bf16 v[112:115], a[220:223], a[28:31], v[112:115]
    ds_read_b64_tr_b16 a[204:205], v31 offset:32768
    ds_read_b64_tr_b16 a[206:207], v31 offset:36864
    v_mfma_f32_16x16x32_bf16 v[68:71], a[224:227], v[116:119], v[68:71]
    buffer_load_dwordx4 v64, s[20:23], s42 offen offset:2048  lds
    v_mfma_f32_16x16x32_bf16 v[72:75], a[224:227], v[120:123], v[72:75]
    s_waitcnt lgkmcnt(6)
    ds_read_b64_tr_b16 a[208:209], v32 offset:32768
    ds_read_b64_tr_b16 a[210:211], v32 offset:36864
    v_mfma_f32_16x16x32_bf16 v[148:151], a[192:195], v[116:119], v[148:151]
    buffer_load_dwordx4 v65, s[20:23], s42 offen offset:3072  lds
    v_mfma_f32_16x16x32_bf16 v[152:155], a[192:195], v[120:123], v[152:155]
    s_waitcnt lgkmcnt(6)
    ds_read_b64_tr_b16 a[212:213], v33 offset:32768
    ds_read_b64_tr_b16 a[214:215], v33 offset:36864
    v_mfma_f32_16x16x32_bf16 v[188:191], a[196:199], v[116:119], v[188:191]
    v_exp_f32 v142, v142
    v_mfma_f32_16x16x32_bf16 v[192:195], a[196:199], v[120:123], v[192:195]
    s_waitcnt lgkmcnt(6)
    ds_read_b64_tr_b16 a[216:217], v34 offset:32768
    ds_read_b64_tr_b16 a[218:219], v34 offset:36864
    v_mfma_f32_16x16x32_bf16 v[156:159], a[200:203], v[116:119], v[156:159]
    v_exp_f32 v143, v143
    v_mfma_f32_16x16x32_bf16 v[160:163], a[200:203], v[120:123], v[160:163]
    s_waitcnt lgkmcnt(6)
    ds_read_b64_tr_b16 a[220:221], v35 offset:32768
    ds_read_b64_tr_b16 a[222:223], v35 offset:36864
    v_mfma_f32_16x16x32_bf16 v[204:207], a[204:207], v[116:119], v[204:207]
    v_cvt_pk_bf16_f32 v132, v132, v133
    v_cvt_pk_bf16_f32 v133, v134, v135
    v_mfma_f32_16x16x32_bf16 v[208:211], a[204:207], v[120:123], v[208:211]
    s_waitcnt lgkmcnt(6)
    v_cvt_pk_bf16_f32 v134, v140, v141
    v_cvt_pk_bf16_f32 v135, v142, v143
    v_mfma_f32_16x16x32_bf16 v[164:167], a[208:211], v[116:119], v[164:167]
    v_exp_f32 v136, v136
    v_mfma_f32_16x16x32_bf16 v[168:171], a[208:211], v[120:123], v[168:171]
    s_waitcnt lgkmcnt(4)
    ds_read_b64_tr_b16 a[192:193], v28 offset:40960
    ds_read_b64_tr_b16 a[194:195], v28 offset:45056
    v_mfma_f32_16x16x32_bf16 v[220:223], a[212:215], v[116:119], v[220:223]
    v_exp_f32 v137, v137
    v_mfma_f32_16x16x32_bf16 v[224:227], a[212:215], v[120:123], v[224:227]
    s_waitcnt lgkmcnt(4)
    ds_read_b64_tr_b16 a[196:197], v29 offset:40960
    ds_read_b64_tr_b16 a[198:199], v29 offset:45056
    v_mfma_f32_16x16x32_bf16 v[172:175], a[216:219], v[116:119], v[172:175]
    v_exp_f32 v138, v138
    v_mfma_f32_16x16x32_bf16 v[176:179], a[216:219], v[120:123], v[176:179]
    s_waitcnt lgkmcnt(4)
    ds_read_b64_tr_b16 a[200:201], v30 offset:40960
    ds_read_b64_tr_b16 a[202:203], v30 offset:45056
    v_mfma_f32_16x16x32_bf16 v[236:239], a[220:223], v[116:119], v[236:239]
    v_exp_f32 v139, v139
    v_mfma_f32_16x16x32_bf16 v[240:243], a[220:223], v[120:123], v[240:243]
    ds_read_b64_tr_b16 a[204:205], v31 offset:40960
    ds_read_b64_tr_b16 a[206:207], v31 offset:45056
    v_exp_f32 v144, v144
    v_exp_f32 v145, v145
    v_exp_f32 v146, v146
    v_exp_f32 v147, v147
    v_cvt_pk_bf16_f32 v136, v136, v137
    v_cvt_pk_bf16_f32 v137, v138, v139
    v_cvt_pk_bf16_f32 v138, v144, v145
    v_cvt_pk_bf16_f32 v139, v146, v147
    v_mfma_f32_16x16x32_bf16 v[68:71], a[224:227], v[132:135], v[68:71]
    s_nop 0
    v_mfma_f32_16x16x32_bf16 v[72:75], a[224:227], v[136:139], v[72:75]
    s_waitcnt lgkmcnt(6)
    ds_read_b64_tr_b16 a[208:209], v32 offset:40960
    ds_read_b64_tr_b16 a[210:211], v32 offset:45056
    v_mfma_f32_16x16x32_bf16 v[148:151], a[192:195], v[132:135], v[148:151]
    v_mfma_f32_16x16x32_bf16 v[152:155], a[192:195], v[136:139], v[152:155]
    s_waitcnt lgkmcnt(6)
    ds_read_b64_tr_b16 a[212:213], v33 offset:40960
    ds_read_b64_tr_b16 a[214:215], v33 offset:45056
    v_mfma_f32_16x16x32_bf16 v[188:191], a[196:199], v[132:135], v[188:191]
    v_mfma_f32_16x16x32_bf16 v[192:195], a[196:199], v[136:139], v[192:195]
    s_waitcnt lgkmcnt(6)
    ds_read_b64_tr_b16 a[216:217], v34 offset:40960
    ds_read_b64_tr_b16 a[218:219], v34 offset:45056
    v_mfma_f32_16x16x32_bf16 v[156:159], a[200:203], v[132:135], v[156:159]
    v_mfma_f32_16x16x32_bf16 v[160:163], a[200:203], v[136:139], v[160:163]
    s_waitcnt lgkmcnt(6)
    ds_read_b64_tr_b16 a[220:221], v35 offset:40960
    ds_read_b64_tr_b16 a[222:223], v35 offset:45056
    v_mfma_f32_16x16x32_bf16 v[204:207], a[204:207], v[132:135], v[204:207]
    v_mfma_f32_16x16x32_bf16 v[208:211], a[204:207], v[136:139], v[208:211]
    s_waitcnt lgkmcnt(6)
    s_barrier
    s_waitcnt vmcnt(4)
    v_cmp_ne_u32 s[62:63], 1, v10
    s_nop 0
    s_cmp_lg_u64 s[62:63], 0
    s_cbranch_scc1 w2_p0_spin
w2_p0_back:
    ds_read_b64_tr_b16 a[192:193], v20 offset:49152
    ds_read_b64_tr_b16 a[194:195], v20 offset:53248
    v_mfma_f32_16x16x32_bf16 v[164:167], a[208:211], v[132:135], v[164:167]
    s_add_u32 s42, s85, 0
    buffer_load_dwordx4 a[32:35], v16, s[24:27], s42 offen offset:0 sc1
    v_mfma_f32_16x16x32_bf16 v[168:171], a[208:211], v[136:139], v[168:171]
    s_waitcnt lgkmcnt(6)
    ds_read_b64_tr_b16 a[196:197], v21 offset:49152
    ds_read_b64_tr_b16 a[198:199], v21 offset:53248
    v_mfma_f32_16x16x32_bf16 v[220:223], a[212:215], v[132:135], v[220:223]
    buffer_load_dwordx4 a[36:39], v16, s[24:27], s42 offen offset:2048 sc1
    v_mfma_f32_16x16x32_bf16 v[224:227], a[212:215], v[136:139], v[224:227]
    s_waitcnt lgkmcnt(6)
    ds_read_b64_tr_b16 a[200:201], v22 offset:49152
    ds_read_b64_tr_b16 a[202:203], v22 offset:53248
    v_mfma_f32_16x16x32_bf16 v[172:175], a[216:219], v[132:135], v[172:175]
    buffer_load_dwordx4 a[40:43], v16, s[24:27], s42 offen offset:1024 sc1
    v_mfma_f32_16x16x32_bf16 v[176:179], a[216:219], v[136:139], v[176:179]
    s_waitcnt lgkmcnt(6)
    ds_read_b64_tr_b16 a[204:205], v23 offset:49152
    ds_read_b64_tr_b16 a[206:207], v23 offset:53248
    v_mfma_f32_16x16x32_bf16 v[236:239], a[220:223], v[132:135], v[236:239]
    buffer_load_dwordx4 a[44:47], v16, s[24:27], s42 offen offset:3072 sc1
    v_mfma_f32_16x16x32_bf16 v[240:243], a[220:223], v[136:139], v[240:243]
    s_waitcnt lgkmcnt(6)
    ds_read_b64_tr_b16 a[208:209], v24 offset:49152
    ds_read_b64_tr_b16 a[210:211], v24 offset:53248
    v_rcp_f32 v17, v68
    v_rcp_f32 v18, v72
    v_mul_f32 v148, v17, v148
    v_mul_f32 v149, v17, v149
    v_mul_f32 v150, v17, v150
    v_mul_f32 v151, v17, v151
    v_mul_f32 v188, v17, v188
    v_mul_f32 v189, v17, v189
    v_mul_f32 v190, v17, v190
    v_mul_f32 v191, v17, v191
    v_cvt_pk_bf16_f32 v116, v148, v149
    v_cvt_pk_bf16_f32 v117, v150, v151
    v_cvt_pk_bf16_f32 v118, v188, v189
    v_cvt_pk_bf16_f32 v119, v190, v191
    s_add_u32 s43, s84, 7340032
    buffer_store_dwordx4 v[116:119], v16, s[24:27], s43 offen sc1
    v_mul_f32 v152, v18, v152
    v_mul_f32 v153, v18, v153
    v_mul_f32 v154, v18, v154
    v_mul_f32 v155, v18, v155
    v_mul_f32 v192, v18, v192
    v_mul_f32 v193, v18, v193
    v_mul_f32 v194, v18, v194
    v_mul_f32 v195, v18, v195
    v_cvt_pk_bf16_f32 v120, v152, v153
    v_cvt_pk_bf16_f32 v121, v154, v155
    v_cvt_pk_bf16_f32 v122, v192, v193
    v_cvt_pk_bf16_f32 v123, v194, v195
    s_add_u32 s43, s84, 7342080
    buffer_store_dwordx4 v[120:123], v16, s[24:27], s43 offen sc1
    v_mul_f32 v156, v17, v156
    v_mul_f32 v157, v17, v157
    v_mul_f32 v158, v17, v158
    v_mul_f32 v159, v17, v159
    v_mul_f32 v204, v17, v204
    v_mul_f32 v205, v17, v205
    v_mul_f32 v206, v17, v206
    v_mul_f32 v207, v17, v207
    v_cvt_pk_bf16_f32 v124, v156, v157
    v_cvt_pk_bf16_f32 v125, v158, v159
    v_cvt_pk_bf16_f32 v126, v204, v205
    v_cvt_pk_bf16_f32 v127, v206, v207
    s_add_u32 s43, s84, 7341056
    buffer_store_dwordx4 v[124:127], v16, s[24:27], s43 offen sc1
    v_mul_f32 v160, v18, v160
    v_mul_f32 v161, v18, v161
    v_mul_f32 v162, v18, v162
    v_mul_f32 v163, v18, v163
    v_mul_f32 v208, v18, v208
    v_mul_f32 v209, v18, v209
    v_mul_f32 v210, v18, v210
    v_mul_f32 v211, v18, v211
    v_cvt_pk_bf16_f32 v128, v160, v161
    v_cvt_pk_bf16_f32 v129, v162, v163
    v_cvt_pk_bf16_f32 v130, v208, v209
    v_cvt_pk_bf16_f32 v131, v210, v211
    s_add_u32 s43, s84, 7343104
    buffer_store_dwordx4 v[128:131], v16, s[24:27], s43 offen sc1
    v_mul_f32 v164, v17, v164
    v_mul_f32 v165, v17, v165
    v_mul_f32 v166, v17, v166
    v_mul_f32 v167, v17, v167
    v_mul_f32 v220, v17, v220
    v_mul_f32 v221, v17, v221
    v_mul_f32 v222, v17, v222
    v_mul_f32 v223, v17, v223
    v_cvt_pk_bf16_f32 v140, v164, v165
    v_cvt_pk_bf16_f32 v141, v166, v167
    v_cvt_pk_bf16_f32 v142, v220, v221
    v_cvt_pk_bf16_f32 v143, v222, v223
    s_add_u32 s43, s84, 11010048
    buffer_store_dwordx4 v[140:143], v16, s[24:27], s43 offen sc1
    v_mul_f32 v168, v18, v168
    v_mul_f32 v169, v18, v169
    v_mul_f32 v170, v18, v170
    v_mul_f32 v171, v18, v171
    v_mul_f32 v224, v18, v224
    v_mul_f32 v225, v18, v225
    v_mul_f32 v226, v18, v226
    v_mul_f32 v227, v18, v227
    v_cvt_pk_bf16_f32 v144, v168, v169
    v_cvt_pk_bf16_f32 v145, v170, v171
    v_cvt_pk_bf16_f32 v146, v224, v225
    v_cvt_pk_bf16_f32 v147, v226, v227
    s_add_u32 s43, s84, 11012096
    buffer_store_dwordx4 v[144:147], v16, s[24:27], s43 offen sc1
    v_mul_f32 v172, v17, v172
    v_mul_f32 v173, v17, v173
    v_mul_f32 v174, v17, v174
    v_mul_f32 v175, v17, v175
    v_mul_f32 v236, v17, v236
    v_mul_f32 v237, v17, v237
    v_mul_f32 v238, v17, v238
    v_mul_f32 v239, v17, v239
    v_cvt_pk_bf16_f32 v132, v172, v173
    v_cvt_pk_bf16_f32 v133, v174, v175
    v_cvt_pk_bf16_f32 v134, v236, v237
    v_cvt_pk_bf16_f32 v135, v238, v239
    s_add_u32 s43, s84, 11011072
    buffer_store_dwordx4 v[132:135], v16, s[24:27], s43 offen sc1
    v_mul_f32 v176, v18, v176
    v_mul_f32 v177, v18, v177
    v_mul_f32 v178, v18, v178
    v_mul_f32 v179, v18, v179
    v_mul_f32 v240, v18, v240
    v_mul_f32 v241, v18, v241
    v_mul_f32 v242, v18, v242
    v_mul_f32 v243, v18, v243
    v_cvt_pk_bf16_f32 v136, v176, v177
    v_cvt_pk_bf16_f32 v137, v178, v179
    v_cvt_pk_bf16_f32 v138, v240, v241
    v_cvt_pk_bf16_f32 v139, v242, v243
    s_add_u32 s43, s84, 11013120
    buffer_store_dwordx4 v[136:139], v16, s[24:27], s43 offen sc1
    v_mfma_f32_16x16x32_bf16 v[180:183], a[192:195], v[116:119], v[180:183]
    v_mfma_f32_16x16x32_bf16 v[184:187], a[192:195], v[120:123], v[184:187]
    s_waitcnt lgkmcnt(6)
    ds_read_b64_tr_b16 a[212:213], v25 offset:49152
    ds_read_b64_tr_b16 a[214:215], v25 offset:53248
    v_mfma_f32_16x16x32_bf16 v[84:87], a[196:199], v[116:119], v[84:87]
    v_mfma_f32_16x16x32_bf16 v[88:91], a[196:199], v[120:123], v[88:91]
    s_waitcnt lgkmcnt(6)
    ds_read_b64_tr_b16 a[216:217], v26 offset:49152
    ds_read_b64_tr_b16 a[218:219], v26 offset:53248
    v_mfma_f32_16x16x32_bf16 v[196:199], a[200:203], v[116:119], v[196:199]
    v_mfma_f32_16x16x32_bf16 v[200:203], a[200:203], v[120:123], v[200:203]
    s_waitcnt lgkmcnt(6)
    ds_read_b64_tr_b16 a[220:221], v27 offset:49152
    ds_read_b64_tr_b16 a[222:223], v27 offset:53248
    v_mfma_f32_16x16x32_bf16 v[92:95], a[204:207], v[116:119], v[92:95]
    v_mfma_f32_16x16x32_bf16 v[96:99], a[204:207], v[120:123], v[96:99]
    s_waitcnt lgkmcnt(6)
    ds_read_b64_tr_b16 a[192:193], v20 offset:57344
    ds_read_b64_tr_b16 a[194:195], v20 offset:61440
    v_mfma_f32_16x16x32_bf16 v[212:215], a[208:211], v[116:119], v[212:215]
    v_mfma_f32_16x16x32_bf16 v[216:219], a[208:211], v[120:123], v[216:219]
    s_waitcnt lgkmcnt(6)
    ds_read_b64_tr_b16 a[196:197], v21 offset:57344
    ds_read_b64_tr_b16 a[198:199], v21 offset:61440
    v_mfma_f32_16x16x32_bf16 v[100:103], a[212:215], v[116:119], v[100:103]
    v_mfma_f32_16x16x32_bf16 v[104:107], a[212:215], v[120:123], v[104:107]
    s_waitcnt lgkmcnt(6)
    ds_read_b64_tr_b16 a[200:201], v22 offset:57344
    ds_read_b64_tr_b16 a[202:203], v22 offset:61440
    v_mfma_f32_16x16x32_bf16 v[228:231], a[216:219], v[116:119], v[228:231]
    v_mfma_f32_16x16x32_bf16 v[232:235], a[216:219], v[120:123], v[232:235]
    s_waitcnt lgkmcnt(6)
    ds_read_b64_tr_b16 a[204:205], v23 offset:57344
    ds_read_b64_tr_b16 a[206:207], v23 offset:61440
    v_mfma_f32_16x16x32_bf16 v[108:111], a[220:223], v[116:119], v[108:111]
    v_mfma_f32_16x16x32_bf16 v[112:115], a[220:223], v[120:123], v[112:115]
    s_waitcnt lgkmcnt(6)
    ds_read_b64_tr_b16 a[208:209], v24 offset:57344
    ds_read_b64_tr_b16 a[210:211], v24 offset:61440
    v_mfma_f32_16x16x32_bf16 v[180:183], a[192:195], v[124:127], v[180:183]
    v_mfma_f32_16x16x32_bf16 v[184:187], a[192:195], v[128:131], v[184:187]
    s_waitcnt lgkmcnt(6)
    ds_read_b64_tr_b16 a[212:213], v25 offset:57344
    ds_read_b64_tr_b16 a[214:215], v25 offset:61440
    v_mfma_f32_16x16x32_bf16 v[84:87], a[196:199], v[124:127], v[84:87]
    v_mfma_f32_16x16x32_bf16 v[88:91], a[196:199], v[128:131], v[88:91]
    s_waitcnt lgkmcnt(6)
    ds_read_b64_tr_b16 a[216:217], v26 offset:57344
    ds_read_b64_tr_b16 a[218:219], v26 offset:61440
    v_mfma_f32_16x16x32_bf16 v[196:199], a[200:203], v[124:127], v[196:199]
    v_mfma_f32_16x16x32_bf16 v[200:203], a[200:203], v[128:131], v[200:203]
    s_waitcnt lgkmcnt(6)
    ds_read_b64_tr_b16 a[220:221], v27 offset:57344
    ds_read_b64_tr_b16 a[222:223], v27 offset:61440
    v_mfma_f32_16x16x32_bf16 v[92:95], a[204:207], v[124:127], v[92:95]
    v_mfma_f32_16x16x32_bf16 v[96:99], a[204:207], v[128:131], v[96:99]
    s_waitcnt lgkmcnt(6)
    s_barrier
    ds_read_b64_tr_b16 a[192:193], v20 offset:16384
    ds_read_b64_tr_b16 a[194:195], v20 offset:20480
    s_add_u32 s42, s86, 0
    buffer_load_dwordx4 a[64:67], v16, s[24:27], s42 offen offset:0 sc1
    v_mfma_f32_16x16x32_bf16 v[212:215], a[208:211], v[124:127], v[212:215]
    buffer_load_dwordx4 a[68:71], v16, s[24:27], s42 offen offset:2048 sc1
    v_mfma_f32_16x16x32_bf16 v[216:219], a[208:211], v[128:131], v[216:219]
    s_waitcnt lgkmcnt(6)
    ds_read_b64_tr_b16 a[196:197], v21 offset:16384
    ds_read_b64_tr_b16 a[198:199], v21 offset:20480
    buffer_load_dwordx4 a[72:75], v16, s[24:27], s42 offen offset:1024 sc1
    v_mfma_f32_16x16x32_bf16 v[100:103], a[212:215], v[124:127], v[100:103]
    buffer_load_dwordx4 a[76:79], v16, s[24:27], s42 offen offset:3072 sc1
    v_mfma_f32_16x16x32_bf16 v[104:107], a[212:215], v[128:131], v[104:107]
    s_waitcnt lgkmcnt(6)
    ds_read_b64_tr_b16 a[200:201], v22 offset:16384
    ds_read_b64_tr_b16 a[202:203], v22 offset:20480
    s_add_u32 m0, s37, 32768
    s_add_u32 s42, s82, 65536
    buffer_load_dwordx4 v62, s[20:23], s42 offen offset:0  lds
    v_mfma_f32_16x16x32_bf16 v[228:231], a[216:219], v[124:127], v[228:231]
    buffer_load_dwordx4 v63, s[20:23], s42 offen offset:1024  lds
    v_mfma_f32_16x16x32_bf16 v[232:235], a[216:219], v[128:131], v[232:235]
    s_waitcnt lgkmcnt(6)
    ds_read_b64_tr_b16 a[204:205], v23 offset:16384
    ds_read_b64_tr_b16 a[206:207], v23 offset:20480
    buffer_load_dwordx4 v64, s[20:23], s42 offen offset:2048  lds
    v_mfma_f32_16x16x32_bf16 v[108:111], a[220:223], v[124:127], v[108:111]
    buffer_load_dwordx4 v65, s[20:23], s42 offen offset:3072  lds
    v_mfma_f32_16x16x32_bf16 v[112:115], a[220:223], v[128:131], v[112:115]
    s_waitcnt lgkmcnt(6)
    ds_read_b64_tr_b16 a[208:209], v24 offset:16384
    ds_read_b64_tr_b16 a[210:211], v24 offset:20480
    s_add_u32 s42, s87, 0
    buffer_load_dwordx4 a[96:99], v16, s[24:27], s42 offen offset:0 sc1
    v_mfma_f32_16x16x32_bf16 v[180:183], a[192:195], v[140:143], v[180:183]
    buffer_load_dwordx4 a[100:103], v16, s[24:27], s42 offen offset:2048 sc1
    v_mfma_f32_16x16x32_bf16 v[184:187], a[192:195], v[144:147], v[184:187]
    s_waitcnt lgkmcnt(6)
    ds_read_b64_tr_b16 a[212:213], v25 offset:16384
    ds_read_b64_tr_b16 a[214:215], v25 offset:20480
    v_mfma_f32_16x16x32_bf16 v[84:87], a[196:199], v[140:143], v[84:87]
    buffer_load_dwordx4 a[104:107], v16, s[24:27], s42 offen offset:1024 sc1
    v_mfma_f32_16x16x32_bf16 v[88:91], a[196:199], v[144:147], v[88:91]
    s_waitcnt lgkmcnt(6)
    ds_read_b64_tr_b16 a[216:217], v26 offset:16384
    ds_read_b64_tr_b16 a[218:219], v26 offset:20480
    v_mfma_f32_16x16x32_bf16 v[196:199], a[200:203], v[140:143], v[196:199]
    buffer_load_dwordx4 a[108:111], v16, s[24:27], s42 offen offset:3072 sc1
    v_mfma_f32_16x16x32_bf16 v[200:203], a[200:203], v[144:147], v[200:203]
    s_waitcnt lgkmcnt(6)
    ds_read_b64_tr_b16 a[220:221], v27 offset:16384
    ds_read_b64_tr_b16 a[222:223], v27 offset:20480
    v_mfma_f32_16x16x32_bf16 v[92:95], a[204:207], v[140:143], v[92:95]
    v_mfma_f32_16x16x32_bf16 v[96:99], a[204:207], v[144:147], v[96:99]
    s_waitcnt lgkmcnt(6)
    ds_read_b64_tr_b16 a[192:193], v20 offset:24576
    ds_read_b64_tr_b16 a[194:195], v20 offset:28672
    v_mfma_f32_16x16x32_bf16 v[212:215], a[208:211], v[140:143], v[212:215]
    v_mfma_f32_16x16x32_bf16 v[216:219], a[208:211], v[144:147], v[216:219]
    s_waitcnt lgkmcnt(6)
    ds_read_b64_tr_b16 a[196:197], v21 offset:24576
    ds_read_b64_tr_b16 a[198:199], v21 offset:28672
    v_mfma_f32_16x16x32_bf16 v[100:103], a[212:215], v[140:143], v[100:103]
    v_mfma_f32_16x16x32_bf16 v[104:107], a[212:215], v[144:147], v[104:107]
    s_waitcnt lgkmcnt(6)
    ds_read_b64_tr_b16 a[200:201], v22 offset:24576
    ds_read_b64_tr_b16 a[202:203], v22 offset:28672
    v_mfma_f32_16x16x32_bf16 v[228:231], a[216:219], v[140:143], v[228:231]
    v_mfma_f32_16x16x32_bf16 v[232:235], a[216:219], v[144:147], v[232:235]
    s_waitcnt lgkmcnt(6)
    ds_read_b64_tr_b16 a[204:205], v23 offset:24576
    ds_read_b64_tr_b16 a[206:207], v23 offset:28672
    v_mfma_f32_16x16x32_bf16 v[108:111], a[220:223], v[140:143], v[108:111]
    v_mfma_f32_16x16x32_bf16 v[112:115], a[220:223], v[144:147], v[112:115]
    s_waitcnt lgkmcnt(6)
    ds_read_b64_tr_b16 a[208:209], v24 offset:24576
    ds_read_b64_tr_b16 a[210:211], v24 offset:28672
    v_mfma_f32_16x16x32_bf16 v[180:183], a[192:195], v[132:135], v[180:183]
    v_mfma_f32_16x16x32_bf16 v[184:187], a[192:195], v[136:139], v[184:187]
    s_waitcnt lgkmcnt(6)
    ds_read_b64_tr_b16 a[212:213], v25 offset:24576
    ds_read_b64_tr_b16 a[214:215], v25 offset:28672
    v_mfma_f32_16x16x32_bf16 v[84:87], a[196:199], v[132:135], v[84:87]
    v_mfma_f32_16x16x32_bf16 v[88:91], a[196:199], v[136:139], v[88:91]
    s_waitcnt lgkmcnt(6)
    ds_read_b64_tr_b16 a[216:217], v26 offset:24576
    ds_read_b64_tr_b16 a[218:219], v26 offset:28672
    v_mfma_f32_16x16x32_bf16 v[196:199], a[200:203], v[132:135], v[196:199]
    v_mfma_f32_16x16x32_bf16 v[200:203], a[200:203], v[136:139], v[200:203]
    s_waitcnt lgkmcnt(6)
    ds_read_b64_tr_b16 a[220:221], v27 offset:24576
    ds_read_b64_tr_b16 a[222:223], v27 offset:28672
    v_mfma_f32_16x16x32_bf16 v[92:95], a[204:207], v[132:135], v[92:95]
    v_mfma_f32_16x16x32_bf16 v[96:99], a[204:207], v[136:139], v[96:99]
    s_waitcnt lgkmcnt(6)
    s_barrier
    s_waitcnt vmcnt(12)
    s_add_u32 s43, s53, 131072
    buffer_store_dword v13, v14, s[24:27], s43 offen sc1
    ds_read_b64_tr_b16 a[192:193], v36 offset:0
    ds_read_b64_tr_b16 a[194:195], v36 offset:4096
    v_mfma_f32_16x16x32_bf16 v[212:215], a[208:211], v[132:135], v[212:215]
    s_add_u32 s42, s85, 3670016
    buffer_load_dwordx4 a[48:51], v16, s[24:27], s42 offen offset:0 sc1
    v_mfma_f32_16x16x32_bf16 v[216:219], a[208:211], v[136:139], v[216:219]
    s_waitcnt lgkmcnt(6)
    ds_read_b64_tr_b16 a[196:197], v37 offset:0
    ds_read_b64_tr_b16 a[198:199], v37 offset:4096
    v_mfma_f32_16x16x32_bf16 v[100:103], a[212:215], v[132:135], v[100:103]
    buffer_load_dwordx4 a[52:55], v16, s[24:27], s42 offen offset:2048 sc1
    v_mfma_f32_16x16x32_bf16 v[104:107], a[212:215], v[136:139], v[104:107]
    s_waitcnt lgkmcnt(6)
    ds_read_b64_tr_b16 a[200:201], v38 offset:0
    ds_read_b64_tr_b16 a[202:203], v38 offset:4096
    v_mfma_f32_16x16x32_bf16 v[228:231], a[216:219], v[132:135], v[228:231]
    buffer_load_dwordx4 a[56:59], v16, s[24:27], s42 offen offset:1024 sc1
    v_mfma_f32_16x16x32_bf16 v[232:235], a[216:219], v[136:139], v[232:235]
    s_waitcnt lgkmcnt(6)
    ds_read_b64_tr_b16 a[204:205], v39 offset:0
    ds_read_b64_tr_b16 a[206:207], v39 offset:4096
    v_mfma_f32_16x16x32_bf16 v[108:111], a[220:223], v[132:135], v[108:111]
    buffer_load_dwordx4 a[60:63], v16, s[24:27], s42 offen offset:3072 sc1
    v_mfma_f32_16x16x32_bf16 v[112:115], a[220:223], v[136:139], v[112:115]
    s_waitcnt lgkmcnt(6)
    ds_read_b64_tr_b16 a[208:209], v40 offset:0
    ds_read_b64_tr_b16 a[210:211], v40 offset:4096
    v_mfma_f32_16x16x32_bf16 v[180:183], a[192:195], a[32:35], v[180:183]
    s_add_u32 m0, s37, 81920
    s_add_u32 s42, s83, 65536
    v_mfma_f32_16x16x32_bf16 v[184:187], a[192:195], a[36:39], v[184:187]
    s_waitcnt lgkmcnt(6)
    ds_read_b64_tr_b16 a[212:213], v41 offset:0
    ds_read_b64_tr_b16 a[214:215], v41 offset:4096
    v_mfma_f32_16x16x32_bf16 v[84:87], a[196:199], a[32:35], v[84:87]
    buffer_load_dwordx4 v62, s[20:23], s42 offen offset:0  lds
    v_mfma_f32_16x16x32_bf16 v[88:91], a[196:199], a[36:39], v[88:91]
    s_waitcnt lgkmcnt(6)
    ds_read_b64_tr_b16 a[216:217], v42 offset:0
    ds_read_b64_tr_b16 a[218:219], v42 offset:4096
    v_mfma_f32_16x16x32_bf16 v[196:199], a[200:203], a[32:35], v[196:199]
    buffer_load_dwordx4 v63, s[20:23], s42 offen offset:1024  lds
    v_mfma_f32_16x16x32_bf16 v[200:203], a[200:203], a[36:39], v[200:203]
    s_waitcnt lgkmcnt(6)
    ds_read_b64_tr_b16 a[220:221], v43 offset:0
    ds_read_b64_tr_b16 a[222:223], v43 offset:4096
    v_mfma_f32_16x16x32_bf16 v[92:95], a[204:207], a[32:35], v[92:95]
    buffer_load_dwordx4 v64, s[20:23], s42 offen offset:2048  lds
    v_mfma_f32_16x16x32_bf16 v[96:99], a[204:207], a[36:39], v[96:99]
    s_waitcnt lgkmcnt(6)
    ds_read_b64_tr_b16 a[192:193], v36 offset:8192
    ds_read_b64_tr_b16 a[194:195], v36 offset:12288
    v_mfma_f32_16x16x32_bf16 v[212:215], a[208:211], a[32:35], v[212:215]
    buffer_load_dwordx4 v65, s[20:23], s42 offen offset:3072  lds
    v_mfma_f32_16x16x32_bf16 v[216:219], a[208:211], a[36:39], v[216:219]
    s_waitcnt lgkmcnt(6)
    ds_read_b64_tr_b16 a[196:197], v37 offset:8192
    ds_read_b64_tr_b16 a[198:199], v37 offset:12288
    v_mfma_f32_16x16x32_bf16 v[100:103], a[212:215], a[32:35], v[100:103]
    v_mfma_f32_16x16x32_bf16 v[104:107], a[212:215], a[36:39], v[104:107]
    s_waitcnt lgkmcnt(6)
    ds_read_b64_tr_b16 a[200:201], v38 offset:8192
    ds_read_b64_tr_b16 a[202:203], v38 offset:12288
    v_mfma_f32_16x16x32_bf16 v[228:231], a[216:219], a[32:35], v[228:231]
    v_mfma_f32_16x16x32_bf16 v[232:235], a[216:219], a[36:39], v[232:235]
    s_waitcnt lgkmcnt(6)
    ds_read_b64_tr_b16 a[204:205], v39 offset:8192
    ds_read_b64_tr_b16 a[206:207], v39 offset:12288
    v_mfma_f32_16x16x32_bf16 v[108:111], a[220:223], a[32:35], v[108:111]
    v_mfma_f32_16x16x32_bf16 v[112:115], a[220:223], a[36:39], v[112:115]
    s_waitcnt lgkmcnt(6)
    ds_read_b64_tr_b16 a[208:209], v40 offset:8192
    ds_read_b64_tr_b16 a[210:211], v40 offset:12288
    v_mfma_f32_16x16x32_bf16 v[180:183], a[192:195], a[40:43], v[180:183]
    v_mfma_f32_16x16x32_bf16 v[184:187], a[192:195], a[44:47], v[184:187]
    s_waitcnt lgkmcnt(6)
    ds_read_b64_tr_b16 a[212:213], v41 offset:8192
    ds_read_b64_tr_b16 a[214:215], v41 offset:12288
    v_mfma_f32_16x16x32_bf16 v[84:87], a[196:199], a[40:43], v[84:87]
    v_mfma_f32_16x16x32_bf16 v[88:91], a[196:199], a[44:47], v[88:91]
    s_waitcnt lgkmcnt(6)
    ds_read_b64_tr_b16 a[216:217], v42 offset:8192
    ds_read_b64_tr_b16 a[218:219], v42 offset:12288
    v_mfma_f32_16x16x32_bf16 v[196:199], a[200:203], a[40:43], v[196:199]
    v_mfma_f32_16x16x32_bf16 v[200:203], a[200:203], a[44:47], v[200:203]
    s_waitcnt lgkmcnt(6)
    ds_read_b64_tr_b16 a[220:221], v43 offset:8192
    ds_read_b64_tr_b16 a[222:223], v43 offset:12288
    v_mfma_f32_16x16x32_bf16 v[92:95], a[204:207], a[40:43], v[92:95]
    v_mfma_f32_16x16x32_bf16 v[96:99], a[204:207], a[44:47], v[96:99]
    s_waitcnt lgkmcnt(6)
    s_barrier
    ds_read_b64_tr_b16 a[192:193], v36 offset:16384
    ds_read_b64_tr_b16 a[194:195], v36 offset:20480
    v_mfma_f32_16x16x32_bf16 v[212:215], a[208:211], a[40:43], v[212:215]
    s_add_u32 s42, s86, 3670016
    buffer_load_dwordx4 a[80:83], v16, s[24:27], s42 offen offset:0 sc1
    v_mfma_f32_16x16x32_bf16 v[216:219], a[208:211], a[44:47], v[216:219]
    s_waitcnt lgkmcnt(6)
    ds_read_b64_tr_b16 a[196:197], v37 offset:16384
    ds_read_b64_tr_b16 a[198:199], v37 offset:20480
    v_mfma_f32_16x16x32_bf16 v[100:103], a[212:215], a[40:43], v[100:103]
    buffer_load_dwordx4 a[84:87], v16, s[24:27], s42 offen offset:2048 sc1
    v_mfma_f32_16x16x32_bf16 v[104:107], a[212:215], a[44:47], v[104:107]
    s_waitcnt lgkmcnt(6)
    ds_read_b64_tr_b16 a[200:201], v38 offset:16384
    ds_read_b64_tr_b16 a[202:203], v38 offset:20480
    v_mfma_f32_16x16x32_bf16 v[228:231], a[216:219], a[40:43], v[228:231]
    buffer_load_dwordx4 a[88:91], v16, s[24:27], s42 offen offset:1024 sc1
    v_mfma_f32_16x16x32_bf16 v[232:235], a[216:219], a[44:47], v[232:235]
    s_waitcnt lgkmcnt(6)
    ds_read_b64_tr_b16 a[204:205], v39 offset:16384
    ds_read_b64_tr_b16 a[206:207], v39 offset:20480
    v_mfma_f32_16x16x32_bf16 v[108:111], a[220:223], a[40:43], v[108:111]
    buffer_load_dwordx4 a[92:95], v16, s[24:27], s42 offen offset:3072 sc1
    v_mfma_f32_16x16x32_bf16 v[112:115], a[220:223], a[44:47], v[112:115]
    s_waitcnt vmcnt(21)
    s_waitcnt lgkmcnt(6)
    ds_read_b64_tr_b16 a[208:209], v40 offset:16384
    ds_read_b64_tr_b16 a[210:211], v40 offset:20480
    v_mfma_f32_16x16x32_bf16 v[180:183], a[192:195], a[64:67], v[180:183]
    s_add_u32 s42, s87, 3670016
    buffer_load_dwordx4 a[112:115], v16, s[24:27], s42 offen offset:0 sc1
    v_mfma_f32_16x16x32_bf16 v[184:187], a[192:195], a[68:71], v[184:187]
    s_waitcnt lgkmcnt(6)
    ds_read_b64_tr_b16 a[212:213], v41 offset:16384
    ds_read_b64_tr_b16 a[214:215], v41 offset:20480
    v_mfma_f32_16x16x32_bf16 v[84:87], a[196:199], a[64:67], v[84:87]
    buffer_load_dwordx4 a[116:119], v16, s[24:27], s42 offen offset:2048 sc1
    v_mfma_f32_16x16x32_bf16 v[88:91], a[196:199], a[68:71], v[88:91]
    s_waitcnt lgkmcnt(6)
    ds_read_b64_tr_b16 a[216:217], v42 offset:16384
    ds_read_b64_tr_b16 a[218:219], v42 offset:20480
    v_mfma_f32_16x16x32_bf16 v[196:199], a[200:203], a[64:67], v[196:199]
    buffer_load_dwordx4 a[120:123], v16, s[24:27], s42 offen offset:1024 sc1
    v_mfma_f32_16x16x32_bf16 v[200:203], a[200:203], a[68:71], v[200:203]
    s_waitcnt lgkmcnt(6)
    ds_read_b64_tr_b16 a[220:221], v43 offset:16384
    ds_read_b64_tr_b16 a[222:223], v43 offset:20480
    v_mfma_f32_16x16x32_bf16 v[92:95], a[204:207], a[64:67], v[92:95]
    buffer_load_dwordx4 a[124:127], v16, s[24:27], s42 offen offset:3072 sc1
    v_mfma_f32_16x16x32_bf16 v[96:99], a[204:207], a[68:71], v[96:99]
    s_waitcnt lgkmcnt(6)
    ds_read_b64_tr_b16 a[192:193], v36 offset:24576
    ds_read_b64_tr_b16 a[194:195], v36 offset:28672
    v_mfma_f32_16x16x32_bf16 v[212:215], a[208:211], a[64:67], v[212:215]
    s_add_u32 m0, s37, 65536
    s_add_u32 s42, s81, 131072
    v_mfma_f32_16x16x32_bf16 v[216:219], a[208:211], a[68:71], v[216:219]
    s_waitcnt lgkmcnt(6)
    ds_read_b64_tr_b16 a[196:197], v37 offset:24576
    ds_read_b64_tr_b16 a[198:199], v37 offset:28672
    v_mfma_f32_16x16x32_bf16 v[100:103], a[212:215], a[64:67], v[100:103]
    buffer_load_dwordx4 v62, s[20:23], s42 offen offset:0  lds
    v_mfma_f32_16x16x32_bf16 v[104:107], a[212:215], a[68:71], v[104:107]
    s_waitcnt lgkmcnt(6)
    ds_read_b64_tr_b16 a[200:201], v38 offset:24576
    ds_read_b64_tr_b16 a[202:203], v38 offset:28672
    v_mfma_f32_16x16x32_bf16 v[228:231], a[216:219], a[64:67], v[228:231]
    buffer_load_dwordx4 v63, s[20:23], s42 offen offset:1024  lds
    v_mfma_f32_16x16x32_bf16 v[232:235], a[216:219], a[68:71], v[232:235]
    s_waitcnt lgkmcnt(6)
    ds_read_b64_tr_b16 a[204:205], v39 offset:24576
    ds_read_b64_tr_b16 a[206:207], v39 offset:28672
    v_mfma_f32_16x16x32_bf16 v[108:111], a[220:223], a[64:67], v[108:111]
    buffer_load_dwordx4 v64, s[20:23], s42 offen offset:2048  lds
    v_mfma_f32_16x16x32_bf16 v[112:115], a[220:223], a[68:71], v[112:115]
    s_waitcnt lgkmcnt(6)
    ds_read_b64_tr_b16 a[208:209], v40 offset:24576
    ds_read_b64_tr_b16 a[210:211], v40 offset:28672
    v_mfma_f32_16x16x32_bf16 v[180:183], a[192:195], a[72:75], v[180:183]
    buffer_load_dwordx4 v65, s[20:23], s42 offen offset:3072  lds
    v_mfma_f32_16x16x32_bf16 v[184:187], a[192:195], a[76:79], v[184:187]
    s_waitcnt lgkmcnt(6)
    ds_read_b64_tr_b16 a[212:213], v41 offset:24576
    ds_read_b64_tr_b16 a[214:215], v41 offset:28672
    v_mfma_f32_16x16x32_bf16 v[84:87], a[196:199], a[72:75], v[84:87]
    v_mfma_f32_16x16x32_bf16 v[88:91], a[196:199], a[76:79], v[88:91]
    s_waitcnt lgkmcnt(6)
    ds_read_b64_tr_b16 a[216:217], v42 offset:24576
    ds_read_b64_tr_b16 a[218:219], v42 offset:28672
    v_mfma_f32_16x16x32_bf16 v[196:199], a[200:203], a[72:75], v[196:199]
    v_mfma_f32_16x16x32_bf16 v[200:203], a[200:203], a[76:79], v[200:203]
    s_waitcnt lgkmcnt(6)
    ds_read_b64_tr_b16 a[220:221], v43 offset:24576
    ds_read_b64_tr_b16 a[222:223], v43 offset:28672
    v_mfma_f32_16x16x32_bf16 v[92:95], a[204:207], a[72:75], v[92:95]
    v_mfma_f32_16x16x32_bf16 v[96:99], a[204:207], a[76:79], v[96:99]
    s_waitcnt lgkmcnt(6)
    s_barrier
    s_add_u32 s43, s54, 131072
    buffer_load_dword v10, v11, s[24:27], s43 offen sc1
    ds_read_b64_tr_b16 a[192:193], v28 offset:49152
    ds_read_b64_tr_b16 a[194:195], v28 offset:53248
    v_mfma_f32_16x16x32_bf16 v[212:215], a[208:211], a[72:75], v[212:215]
    s_add_u32 m0, s37, 98304
    s_add_u32 s42, s82, 131072
    v_mfma_f32_16x16x32_bf16 v[216:219], a[208:211], a[76:79], v[216:219]
    s_waitcnt lgkmcnt(6)
    ds_read_b64_tr_b16 a[196:197], v29 offset:49152
    ds_read_b64_tr_b16 a[198:199], v29 offset:53248
    v_mfma_f32_16x16x32_bf16 v[100:103], a[212:215], a[72:75], v[100:103]
    buffer_load_dwordx4 v62, s[20:23], s42 offen offset:0  lds
    v_mfma_f32_16x16x32_bf16 v[104:107], a[212:215], a[76:79], v[104:107]
    s_waitcnt lgkmcnt(6)
    ds_read_b64_tr_b16 a[200:201], v30 offset:49152
    ds_read_b64_tr_b16 a[202:203], v30 offset:53248
    v_mfma_f32_16x16x32_bf16 v[228:231], a[216:219], a[72:75], v[228:231]
    buffer_load_dwordx4 v63, s[20:23], s42 offen offset:1024  lds
    v_mfma_f32_16x16x32_bf16 v[232:235], a[216:219], a[76:79], v[232:235]
    s_waitcnt lgkmcnt(6)
    ds_read_b64_tr_b16 a[204:205], v31 offset:49152
    ds_read_b64_tr_b16 a[206:207], v31 offset:53248
    v_mfma_f32_16x16x32_bf16 v[108:111], a[220:223], a[72:75], v[108:111]
    buffer_load_dwordx4 v64, s[20:23], s42 offen offset:2048  lds
    v_mfma_f32_16x16x32_bf16 v[112:115], a[220:223], a[76:79], v[112:115]
    s_waitcnt vmcnt(25)
    s_waitcnt lgkmcnt(6)
    ds_read_b64_tr_b16 a[208:209], v32 offset:49152
    ds_read_b64_tr_b16 a[210:211], v32 offset:53248
    v_mfma_f32_16x16x32_bf16 v[180:183], a[192:195], a[96:99], v[180:183]
    buffer_load_dwordx4 v65, s[20:23], s42 offen offset:3072  lds
    v_mfma_f32_16x16x32_bf16 v[184:187], a[192:195], a[100:103], v[184:187]
    s_waitcnt lgkmcnt(6)
    ds_read_b64_tr_b16 a[212:213], v33 offset:49152
    ds_read_b64_tr_b16 a[214:215], v33 offset:53248
    v_mfma_f32_16x16x32_bf16 v[84:87], a[196:199], a[96:99], v[84:87]
    s_add_u32 m0, s37, 49152
    s_add_u32 s42, s83, 131072
    v_mfma_f32_16x16x32_bf16 v[88:91], a[196:199], a[100:103], v[88:91]
    s_waitcnt lgkmcnt(6)
    ds_read_b64_tr_b16 a[216:217], v34 offset:49152
    ds_read_b64_tr_b16 a[218:219], v34 offset:53248
    v_mfma_f32_16x16x32_bf16 v[196:199], a[200:203], a[96:99], v[196:199]
    buffer_load_dwordx4 v62, s[20:23], s42 offen offset:0  lds
    v_mfma_f32_16x16x32_bf16 v[200:203], a[200:203], a[100:103], v[200:203]
    s_waitcnt lgkmcnt(6)
    ds_read_b64_tr_b16 a[220:221], v35 offset:49152
    ds_read_b64_tr_b16 a[222:223], v35 offset:53248
    v_mfma_f32_16x16x32_bf16 v[92:95], a[204:207], a[96:99], v[92:95]
    buffer_load_dwordx4 v63, s[20:23], s42 offen offset:1024  lds
    v_mfma_f32_16x16x32_bf16 v[96:99], a[204:207], a[100:103], v[96:99]
    s_waitcnt lgkmcnt(6)
    ds_read_b64_tr_b16 a[192:193], v28 offset:57344
    ds_read_b64_tr_b16 a[194:195], v28 offset:61440
    v_mfma_f32_16x16x32_bf16 v[212:215], a[208:211], a[96:99], v[212:215]
    buffer_load_dwordx4 v64, s[20:23], s42 offen offset:2048  lds
    v_mfma_f32_16x16x32_bf16 v[216:219], a[208:211], a[100:103], v[216:219]
    s_waitcnt lgkmcnt(6)
    ds_read_b64_tr_b16 a[196:197], v29 offset:57344
    ds_read_b64_tr_b16 a[198:199], v29 offset:61440
    v_mfma_f32_16x16x32_bf16 v[100:103], a[212:215], a[96:99], v[100:103]
    buffer_load_dwordx4 v65, s[20:23], s42 offen offset:3072  lds
    v_mfma_f32_16x16x32_bf16 v[104:107], a[212:215], a[100:103], v[104:107]
    s_waitcnt lgkmcnt(6)
    ds_read_b64_tr_b16 a[200:201], v30 offset:57344
    ds_read_b64_tr_b16 a[202:203], v30 offset:61440
    v_mfma_f32_16x16x32_bf16 v[228:231], a[216:219], a[96:99], v[228:231]
    v_mfma_f32_16x16x32_bf16 v[232:235], a[216:219], a[100:103], v[232:235]
    s_waitcnt lgkmcnt(6)
    ds_read_b64_tr_b16 a[204:205], v31 offset:57344
    ds_read_b64_tr_b16 a[206:207], v31 offset:61440
    v_mfma_f32_16x16x32_bf16 v[108:111], a[220:223], a[96:99], v[108:111]
    v_mfma_f32_16x16x32_bf16 v[112:115], a[220:223], a[100:103], v[112:115]
    s_waitcnt lgkmcnt(6)
    ds_read_b64_tr_b16 a[208:209], v32 offset:57344
    ds_read_b64_tr_b16 a[210:211], v32 offset:61440
    v_mfma_f32_16x16x32_bf16 v[180:183], a[192:195], a[104:107], v[180:183]
    v_mfma_f32_16x16x32_bf16 v[184:187], a[192:195], a[108:111], v[184:187]
    s_waitcnt lgkmcnt(6)
    ds_read_b64_tr_b16 a[212:213], v33 offset:57344
    ds_read_b64_tr_b16 a[214:215], v33 offset:61440
    v_mfma_f32_16x16x32_bf16 v[84:87], a[196:199], a[104:107], v[84:87]
    v_mfma_f32_16x16x32_bf16 v[88:91], a[196:199], a[108:111], v[88:91]
    s_waitcnt lgkmcnt(6)
    ds_read_b64_tr_b16 a[216:217], v34 offset:57344
    ds_read_b64_tr_b16 a[218:219], v34 offset:61440
    v_mfma_f32_16x16x32_bf16 v[196:199], a[200:203], a[104:107], v[196:199]
    v_mfma_f32_16x16x32_bf16 v[200:203], a[200:203], a[108:111], v[200:203]
    s_waitcnt lgkmcnt(6)
    ds_read_b64_tr_b16 a[220:221], v35 offset:57344
    ds_read_b64_tr_b16 a[222:223], v35 offset:61440
    v_mfma_f32_16x16x32_bf16 v[92:95], a[204:207], a[104:107], v[92:95]
    v_mfma_f32_16x16x32_bf16 v[96:99], a[204:207], a[108:111], v[96:99]
    s_waitcnt lgkmcnt(6)
    s_barrier
    s_waitcnt vmcnt(8)
    v_cmp_ne_u32 s[62:63], 1, v10
    s_nop 0
    s_cmp_lg_u64 s[62:63], 0
    s_cbranch_scc1 w2_p1_spin
w2_p1_back:
    ds_read_b64_tr_b16 a[192:193], v20 offset:0
    ds_read_b64_tr_b16 a[194:195], v20 offset:4096
    v_mfma_f32_16x16x32_bf16 v[212:215], a[208:211], a[104:107], v[212:215]
    s_add_u32 s42, s85, 7340032
    buffer_load_dwordx4 a[128:131], v16, s[24:27], s42 offen offset:0 sc1
    v_mfma_f32_16x16x32_bf16 v[216:219], a[208:211], a[108:111], v[216:219]
    s_waitcnt lgkmcnt(6)
    ds_read_b64_tr_b16 a[196:197], v21 offset:0
    ds_read_b64_tr_b16 a[198:199], v21 offset:4096
    v_mfma_f32_16x16x32_bf16 v[100:103], a[212:215], a[104:107], v[100:103]
    buffer_load_dwordx4 a[132:135], v16, s[24:27], s42 offen offset:2048 sc1
    v_mfma_f32_16x16x32_bf16 v[104:107], a[212:215], a[108:111], v[104:107]
    s_waitcnt lgkmcnt(6)
    ds_read_b64_tr_b16 a[200:201], v22 offset:0
    ds_read_b64_tr_b16 a[202:203], v22 offset:4096
    v_mfma_f32_16x16x32_bf16 v[228:231], a[216:219], a[104:107], v[228:231]
    buffer_load_dwordx4 a[136:139], v16, s[24:27], s42 offen offset:1024 sc1
    v_mfma_f32_16x16x32_bf16 v[232:235], a[216:219], a[108:111], v[232:235]
    s_waitcnt lgkmcnt(6)
    ds_read_b64_tr_b16 a[204:205], v23 offset:0
    ds_read_b64_tr_b16 a[206:207], v23 offset:4096
    v_mfma_f32_16x16x32_bf16 v[108:111], a[220:223], a[104:107], v[108:111]
    buffer_load_dwordx4 a[140:143], v16, s[24:27], s42 offen offset:3072 sc1
    v_mfma_f32_16x16x32_bf16 v[112:115], a[220:223], a[108:111], v[112:115]
    s_waitcnt lgkmcnt(6)
    ds_read_b64_tr_b16 a[208:209], v24 offset:0
    ds_read_b64_tr_b16 a[210:211], v24 offset:4096
    v_mfma_f32_16x16x32_bf16 v[180:183], a[192:195], a[48:51], v[180:183]
    s_add_u32 m0, s37, 16384
    s_add_u32 s42, s81, 196608
    v_mfma_f32_16x16x32_bf16 v[184:187], a[192:195], a[52:55], v[184:187]
    s_waitcnt lgkmcnt(6)
    ds_read_b64_tr_b16 a[212:213], v25 offset:0
    ds_read_b64_tr_b16 a[214:215], v25 offset:4096
    v_mfma_f32_16x16x32_bf16 v[84:87], a[196:199], a[48:51], v[84:87]
    buffer_load_dwordx4 v62, s[20:23], s42 offen offset:0  lds
    v_mfma_f32_16x16x32_bf16 v[88:91], a[196:199], a[52:55], v[88:91]
    s_waitcnt lgkmcnt(6)
    ds_read_b64_tr_b16 a[216:217], v26 offset:0
    ds_read_b64_tr_b16 a[218:219], v26 offset:4096
    v_mfma_f32_16x16x32_bf16 v[196:199], a[200:203], a[48:51], v[196:199]
    buffer_load_dwordx4 v63, s[20:23], s42 offen offset:1024  lds
    v_mfma_f32_16x16x32_bf16 v[200:203], a[200:203], a[52:55], v[200:203]
    s_waitcnt lgkmcnt(6)
    ds_read_b64_tr_b16 a[220:221], v27 offset:0
    ds_read_b64_tr_b16 a[222:223], v27 offset:4096
    v_mfma_f32_16x16x32_bf16 v[92:95], a[204:207], a[48:51], v[92:95]
    buffer_load_dwordx4 v64, s[20:23], s42 offen offset:2048  lds
    v_mfma_f32_16x16x32_bf16 v[96:99], a[204:207], a[52:55], v[96:99]
    s_waitcnt lgkmcnt(6)
    ds_read_b64_tr_b16 a[192:193], v20 offset:8192
    ds_read_b64_tr_b16 a[194:195], v20 offset:12288
    v_mfma_f32_16x16x32_bf16 v[212:215], a[208:211], a[48:51], v[212:215]
    buffer_load_dwordx4 v65, s[20:23], s42 offen offset:3072  lds
    v_mfma_f32_16x16x32_bf16 v[216:219], a[208:211], a[52:55], v[216:219]
    s_waitcnt lgkmcnt(6)
    ds_read_b64_tr_b16 a[196:197], v21 offset:8192
    ds_read_b64_tr_b16 a[198:199], v21 offset:12288
    v_mfma_f32_16x16x32_bf16 v[100:103], a[212:215], a[48:51], v[100:103]
    v_mfma_f32_16x16x32_bf16 v[104:107], a[212:215], a[52:55], v[104:107]
    s_waitcnt lgkmcnt(6)
    ds_read_b64_tr_b16 a[200:201], v22 offset:8192
    ds_read_b64_tr_b16 a[202:203], v22 offset:12288
    v_mfma_f32_16x16x32_bf16 v[228:231], a[216:219], a[48:51], v[228:231]
    v_mfma_f32_16x16x32_bf16 v[232:235], a[216:219], a[52:55], v[232:235]
    s_waitcnt lgkmcnt(6)
    ds_read_b64_tr_b16 a[204:205], v23 offset:8192
    ds_read_b64_tr_b16 a[206:207], v23 offset:12288
    v_mfma_f32_16x16x32_bf16 v[108:111], a[220:223], a[48:51], v[108:111]
    v_mfma_f32_16x16x32_bf16 v[112:115], a[220:223], a[52:55], v[112:115]
    s_waitcnt lgkmcnt(6)
    ds_read_b64_tr_b16 a[208:209], v24 offset:8192
    ds_read_b64_tr_b16 a[210:211], v24 offset:12288
    v_mfma_f32_16x16x32_bf16 v[180:183], a[192:195], a[56:59], v[180:183]
    v_mfma_f32_16x16x32_bf16 v[184:187], a[192:195], a[60:63], v[184:187]
    s_waitcnt lgkmcnt(6)
    ds_read_b64_tr_b16 a[212:213], v25 offset:8192
    ds_read_b64_tr_b16 a[214:215], v25 offset:12288
    v_mfma_f32_16x16x32_bf16 v[84:87], a[196:199], a[56:59], v[84:87]
    v_mfma_f32_16x16x32_bf16 v[88:91], a[196:199], a[60:63], v[88:91]
    s_waitcnt lgkmcnt(6)
    ds_read_b64_tr_b16 a[216:217], v26 offset:8192
    ds_read_b64_tr_b16 a[218:219], v26 offset:12288
    v_mfma_f32_16x16x32_bf16 v[196:199], a[200:203], a[56:59], v[196:199]
    v_mfma_f32_16x16x32_bf16 v[200:203], a[200:203], a[60:63], v[200:203]
    s_waitcnt lgkmcnt(6)
    ds_read_b64_tr_b16 a[220:221], v27 offset:8192
    ds_read_b64_tr_b16 a[222:223], v27 offset:12288
    v_mfma_f32_16x16x32_bf16 v[92:95], a[204:207], a[56:59], v[92:95]
    v_mfma_f32_16x16x32_bf16 v[96:99], a[204:207], a[60:63], v[96:99]
    s_waitcnt lgkmcnt(6)
    s_barrier
    ds_read_b64_tr_b16 a[192:193], v20 offset:32768
    ds_read_b64_tr_b16 a[194:195], v20 offset:36864
    v_mfma_f32_16x16x32_bf16 v[212:215], a[208:211], a[56:59], v[212:215]
    s_add_u32 s42, s86, 7340032
    buffer_load_dwordx4 a[160:163], v16, s[24:27], s42 offen offset:0 sc1
    v_mfma_f32_16x16x32_bf16 v[216:219], a[208:211], a[60:63], v[216:219]
    s_waitcnt lgkmcnt(6)
    ds_read_b64_tr_b16 a[196:197], v21 offset:32768
    ds_read_b64_tr_b16 a[198:199], v21 offset:36864
    v_mfma_f32_16x16x32_bf16 v[100:103], a[212:215], a[56:59], v[100:103]
    buffer_load_dwordx4 a[164:167], v16, s[24:27], s42 offen offset:2048 sc1
    v_mfma_f32_16x16x32_bf16 v[104:107], a[212:215], a[60:63], v[104:107]
    s_waitcnt lgkmcnt(6)
    ds_read_b64_tr_b16 a[200:201], v22 offset:32768
    ds_read_b64_tr_b16 a[202:203], v22 offset:36864
    v_mfma_f32_16x16x32_bf16 v[228:231], a[216:219], a[56:59], v[228:231]
    buffer_load_dwordx4 a[168:171], v16, s[24:27], s42 offen offset:1024 sc1
    v_mfma_f32_16x16x32_bf16 v[232:235], a[216:219], a[60:63], v[232:235]
    s_waitcnt lgkmcnt(6)
    ds_read_b64_tr_b16 a[204:205], v23 offset:32768
    ds_read_b64_tr_b16 a[206:207], v23 offset:36864
    v_mfma_f32_16x16x32_bf16 v[108:111], a[220:223], a[56:59], v[108:111]
    buffer_load_dwordx4 a[172:175], v16, s[24:27], s42 offen offset:3072 sc1
    v_mfma_f32_16x16x32_bf16 v[112:115], a[220:223], a[60:63], v[112:115]
    s_waitcnt lgkmcnt(6)
    ds_read_b64_tr_b16 a[208:209], v24 offset:32768
    ds_read_b64_tr_b16 a[210:211], v24 offset:36864
    v_mfma_f32_16x16x32_bf16 v[180:183], a[192:195], a[80:83], v[180:183]
    s_add_u32 s42, s87, 7340032
    buffer_load_dwordx4 a[224:227], v16, s[24:27], s42 offen offset:0 sc1
    v_mfma_f32_16x16x32_bf16 v[184:187], a[192:195], a[84:87], v[184:187]
    s_waitcnt lgkmcnt(6)
    ds_read_b64_tr_b16 a[212:213], v25 offset:32768
    ds_read_b64_tr_b16 a[214:215], v25 offset:36864
    v_mfma_f32_16x16x32_bf16 v[84:87], a[196:199], a[80:83], v[84:87]
    buffer_load_dwordx4 a[228:231], v16, s[24:27], s42 offen offset:2048 sc1
    v_mfma_f32_16x16x32_bf16 v[88:91], a[196:199], a[84:87], v[88:91]
    s_waitcnt lgkmcnt(6)
    ds_read_b64_tr_b16 a[216:217], v20 offset:40960
    ds_read_b64_tr_b16 a[218:219], v20 offset:45056
    v_mfma_f32_16x16x32_bf16 v[196:199], a[200:203], a[80:83], v[196:199]
    buffer_load_dwordx4 a[232:235], v16, s[24:27], s42 offen offset:1024 sc1
    v_mfma_f32_16x16x32_bf16 v[200:203], a[200:203], a[84:87], v[200:203]
    s_waitcnt lgkmcnt(6)
    ds_read_b64_tr_b16 a[220:221], v21 offset:40960
    ds_read_b64_tr_b16 a[222:223], v21 offset:45056
    v_mfma_f32_16x16x32_bf16 v[92:95], a[204:207], a[80:83], v[92:95]
    buffer_load_dwordx4 a[236:239], v16, s[24:27], s42 offen offset:3072 sc1
    v_mfma_f32_16x16x32_bf16 v[96:99], a[204:207], a[84:87], v[96:99]
    s_waitcnt lgkmcnt(6)
    ds_read_b64_tr_b16 a[192:193], v22 offset:40960
    ds_read_b64_tr_b16 a[194:195], v22 offset:45056
    v_mfma_f32_16x16x32_bf16 v[212:215], a[208:211], a[80:83], v[212:215]
    s_add_u32 m0, s37, 131072
    s_add_u32 s42, s82, 196608
    v_mfma_f32_16x16x32_bf16 v[216:219], a[208:211], a[84:87], v[216:219]
    s_waitcnt lgkmcnt(6)
    ds_read_b64_tr_b16 a[196:197], v23 offset:40960
    ds_read_b64_tr_b16 a[198:199], v23 offset:45056
    v_mfma_f32_16x16x32_bf16 v[100:103], a[212:215], a[80:83], v[100:103]
    buffer_load_dwordx4 v62, s[20:23], s42 offen offset:0  lds
    v_mfma_f32_16x16x32_bf16 v[104:107], a[212:215], a[84:87], v[104:107]
    s_waitcnt lgkmcnt(6)
    ds_read_b64_tr_b16 a[200:201], v24 offset:40960
    ds_read_b64_tr_b16 a[202:203], v24 offset:45056
    v_mfma_f32_16x16x32_bf16 v[180:183], a[216:219], a[88:91], v[180:183]
    buffer_load_dwordx4 v63, s[20:23], s42 offen offset:1024  lds
    v_mfma_f32_16x16x32_bf16 v[184:187], a[216:219], a[92:95], v[184:187]
    s_waitcnt lgkmcnt(6)
    ds_read_b64_tr_b16 a[204:205], v25 offset:40960
    ds_read_b64_tr_b16 a[206:207], v25 offset:45056
    v_mfma_f32_16x16x32_bf16 v[84:87], a[220:223], a[88:91], v[84:87]
    buffer_load_dwordx4 v64, s[20:23], s42 offen offset:2048  lds
    v_mfma_f32_16x16x32_bf16 v[88:91], a[220:223], a[92:95], v[88:91]
    s_waitcnt lgkmcnt(6)
    s_barrier
    ds_read_b64_tr_b16 a[208:209], v28 offset:16384
    ds_read_b64_tr_b16 a[210:211], v28 offset:20480
    v_mfma_f32_16x16x32_bf16 v[196:199], a[192:195], a[88:91], v[196:199]
    buffer_load_dwordx4 v65, s[20:23], s42 offen offset:3072  lds
    v_mfma_f32_16x16x32_bf16 v[200:203], a[192:195], a[92:95], v[200:203]
    s_waitcnt lgkmcnt(6)
    ds_read_b64_tr_b16 a[212:213], v29 offset:16384
    ds_read_b64_tr_b16 a[214:215], v29 offset:20480
    v_mfma_f32_16x16x32_bf16 v[92:95], a[196:199], a[88:91], v[92:95]
    s_add_u32 s42, s85, 11010048
    buffer_load_dwordx4 a[144:147], v16, s[24:27], s42 offen offset:0 sc1
    v_mfma_f32_16x16x32_bf16 v[96:99], a[196:199], a[92:95], v[96:99]
    s_waitcnt lgkmcnt(6)
    ds_read_b64_tr_b16 a[216:217], v30 offset:16384
    ds_read_b64_tr_b16 a[218:219], v30 offset:20480
    v_mfma_f32_16x16x32_bf16 v[212:215], a[200:203], a[88:91], v[212:215]
    buffer_load_dwordx4 a[148:151], v16, s[24:27], s42 offen offset:2048 sc1
    v_mfma_f32_16x16x32_bf16 v[216:219], a[200:203], a[92:95], v[216:219]
    s_waitcnt lgkmcnt(6)
    ds_read_b64_tr_b16 a[220:221], v31 offset:16384
    ds_read_b64_tr_b16 a[222:223], v31 offset:20480
    v_mfma_f32_16x16x32_bf16 v[100:103], a[204:207], a[88:91], v[100:103]
    buffer_load_dwordx4 a[152:155], v16, s[24:27], s42 offen offset:1024 sc1
    v_mfma_f32_16x16x32_bf16 v[104:107], a[204:207], a[92:95], v[104:107]
    s_waitcnt lgkmcnt(6)
    ds_read_b64_tr_b16 a[192:193], v32 offset:16384
    ds_read_b64_tr_b16 a[194:195], v32 offset:20480
    v_mfma_f32_16x16x32_bf16 v[180:183], a[208:211], a[112:115], v[180:183]
    buffer_load_dwordx4 a[156:159], v16, s[24:27], s42 offen offset:3072 sc1
    v_mfma_f32_16x16x32_bf16 v[184:187], a[208:211], a[116:119], v[184:187]
    s_waitcnt lgkmcnt(6)
    ds_read_b64_tr_b16 a[196:197], v33 offset:16384
    ds_read_b64_tr_b16 a[198:199], v33 offset:20480
    v_mfma_f32_16x16x32_bf16 v[84:87], a[212:215], a[112:115], v[84:87]
    s_add_u32 m0, s37, 147456
    s_add_u32 s42, s83, 196608
    v_mfma_f32_16x16x32_bf16 v[88:91], a[212:215], a[116:119], v[88:91]
    s_waitcnt lgkmcnt(6)
    ds_read_b64_tr_b16 a[200:201], v28 offset:24576
    ds_read_b64_tr_b16 a[202:203], v28 offset:28672
    v_mfma_f32_16x16x32_bf16 v[196:199], a[216:219], a[112:115], v[196:199]
    buffer_load_dwordx4 v62, s[20:23], s42 offen offset:0  lds
    v_mfma_f32_16x16x32_bf16 v[200:203], a[216:219], a[116:119], v[200:203]
    s_waitcnt lgkmcnt(6)
    ds_read_b64_tr_b16 a[204:205], v29 offset:24576
    ds_read_b64_tr_b16 a[206:207], v29 offset:28672
    v_mfma_f32_16x16x32_bf16 v[92:95], a[220:223], a[112:115], v[92:95]
    buffer_load_dwordx4 v63, s[20:23], s42 offen offset:1024  lds
    v_mfma_f32_16x16x32_bf16 v[96:99], a[220:223], a[116:119], v[96:99]
    s_waitcnt lgkmcnt(6)
    ds_read_b64_tr_b16 a[208:209], v30 offset:24576
    ds_read_b64_tr_b16 a[210:211], v30 offset:28672
    v_mfma_f32_16x16x32_bf16 v[212:215], a[192:195], a[112:115], v[212:215]
    buffer_load_dwordx4 v64, s[20:23], s42 offen offset:2048  lds
    v_mfma_f32_16x16x32_bf16 v[216:219], a[192:195], a[116:119], v[216:219]
    s_waitcnt lgkmcnt(6)
    ds_read_b64_tr_b16 a[212:213], v31 offset:24576
    ds_read_b64_tr_b16 a[214:215], v31 offset:28672
    v_mfma_f32_16x16x32_bf16 v[100:103], a[196:199], a[112:115], v[100:103]
    buffer_load_dwordx4 v65, s[20:23], s42 offen offset:3072  lds
    v_mfma_f32_16x16x32_bf16 v[104:107], a[196:199], a[116:119], v[104:107]
    s_waitcnt lgkmcnt(6)
    ds_read_b64_tr_b16 a[216:217], v32 offset:24576
    ds_read_b64_tr_b16 a[218:219], v32 offset:28672
    v_mfma_f32_16x16x32_bf16 v[180:183], a[200:203], a[120:123], v[180:183]
    v_mfma_f32_16x16x32_bf16 v[184:187], a[200:203], a[124:127], v[184:187]
    s_waitcnt lgkmcnt(6)
    ds_read_b64_tr_b16 a[220:221], v33 offset:24576
    ds_read_b64_tr_b16 a[222:223], v33 offset:28672
    v_mfma_f32_16x16x32_bf16 v[84:87], a[204:207], a[120:123], v[84:87]
    v_mfma_f32_16x16x32_bf16 v[88:91], a[204:207], a[124:127], v[88:91]
    s_waitcnt lgkmcnt(6)
    s_barrier
    ds_read_b64_tr_b16 a[192:193], v28 offset:0
    ds_read_b64_tr_b16 a[194:195], v28 offset:4096
    v_mfma_f32_16x16x32_bf16 v[196:199], a[208:211], a[120:123], v[196:199]
    s_add_u32 s42, s86, 11010048
    buffer_load_dwordx4 a[176:179], v16, s[24:27], s42 offen offset:0 sc1
    v_mfma_f32_16x16x32_bf16 v[200:203], a[208:211], a[124:127], v[200:203]
    s_waitcnt lgkmcnt(6)
    ds_read_b64_tr_b16 a[196:197], v29 offset:0
    ds_read_b64_tr_b16 a[198:199], v29 offset:4096
    v_mfma_f32_16x16x32_bf16 v[92:95], a[212:215], a[120:123], v[92:95]
    buffer_load_dwordx4 a[180:183], v16, s[24:27], s42 offen offset:2048 sc1
    v_mfma_f32_16x16x32_bf16 v[96:99], a[212:215], a[124:127], v[96:99]
    s_waitcnt lgkmcnt(6)
    ds_read_b64_tr_b16 a[200:201], v30 offset:0
    ds_read_b64_tr_b16 a[202:203], v30 offset:4096
    v_mfma_f32_16x16x32_bf16 v[212:215], a[216:219], a[120:123], v[212:215]
    buffer_load_dwordx4 a[184:187], v16, s[24:27], s42 offen offset:1024 sc1
    v_mfma_f32_16x16x32_bf16 v[216:219], a[216:219], a[124:127], v[216:219]
    s_waitcnt lgkmcnt(6)
    ds_read_b64_tr_b16 a[204:205], v31 offset:0
    ds_read_b64_tr_b16 a[206:207], v31 offset:4096
    v_mfma_f32_16x16x32_bf16 v[100:103], a[220:223], a[120:123], v[100:103]
    buffer_load_dwordx4 a[188:191], v16, s[24:27], s42 offen offset:3072 sc1
    v_mfma_f32_16x16x32_bf16 v[104:107], a[220:223], a[124:127], v[104:107]
    s_waitcnt vmcnt(28)
    s_waitcnt lgkmcnt(6)
    ds_read_b64_tr_b16 a[208:209], v32 offset:0
    ds_read_b64_tr_b16 a[210:211], v32 offset:4096
    v_mfma_f32_16x16x32_bf16 v[180:183], a[192:195], a[128:131], v[180:183]
    s_add_u32 s42, s87, 11010048
    buffer_load_dwordx4 a[240:243], v16, s[24:27], s42 offen offset:0 sc1
    v_mfma_f32_16x16x32_bf16 v[184:187], a[192:195], a[132:135], v[184:187]
    s_waitcnt lgkmcnt(6)
    ds_read_b64_tr_b16 a[212:213], v33 offset:0
    ds_read_b64_tr_b16 a[214:215], v33 offset:4096
    v_mfma_f32_16x16x32_bf16 v[84:87], a[196:199], a[128:131], v[84:87]
    buffer_load_dwordx4 a[244:247], v16, s[24:27], s42 offen offset:2048 sc1
    v_mfma_f32_16x16x32_bf16 v[88:91], a[196:199], a[132:135], v[88:91]
    s_waitcnt lgkmcnt(6)
    ds_read_b64_tr_b16 a[216:217], v28 offset:8192
    ds_read_b64_tr_b16 a[218:219], v28 offset:12288
    v_mfma_f32_16x16x32_bf16 v[196:199], a[200:203], a[128:131], v[196:199]
    buffer_load_dwordx4 a[248:251], v16, s[24:27], s42 offen offset:1024 sc1
    v_mfma_f32_16x16x32_bf16 v[200:203], a[200:203], a[132:135], v[200:203]
    s_waitcnt lgkmcnt(6)
    ds_read_b64_tr_b16 a[220:221], v29 offset:8192
    ds_read_b64_tr_b16 a[222:223], v29 offset:12288
    v_mfma_f32_16x16x32_bf16 v[92:95], a[204:207], a[128:131], v[92:95]
    buffer_load_dwordx4 a[252:255], v16, s[24:27], s42 offen offset:3072 sc1
    v_mfma_f32_16x16x32_bf16 v[96:99], a[204:207], a[132:135], v[96:99]
    s_waitcnt lgkmcnt(6)
    ds_read_b64_tr_b16 a[192:193], v30 offset:8192
    ds_read_b64_tr_b16 a[194:195], v30 offset:12288
    v_mfma_f32_16x16x32_bf16 v[212:215], a[208:211], a[128:131], v[212:215]
    v_mfma_f32_16x16x32_bf16 v[216:219], a[208:211], a[132:135], v[216:219]
    s_waitcnt lgkmcnt(6)
    ds_read_b64_tr_b16 a[196:197], v31 offset:8192
    ds_read_b64_tr_b16 a[198:199], v31 offset:12288
    v_mfma_f32_16x16x32_bf16 v[100:103], a[212:215], a[128:131], v[100:103]
    v_mfma_f32_16x16x32_bf16 v[104:107], a[212:215], a[132:135], v[104:107]
    s_waitcnt lgkmcnt(6)
    ds_read_b64_tr_b16 a[200:201], v32 offset:8192
    ds_read_b64_tr_b16 a[202:203], v32 offset:12288
    v_mfma_f32_16x16x32_bf16 v[180:183], a[216:219], a[136:139], v[180:183]
    v_mfma_f32_16x16x32_bf16 v[184:187], a[216:219], a[140:143], v[184:187]
    s_waitcnt lgkmcnt(6)
    ds_read_b64_tr_b16 a[204:205], v33 offset:8192
    ds_read_b64_tr_b16 a[206:207], v33 offset:12288
    v_mfma_f32_16x16x32_bf16 v[84:87], a[220:223], a[136:139], v[84:87]
    v_mfma_f32_16x16x32_bf16 v[88:91], a[220:223], a[140:143], v[88:91]
    s_waitcnt lgkmcnt(6)
    s_barrier
    ds_read_b64_tr_b16 a[208:209], v28 offset:32768
    ds_read_b64_tr_b16 a[210:211], v28 offset:36864
    v_mfma_f32_16x16x32_bf16 v[196:199], a[192:195], a[136:139], v[196:199]
    v_mfma_f32_16x16x32_bf16 v[200:203], a[192:195], a[140:143], v[200:203]
    s_waitcnt lgkmcnt(6)
    ds_read_b64_tr_b16 a[212:213], v29 offset:32768
    ds_read_b64_tr_b16 a[214:215], v29 offset:36864
    v_mfma_f32_16x16x32_bf16 v[92:95], a[196:199], a[136:139], v[92:95]
    v_mfma_f32_16x16x32_bf16 v[96:99], a[196:199], a[140:143], v[96:99]
    s_waitcnt lgkmcnt(6)
    ds_read_b64_tr_b16 a[216:217], v30 offset:32768
    ds_read_b64_tr_b16 a[218:219], v30 offset:36864
    v_mfma_f32_16x16x32_bf16 v[212:215], a[200:203], a[136:139], v[212:215]
    v_mfma_f32_16x16x32_bf16 v[216:219], a[200:203], a[140:143], v[216:219]
    s_waitcnt lgkmcnt(6)
    ds_read_b64_tr_b16 a[220:221], v31 offset:32768
    ds_read_b64_tr_b16 a[222:223], v31 offset:36864
    v_mfma_f32_16x16x32_bf16 v[100:103], a[204:207], a[136:139], v[100:103]
    v_mfma_f32_16x16x32_bf16 v[104:107], a[204:207], a[140:143], v[104:107]
    s_waitcnt vmcnt(24)
    s_waitcnt lgkmcnt(6)
    ds_read_b64_tr_b16 a[192:193], v32 offset:32768
    ds_read_b64_tr_b16 a[194:195], v32 offset:36864
    v_mfma_f32_16x16x32_bf16 v[180:183], a[208:211], a[160:163], v[180:183]
    v_mfma_f32_16x16x32_bf16 v[184:187], a[208:211], a[164:167], v[184:187]
    s_waitcnt lgkmcnt(6)
    ds_read_b64_tr_b16 a[196:197], v33 offset:32768
    ds_read_b64_tr_b16 a[198:199], v33 offset:36864
    v_mfma_f32_16x16x32_bf16 v[84:87], a[212:215], a[160:163], v[84:87]
    v_mfma_f32_16x16x32_bf16 v[88:91], a[212:215], a[164:167], v[88:91]
    s_waitcnt lgkmcnt(6)
    ds_read_b64_tr_b16 a[200:201], v28 offset:40960
    ds_read_b64_tr_b16 a[202:203], v28 offset:45056
    v_mfma_f32_16x16x32_bf16 v[196:199], a[216:219], a[160:163], v[196:199]
    v_mfma_f32_16x16x32_bf16 v[200:203], a[216:219], a[164:167], v[200:203]
    s_waitcnt lgkmcnt(6)
    ds_read_b64_tr_b16 a[204:205], v29 offset:40960
    ds_read_b64_tr_b16 a[206:207], v29 offset:45056
    v_mfma_f32_16x16x32_bf16 v[92:95], a[220:223], a[160:163], v[92:95]
    v_mfma_f32_16x16x32_bf16 v[96:99], a[220:223], a[164:167], v[96:99]
    s_waitcnt lgkmcnt(6)
    ds_read_b64_tr_b16 a[208:209], v30 offset:40960
    ds_read_b64_tr_b16 a[210:211], v30 offset:45056
    v_mfma_f32_16x16x32_bf16 v[212:215], a[192:195], a[160:163], v[212:215]
    v_mfma_f32_16x16x32_bf16 v[216:219], a[192:195], a[164:167], v[216:219]
    s_waitcnt lgkmcnt(6)
    ds_read_b64_tr_b16 a[212:213], v31 offset:40960
    ds_read_b64_tr_b16 a[214:215], v31 offset:45056
    v_mfma_f32_16x16x32_bf16 v[100:103], a[196:199], a[160:163], v[100:103]
    v_mfma_f32_16x16x32_bf16 v[104:107], a[196:199], a[164:167], v[104:107]
    s_waitcnt lgkmcnt(6)
    ds_read_b64_tr_b16 a[216:217], v32 offset:40960
    ds_read_b64_tr_b16 a[218:219], v32 offset:45056
    v_mfma_f32_16x16x32_bf16 v[180:183], a[200:203], a[168:171], v[180:183]
    v_mfma_f32_16x16x32_bf16 v[184:187], a[200:203], a[172:175], v[184:187]
    s_waitcnt lgkmcnt(6)
    ds_read_b64_tr_b16 a[220:221], v33 offset:40960
    ds_read_b64_tr_b16 a[222:223], v33 offset:45056
    v_mfma_f32_16x16x32_bf16 v[84:87], a[204:207], a[168:171], v[84:87]
    v_mfma_f32_16x16x32_bf16 v[88:91], a[204:207], a[172:175], v[88:91]
    s_waitcnt lgkmcnt(6)
    s_waitcnt vmcnt(8)
    s_barrier
    ds_read_b64_tr_b16 a[192:193], v20 offset:49152
    ds_read_b64_tr_b16 a[194:195], v20 offset:53248
    v_mfma_f32_16x16x32_bf16 v[196:199], a[208:211], a[168:171], v[196:199]
    v_mfma_f32_16x16x32_bf16 v[200:203], a[208:211], a[172:175], v[200:203]
    s_waitcnt lgkmcnt(6)
    ds_read_b64_tr_b16 a[196:197], v21 offset:49152
    ds_read_b64_tr_b16 a[198:199], v21 offset:53248
    v_mfma_f32_16x16x32_bf16 v[92:95], a[212:215], a[168:171], v[92:95]
    v_mfma_f32_16x16x32_bf16 v[96:99], a[212:215], a[172:175], v[96:99]
    s_waitcnt lgkmcnt(6)
    ds_read_b64_tr_b16 a[200:201], v22 offset:49152
    ds_read_b64_tr_b16 a[202:203], v22 offset:53248
    v_mfma_f32_16x16x32_bf16 v[212:215], a[216:219], a[168:171], v[212:215]
    v_mfma_f32_16x16x32_bf16 v[216:219], a[216:219], a[172:175], v[216:219]
    s_waitcnt lgkmcnt(6)
    ds_read_b64_tr_b16 a[204:205], v23 offset:49152
    ds_read_b64_tr_b16 a[206:207], v23 offset:53248
    v_mfma_f32_16x16x32_bf16 v[100:103], a[220:223], a[168:171], v[100:103]
    v_mfma_f32_16x16x32_bf16 v[104:107], a[220:223], a[172:175], v[104:107]
    s_waitcnt lgkmcnt(6)
    ds_read_b64_tr_b16 a[208:209], v24 offset:49152
    ds_read_b64_tr_b16 a[210:211], v24 offset:53248
    v_mfma_f32_16x16x32_bf16 v[180:183], a[192:195], a[224:227], v[180:183]
    v_mfma_f32_16x16x32_bf16 v[184:187], a[192:195], a[228:231], v[184:187]
    s_waitcnt lgkmcnt(6)
    ds_read_b64_tr_b16 a[212:213], v25 offset:49152
    ds_read_b64_tr_b16 a[214:215], v25 offset:53248
    v_mfma_f32_16x16x32_bf16 v[84:87], a[196:199], a[224:227], v[84:87]
    v_mfma_f32_16x16x32_bf16 v[88:91], a[196:199], a[228:231], v[88:91]
    s_waitcnt lgkmcnt(6)
    ds_read_b64_tr_b16 a[216:217], v20 offset:57344
    ds_read_b64_tr_b16 a[218:219], v20 offset:61440
    v_mfma_f32_16x16x32_bf16 v[196:199], a[200:203], a[224:227], v[196:199]
    v_mfma_f32_16x16x32_bf16 v[200:203], a[200:203], a[228:231], v[200:203]
    s_waitcnt lgkmcnt(6)
    ds_read_b64_tr_b16 a[220:221], v21 offset:57344
    ds_read_b64_tr_b16 a[222:223], v21 offset:61440
    v_mfma_f32_16x16x32_bf16 v[92:95], a[204:207], a[224:227], v[92:95]
    v_mfma_f32_16x16x32_bf16 v[96:99], a[204:207], a[228:231], v[96:99]
    s_waitcnt lgkmcnt(6)
    ds_read_b64_tr_b16 a[192:193], v22 offset:57344
    ds_read_b64_tr_b16 a[194:195], v22 offset:61440
    v_mfma_f32_16x16x32_bf16 v[212:215], a[208:211], a[224:227], v[212:215]
    v_mfma_f32_16x16x32_bf16 v[216:219], a[208:211], a[228:231], v[216:219]
    s_waitcnt lgkmcnt(6)
    ds_read_b64_tr_b16 a[196:197], v23 offset:57344
    ds_read_b64_tr_b16 a[198:199], v23 offset:61440
    v_mfma_f32_16x16x32_bf16 v[100:103], a[212:215], a[224:227], v[100:103]
    v_mfma_f32_16x16x32_bf16 v[104:107], a[212:215], a[228:231], v[104:107]
    s_waitcnt lgkmcnt(6)
    ds_read_b64_tr_b16 a[200:201], v24 offset:57344
    ds_read_b64_tr_b16 a[202:203], v24 offset:61440
    v_mfma_f32_16x16x32_bf16 v[180:183], a[216:219], a[232:235], v[180:183]
    v_mfma_f32_16x16x32_bf16 v[184:187], a[216:219], a[236:239], v[184:187]
    s_waitcnt lgkmcnt(6)
    ds_read_b64_tr_b16 a[204:205], v25 offset:57344
    ds_read_b64_tr_b16 a[206:207], v25 offset:61440
    v_mfma_f32_16x16x32_bf16 v[84:87], a[220:223], a[232:235], v[84:87]
    v_mfma_f32_16x16x32_bf16 v[88:91], a[220:223], a[236:239], v[88:91]
    s_waitcnt lgkmcnt(6)
    ds_read_b64_tr_b16 a[208:209], v20 offset:16384
    ds_read_b64_tr_b16 a[210:211], v20 offset:20480
    v_mfma_f32_16x16x32_bf16 v[196:199], a[192:195], a[232:235], v[196:199]
    v_mfma_f32_16x16x32_bf16 v[200:203], a[192:195], a[236:239], v[200:203]
    s_waitcnt lgkmcnt(6)
    ds_read_b64_tr_b16 a[212:213], v21 offset:16384
    ds_read_b64_tr_b16 a[214:215], v21 offset:20480
    v_mfma_f32_16x16x32_bf16 v[92:95], a[196:199], a[232:235], v[92:95]
    v_mfma_f32_16x16x32_bf16 v[96:99], a[196:199], a[236:239], v[96:99]
    s_waitcnt lgkmcnt(6)
    ds_read_b64_tr_b16 a[216:217], v22 offset:16384
    ds_read_b64_tr_b16 a[218:219], v22 offset:20480
    v_mfma_f32_16x16x32_bf16 v[212:215], a[200:203], a[232:235], v[212:215]
    v_mfma_f32_16x16x32_bf16 v[216:219], a[200:203], a[236:239], v[216:219]
    s_waitcnt lgkmcnt(6)
    ds_read_b64_tr_b16 a[220:221], v23 offset:16384
    ds_read_b64_tr_b16 a[222:223], v23 offset:20480
    v_mfma_f32_16x16x32_bf16 v[100:103], a[204:207], a[232:235], v[100:103]
    v_mfma_f32_16x16x32_bf16 v[104:107], a[204:207], a[236:239], v[104:107]
    s_waitcnt lgkmcnt(6)
    ds_read_b64_tr_b16 a[192:193], v24 offset:16384
    ds_read_b64_tr_b16 a[194:195], v24 offset:20480
    v_mfma_f32_16x16x32_bf16 v[180:183], a[208:211], a[144:147], v[180:183]
    v_mfma_f32_16x16x32_bf16 v[184:187], a[208:211], a[148:151], v[184:187]
    s_waitcnt lgkmcnt(6)
    ds_read_b64_tr_b16 a[196:197], v25 offset:16384
    ds_read_b64_tr_b16 a[198:199], v25 offset:20480
    v_mfma_f32_16x16x32_bf16 v[84:87], a[212:215], a[144:147], v[84:87]
    v_mfma_f32_16x16x32_bf16 v[88:91], a[212:215], a[148:151], v[88:91]
    s_waitcnt lgkmcnt(6)
    ds_read_b64_tr_b16 a[200:201], v20 offset:24576
    ds_read_b64_tr_b16 a[202:203], v20 offset:28672
    v_mfma_f32_16x16x32_bf16 v[196:199], a[216:219], a[144:147], v[196:199]
    v_mfma_f32_16x16x32_bf16 v[200:203], a[216:219], a[148:151], v[200:203]
    s_waitcnt lgkmcnt(6)
    ds_read_b64_tr_b16 a[204:205], v21 offset:24576
    ds_read_b64_tr_b16 a[206:207], v21 offset:28672
    v_mfma_f32_16x16x32_bf16 v[92:95], a[220:223], a[144:147], v[92:95]
    v_mfma_f32_16x16x32_bf16 v[96:99], a[220:223], a[148:151], v[96:99]
    s_waitcnt lgkmcnt(6)
    ds_read_b64_tr_b16 a[208:209], v22 offset:24576
    ds_read_b64_tr_b16 a[210:211], v22 offset:28672
    v_mfma_f32_16x16x32_bf16 v[212:215], a[192:195], a[144:147], v[212:215]
    v_mfma_f32_16x16x32_bf16 v[216:219], a[192:195], a[148:151], v[216:219]
    s_waitcnt lgkmcnt(6)
    ds_read_b64_tr_b16 a[212:213], v23 offset:24576
    ds_read_b64_tr_b16 a[214:215], v23 offset:28672
    v_mfma_f32_16x16x32_bf16 v[100:103], a[196:199], a[144:147], v[100:103]
    v_mfma_f32_16x16x32_bf16 v[104:107], a[196:199], a[148:151], v[104:107]
    s_waitcnt lgkmcnt(6)
    ds_read_b64_tr_b16 a[216:217], v24 offset:24576
    ds_read_b64_tr_b16 a[218:219], v24 offset:28672
    v_mfma_f32_16x16x32_bf16 v[180:183], a[200:203], a[152:155], v[180:183]
    v_mfma_f32_16x16x32_bf16 v[184:187], a[200:203], a[156:159], v[184:187]
    s_waitcnt lgkmcnt(6)
    ds_read_b64_tr_b16 a[220:221], v25 offset:24576
    ds_read_b64_tr_b16 a[222:223], v25 offset:28672
    v_mfma_f32_16x16x32_bf16 v[84:87], a[204:207], a[152:155], v[84:87]
    v_mfma_f32_16x16x32_bf16 v[88:91], a[204:207], a[156:159], v[88:91]
    s_waitcnt lgkmcnt(6)
    ds_read_b64_tr_b16 a[192:193], v36 offset:0
    ds_read_b64_tr_b16 a[194:195], v36 offset:4096
    v_mfma_f32_16x16x32_bf16 v[196:199], a[208:211], a[152:155], v[196:199]
    v_mfma_f32_16x16x32_bf16 v[200:203], a[208:211], a[156:159], v[200:203]
    s_waitcnt lgkmcnt(6)
    ds_read_b64_tr_b16 a[196:197], v37 offset:0
    ds_read_b64_tr_b16 a[198:199], v37 offset:4096
    v_mfma_f32_16x16x32_bf16 v[92:95], a[212:215], a[152:155], v[92:95]
    v_mfma_f32_16x16x32_bf16 v[96:99], a[212:215], a[156:159], v[96:99]
    s_waitcnt lgkmcnt(6)
    ds_read_b64_tr_b16 a[200:201], v38 offset:0
    ds_read_b64_tr_b16 a[202:203], v38 offset:4096
    v_mfma_f32_16x16x32_bf16 v[212:215], a[216:219], a[152:155], v[212:215]
    v_mfma_f32_16x16x32_bf16 v[216:219], a[216:219], a[156:159], v[216:219]
    s_waitcnt lgkmcnt(6)
    ds_read_b64_tr_b16 a[204:205], v39 offset:0
    ds_read_b64_tr_b16 a[206:207], v39 offset:4096
    v_mfma_f32_16x16x32_bf16 v[100:103], a[220:223], a[152:155], v[100:103]
    v_mfma_f32_16x16x32_bf16 v[104:107], a[220:223], a[156:159], v[104:107]
    s_waitcnt vmcnt(4)
    s_waitcnt lgkmcnt(6)
    ds_read_b64_tr_b16 a[208:209], v40 offset:0
    ds_read_b64_tr_b16 a[210:211], v40 offset:4096
    v_mfma_f32_16x16x32_bf16 v[180:183], a[192:195], a[176:179], v[180:183]
    v_mfma_f32_16x16x32_bf16 v[184:187], a[192:195], a[180:183], v[184:187]
    s_waitcnt lgkmcnt(6)
    ds_read_b64_tr_b16 a[212:213], v41 offset:0
    ds_read_b64_tr_b16 a[214:215], v41 offset:4096
    v_mfma_f32_16x16x32_bf16 v[84:87], a[196:199], a[176:179], v[84:87]
    v_mfma_f32_16x16x32_bf16 v[88:91], a[196:199], a[180:183], v[88:91]
    s_waitcnt lgkmcnt(6)
    ds_read_b64_tr_b16 a[216:217], v36 offset:8192
    ds_read_b64_tr_b16 a[218:219], v36 offset:12288
    v_mfma_f32_16x16x32_bf16 v[196:199], a[200:203], a[176:179], v[196:199]
    v_mfma_f32_16x16x32_bf16 v[200:203], a[200:203], a[180:183], v[200:203]
    s_waitcnt lgkmcnt(6)
    ds_read_b64_tr_b16 a[220:221], v37 offset:8192
    ds_read_b64_tr_b16 a[222:223], v37 offset:12288
    v_mfma_f32_16x16x32_bf16 v[92:95], a[204:207], a[176:179], v[92:95]
    v_mfma_f32_16x16x32_bf16 v[96:99], a[204:207], a[180:183], v[96:99]
    s_waitcnt lgkmcnt(6)
    ds_read_b64_tr_b16 a[192:193], v38 offset:8192
    ds_read_b64_tr_b16 a[194:195], v38 offset:12288
    v_mfma_f32_16x16x32_bf16 v[212:215], a[208:211], a[176:179], v[212:215]
    v_mfma_f32_16x16x32_bf16 v[216:219], a[208:211], a[180:183], v[216:219]
    s_waitcnt lgkmcnt(6)
    ds_read_b64_tr_b16 a[196:197], v39 offset:8192
    ds_read_b64_tr_b16 a[198:199], v39 offset:12288
    v_mfma_f32_16x16x32_bf16 v[100:103], a[212:215], a[176:179], v[100:103]
    v_mfma_f32_16x16x32_bf16 v[104:107], a[212:215], a[180:183], v[104:107]
    s_waitcnt lgkmcnt(6)
    ds_read_b64_tr_b16 a[200:201], v40 offset:8192
    ds_read_b64_tr_b16 a[202:203], v40 offset:12288
    v_mfma_f32_16x16x32_bf16 v[180:183], a[216:219], a[184:187], v[180:183]
    v_mfma_f32_16x16x32_bf16 v[184:187], a[216:219], a[188:191], v[184:187]
    s_waitcnt lgkmcnt(6)
    ds_read_b64_tr_b16 a[204:205], v41 offset:8192
    ds_read_b64_tr_b16 a[206:207], v41 offset:12288
    v_mfma_f32_16x16x32_bf16 v[84:87], a[220:223], a[184:187], v[84:87]
    v_mfma_f32_16x16x32_bf16 v[88:91], a[220:223], a[188:191], v[88:91]
    s_waitcnt lgkmcnt(6)
    ds_read_b64_tr_b16 a[208:209], v36 offset:16384
    ds_read_b64_tr_b16 a[210:211], v36 offset:20480
    v_mfma_f32_16x16x32_bf16 v[196:199], a[192:195], a[184:187], v[196:199]
    v_mfma_f32_16x16x32_bf16 v[200:203], a[192:195], a[188:191], v[200:203]
    s_waitcnt lgkmcnt(6)
    ds_read_b64_tr_b16 a[212:213], v37 offset:16384
    ds_read_b64_tr_b16 a[214:215], v37 offset:20480
    v_mfma_f32_16x16x32_bf16 v[92:95], a[196:199], a[184:187], v[92:95]
    v_mfma_f32_16x16x32_bf16 v[96:99], a[196:199], a[188:191], v[96:99]
    s_waitcnt lgkmcnt(6)
    ds_read_b64_tr_b16 a[216:217], v38 offset:16384
    ds_read_b64_tr_b16 a[218:219], v38 offset:20480
    v_mfma_f32_16x16x32_bf16 v[212:215], a[200:203], a[184:187], v[212:215]
    v_mfma_f32_16x16x32_bf16 v[216:219], a[200:203], a[188:191], v[216:219]
    s_waitcnt lgkmcnt(6)
    ds_read_b64_tr_b16 a[220:221], v39 offset:16384
    ds_read_b64_tr_b16 a[222:223], v39 offset:20480
    v_mfma_f32_16x16x32_bf16 v[100:103], a[204:207], a[184:187], v[100:103]
    v_mfma_f32_16x16x32_bf16 v[104:107], a[204:207], a[188:191], v[104:107]
    s_waitcnt vmcnt(0)
    s_waitcnt lgkmcnt(6)
    ds_read_b64_tr_b16 a[192:193], v40 offset:16384
    ds_read_b64_tr_b16 a[194:195], v40 offset:20480
    v_mfma_f32_16x16x32_bf16 v[180:183], a[208:211], a[240:243], v[180:183]
    v_mfma_f32_16x16x32_bf16 v[184:187], a[208:211], a[244:247], v[184:187]
    s_waitcnt lgkmcnt(6)
    ds_read_b64_tr_b16 a[196:197], v41 offset:16384
    ds_read_b64_tr_b16 a[198:199], v41 offset:20480
    v_mfma_f32_16x16x32_bf16 v[84:87], a[212:215], a[240:243], v[84:87]
    v_mfma_f32_16x16x32_bf16 v[88:91], a[212:215], a[244:247], v[88:91]
    s_waitcnt lgkmcnt(6)
    ds_read_b64_tr_b16 a[200:201], v36 offset:24576
    ds_read_b64_tr_b16 a[202:203], v36 offset:28672
    v_mfma_f32_16x16x32_bf16 v[196:199], a[216:219], a[240:243], v[196:199]
    v_mfma_f32_16x16x32_bf16 v[200:203], a[216:219], a[244:247], v[200:203]
    s_waitcnt lgkmcnt(6)
    ds_read_b64_tr_b16 a[204:205], v37 offset:24576
    ds_read_b64_tr_b16 a[206:207], v37 offset:28672
    v_mfma_f32_16x16x32_bf16 v[92:95], a[220:223], a[240:243], v[92:95]
    v_mfma_f32_16x16x32_bf16 v[96:99], a[220:223], a[244:247], v[96:99]
    s_waitcnt lgkmcnt(6)
    ds_read_b64_tr_b16 a[208:209], v38 offset:24576
    ds_read_b64_tr_b16 a[210:211], v38 offset:28672
    v_mfma_f32_16x16x32_bf16 v[212:215], a[192:195], a[240:243], v[212:215]
    v_mfma_f32_16x16x32_bf16 v[216:219], a[192:195], a[244:247], v[216:219]
    s_waitcnt lgkmcnt(6)
    ds_read_b64_tr_b16 a[212:213], v39 offset:24576
    ds_read_b64_tr_b16 a[214:215], v39 offset:28672
    v_mfma_f32_16x16x32_bf16 v[100:103], a[196:199], a[240:243], v[100:103]
    v_mfma_f32_16x16x32_bf16 v[104:107], a[196:199], a[244:247], v[104:107]
    s_waitcnt lgkmcnt(6)
    ds_read_b64_tr_b16 a[216:217], v40 offset:24576
    ds_read_b64_tr_b16 a[218:219], v40 offset:28672
    v_mfma_f32_16x16x32_bf16 v[180:183], a[200:203], a[248:251], v[180:183]
    v_mfma_f32_16x16x32_bf16 v[184:187], a[200:203], a[252:255], v[184:187]
    s_waitcnt lgkmcnt(6)
    ds_read_b64_tr_b16 a[220:221], v41 offset:24576
    ds_read_b64_tr_b16 a[222:223], v41 offset:28672
    v_mfma_f32_16x16x32_bf16 v[84:87], a[204:207], a[248:251], v[84:87]
    v_mfma_f32_16x16x32_bf16 v[88:91], a[204:207], a[252:255], v[88:91]
    s_waitcnt lgkmcnt(6)
    ds_read_b64_tr_b16 a[192:193], v26 offset:32768
    ds_read_b64_tr_b16 a[194:195], v26 offset:36864
    v_mfma_f32_16x16x32_bf16 v[196:199], a[208:211], a[248:251], v[196:199]
    v_mfma_f32_16x16x32_bf16 v[200:203], a[208:211], a[252:255], v[200:203]
    s_waitcnt lgkmcnt(6)
    ds_read_b64_tr_b16 a[196:197], v27 offset:32768
    ds_read_b64_tr_b16 a[198:199], v27 offset:36864
    v_mfma_f32_16x16x32_bf16 v[92:95], a[212:215], a[248:251], v[92:95]
    v_cvt_pk_bf16_f32 v180, v180, v181
    v_cvt_pk_bf16_f32 v181, v182, v183
    v_mfma_f32_16x16x32_bf16 v[96:99], a[212:215], a[252:255], v[96:99]
    s_waitcnt lgkmcnt(6)
    ds_read_b64_tr_b16 a[200:201], v26 offset:40960
    ds_read_b64_tr_b16 a[202:203], v26 offset:45056
    v_mfma_f32_16x16x32_bf16 v[212:215], a[216:219], a[248:251], v[212:215]
    v_cvt_pk_bf16_f32 v182, v84, v85
    v_cvt_pk_bf16_f32 v183, v86, v87
    v_mfma_f32_16x16x32_bf16 v[216:219], a[216:219], a[252:255], v[216:219]
    s_waitcnt lgkmcnt(6)
    ds_read_b64_tr_b16 a[204:205], v27 offset:40960
    ds_read_b64_tr_b16 a[206:207], v27 offset:45056
    v_mfma_f32_16x16x32_bf16 v[100:103], a[220:223], a[248:251], v[100:103]
    buffer_store_dwordx4 v[180:183], v16, s[24:27], s56 offen offset:0 sc1
    v_mfma_f32_16x16x32_bf16 v[104:107], a[220:223], a[252:255], v[104:107]
    s_waitcnt lgkmcnt(6)
    ds_read_b64_tr_b16 a[208:209], v34 offset:16384
    ds_read_b64_tr_b16 a[210:211], v34 offset:20480
    v_mfma_f32_16x16x32_bf16 v[228:231], a[192:195], a[80:83], v[228:231]
    v_cvt_pk_bf16_f32 v184, v184, v185
    v_cvt_pk_bf16_f32 v185, v186, v187
    v_cvt_pk_bf16_f32 v186, v88, v89
    v_cvt_pk_bf16_f32 v187, v90, v91
    v_mfma_f32_16x16x32_bf16 v[232:235], a[192:195], a[84:87], v[232:235]
    s_waitcnt lgkmcnt(6)
    ds_read_b64_tr_b16 a[212:213], v35 offset:16384
    ds_read_b64_tr_b16 a[214:215], v35 offset:20480
    buffer_store_dwordx4 v[184:187], v16, s[24:27], s56 offen offset:1024 sc1
    v_cvt_pk_bf16_f32 v196, v196, v197
    v_cvt_pk_bf16_f32 v197, v198, v199
    v_mfma_f32_16x16x32_bf16 v[108:111], a[196:199], a[80:83], v[108:111]
    v_cvt_pk_bf16_f32 v198, v92, v93
    v_cvt_pk_bf16_f32 v199, v94, v95
    v_mfma_f32_16x16x32_bf16 v[112:115], a[196:199], a[84:87], v[112:115]
    s_waitcnt lgkmcnt(6)
    ds_read_b64_tr_b16 a[216:217], v34 offset:24576
    ds_read_b64_tr_b16 a[218:219], v34 offset:28672
    buffer_store_dwordx4 v[196:199], v16, s[24:27], s57 offen offset:0 sc1
    v_cvt_pk_bf16_f32 v200, v200, v201
    v_cvt_pk_bf16_f32 v201, v202, v203
    v_mfma_f32_16x16x32_bf16 v[228:231], a[200:203], a[88:91], v[228:231]
    v_cvt_pk_bf16_f32 v202, v96, v97
    v_cvt_pk_bf16_f32 v203, v98, v99
    v_mfma_f32_16x16x32_bf16 v[232:235], a[200:203], a[92:95], v[232:235]
    s_waitcnt lgkmcnt(6)
    ds_read_b64_tr_b16 a[220:221], v35 offset:24576
    ds_read_b64_tr_b16 a[222:223], v35 offset:28672
    buffer_store_dwordx4 v[200:203], v16, s[24:27], s57 offen offset:1024 sc1
    v_cvt_pk_bf16_f32 v212, v212, v213
    v_cvt_pk_bf16_f32 v213, v214, v215
    v_mfma_f32_16x16x32_bf16 v[108:111], a[204:207], a[88:91], v[108:111]
    v_cvt_pk_bf16_f32 v214, v100, v101
    v_cvt_pk_bf16_f32 v215, v102, v103
    v_mfma_f32_16x16x32_bf16 v[112:115], a[204:207], a[92:95], v[112:115]
    s_waitcnt lgkmcnt(6)
    ds_read_b64_tr_b16 a[192:193], v34 offset:0
    ds_read_b64_tr_b16 a[194:195], v34 offset:4096
    buffer_store_dwordx4 v[212:215], v16, s[24:27], s58 offen offset:0 sc1
    v_cvt_pk_bf16_f32 v216, v216, v217
    v_cvt_pk_bf16_f32 v217, v218, v219
    v_mfma_f32_16x16x32_bf16 v[228:231], a[208:211], a[112:115], v[228:231]
    v_cvt_pk_bf16_f32 v218, v104, v105
    v_cvt_pk_bf16_f32 v219, v106, v107
    v_mfma_f32_16x16x32_bf16 v[232:235], a[208:211], a[116:119], v[232:235]
    s_waitcnt lgkmcnt(6)
    ds_read_b64_tr_b16 a[196:197], v35 offset:0
    ds_read_b64_tr_b16 a[198:199], v35 offset:4096
    v_mfma_f32_16x16x32_bf16 v[108:111], a[212:215], a[112:115], v[108:111]
    buffer_store_dwordx4 v[216:219], v16, s[24:27], s58 offen offset:1024 sc1
    v_mfma_f32_16x16x32_bf16 v[112:115], a[212:215], a[116:119], v[112:115]
    s_waitcnt lgkmcnt(6)
    ds_read_b64_tr_b16 a[200:201], v34 offset:8192
    ds_read_b64_tr_b16 a[202:203], v34 offset:12288
    v_mfma_f32_16x16x32_bf16 v[228:231], a[216:219], a[120:123], v[228:231]
    v_mfma_f32_16x16x32_bf16 v[232:235], a[216:219], a[124:127], v[232:235]
    s_waitcnt lgkmcnt(6)
    ds_read_b64_tr_b16 a[204:205], v35 offset:8192
    ds_read_b64_tr_b16 a[206:207], v35 offset:12288
    v_mfma_f32_16x16x32_bf16 v[108:111], a[220:223], a[120:123], v[108:111]
    v_mfma_f32_16x16x32_bf16 v[112:115], a[220:223], a[124:127], v[112:115]
    s_waitcnt lgkmcnt(6)
    ds_read_b64_tr_b16 a[208:209], v34 offset:32768
    ds_read_b64_tr_b16 a[210:211], v34 offset:36864
    v_mfma_f32_16x16x32_bf16 v[228:231], a[192:195], a[128:131], v[228:231]
    v_mfma_f32_16x16x32_bf16 v[232:235], a[192:195], a[132:135], v[232:235]
    s_waitcnt lgkmcnt(6)
    ds_read_b64_tr_b16 a[212:213], v35 offset:32768
    ds_read_b64_tr_b16 a[214:215], v35 offset:36864
    v_mfma_f32_16x16x32_bf16 v[108:111], a[196:199], a[128:131], v[108:111]
    v_mfma_f32_16x16x32_bf16 v[112:115], a[196:199], a[132:135], v[112:115]
    s_waitcnt lgkmcnt(6)
    ds_read_b64_tr_b16 a[216:217], v34 offset:40960
    ds_read_b64_tr_b16 a[218:219], v34 offset:45056
    v_mfma_f32_16x16x32_bf16 v[228:231], a[200:203], a[136:139], v[228:231]
    v_mfma_f32_16x16x32_bf16 v[232:235], a[200:203], a[140:143], v[232:235]
    s_waitcnt lgkmcnt(6)
    ds_read_b64_tr_b16 a[220:221], v35 offset:40960
    ds_read_b64_tr_b16 a[222:223], v35 offset:45056
    v_mfma_f32_16x16x32_bf16 v[108:111], a[204:207], a[136:139], v[108:111]
    v_mfma_f32_16x16x32_bf16 v[112:115], a[204:207], a[140:143], v[112:115]
    s_waitcnt lgkmcnt(6)
    ds_read_b64_tr_b16 a[192:193], v26 offset:49152
    ds_read_b64_tr_b16 a[194:195], v26 offset:53248
    v_mfma_f32_16x16x32_bf16 v[228:231], a[208:211], a[160:163], v[228:231]
    v_mfma_f32_16x16x32_bf16 v[232:235], a[208:211], a[164:167], v[232:235]
    s_waitcnt lgkmcnt(6)
    ds_read_b64_tr_b16 a[196:197], v27 offset:49152
    ds_read_b64_tr_b16 a[198:199], v27 offset:53248
    v_mfma_f32_16x16x32_bf16 v[108:111], a[212:215], a[160:163], v[108:111]
    v_mfma_f32_16x16x32_bf16 v[112:115], a[212:215], a[164:167], v[112:115]
    s_waitcnt lgkmcnt(6)
    ds_read_b64_tr_b16 a[200:201], v26 offset:57344
    ds_read_b64_tr_b16 a[202:203], v26 offset:61440
    v_mfma_f32_16x16x32_bf16 v[228:231], a[216:219], a[168:171], v[228:231]
    v_mfma_f32_16x16x32_bf16 v[232:235], a[216:219], a[172:175], v[232:235]
    s_waitcnt lgkmcnt(6)
    ds_read_b64_tr_b16 a[204:205], v27 offset:57344
    ds_read_b64_tr_b16 a[206:207], v27 offset:61440
    v_mfma_f32_16x16x32_bf16 v[108:111], a[220:223], a[168:171], v[108:111]
    v_mfma_f32_16x16x32_bf16 v[112:115], a[220:223], a[172:175], v[112:115]
    s_waitcnt lgkmcnt(6)
    ds_read_b64_tr_b16 a[208:209], v26 offset:16384
    ds_read_b64_tr_b16 a[210:211], v26 offset:20480
    v_mfma_f32_16x16x32_bf16 v[228:231], a[192:195], a[224:227], v[228:231]
    v_mfma_f32_16x16x32_bf16 v[232:235], a[192:195], a[228:231], v[232:235]
    s_waitcnt lgkmcnt(6)
    ds_read_b64_tr_b16 a[212:213], v27 offset:16384
    ds_read_b64_tr_b16 a[214:215], v27 offset:20480
    v_mfma_f32_16x16x32_bf16 v[108:111], a[196:199], a[224:227], v[108:111]
    v_mfma_f32_16x16x32_bf16 v[112:115], a[196:199], a[228:231], v[112:115]
    s_waitcnt lgkmcnt(6)
    ds_read_b64_tr_b16 a[216:217], v26 offset:24576
    ds_read_b64_tr_b16 a[218:219], v26 offset:28672
    v_mfma_f32_16x16x32_bf16 v[228:231], a[200:203], a[232:235], v[228:231]
    v_mfma_f32_16x16x32_bf16 v[232:235], a[200:203], a[236:239], v[232:235]
    s_waitcnt lgkmcnt(6)
    ds_read_b64_tr_b16 a[220:221], v27 offset:24576
    ds_read_b64_tr_b16 a[222:223], v27 offset:28672
    v_mfma_f32_16x16x32_bf16 v[108:111], a[204:207], a[232:235], v[108:111]
    v_mfma_f32_16x16x32_bf16 v[112:115], a[204:207], a[236:239], v[112:115]
    s_waitcnt vmcnt(0)
    s_add_u32 s43, s53, 262144
    buffer_store_dword v13, v14, s[24:27], s43 offen sc1
    s_waitcnt lgkmcnt(6)
    ds_read_b64_tr_b16 a[192:193], v42 offset:0
    ds_read_b64_tr_b16 a[194:195], v42 offset:4096
    v_mfma_f32_16x16x32_bf16 v[228:231], a[208:211], a[144:147], v[228:231]
    v_mfma_f32_16x16x32_bf16 v[232:235], a[208:211], a[148:151], v[232:235]
    s_waitcnt lgkmcnt(6)
    ds_read_b64_tr_b16 a[196:197], v43 offset:0
    ds_read_b64_tr_b16 a[198:199], v43 offset:4096
    v_mfma_f32_16x16x32_bf16 v[108:111], a[212:215], a[144:147], v[108:111]
    v_mfma_f32_16x16x32_bf16 v[112:115], a[212:215], a[148:151], v[112:115]
    s_waitcnt lgkmcnt(6)
    ds_read_b64_tr_b16 a[200:201], v42 offset:8192
    ds_read_b64_tr_b16 a[202:203], v42 offset:12288
    v_mfma_f32_16x16x32_bf16 v[228:231], a[216:219], a[152:155], v[228:231]
    v_mfma_f32_16x16x32_bf16 v[232:235], a[216:219], a[156:159], v[232:235]
    s_waitcnt lgkmcnt(6)
    ds_read_b64_tr_b16 a[204:205], v43 offset:8192
    ds_read_b64_tr_b16 a[206:207], v43 offset:12288
    v_mfma_f32_16x16x32_bf16 v[108:111], a[220:223], a[152:155], v[108:111]
    v_mfma_f32_16x16x32_bf16 v[112:115], a[220:223], a[156:159], v[112:115]
    s_waitcnt lgkmcnt(6)
    ds_read_b64_tr_b16 a[208:209], v42 offset:16384
    ds_read_b64_tr_b16 a[210:211], v42 offset:20480
    v_mfma_f32_16x16x32_bf16 v[228:231], a[192:195], a[176:179], v[228:231]
    v_mfma_f32_16x16x32_bf16 v[232:235], a[192:195], a[180:183], v[232:235]
    s_waitcnt lgkmcnt(6)
    ds_read_b64_tr_b16 a[212:213], v43 offset:16384
    ds_read_b64_tr_b16 a[214:215], v43 offset:20480
    v_mfma_f32_16x16x32_bf16 v[108:111], a[196:199], a[176:179], v[108:111]
    v_mfma_f32_16x16x32_bf16 v[112:115], a[196:199], a[180:183], v[112:115]
    s_waitcnt lgkmcnt(6)
    ds_read_b64_tr_b16 a[216:217], v42 offset:24576
    ds_read_b64_tr_b16 a[218:219], v42 offset:28672
    v_mfma_f32_16x16x32_bf16 v[228:231], a[200:203], a[184:187], v[228:231]
    v_mfma_f32_16x16x32_bf16 v[232:235], a[200:203], a[188:191], v[232:235]
    s_waitcnt lgkmcnt(6)
    ds_read_b64_tr_b16 a[220:221], v43 offset:24576
    ds_read_b64_tr_b16 a[222:223], v43 offset:28672
    v_mfma_f32_16x16x32_bf16 v[108:111], a[204:207], a[184:187], v[108:111]
    v_mfma_f32_16x16x32_bf16 v[112:115], a[204:207], a[188:191], v[112:115]
    s_waitcnt lgkmcnt(6)
    v_mfma_f32_16x16x32_bf16 v[228:231], a[208:211], a[240:243], v[228:231]
    v_mfma_f32_16x16x32_bf16 v[232:235], a[208:211], a[244:247], v[232:235]
    s_waitcnt lgkmcnt(4)
    v_mfma_f32_16x16x32_bf16 v[108:111], a[212:215], a[240:243], v[108:111]
    v_mfma_f32_16x16x32_bf16 v[112:115], a[212:215], a[244:247], v[112:115]
    s_waitcnt lgkmcnt(2)
    v_mfma_f32_16x16x32_bf16 v[228:231], a[216:219], a[248:251], v[228:231]
    v_mfma_f32_16x16x32_bf16 v[232:235], a[216:219], a[252:255], v[232:235]
    s_waitcnt lgkmcnt(0)
    v_mfma_f32_16x16x32_bf16 v[108:111], a[220:223], a[248:251], v[108:111]
    v_mfma_f32_16x16x32_bf16 v[112:115], a[220:223], a[252:255], v[112:115]
    s_mov_b32 s43, s55
    buffer_load_dword v10, v12, s[24:27], s43 offen sc1
    s_waitcnt vmcnt(0)
    v_cmp_ne_u32 s[62:63], 1, v10
    s_nop 0
    s_cmp_lg_u64 s[62:63], 0
    s_cbranch_scc1 w2_p2_spin
w2_p2_back:
    s_add_u32 s42, s59, 1835008
    s_add_u32 s43, s59, 3670016
    buffer_load_dwordx4 v[148:151], v16, s[24:27], s59 offen offset:0 sc1
    buffer_load_dwordx4 v[152:155], v16, s[24:27], s59 offen offset:1024 sc1
    buffer_load_dwordx4 v[156:159], v16, s[24:27], s42 offen offset:0 sc1
    buffer_load_dwordx4 v[160:163], v16, s[24:27], s42 offen offset:1024 sc1
    buffer_load_dwordx4 v[164:167], v16, s[24:27], s43 offen offset:0 sc1
    buffer_load_dwordx4 v[168:171], v16, s[24:27], s43 offen offset:1024 sc1
    s_waitcnt vmcnt(5)
    v_lshlrev_b32 v244, 16, v148
    v_and_b32 v245, 0xffff0000, v148
    v_pk_add_f32 v[228:229], v[228:229], v[244:245]
    v_lshlrev_b32 v246, 16, v149
    v_and_b32 v247, 0xffff0000, v149
    v_pk_add_f32 v[230:231], v[230:231], v[246:247]
    v_lshlrev_b32 v248, 16, v150
    v_and_b32 v249, 0xffff0000, v150
    v_pk_add_f32 v[108:109], v[108:109], v[248:249]
    v_lshlrev_b32 v250, 16, v151
    v_and_b32 v251, 0xffff0000, v151
    v_pk_add_f32 v[110:111], v[110:111], v[250:251]
    s_waitcnt vmcnt(4)
    v_lshlrev_b32 v244, 16, v152
    v_and_b32 v245, 0xffff0000, v152
    v_pk_add_f32 v[232:233], v[232:233], v[244:245]
    v_lshlrev_b32 v246, 16, v153
    v_and_b32 v247, 0xffff0000, v153
    v_pk_add_f32 v[234:235], v[234:235], v[246:247]
    v_lshlrev_b32 v248, 16, v154
    v_and_b32 v249, 0xffff0000, v154
    v_pk_add_f32 v[112:113], v[112:113], v[248:249]
    v_lshlrev_b32 v250, 16, v155
    v_and_b32 v251, 0xffff0000, v155
    v_pk_add_f32 v[114:115], v[114:115], v[250:251]
    s_waitcnt vmcnt(3)
    v_lshlrev_b32 v244, 16, v156
    v_and_b32 v245, 0xffff0000, v156
    v_pk_add_f32 v[228:229], v[228:229], v[244:245]
    v_lshlrev_b32 v246, 16, v157
    v_and_b32 v247, 0xffff0000, v157
    v_pk_add_f32 v[230:231], v[230:231], v[246:247]
    v_lshlrev_b32 v248, 16, v158
    v_and_b32 v249, 0xffff0000, v158
    v_pk_add_f32 v[108:109], v[108:109], v[248:249]
    v_lshlrev_b32 v250, 16, v159
    v_and_b32 v251, 0xffff0000, v159
    v_pk_add_f32 v[110:111], v[110:111], v[250:251]
    s_waitcnt vmcnt(2)
    v_lshlrev_b32 v244, 16, v160
    v_and_b32 v245, 0xffff0000, v160
    v_pk_add_f32 v[232:233], v[232:233], v[244:245]
    v_lshlrev_b32 v246, 16, v161
    v_and_b32 v247, 0xffff0000, v161
    v_pk_add_f32 v[234:235], v[234:235], v[246:247]
    v_lshlrev_b32 v248, 16, v162
    v_and_b32 v249, 0xffff0000, v162
    v_pk_add_f32 v[112:113], v[112:113], v[248:249]
    v_lshlrev_b32 v250, 16, v163
    v_and_b32 v251, 0xffff0000, v163
    v_pk_add_f32 v[114:115], v[114:115], v[250:251]
    s_waitcnt vmcnt(1)
    v_lshlrev_b32 v244, 16, v164
    v_and_b32 v245, 0xffff0000, v164
    v_pk_add_f32 v[228:229], v[228:229], v[244:245]
    v_lshlrev_b32 v246, 16, v165
    v_and_b32 v247, 0xffff0000, v165
    v_pk_add_f32 v[230:231], v[230:231], v[246:247]
    v_lshlrev_b32 v248, 16, v166
    v_and_b32 v249, 0xffff0000, v166
    v_pk_add_f32 v[108:109], v[108:109], v[248:249]
    v_lshlrev_b32 v250, 16, v167
    v_and_b32 v251, 0xffff0000, v167
    v_pk_add_f32 v[110:111], v[110:111], v[250:251]
    s_waitcnt vmcnt(0)
    v_lshlrev_b32 v244, 16, v168
    v_and_b32 v245, 0xffff0000, v168
    v_pk_add_f32 v[232:233], v[232:233], v[244:245]
    v_lshlrev_b32 v246, 16, v169
    v_and_b32 v247, 0xffff0000, v169
    v_pk_add_f32 v[234:235], v[234:235], v[246:247]
    v_lshlrev_b32 v248, 16, v170
    v_and_b32 v249, 0xffff0000, v170
    v_pk_add_f32 v[112:113], v[112:113], v[248:249]
    v_lshlrev_b32 v250, 16, v171
    v_and_b32 v251, 0xffff0000, v171
    v_pk_add_f32 v[114:115], v[114:115], v[250:251]
    v_cvt_pk_bf16_f32 v228, v228, v229
    v_cvt_pk_bf16_f32 v229, v230, v231
    v_cvt_pk_bf16_f32 v230, v108, v109
    v_cvt_pk_bf16_f32 v231, v110, v111
    v_cvt_pk_bf16_f32 v232, v232, v233
    v_cvt_pk_bf16_f32 v233, v234, v235
    v_cvt_pk_bf16_f32 v234, v112, v113
    v_cvt_pk_bf16_f32 v235, v114, v115
    v_permlane32_swap_b32 v228, v230
    v_permlane32_swap_b32 v229, v231
    v_permlane32_swap_b32 v232, v234
    v_permlane32_swap_b32 v233, v235
    v_permlane16_swap_b32 v228, v230
    v_permlane16_swap_b32 v229, v231
    v_permlane16_swap_b32 v232, v234
    v_permlane16_swap_b32 v233, v235
    s_add_u32 s43, s60, 16384
    buffer_store_dwordx4 v[228:231], v66, s[28:31], s60 offen sc1
    buffer_store_dwordx4 v[232:235], v66, s[28:31], s43 offen sc1
    s_endpgm

.p2align 6
k1_w3:
    s_waitcnt vmcnt(4)
    s_barrier
    ds_read_b64 a[0:1], v148 offset:0
    ds_read_b64 a[2:3], v149 offset:0
    ds_read_b64_tr_b16 a[192:193], v20 offset:16384
    ds_read_b64_tr_b16 a[194:195], v20 offset:20480
    ds_read_b64_tr_b16 a[196:197], v21 offset:16384
    ds_read_b64_tr_b16 a[198:199], v21 offset:20480
    ds_read_b64_tr_b16 a[200:201], v22 offset:16384
    ds_read_b64_tr_b16 a[202:203], v22 offset:20480
    ds_read_b64_tr_b16 a[204:205], v23 offset:16384
    ds_read_b64_tr_b16 a[206:207], v23 offset:20480
    ds_read_b64_tr_b16 a[208:209], v24 offset:16384
    ds_read_b64_tr_b16 a[210:211], v24 offset:20480
    s_waitcnt lgkmcnt(8)
    v_mfma_f32_16x16x32_bf16 v[84:87], a[192:195], a[0:3], 0
    s_waitcnt lgkmcnt(6)
    ds_read_b64_tr_b16 a[212:213], v25 offset:16384
    ds_read_b64_tr_b16 a[214:215], v25 offset:20480
    s_add_u32 s42, s52, 524288
    s_and_b32 s42, s42, 0x3fffff
    s_add_u32 m0, s37, 49152
    s_add_u32 s42, s42, s40
    v_mfma_f32_16x16x32_bf16 v[92:95], a[196:199], a[0:3], 0
    s_waitcnt lgkmcnt(6)
    ds_read_b64_tr_b16 a[216:217], v26 offset:16384
    ds_read_b64_tr_b16 a[218:219], v26 offset:20480
    buffer_load_dwordx4 v62, s[16:19], s42 offen offset:0  lds
    v_mfma_f32_16x16x32_bf16 v[100:103], a[200:203], a[0:3], 0
    s_waitcnt lgkmcnt(6)
    ds_read_b64_tr_b16 a[220:221], v27 offset:16384
    ds_read_b64_tr_b16 a[222:223], v27 offset:20480
    buffer_load_dwordx4 v63, s[16:19], s42 offen offset:1024  lds
    v_mfma_f32_16x16x32_bf16 v[108:111], a[204:207], a[0:3], 0
    s_waitcnt lgkmcnt(6)
    ds_read_b64 a[8:9], v150 offset:0
    ds_read_b64 a[10:11], v151 offset:0
    ds_read_b64_tr_b16 a[192:193], v20 offset:24576
    ds_read_b64_tr_b16 a[194:195], v20 offset:28672
    buffer_load_dwordx4 v64, s[16:19], s42 offen offset:2048  lds
    v_mfma_f32_16x16x32_bf16 v[116:119], a[208:211], a[0:3], 0
    s_waitcnt lgkmcnt(8)
    ds_read_b64_tr_b16 a[196:197], v21 offset:24576
    ds_read_b64_tr_b16 a[198:199], v21 offset:28672
    buffer_load_dwordx4 v65, s[16:19], s42 offen offset:3072  lds
    v_mfma_f32_16x16x32_bf16 v[124:127], a[212:215], a[0:3], 0
    s_waitcnt lgkmcnt(8)
    ds_read_b64_tr_b16 a[200:201], v22 offset:24576
    ds_read_b64_tr_b16 a[202:203], v22 offset:28672
    s_add_u32 s42, s52, 256
    s_and_b32 s42, s42, 0x3fffff
    s_add_u32 m0, s37, 65536
    s_add_u32 s42, s42, s40
    v_mfma_f32_16x16x32_bf16 v[132:135], a[216:219], a[0:3], 0
    s_waitcnt lgkmcnt(8)
    ds_read_b64_tr_b16 a[204:205], v23 offset:24576
    ds_read_b64_tr_b16 a[206:207], v23 offset:28672
    buffer_load_dwordx4 v62, s[16:19], s42 offen offset:0  lds
    v_mfma_f32_16x16x32_bf16 v[140:143], a[220:223], a[0:3], 0
    s_waitcnt lgkmcnt(6)
    ds_read_b64_tr_b16 a[208:209], v24 offset:24576
    ds_read_b64_tr_b16 a[210:211], v24 offset:28672
    buffer_load_dwordx4 v63, s[16:19], s42 offen offset:1024  lds
    v_mfma_f32_16x16x32_bf16 v[84:87], a[192:195], a[8:11], v[84:87]
    s_waitcnt lgkmcnt(6)
    ds_read_b64_tr_b16 a[212:213], v25 offset:24576
    ds_read_b64_tr_b16 a[214:215], v25 offset:28672
    buffer_load_dwordx4 v64, s[16:19], s42 offen offset:2048  lds
    v_mfma_f32_16x16x32_bf16 v[92:95], a[196:199], a[8:11], v[92:95]
    s_waitcnt lgkmcnt(6)
    ds_read_b64_tr_b16 a[216:217], v26 offset:24576
    ds_read_b64_tr_b16 a[218:219], v26 offset:28672
    buffer_load_dwordx4 v65, s[16:19], s42 offen offset:3072  lds
    v_mfma_f32_16x16x32_bf16 v[100:103], a[200:203], a[8:11], v[100:103]
    s_waitcnt lgkmcnt(6)
    ds_read_b64_tr_b16 a[220:221], v27 offset:24576
    ds_read_b64_tr_b16 a[222:223], v27 offset:28672
    s_add_u32 s42, s41, 256
    s_and_b32 s42, s42, 0x3ff
    s_add_u32 m0, s37, 81920
    s_add_u32 s42, s42, s38
    v_mfma_f32_16x16x32_bf16 v[108:111], a[204:207], a[8:11], v[108:111]
    s_waitcnt lgkmcnt(6)
    s_waitcnt vmcnt(4)
    s_barrier
    ds_read_b64 a[16:17], v148 offset:32768
    ds_read_b64 a[18:19], v149 offset:32768
    ds_read_b64_tr_b16 a[192:193], v20 offset:49152
    ds_read_b64_tr_b16 a[194:195], v20 offset:53248
    buffer_load_dwordx4 v160, s[4:7], s42 offen offset:0  lds
    v_mfma_f32_16x16x32_bf16 v[116:119], a[208:211], a[8:11], v[116:119]
    s_waitcnt lgkmcnt(8)
    ds_read_b64_tr_b16 a[196:197], v21 offset:49152
    ds_read_b64_tr_b16 a[198:199], v21 offset:53248
    buffer_load_dwordx4 v161, s[4:7], s42 offen offset:1024  lds
    v_mfma_f32_16x16x32_bf16 v[124:127], a[212:215], a[8:11], v[124:127]
    s_waitcnt lgkmcnt(8)
    ds_read_b64_tr_b16 a[200:201], v22 offset:49152
    ds_read_b64_tr_b16 a[202:203], v22 offset:53248
    s_add_u32 s42, s52, 1048576
    s_and_b32 s42, s42, 0x3fffff
    s_add_u32 m0, s37, 98304
    s_add_u32 s42, s42, s40
    v_mfma_f32_16x16x32_bf16 v[132:135], a[216:219], a[8:11], v[132:135]
    s_waitcnt lgkmcnt(8)
    ds_read_b64_tr_b16 a[204:205], v23 offset:49152
    ds_read_b64_tr_b16 a[206:207], v23 offset:53248
    buffer_load_dwordx4 v62, s[16:19], s42 offen offset:0  lds
    v_mfma_f32_16x16x32_bf16 v[140:143], a[220:223], a[8:11], v[140:143]
    s_waitcnt lgkmcnt(6)
    ds_read_b64_tr_b16 a[208:209], v24 offset:49152
    ds_read_b64_tr_b16 a[210:211], v24 offset:53248
    buffer_load_dwordx4 v63, s[16:19], s42 offen offset:1024  lds
    v_mfma_f32_16x16x32_bf16 v[84:87], a[192:195], a[16:19], v[84:87]
    s_waitcnt lgkmcnt(6)
    ds_read_b64_tr_b16 a[212:213], v25 offset:49152
    ds_read_b64_tr_b16 a[214:215], v25 offset:53248
    buffer_load_dwordx4 v64, s[16:19], s42 offen offset:2048  lds
    v_mfma_f32_16x16x32_bf16 v[92:95], a[196:199], a[16:19], v[92:95]
    s_waitcnt lgkmcnt(6)
    ds_read_b64_tr_b16 a[216:217], v26 offset:49152
    ds_read_b64_tr_b16 a[218:219], v26 offset:53248
    buffer_load_dwordx4 v65, s[16:19], s42 offen offset:3072  lds
    v_mfma_f32_16x16x32_bf16 v[100:103], a[200:203], a[16:19], v[100:103]
    s_waitcnt lgkmcnt(6)
    ds_read_b64_tr_b16 a[220:221], v27 offset:49152
    ds_read_b64_tr_b16 a[222:223], v27 offset:53248
    s_add_u32 s42, s52, 524544
    s_and_b32 s42, s42, 0x3fffff
    s_add_u32 m0, s37, 114688
    s_add_u32 s42, s42, s40
    v_mfma_f32_16x16x32_bf16 v[108:111], a[204:207], a[16:19], v[108:111]
    s_waitcnt lgkmcnt(6)
    ds_read_b64 a[24:25], v150 offset:32768
    ds_read_b64 a[26:27], v151 offset:32768
    ds_read_b64_tr_b16 a[192:193], v20 offset:57344
    ds_read_b64_tr_b16 a[194:195], v20 offset:61440
    buffer_load_dwordx4 v62, s[16:19], s42 offen offset:0  lds
    v_mfma_f32_16x16x32_bf16 v[116:119], a[208:211], a[16:19], v[116:119]
    s_waitcnt lgkmcnt(8)
    ds_read_b64_tr_b16 a[196:197], v21 offset:57344
    ds_read_b64_tr_b16 a[198:199], v21 offset:61440
    buffer_load_dwordx4 v63, s[16:19], s42 offen offset:1024  lds
    v_mfma_f32_16x16x32_bf16 v[124:127], a[212:215], a[16:19], v[124:127]
    s_waitcnt lgkmcnt(8)
    ds_read_b64_tr_b16 a[200:201], v22 offset:57344
    ds_read_b64_tr_b16 a[202:203], v22 offset:61440
    buffer_load_dwordx4 v64, s[16:19], s42 offen offset:2048  lds
    v_mfma_f32_16x16x32_bf16 v[132:135], a[216:219], a[16:19], v[132:135]
    s_waitcnt lgkmcnt(8)
    ds_read_b64_tr_b16 a[204:205], v23 offset:57344
    ds_read_b64_tr_b16 a[206:207], v23 offset:61440
    buffer_load_dwordx4 v65, s[16:19], s42 offen offset:3072  lds
    v_mfma_f32_16x16x32_bf16 v[140:143], a[220:223], a[16:19], v[140:143]
    s_waitcnt lgkmcnt(6)
    ds_read_b64_tr_b16 a[208:209], v24 offset:57344
    ds_read_b64_tr_b16 a[210:211], v24 offset:61440
    s_add_u32 s42, s41, 384
    s_and_b32 s42, s42, 0x3ff
    s_add_u32 m0, s37, 131072
    s_add_u32 s42, s42, s38
    v_mfma_f32_16x16x32_bf16 v[84:87], a[192:195], a[24:27], v[84:87]
    s_waitcnt lgkmcnt(6)
    ds_read_b64_tr_b16 a[212:213], v25 offset:57344
    ds_read_b64_tr_b16 a[214:215], v25 offset:61440
    buffer_load_dwordx4 v160, s[4:7], s42 offen offset:0  lds
    v_mfma_f32_16x16x32_bf16 v[92:95], a[196:199], a[24:27], v[92:95]
    s_waitcnt lgkmcnt(6)
    ds_read_b64_tr_b16 a[216:217], v26 offset:57344
    ds_read_b64_tr_b16 a[218:219], v26 offset:61440
    buffer_load_dwordx4 v161, s[4:7], s42 offen offset:1024  lds
    v_mfma_f32_16x16x32_bf16 v[100:103], a[200:203], a[24:27], v[100:103]
    s_waitcnt lgkmcnt(6)
    ds_read_b64_tr_b16 a[220:221], v27 offset:57344
    ds_read_b64_tr_b16 a[222:223], v27 offset:61440
    v_mfma_f32_16x16x32_bf16 v[108:111], a[204:207], a[24:27], v[108:111]
    s_waitcnt lgkmcnt(6)
    s_waitcnt vmcnt(12)
    s_barrier
    s_and_b32 s43, s48, 3
    s_cmp_eq_u32 s43, 0
    s_cselect_b32 s43, s1, 4
    s_cmp_lt_u32 s43, 3
    s_cbranch_scc0 w1_notell0
    s_lshl_b32 s43, s48, 2
    s_mov_b32 s61, 1
    s_atomic_add s61, s[32:33], s43
w1_notell0:
    ds_read_b64_tr_b16 a[192:193], v28 offset:0
    ds_read_b64_tr_b16 a[194:195], v28 offset:4096
    s_add_u32 s42, s52, 1572864
    s_and_b32 s42, s42, 0x3fffff
    s_add_u32 m0, s37, 147456
    s_add_u32 s42, s42, s40
    v_mfma_f32_16x16x32_bf16 v[116:119], a[208:211], a[24:27], v[116:119]
    s_waitcnt lgkmcnt(6)
    ds_read_b64_tr_b16 a[196:197], v29 offset:0
    ds_read_b64_tr_b16 a[198:199], v29 offset:4096
    buffer_load_dwordx4 v62, s[16:19], s42 offen offset:0  lds
    v_mfma_f32_16x16x32_bf16 v[124:127], a[212:215], a[24:27], v[124:127]
    s_waitcnt lgkmcnt(6)
    ds_read_b64_tr_b16 a[200:201], v30 offset:0
    ds_read_b64_tr_b16 a[202:203], v30 offset:4096
    buffer_load_dwordx4 v63, s[16:19], s42 offen offset:1024  lds
    v_mfma_f32_16x16x32_bf16 v[132:135], a[216:219], a[24:27], v[132:135]
    s_waitcnt lgkmcnt(6)
    ds_read_b64_tr_b16 a[204:205], v31 offset:0
    ds_read_b64_tr_b16 a[206:207], v31 offset:4096
    buffer_load_dwordx4 v64, s[16:19], s42 offen offset:2048  lds
    v_mfma_f32_16x16x32_bf16 v[140:143], a[220:223], a[24:27], v[140:143]
    s_waitcnt lgkmcnt(6)
    ds_read_b64_tr_b16 a[208:209], v32 offset:0
    ds_read_b64_tr_b16 a[210:211], v32 offset:4096
    buffer_load_dwordx4 v65, s[16:19], s42 offen offset:3072  lds
    v_mfma_f32_16x16x32_bf16 v[180:183], a[192:195], a[0:3], 0
    s_waitcnt lgkmcnt(6)
    ds_read_b64_tr_b16 a[212:213], v33 offset:0
    ds_read_b64_tr_b16 a[214:215], v33 offset:4096
    s_add_u32 s42, s52, 1048832
    s_and_b32 s42, s42, 0x3fffff
    s_add_u32 m0, s37, 0
    s_add_u32 s42, s42, s40
    v_mfma_f32_16x16x32_bf16 v[188:191], a[196:199], a[0:3], 0
    s_waitcnt lgkmcnt(6)
    ds_read_b64_tr_b16 a[216:217], v34 offset:0
    ds_read_b64_tr_b16 a[218:219], v34 offset:4096
    buffer_load_dwordx4 v62, s[16:19], s42 offen offset:0  lds
    v_mfma_f32_16x16x32_bf16 v[196:199], a[200:203], a[0:3], 0
    s_waitcnt lgkmcnt(6)
    ds_read_b64_tr_b16 a[220:221], v35 offset:0
    ds_read_b64_tr_b16 a[222:223], v35 offset:4096
    buffer_load_dwordx4 v63, s[16:19], s42 offen offset:1024  lds
    v_mfma_f32_16x16x32_bf16 v[204:207], a[204:207], a[0:3], 0
    s_waitcnt lgkmcnt(6)
    ds_read_b64_tr_b16 a[192:193], v28 offset:8192
    ds_read_b64_tr_b16 a[194:195], v28 offset:12288
    buffer_load_dwordx4 v64, s[16:19], s42 offen offset:2048  lds
    v_mfma_f32_16x16x32_bf16 v[212:215], a[208:211], a[0:3], 0
    s_waitcnt lgkmcnt(6)
    ds_read_b64_tr_b16 a[196:197], v29 offset:8192
    ds_read_b64_tr_b16 a[198:199], v29 offset:12288
    buffer_load_dwordx4 v65, s[16:19], s42 offen offset:3072  lds
    v_mfma_f32_16x16x32_bf16 v[220:223], a[212:215], a[0:3], 0
    s_waitcnt lgkmcnt(6)
    ds_read_b64_tr_b16 a[200:201], v30 offset:8192
    ds_read_b64_tr_b16 a[202:203], v30 offset:12288
    s_add_u32 s42, s41, 512
    s_and_b32 s42, s42, 0x3ff
    s_add_u32 m0, s37, 16384
    s_add_u32 s42, s42, s38
    v_mfma_f32_16x16x32_bf16 v[228:231], a[216:219], a[0:3], 0
    s_waitcnt lgkmcnt(6)
    ds_read_b64_tr_b16 a[204:205], v31 offset:8192
    ds_read_b64_tr_b16 a[206:207], v31 offset:12288
    buffer_load_dwordx4 v160, s[4:7], s42 offen offset:0  lds
    v_mfma_f32_16x16x32_bf16 v[236:239], a[220:223], a[0:3], 0
    s_waitcnt lgkmcnt(6)
    ds_read_b64_tr_b16 a[208:209], v32 offset:8192
    ds_read_b64_tr_b16 a[210:211], v32 offset:12288
    buffer_load_dwordx4 v161, s[4:7], s42 offen offset:1024  lds
    v_mfma_f32_16x16x32_bf16 v[180:183], a[192:195], a[8:11], v[180:183]
    s_waitcnt lgkmcnt(6)
    ds_read_b64_tr_b16 a[212:213], v33 offset:8192
    ds_read_b64_tr_b16 a[214:215], v33 offset:12288
    v_mfma_f32_16x16x32_bf16 v[188:191], a[196:199], a[8:11], v[188:191]
    s_waitcnt lgkmcnt(6)
    ds_read_b64_tr_b16 a[216:217], v34 offset:8192
    ds_read_b64_tr_b16 a[218:219], v34 offset:12288
    v_mfma_f32_16x16x32_bf16 v[196:199], a[200:203], a[8:11], v[196:199]
    s_waitcnt lgkmcnt(6)
    ds_read_b64_tr_b16 a[220:221], v35 offset:8192
    ds_read_b64_tr_b16 a[222:223], v35 offset:12288
    v_mfma_f32_16x16x32_bf16 v[204:207], a[204:207], a[8:11], v[204:207]
    s_waitcnt lgkmcnt(6)
    s_waitcnt vmcnt(16)
    s_barrier
    s_and_b32 s43, s48, 3
    s_cmp_eq_u32 s43, 1
    s_cselect_b32 s43, s1, 4
    s_cmp_lt_u32 s43, 3
    s_cbranch_scc0 w1_notell1
    s_lshl_b32 s43, s48, 2
    s_mov_b32 s61, 1
    s_atomic_add s61, s[32:33], s43
w1_notell1:
    ds_read_b64 a[32:33], v152 offset:16384
    ds_read_b64 a[34:35], v153 offset:16384
    ds_read_b64_tr_b16 a[192:193], v28 offset:32768
    ds_read_b64_tr_b16 a[194:195], v28 offset:36864
    s_add_u32 s42, s52, 2097152
    s_and_b32 s42, s42, 0x3fffff
    v_mfma_f32_16x16x32_bf16 v[212:215], a[208:211], a[8:11], v[212:215]
    s_waitcnt lgkmcnt(8)
    ds_read_b64_tr_b16 a[196:197], v29 offset:32768
    ds_read_b64_tr_b16 a[198:199], v29 offset:36864
    s_add_u32 m0, s37, 32768
    s_add_u32 s42, s42, s40
    buffer_load_dwordx4 v62, s[16:19], s42 offen offset:0  lds
    v_mfma_f32_16x16x32_bf16 v[220:223], a[212:215], a[8:11], v[220:223]
    s_waitcnt lgkmcnt(8)
    ds_read_b64_tr_b16 a[200:201], v30 offset:32768
    ds_read_b64_tr_b16 a[202:203], v30 offset:36864
    buffer_load_dwordx4 v63, s[16:19], s42 offen offset:1024  lds
    v_mfma_f32_16x16x32_bf16 v[228:231], a[216:219], a[8:11], v[228:231]
    s_waitcnt lgkmcnt(8)
    ds_read_b64_tr_b16 a[204:205], v31 offset:32768
    ds_read_b64_tr_b16 a[206:207], v31 offset:36864
    buffer_load_dwordx4 v64, s[16:19], s42 offen offset:2048  lds
    v_mfma_f32_16x16x32_bf16 v[236:239], a[220:223], a[8:11], v[236:239]
    s_waitcnt lgkmcnt(6)
    ds_read_b64_tr_b16 a[208:209], v32 offset:32768
    ds_read_b64_tr_b16 a[210:211], v32 offset:36864
    buffer_load_dwordx4 v65, s[16:19], s42 offen offset:3072  lds
    v_mfma_f32_16x16x32_bf16 v[84:87], a[192:195], a[32:35], v[84:87]
    s_waitcnt lgkmcnt(6)
    ds_read_b64_tr_b16 a[212:213], v33 offset:32768
    ds_read_b64_tr_b16 a[214:215], v33 offset:36864
    s_add_u32 m0, s37, 49152
    s_add_u32 s42, s39, 0
    buffer_load_dwordx4 v56, s[8:11], s42 offen offset:0 nt lds
    v_mfma_f32_16x16x32_bf16 v[92:95], a[196:199], a[32:35], v[92:95]
    s_waitcnt lgkmcnt(6)
    ds_read_b64_tr_b16 a[216:217], v34 offset:32768
    ds_read_b64_tr_b16 a[218:219], v34 offset:36864
    buffer_load_dwordx4 v57, s[8:11], s42 offen offset:1024 nt lds
    v_mfma_f32_16x16x32_bf16 v[100:103], a[200:203], a[32:35], v[100:103]
    s_waitcnt lgkmcnt(6)
    ds_read_b64_tr_b16 a[220:221], v35 offset:32768
    ds_read_b64_tr_b16 a[222:223], v35 offset:36864
    buffer_load_dwordx4 v58, s[8:11], s42 offen offset:2048 nt lds
    v_mfma_f32_16x16x32_bf16 v[108:111], a[204:207], a[32:35], v[108:111]
    s_waitcnt lgkmcnt(6)
    ds_read_b64 a[40:41], v154 offset:16384
    ds_read_b64 a[42:43], v155 offset:16384
    ds_read_b64_tr_b16 a[192:193], v28 offset:40960
    ds_read_b64_tr_b16 a[194:195], v28 offset:45056
    buffer_load_dwordx4 v59, s[8:11], s42 offen offset:3072 nt lds
    v_mfma_f32_16x16x32_bf16 v[116:119], a[208:211], a[32:35], v[116:119]
    s_waitcnt lgkmcnt(8)
    ds_read_b64_tr_b16 a[196:197], v29 offset:40960
    ds_read_b64_tr_b16 a[198:199], v29 offset:45056
    v_mfma_f32_16x16x32_bf16 v[124:127], a[212:215], a[32:35], v[124:127]
    s_waitcnt lgkmcnt(8)
    ds_read_b64_tr_b16 a[200:201], v30 offset:40960
    ds_read_b64_tr_b16 a[202:203], v30 offset:45056
    v_mfma_f32_16x16x32_bf16 v[132:135], a[216:219], a[32:35], v[132:135]
    s_waitcnt lgkmcnt(8)
    ds_read_b64_tr_b16 a[204:205], v31 offset:40960
    ds_read_b64_tr_b16 a[206:207], v31 offset:45056
    v_mfma_f32_16x16x32_bf16 v[140:143], a[220:223], a[32:35], v[140:143]
    s_waitcnt lgkmcnt(6)
    ds_read_b64_tr_b16 a[208:209], v32 offset:40960
    ds_read_b64_tr_b16 a[210:211], v32 offset:45056
    v_mfma_f32_16x16x32_bf16 v[84:87], a[192:195], a[40:43], v[84:87]
    s_waitcnt lgkmcnt(6)
    ds_read_b64_tr_b16 a[212:213], v33 offset:40960
    ds_read_b64_tr_b16 a[214:215], v33 offset:45056
    v_mfma_f32_16x16x32_bf16 v[92:95], a[196:199], a[40:43], v[92:95]
    s_waitcnt lgkmcnt(6)
    ds_read_b64_tr_b16 a[216:217], v34 offset:40960
    ds_read_b64_tr_b16 a[218:219], v34 offset:45056
    v_mfma_f32_16x16x32_bf16 v[100:103], a[200:203], a[40:43], v[100:103]
    s_waitcnt lgkmcnt(6)
    ds_read_b64_tr_b16 a[220:221], v35 offset:40960
    ds_read_b64_tr_b16 a[222:223], v35 offset:45056
    v_mfma_f32_16x16x32_bf16 v[108:111], a[204:207], a[40:43], v[108:111]
    s_waitcnt lgkmcnt(6)
    s_waitcnt vmcnt(20)
    s_barrier
    s_and_b32 s43, s48, 3
    s_cmp_eq_u32 s43, 2
    s_cselect_b32 s43, s1, 4
    s_cmp_lt_u32 s43, 3
    s_cbranch_scc0 w1_notell2
    s_lshl_b32 s43, s48, 2
    s_mov_b32 s61, 1
    s_atomic_add s61, s[32:33], s43
w1_notell2:
    s_and_b32 s43, s48, 7
    s_lshl2_add_u32 s43, s43, s50
    s_lshl2_add_u32 s43, s43, s36
    s_lshl_b32 s43, s43, 13
    s_lshl_b32 s62, s51, 20
    s_add_u32 s62, s62, 0
    s_add_u32 s43, s43, s62
    v_lshlrev_b32 v6, 2, v16
    buffer_load_dword v7, v6, s[20:23], s43 offen
    ds_read_b64_tr_b16 a[192:193], v28 offset:49152
    ds_read_b64_tr_b16 a[194:195], v28 offset:53248
    s_add_u32 s42, s52, 1573120
    s_and_b32 s42, s42, 0x3fffff
    s_add_u32 m0, s37, 65536
    s_add_u32 s42, s42, s40
    v_mfma_f32_16x16x32_bf16 v[116:119], a[208:211], a[40:43], v[116:119]
    s_waitcnt lgkmcnt(6)
    ds_read_b64_tr_b16 a[196:197], v29 offset:49152
    ds_read_b64_tr_b16 a[198:199], v29 offset:53248
    buffer_load_dwordx4 v62, s[16:19], s42 offen offset:0  lds
    v_mfma_f32_16x16x32_bf16 v[124:127], a[212:215], a[40:43], v[124:127]
    s_waitcnt lgkmcnt(6)
    ds_read_b64_tr_b16 a[200:201], v30 offset:49152
    ds_read_b64_tr_b16 a[202:203], v30 offset:53248
    buffer_load_dwordx4 v63, s[16:19], s42 offen offset:1024  lds
    v_mfma_f32_16x16x32_bf16 v[132:135], a[216:219], a[40:43], v[132:135]
    s_waitcnt lgkmcnt(6)
    ds_read_b64_tr_b16 a[204:205], v31 offset:49152
    ds_read_b64_tr_b16 a[206:207], v31 offset:53248
    buffer_load_dwordx4 v64, s[16:19], s42 offen offset:2048  lds
    v_mfma_f32_16x16x32_bf16 v[140:143], a[220:223], a[40:43], v[140:143]
    s_waitcnt lgkmcnt(6)
    ds_read_b64_tr_b16 a[208:209], v32 offset:49152
    ds_read_b64_tr_b16 a[210:211], v32 offset:53248
    buffer_load_dwordx4 v65, s[16:19], s42 offen offset:3072  lds
    v_mfma_f32_16x16x32_bf16 v[180:183], a[192:195], a[16:19], v[180:183]
    s_waitcnt lgkmcnt(6)
    ds_read_b64_tr_b16 a[212:213], v33 offset:49152
    ds_read_b64_tr_b16 a[214:215], v33 offset:53248
    s_add_u32 s42, s41, 640
    s_and_b32 s42, s42, 0x3ff
    s_add_u32 m0, s37, 81920
    s_add_u32 s42, s42, s38
    v_mfma_f32_16x16x32_bf16 v[188:191], a[196:199], a[16:19], v[188:191]
    s_waitcnt lgkmcnt(6)
    ds_read_b64_tr_b16 a[216:217], v34 offset:49152
    ds_read_b64_tr_b16 a[218:219], v34 offset:53248
    buffer_load_dwordx4 v160, s[4:7], s42 offen offset:0  lds
    v_mfma_f32_16x16x32_bf16 v[196:199], a[200:203], a[16:19], v[196:199]
    s_waitcnt lgkmcnt(6)
    ds_read_b64_tr_b16 a[220:221], v35 offset:49152
    ds_read_b64_tr_b16 a[222:223], v35 offset:53248
    buffer_load_dwordx4 v161, s[4:7], s42 offen offset:1024  lds
    v_mfma_f32_16x16x32_bf16 v[204:207], a[204:207], a[16:19], v[204:207]
    s_waitcnt lgkmcnt(6)
    ds_read_b64_tr_b16 a[192:193], v28 offset:57344
    ds_read_b64_tr_b16 a[194:195], v28 offset:61440
    v_mfma_f32_16x16x32_bf16 v[212:215], a[208:211], a[16:19], v[212:215]
    s_waitcnt lgkmcnt(6)
    ds_read_b64_tr_b16 a[196:197], v29 offset:57344
    ds_read_b64_tr_b16 a[198:199], v29 offset:61440
    v_mfma_f32_16x16x32_bf16 v[220:223], a[212:215], a[16:19], v[220:223]
    s_waitcnt lgkmcnt(6)
    ds_read_b64_tr_b16 a[200:201], v30 offset:57344
    ds_read_b64_tr_b16 a[202:203], v30 offset:61440
    v_mfma_f32_16x16x32_bf16 v[228:231], a[216:219], a[16:19], v[228:231]
    s_waitcnt lgkmcnt(6)
    ds_read_b64_tr_b16 a[204:205], v31 offset:57344
    ds_read_b64_tr_b16 a[206:207], v31 offset:61440
    v_mfma_f32_16x16x32_bf16 v[236:239], a[220:223], a[16:19], v[236:239]
    s_waitcnt lgkmcnt(6)
    ds_read_b64_tr_b16 a[208:209], v32 offset:57344
    ds_read_b64_tr_b16 a[210:211], v32 offset:61440
    v_mfma_f32_16x16x32_bf16 v[180:183], a[192:195], a[24:27], v[180:183]
    s_waitcnt lgkmcnt(6)
    ds_read_b64_tr_b16 a[212:213], v33 offset:57344
    ds_read_b64_tr_b16 a[214:215], v33 offset:61440
    v_mfma_f32_16x16x32_bf16 v[188:191], a[196:199], a[24:27], v[188:191]
    s_waitcnt lgkmcnt(6)
    ds_read_b64_tr_b16 a[216:217], v34 offset:57344
    ds_read_b64_tr_b16 a[218:219], v34 offset:61440
    v_mfma_f32_16x16x32_bf16 v[196:199], a[200:203], a[24:27], v[196:199]
    s_waitcnt lgkmcnt(6)
    ds_read_b64_tr_b16 a[220:221], v35 offset:57344
    ds_read_b64_tr_b16 a[222:223], v35 offset:61440
    v_mfma_f32_16x16x32_bf16 v[204:207], a[204:207], a[24:27], v[204:207]
    s_waitcnt lgkmcnt(6)
    s_waitcnt vmcnt(21)
    s_barrier
    s_and_b32 s43, s48, 3
    s_cmp_eq_u32 s43, 3
    s_cselect_b32 s43, s1, 4
    s_cmp_lt_u32 s43, 3
    s_cbranch_scc0 w1_notell3
    s_lshl_b32 s43, s48, 2
    s_mov_b32 s61, 1
    s_atomic_add s61, s[32:33], s43
w1_notell3:
    ds_read_b64 a[48:49], v156 offset:0
    ds_read_b64 a[50:51], v157 offset:0
    ds_read_b64_tr_b16 a[192:193], v36 offset:16384
    ds_read_b64_tr_b16 a[194:195], v36 offset:20480
    s_add_u32 s42, s52, 2621440
    s_and_b32 s42, s42, 0x3fffff
    v_mfma_f32_16x16x32_bf16 v[212:215], a[208:211], a[24:27], v[212:215]
    s_waitcnt lgkmcnt(8)
    ds_read_b64_tr_b16 a[196:197], v37 offset:16384
    ds_read_b64_tr_b16 a[198:199], v37 offset:20480
    s_add_u32 m0, s37, 98304
    s_add_u32 s42, s42, s40
    buffer_load_dwordx4 v62, s[16:19], s42 offen offset:0  lds
    v_mfma_f32_16x16x32_bf16 v[220:223], a[212:215], a[24:27], v[220:223]
    s_waitcnt lgkmcnt(8)
    ds_read_b64_tr_b16 a[200:201], v38 offset:16384
    ds_read_b64_tr_b16 a[202:203], v38 offset:20480
    buffer_load_dwordx4 v63, s[16:19], s42 offen offset:1024  lds
    v_mfma_f32_16x16x32_bf16 v[228:231], a[216:219], a[24:27], v[228:231]
    s_waitcnt lgkmcnt(8)
    ds_read_b64_tr_b16 a[204:205], v39 offset:16384
    ds_read_b64_tr_b16 a[206:207], v39 offset:20480
    buffer_load_dwordx4 v64, s[16:19], s42 offen offset:2048  lds
    v_mfma_f32_16x16x32_bf16 v[236:239], a[220:223], a[24:27], v[236:239]
    s_waitcnt lgkmcnt(6)
    ds_read_b64_tr_b16 a[208:209], v40 offset:16384
    ds_read_b64_tr_b16 a[210:211], v40 offset:20480
    buffer_load_dwordx4 v65, s[16:19], s42 offen offset:3072  lds
    v_mfma_f32_16x16x32_bf16 v[84:87], a[192:195], a[48:51], v[84:87]
    s_waitcnt lgkmcnt(6)
    ds_read_b64_tr_b16 a[212:213], v41 offset:16384
    ds_read_b64_tr_b16 a[214:215], v41 offset:20480
    v_mfma_f32_16x16x32_bf16 v[92:95], a[196:199], a[48:51], v[92:95]
    s_waitcnt lgkmcnt(6)
    ds_read_b64_tr_b16 a[216:217], v42 offset:16384
    ds_read_b64_tr_b16 a[218:219], v42 offset:20480
    v_mfma_f32_16x16x32_bf16 v[100:103], a[200:203], a[48:51], v[100:103]
    s_waitcnt lgkmcnt(6)
    ds_read_b64_tr_b16 a[220:221], v43 offset:16384
    ds_read_b64_tr_b16 a[222:223], v43 offset:20480
    v_mfma_f32_16x16x32_bf16 v[108:111], a[204:207], a[48:51], v[108:111]
    s_waitcnt lgkmcnt(6)
    ds_read_b64 a[56:57], v158 offset:0
    ds_read_b64 a[58:59], v159 offset:0
    ds_read_b64_tr_b16 a[192:193], v36 offset:24576
    ds_read_b64_tr_b16 a[194:195], v36 offset:28672
    v_mfma_f32_16x16x32_bf16 v[116:119], a[208:211], a[48:51], v[116:119]
    s_waitcnt lgkmcnt(8)
    ds_read_b64_tr_b16 a[196:197], v37 offset:24576
    ds_read_b64_tr_b16 a[198:199], v37 offset:28672
    v_mfma_f32_16x16x32_bf16 v[124:127], a[212:215], a[48:51], v[124:127]
    s_waitcnt lgkmcnt(8)
    ds_read_b64_tr_b16 a[200:201], v38 offset:24576
    ds_read_b64_tr_b16 a[202:203], v38 offset:28672
    v_mfma_f32_16x16x32_bf16 v[132:135], a[216:219], a[48:51], v[132:135]
    s_waitcnt lgkmcnt(8)
    ds_read_b64_tr_b16 a[204:205], v39 offset:24576
    ds_read_b64_tr_b16 a[206:207], v39 offset:28672
    v_mfma_f32_16x16x32_bf16 v[140:143], a[220:223], a[48:51], v[140:143]
    s_waitcnt lgkmcnt(6)
    ds_read_b64_tr_b16 a[208:209], v40 offset:24576
    ds_read_b64_tr_b16 a[210:211], v40 offset:28672
    v_mfma_f32_16x16x32_bf16 v[84:87], a[192:195], a[56:59], v[84:87]
    s_waitcnt lgkmcnt(6)
    ds_read_b64_tr_b16 a[212:213], v41 offset:24576
    ds_read_b64_tr_b16 a[214:215], v41 offset:28672
    v_mfma_f32_16x16x32_bf16 v[92:95], a[196:199], a[56:59], v[92:95]
    s_waitcnt lgkmcnt(6)
    ds_read_b64_tr_b16 a[216:217], v42 offset:24576
    ds_read_b64_tr_b16 a[218:219], v42 offset:28672
    v_mfma_f32_16x16x32_bf16 v[100:103], a[200:203], a[56:59], v[100:103]
    s_waitcnt lgkmcnt(6)
    ds_read_b64_tr_b16 a[220:221], v43 offset:24576
    ds_read_b64_tr_b16 a[222:223], v43 offset:28672
    v_mfma_f32_16x16x32_bf16 v[108:111], a[204:207], a[56:59], v[108:111]
    s_waitcnt lgkmcnt(6)
    s_waitcnt vmcnt(21)
    s_barrier
    ds_read_b64_tr_b16 a[192:193], v20 offset:0
    ds_read_b64_tr_b16 a[194:195], v20 offset:4096
    s_add_u32 m0, s37, 114688
    s_add_u32 s42, s39, 16384
    buffer_load_dwordx4 v56, s[8:11], s42 offen offset:0 nt lds
    v_mfma_f32_16x16x32_bf16 v[116:119], a[208:211], a[56:59], v[116:119]
    s_waitcnt lgkmcnt(6)
    ds_read_b64_tr_b16 a[196:197], v21 offset:0
    ds_read_b64_tr_b16 a[198:199], v21 offset:4096
    buffer_load_dwordx4 v57, s[8:11], s42 offen offset:1024 nt lds
    v_mfma_f32_16x16x32_bf16 v[124:127], a[212:215], a[56:59], v[124:127]
    s_waitcnt lgkmcnt(6)
    ds_read_b64_tr_b16 a[200:201], v22 offset:0
    ds_read_b64_tr_b16 a[202:203], v22 offset:4096
    buffer_load_dwordx4 v58, s[8:11], s42 offen offset:2048 nt lds
    v_mfma_f32_16x16x32_bf16 v[132:135], a[216:219], a[56:59], v[132:135]
    s_waitcnt lgkmcnt(6)
    ds_read_b64_tr_b16 a[204:205], v23 offset:0
    ds_read_b64_tr_b16 a[206:207], v23 offset:4096
    buffer_load_dwordx4 v59, s[8:11], s42 offen offset:3072 nt lds
    v_mfma_f32_16x16x32_bf16 v[140:143], a[220:223], a[56:59], v[140:143]
    s_waitcnt lgkmcnt(6)
    ds_read_b64_tr_b16 a[208:209], v24 offset:0
    ds_read_b64_tr_b16 a[210:211], v24 offset:4096
    s_add_u32 s42, s52, 2097408
    s_and_b32 s42, s42, 0x3fffff
    s_add_u32 m0, s37, 131072
    s_add_u32 s42, s42, s40
    v_mfma_f32_16x16x32_bf16 v[180:183], a[192:195], a[32:35], v[180:183]
    s_waitcnt lgkmcnt(6)
    ds_read_b64_tr_b16 a[212:213], v25 offset:0
    ds_read_b64_tr_b16 a[214:215], v25 offset:4096
    buffer_load_dwordx4 v62, s[16:19], s42 offen offset:0  lds
    v_mfma_f32_16x16x32_bf16 v[188:191], a[196:199], a[32:35], v[188:191]
    s_waitcnt lgkmcnt(6)
    ds_read_b64_tr_b16 a[216:217], v26 offset:0
    ds_read_b64_tr_b16 a[218:219], v26 offset:4096
    buffer_load_dwordx4 v63, s[16:19], s42 offen offset:1024  lds
    v_mfma_f32_16x16x32_bf16 v[196:199], a[200:203], a[32:35], v[196:199]
    s_waitcnt lgkmcnt(6)
    ds_read_b64_tr_b16 a[220:221], v27 offset:0
    ds_read_b64_tr_b16 a[222:223], v27 offset:4096
    buffer_load_dwordx4 v64, s[16:19], s42 offen offset:2048  lds
    v_mfma_f32_16x16x32_bf16 v[204:207], a[204:207], a[32:35], v[204:207]
    s_waitcnt lgkmcnt(6)
    ds_read_b64_tr_b16 a[192:193], v20 offset:8192
    ds_read_b64_tr_b16 a[194:195], v20 offset:12288
    buffer_load_dwordx4 v65, s[16:19], s42 offen offset:3072  lds
    v_mfma_f32_16x16x32_bf16 v[212:215], a[208:211], a[32:35], v[212:215]
    s_waitcnt lgkmcnt(6)
    ds_read_b64_tr_b16 a[196:197], v21 offset:8192
    ds_read_b64_tr_b16 a[198:199], v21 offset:12288
    v_mfma_f32_16x16x32_bf16 v[220:223], a[212:215], a[32:35], v[220:223]
    s_waitcnt lgkmcnt(6)
    ds_read_b64_tr_b16 a[200:201], v22 offset:8192
    ds_read_b64_tr_b16 a[202:203], v22 offset:12288
    v_mfma_f32_16x16x32_bf16 v[228:231], a[216:219], a[32:35], v[228:231]
    s_waitcnt lgkmcnt(6)
    ds_read_b64_tr_b16 a[204:205], v23 offset:8192
    ds_read_b64_tr_b16 a[206:207], v23 offset:12288
    v_mfma_f32_16x16x32_bf16 v[236:239], a[220:223], a[32:35], v[236:239]
    s_waitcnt lgkmcnt(6)
    ds_read_b64_tr_b16 a[208:209], v24 offset:8192
    ds_read_b64_tr_b16 a[210:211], v24 offset:12288
    v_mfma_f32_16x16x32_bf16 v[180:183], a[192:195], a[40:43], v[180:183]
    s_waitcnt lgkmcnt(6)
    ds_read_b64_tr_b16 a[212:213], v25 offset:8192
    ds_read_b64_tr_b16 a[214:215], v25 offset:12288
    v_mfma_f32_16x16x32_bf16 v[188:191], a[196:199], a[40:43], v[188:191]
    s_waitcnt lgkmcnt(6)
    ds_read_b64_tr_b16 a[216:217], v26 offset:8192
    ds_read_b64_tr_b16 a[218:219], v26 offset:12288
    v_mfma_f32_16x16x32_bf16 v[196:199], a[200:203], a[40:43], v[196:199]
    s_waitcnt lgkmcnt(6)
    ds_read_b64_tr_b16 a[220:221], v27 offset:8192
    ds_read_b64_tr_b16 a[222:223], v27 offset:12288
    v_mfma_f32_16x16x32_bf16 v[204:207], a[204:207], a[40:43], v[204:207]
    s_waitcnt lgkmcnt(6)
    s_waitcnt vmcnt(23)
    s_barrier
    ds_read_b64 a[64:65], v148 offset:16384
    ds_read_b64 a[66:67], v149 offset:16384
    ds_read_b64_tr_b16 a[192:193], v20 offset:32768
    ds_read_b64_tr_b16 a[194:195], v20 offset:36864
    s_add_u32 s42, s41, 768
    s_and_b32 s42, s42, 0x3ff
    v_mfma_f32_16x16x32_bf16 v[212:215], a[208:211], a[40:43], v[212:215]
    s_waitcnt lgkmcnt(8)
    ds_read_b64_tr_b16 a[196:197], v21 offset:32768
    ds_read_b64_tr_b16 a[198:199], v21 offset:36864
    s_add_u32 m0, s37, 147456
    s_add_u32 s42, s42, s38
    buffer_load_dwordx4 v160, s[4:7], s42 offen offset:0  lds
    v_mfma_f32_16x16x32_bf16 v[220:223], a[212:215], a[40:43], v[220:223]
    s_waitcnt lgkmcnt(8)
    ds_read_b64_tr_b16 a[200:201], v22 offset:32768
    ds_read_b64_tr_b16 a[202:203], v22 offset:36864
    buffer_load_dwordx4 v161, s[4:7], s42 offen offset:1024  lds
    v_mfma_f32_16x16x32_bf16 v[228:231], a[216:219], a[40:43], v[228:231]
    s_waitcnt lgkmcnt(8)
    ds_read_b64_tr_b16 a[204:205], v23 offset:32768
    ds_read_b64_tr_b16 a[206:207], v23 offset:36864
    v_mfma_f32_16x16x32_bf16 v[236:239], a[220:223], a[40:43], v[236:239]
    s_waitcnt lgkmcnt(6)
    ds_read_b64_tr_b16 a[208:209], v24 offset:32768
    ds_read_b64_tr_b16 a[210:211], v24 offset:36864
    v_mfma_f32_16x16x32_bf16 v[84:87], a[192:195], a[64:67], v[84:87]
    s_waitcnt lgkmcnt(6)
    ds_read_b64_tr_b16 a[212:213], v25 offset:32768
    ds_read_b64_tr_b16 a[214:215], v25 offset:36864
    v_mfma_f32_16x16x32_bf16 v[92:95], a[196:199], a[64:67], v[92:95]
    s_waitcnt lgkmcnt(6)
    ds_read_b64_tr_b16 a[216:217], v26 offset:32768
    ds_read_b64_tr_b16 a[218:219], v26 offset:36864
    v_mfma_f32_16x16x32_bf16 v[100:103], a[200:203], a[64:67], v[100:103]
    s_waitcnt lgkmcnt(6)
    ds_read_b64_tr_b16 a[220:221], v27 offset:32768
    ds_read_b64_tr_b16 a[222:223], v27 offset:36864
    v_mfma_f32_16x16x32_bf16 v[108:111], a[204:207], a[64:67], v[108:111]
    s_waitcnt lgkmcnt(6)
    ds_read_b64 a[72:73], v150 offset:16384
    ds_read_b64 a[74:75], v151 offset:16384
    ds_read_b64_tr_b16 a[192:193], v20 offset:40960
    ds_read_b64_tr_b16 a[194:195], v20 offset:45056
    v_mfma_f32_16x16x32_bf16 v[116:119], a[208:211], a[64:67], v[116:119]
    s_waitcnt lgkmcnt(8)
    ds_read_b64_tr_b16 a[196:197], v21 offset:40960
    ds_read_b64_tr_b16 a[198:199], v21 offset:45056
    v_mfma_f32_16x16x32_bf16 v[124:127], a[212:215], a[64:67], v[124:127]
    s_waitcnt lgkmcnt(8)
    ds_read_b64_tr_b16 a[200:201], v22 offset:40960
    ds_read_b64_tr_b16 a[202:203], v22 offset:45056
    v_mfma_f32_16x16x32_bf16 v[132:135], a[216:219], a[64:67], v[132:135]
    s_waitcnt lgkmcnt(8)
    ds_read_b64_tr_b16 a[204:205], v23 offset:40960
    ds_read_b64_tr_b16 a[206:207], v23 offset:45056
    v_mfma_f32_16x16x32_bf16 v[140:143], a[220:223], a[64:67], v[140:143]
    s_waitcnt lgkmcnt(6)
    ds_read_b64_tr_b16 a[208:209], v24 offset:40960
    ds_read_b64_tr_b16 a[210:211], v24 offset:45056
    v_mfma_f32_16x16x32_bf16 v[84:87], a[192:195], a[72:75], v[84:87]
    s_waitcnt lgkmcnt(6)
    ds_read_b64_tr_b16 a[212:213], v25 offset:40960
    ds_read_b64_tr_b16 a[214:215], v25 offset:45056
    v_mfma_f32_16x16x32_bf16 v[92:95], a[196:199], a[72:75], v[92:95]
    s_waitcnt lgkmcnt(6)
    ds_read_b64_tr_b16 a[216:217], v26 offset:40960
    ds_read_b64_tr_b16 a[218:219], v26 offset:45056
    v_mfma_f32_16x16x32_bf16 v[100:103], a[200:203], a[72:75], v[100:103]
    s_waitcnt lgkmcnt(6)
    ds_read_b64_tr_b16 a[220:221], v27 offset:40960
    ds_read_b64_tr_b16 a[222:223], v27 offset:45056
    v_mfma_f32_16x16x32_bf16 v[108:111], a[204:207], a[72:75], v[108:111]
    s_waitcnt lgkmcnt(6)
    s_waitcnt vmcnt(16)
    s_barrier
    s_and_b32 s43, s48, 7
    s_lshl2_add_u32 s43, s43, s50
    s_lshl2_add_u32 s43, s43, s36
    s_lshl_b32 s43, s43, 13
    s_lshl_b32 s62, s51, 20
    s_add_u32 s62, s62, 4096
    s_add_u32 s43, s43, s62
    v_lshlrev_b32 v6, 2, v16
    buffer_load_dword v7, v6, s[20:23], s43 offen
    ds_read_b64_tr_b16 a[192:193], v28 offset:0
    ds_read_b64_tr_b16 a[194:195], v28 offset:4096
    s_add_u32 s42, s52, 3145728
    s_and_b32 s42, s42, 0x3fffff
    s_add_u32 m0, s37, 0
    s_add_u32 s42, s42, s40
    v_mfma_f32_16x16x32_bf16 v[116:119], a[208:211], a[72:75], v[116:119]
    s_waitcnt lgkmcnt(6)
    ds_read_b64_tr_b16 a[196:197], v29 offset:0
    ds_read_b64_tr_b16 a[198:199], v29 offset:4096
    buffer_load_dwordx4 v62, s[16:19], s42 offen offset:0  lds
    v_mfma_f32_16x16x32_bf16 v[124:127], a[212:215], a[72:75], v[124:127]
    s_waitcnt lgkmcnt(6)
    ds_read_b64_tr_b16 a[200:201], v30 offset:0
    ds_read_b64_tr_b16 a[202:203], v30 offset:4096
    buffer_load_dwordx4 v63, s[16:19], s42 offen offset:1024  lds
    v_mfma_f32_16x16x32_bf16 v[132:135], a[216:219], a[72:75], v[132:135]
    s_waitcnt lgkmcnt(6)
    ds_read_b64_tr_b16 a[204:205], v31 offset:0
    ds_read_b64_tr_b16 a[206:207], v31 offset:4096
    buffer_load_dwordx4 v64, s[16:19], s42 offen offset:2048  lds
    v_mfma_f32_16x16x32_bf16 v[140:143], a[220:223], a[72:75], v[140:143]
    s_waitcnt lgkmcnt(6)
    ds_read_b64_tr_b16 a[208:209], v32 offset:0
    ds_read_b64_tr_b16 a[210:211], v32 offset:4096
    buffer_load_dwordx4 v65, s[16:19], s42 offen offset:3072  lds
    v_mfma_f32_16x16x32_bf16 v[180:183], a[192:195], a[48:51], v[180:183]
    s_waitcnt lgkmcnt(6)
    ds_read_b64_tr_b16 a[212:213], v33 offset:0
    ds_read_b64_tr_b16 a[214:215], v33 offset:4096
    s_add_u32 m0, s37, 16384
    s_add_u32 s42, s39, 0
    buffer_load_dwordx4 v60, s[12:15], s42 offen offset:0 nt lds
    v_mfma_f32_16x16x32_bf16 v[188:191], a[196:199], a[48:51], v[188:191]
    s_waitcnt lgkmcnt(6)
    ds_read_b64_tr_b16 a[216:217], v34 offset:0
    ds_read_b64_tr_b16 a[218:219], v34 offset:4096
    buffer_load_dwordx4 v61, s[12:15], s42 offen offset:1024 nt lds
    v_mfma_f32_16x16x32_bf16 v[196:199], a[200:203], a[48:51], v[196:199]
    s_waitcnt lgkmcnt(6)
    ds_read_b64_tr_b16 a[220:221], v35 offset:0
    ds_read_b64_tr_b16 a[222:223], v35 offset:4096
    buffer_load_dwordx4 v60, s[12:15], s42 offen offset:2048 nt lds
    v_mfma_f32_16x16x32_bf16 v[204:207], a[204:207], a[48:51], v[204:207]
    s_waitcnt lgkmcnt(6)
    ds_read_b64_tr_b16 a[192:193], v28 offset:8192
    ds_read_b64_tr_b16 a[194:195], v28 offset:12288
    buffer_load_dwordx4 v61, s[12:15], s42 offen offset:3072 nt lds
    v_mfma_f32_16x16x32_bf16 v[212:215], a[208:211], a[48:51], v[212:215]
    s_waitcnt lgkmcnt(6)
    ds_read_b64_tr_b16 a[196:197], v29 offset:8192
    ds_read_b64_tr_b16 a[198:199], v29 offset:12288
    v_mfma_f32_16x16x32_bf16 v[220:223], a[212:215], a[48:51], v[220:223]
    s_waitcnt lgkmcnt(6)
    ds_read_b64_tr_b16 a[200:201], v30 offset:8192
    ds_read_b64_tr_b16 a[202:203], v30 offset:12288
    v_mfma_f32_16x16x32_bf16 v[228:231], a[216:219], a[48:51], v[228:231]
    s_waitcnt lgkmcnt(6)
    ds_read_b64_tr_b16 a[204:205], v31 offset:8192
    ds_read_b64_tr_b16 a[206:207], v31 offset:12288
    v_mfma_f32_16x16x32_bf16 v[236:239], a[220:223], a[48:51], v[236:239]
    s_waitcnt lgkmcnt(6)
    ds_read_b64_tr_b16 a[208:209], v32 offset:8192
    ds_read_b64_tr_b16 a[210:211], v32 offset:12288
    v_mfma_f32_16x16x32_bf16 v[180:183], a[192:195], a[56:59], v[180:183]
    s_waitcnt lgkmcnt(6)
    ds_read_b64_tr_b16 a[212:213], v33 offset:8192
    ds_read_b64_tr_b16 a[214:215], v33 offset:12288
    v_mfma_f32_16x16x32_bf16 v[188:191], a[196:199], a[56:59], v[188:191]
    s_waitcnt lgkmcnt(6)
    ds_read_b64_tr_b16 a[216:217], v34 offset:8192
    ds_read_b64_tr_b16 a[218:219], v34 offset:12288
    v_mfma_f32_16x16x32_bf16 v[196:199], a[200:203], a[56:59], v[196:199]
    s_waitcnt lgkmcnt(6)
    ds_read_b64_tr_b16 a[220:221], v35 offset:8192
    ds_read_b64_tr_b16 a[222:223], v35 offset:12288
    v_mfma_f32_16x16x32_bf16 v[204:207], a[204:207], a[56:59], v[204:207]
    s_waitcnt lgkmcnt(6)
    s_waitcnt vmcnt(19)
    s_barrier
    ds_read_b64 a[80:81], v152 offset:16384
    ds_read_b64 a[82:83], v153 offset:16384
    ds_read_b64_tr_b16 a[192:193], v28 offset:32768
    ds_read_b64_tr_b16 a[194:195], v28 offset:36864
    s_add_u32 s42, s52, 2621696
    s_and_b32 s42, s42, 0x3fffff
    v_mfma_f32_16x16x32_bf16 v[212:215], a[208:211], a[56:59], v[212:215]
    s_waitcnt lgkmcnt(8)
    ds_read_b64_tr_b16 a[196:197], v29 offset:32768
    ds_read_b64_tr_b16 a[198:199], v29 offset:36864
    s_add_u32 m0, s37, 32768
    s_add_u32 s42, s42, s40
    buffer_load_dwordx4 v62, s[16:19], s42 offen offset:0  lds
    v_mfma_f32_16x16x32_bf16 v[220:223], a[212:215], a[56:59], v[220:223]
    s_waitcnt lgkmcnt(8)
    ds_read_b64_tr_b16 a[200:201], v30 offset:32768
    ds_read_b64_tr_b16 a[202:203], v30 offset:36864
    buffer_load_dwordx4 v63, s[16:19], s42 offen offset:1024  lds
    v_mfma_f32_16x16x32_bf16 v[228:231], a[216:219], a[56:59], v[228:231]
    s_waitcnt lgkmcnt(8)
    ds_read_b64_tr_b16 a[204:205], v31 offset:32768
    ds_read_b64_tr_b16 a[206:207], v31 offset:36864
    buffer_load_dwordx4 v64, s[16:19], s42 offen offset:2048  lds
    v_mfma_f32_16x16x32_bf16 v[236:239], a[220:223], a[56:59], v[236:239]
    s_waitcnt lgkmcnt(6)
    ds_read_b64_tr_b16 a[208:209], v32 offset:32768
    ds_read_b64_tr_b16 a[210:211], v32 offset:36864
    buffer_load_dwordx4 v65, s[16:19], s42 offen offset:3072  lds
    v_mfma_f32_16x16x32_bf16 v[84:87], a[192:195], a[80:83], v[84:87]
    s_waitcnt lgkmcnt(6)
    ds_read_b64_tr_b16 a[212:213], v33 offset:32768
    ds_read_b64_tr_b16 a[214:215], v33 offset:36864
    v_mfma_f32_16x16x32_bf16 v[92:95], a[196:199], a[80:83], v[92:95]
    s_waitcnt lgkmcnt(6)
    ds_read_b64_tr_b16 a[216:217], v34 offset:32768
    ds_read_b64_tr_b16 a[218:219], v34 offset:36864
    v_mfma_f32_16x16x32_bf16 v[100:103], a[200:203], a[80:83], v[100:103]
    s_waitcnt lgkmcnt(6)
    ds_read_b64_tr_b16 a[220:221], v35 offset:32768
    ds_read_b64_tr_b16 a[222:223], v35 offset:36864
    v_mfma_f32_16x16x32_bf16 v[108:111], a[204:207], a[80:83], v[108:111]
    s_waitcnt lgkmcnt(6)
    ds_read_b64 a[88:89], v154 offset:16384
    ds_read_b64 a[90:91], v155 offset:16384
    ds_read_b64_tr_b16 a[192:193], v28 offset:40960
    ds_read_b64_tr_b16 a[194:195], v28 offset:45056
    v_mfma_f32_16x16x32_bf16 v[116:119], a[208:211], a[80:83], v[116:119]
    s_waitcnt lgkmcnt(8)
    ds_read_b64_tr_b16 a[196:197], v29 offset:40960
    ds_read_b64_tr_b16 a[198:199], v29 offset:45056
    v_mfma_f32_16x16x32_bf16 v[124:127], a[212:215], a[80:83], v[124:127]
    s_waitcnt lgkmcnt(8)
    ds_read_b64_tr_b16 a[200:201], v30 offset:40960
    ds_read_b64_tr_b16 a[202:203], v30 offset:45056
    v_mfma_f32_16x16x32_bf16 v[132:135], a[216:219], a[80:83], v[132:135]
    s_waitcnt lgkmcnt(8)
    ds_read_b64_tr_b16 a[204:205], v31 offset:40960
    ds_read_b64_tr_b16 a[206:207], v31 offset:45056
    v_mfma_f32_16x16x32_bf16 v[140:143], a[220:223], a[80:83], v[140:143]
    s_waitcnt lgkmcnt(6)
    ds_read_b64_tr_b16 a[208:209], v32 offset:40960
    ds_read_b64_tr_b16 a[210:211], v32 offset:45056
    v_mfma_f32_16x16x32_bf16 v[84:87], a[192:195], a[88:91], v[84:87]
    s_waitcnt lgkmcnt(6)
    ds_read_b64_tr_b16 a[212:213], v33 offset:40960
    ds_read_b64_tr_b16 a[214:215], v33 offset:45056
    v_mfma_f32_16x16x32_bf16 v[92:95], a[196:199], a[88:91], v[92:95]
    s_waitcnt lgkmcnt(6)
    ds_read_b64_tr_b16 a[216:217], v34 offset:40960
    ds_read_b64_tr_b16 a[218:219], v34 offset:45056
    v_mfma_f32_16x16x32_bf16 v[100:103], a[200:203], a[88:91], v[100:103]
    s_waitcnt lgkmcnt(6)
    ds_read_b64_tr_b16 a[220:221], v35 offset:40960
    ds_read_b64_tr_b16 a[222:223], v35 offset:45056
    v_mfma_f32_16x16x32_bf16 v[108:111], a[204:207], a[88:91], v[108:111]
    s_waitcnt lgkmcnt(6)
    s_waitcnt vmcnt(15)
    s_barrier
    global_load_dword v7, v67, s[88:89]
    ds_read_b64_tr_b16 a[192:193], v36 offset:0
    ds_read_b64_tr_b16 a[194:195], v36 offset:4096
    s_add_u32 s42, s41, 896
    s_and_b32 s42, s42, 0x3ff
    s_add_u32 m0, s37, 65536
    s_add_u32 s42, s42, s38
    v_mfma_f32_16x16x32_bf16 v[116:119], a[208:211], a[88:91], v[116:119]
    s_waitcnt lgkmcnt(6)
    ds_read_b64_tr_b16 a[196:197], v37 offset:0
    ds_read_b64_tr_b16 a[198:199], v37 offset:4096
    buffer_load_dwordx4 v160, s[4:7], s42 offen offset:0  lds
    v_mfma_f32_16x16x32_bf16 v[124:127], a[212:215], a[88:91], v[124:127]
    s_waitcnt lgkmcnt(6)
    ds_read_b64_tr_b16 a[200:201], v38 offset:0
    ds_read_b64_tr_b16 a[202:203], v38 offset:4096
    buffer_load_dwordx4 v161, s[4:7], s42 offen offset:1024  lds
    v_mfma_f32_16x16x32_bf16 v[132:135], a[216:219], a[88:91], v[132:135]
    s_waitcnt lgkmcnt(6)
    ds_read_b64_tr_b16 a[204:205], v39 offset:0
    ds_read_b64_tr_b16 a[206:207], v39 offset:4096
    s_add_u32 m0, s37, 81920
    s_add_u32 s42, s39, 32768
    buffer_load_dwordx4 v56, s[8:11], s42 offen offset:0 nt lds
    v_mfma_f32_16x16x32_bf16 v[140:143], a[220:223], a[88:91], v[140:143]
    s_waitcnt lgkmcnt(6)
    ds_read_b64_tr_b16 a[208:209], v40 offset:0
    ds_read_b64_tr_b16 a[210:211], v40 offset:4096
    buffer_load_dwordx4 v57, s[8:11], s42 offen offset:1024 nt lds
    v_mfma_f32_16x16x32_bf16 v[180:183], a[192:195], a[64:67], v[180:183]
    s_waitcnt lgkmcnt(6)
    ds_read_b64_tr_b16 a[212:213], v41 offset:0
    ds_read_b64_tr_b16 a[214:215], v41 offset:4096
    buffer_load_dwordx4 v58, s[8:11], s42 offen offset:2048 nt lds
    v_mfma_f32_16x16x32_bf16 v[188:191], a[196:199], a[64:67], v[188:191]
    s_waitcnt lgkmcnt(6)
    ds_read_b64_tr_b16 a[216:217], v42 offset:0
    ds_read_b64_tr_b16 a[218:219], v42 offset:4096
    buffer_load_dwordx4 v59, s[8:11], s42 offen offset:3072 nt lds
    v_mfma_f32_16x16x32_bf16 v[196:199], a[200:203], a[64:67], v[196:199]
    s_waitcnt lgkmcnt(6)
    ds_read_b64_tr_b16 a[220:221], v43 offset:0
    ds_read_b64_tr_b16 a[222:223], v43 offset:4096
    v_mfma_f32_16x16x32_bf16 v[204:207], a[204:207], a[64:67], v[204:207]
    s_waitcnt lgkmcnt(6)
    ds_read_b64_tr_b16 a[192:193], v36 offset:8192
    ds_read_b64_tr_b16 a[194:195], v36 offset:12288
    v_mfma_f32_16x16x32_bf16 v[212:215], a[208:211], a[64:67], v[212:215]
    s_waitcnt lgkmcnt(6)
    ds_read_b64_tr_b16 a[196:197], v37 offset:8192
    ds_read_b64_tr_b16 a[198:199], v37 offset:12288
    v_mfma_f32_16x16x32_bf16 v[220:223], a[212:215], a[64:67], v[220:223]
    s_waitcnt lgkmcnt(6)
    ds_read_b64_tr_b16 a[200:201], v38 offset:8192
    ds_read_b64_tr_b16 a[202:203], v38 offset:12288
    v_mfma_f32_16x16x32_bf16 v[228:231], a[216:219], a[64:67], v[228:231]
    s_waitcnt lgkmcnt(6)
    ds_read_b64_tr_b16 a[204:205], v39 offset:8192
    ds_read_b64_tr_b16 a[206:207], v39 offset:12288
    v_mfma_f32_16x16x32_bf16 v[236:239], a[220:223], a[64:67], v[236:239]
    s_waitcnt lgkmcnt(6)
    ds_read_b64_tr_b16 a[208:209], v40 offset:8192
    ds_read_b64_tr_b16 a[210:211], v40 offset:12288
    v_mfma_f32_16x16x32_bf16 v[180:183], a[192:195], a[72:75], v[180:183]
    s_waitcnt lgkmcnt(6)
    ds_read_b64_tr_b16 a[212:213], v41 offset:8192
    ds_read_b64_tr_b16 a[214:215], v41 offset:12288
    v_mfma_f32_16x16x32_bf16 v[188:191], a[196:199], a[72:75], v[188:191]
    s_waitcnt lgkmcnt(6)
    ds_read_b64_tr_b16 a[216:217], v42 offset:8192
    ds_read_b64_tr_b16 a[218:219], v42 offset:12288
    v_mfma_f32_16x16x32_bf16 v[196:199], a[200:203], a[72:75], v[196:199]
    s_waitcnt lgkmcnt(6)
    ds_read_b64_tr_b16 a[220:221], v43 offset:8192
    ds_read_b64_tr_b16 a[222:223], v43 offset:12288
    v_mfma_f32_16x16x32_bf16 v[204:207], a[204:207], a[72:75], v[204:207]
    s_waitcnt lgkmcnt(6)
    s_waitcnt vmcnt(15)
    s_barrier
    ds_read_b64 a[96:97], v156 offset:16384
    ds_read_b64 a[98:99], v157 offset:16384
    ds_read_b64_tr_b16 a[192:193], v20 offset:0
    ds_read_b64_tr_b16 a[194:195], v20 offset:4096
    s_add_u32 s42, s52, 3670016
    s_and_b32 s42, s42, 0x3fffff
    v_mfma_f32_16x16x32_bf16 v[212:215], a[208:211], a[72:75], v[212:215]
    s_waitcnt lgkmcnt(8)
    ds_read_b64_tr_b16 a[196:197], v21 offset:0
    ds_read_b64_tr_b16 a[198:199], v21 offset:4096
    s_add_u32 m0, s37, 98304
    s_add_u32 s42, s42, s40
    buffer_load_dwordx4 v62, s[16:19], s42 offen offset:0  lds
    v_mfma_f32_16x16x32_bf16 v[220:223], a[212:215], a[72:75], v[220:223]
    s_waitcnt lgkmcnt(8)
    ds_read_b64_tr_b16 a[200:201], v22 offset:0
    ds_read_b64_tr_b16 a[202:203], v22 offset:4096
    buffer_load_dwordx4 v63, s[16:19], s42 offen offset:1024  lds
    v_mfma_f32_16x16x32_bf16 v[228:231], a[216:219], a[72:75], v[228:231]
    s_waitcnt lgkmcnt(8)
    ds_read_b64_tr_b16 a[204:205], v23 offset:0
    ds_read_b64_tr_b16 a[206:207], v23 offset:4096
    buffer_load_dwordx4 v64, s[16:19], s42 offen offset:2048  lds
    v_mfma_f32_16x16x32_bf16 v[236:239], a[220:223], a[72:75], v[236:239]
    s_waitcnt lgkmcnt(6)
    ds_read_b64_tr_b16 a[208:209], v24 offset:0
    ds_read_b64_tr_b16 a[210:211], v24 offset:4096
    buffer_load_dwordx4 v65, s[16:19], s42 offen offset:3072  lds
    v_mfma_f32_16x16x32_bf16 v[84:87], a[192:195], a[96:99], v[84:87]
    s_waitcnt lgkmcnt(6)
    ds_read_b64_tr_b16 a[212:213], v25 offset:0
    ds_read_b64_tr_b16 a[214:215], v25 offset:4096
    v_mfma_f32_16x16x32_bf16 v[92:95], a[196:199], a[96:99], v[92:95]
    s_waitcnt lgkmcnt(6)
    ds_read_b64_tr_b16 a[216:217], v26 offset:0
    ds_read_b64_tr_b16 a[218:219], v26 offset:4096
    v_mfma_f32_16x16x32_bf16 v[100:103], a[200:203], a[96:99], v[100:103]
    s_waitcnt lgkmcnt(6)
    ds_read_b64_tr_b16 a[220:221], v27 offset:0
    ds_read_b64_tr_b16 a[222:223], v27 offset:4096
    v_mfma_f32_16x16x32_bf16 v[108:111], a[204:207], a[96:99], v[108:111]
    s_waitcnt lgkmcnt(6)
    ds_read_b64 a[104:105], v158 offset:16384
    ds_read_b64 a[106:107], v159 offset:16384
    ds_read_b64_tr_b16 a[192:193], v20 offset:8192
    ds_read_b64_tr_b16 a[194:195], v20 offset:12288
    v_mfma_f32_16x16x32_bf16 v[116:119], a[208:211], a[96:99], v[116:119]
    s_waitcnt lgkmcnt(8)
    ds_read_b64_tr_b16 a[196:197], v21 offset:8192
    ds_read_b64_tr_b16 a[198:199], v21 offset:12288
    v_mfma_f32_16x16x32_bf16 v[124:127], a[212:215], a[96:99], v[124:127]
    s_waitcnt lgkmcnt(8)
    ds_read_b64_tr_b16 a[200:201], v22 offset:8192
    ds_read_b64_tr_b16 a[202:203], v22 offset:12288
    v_mfma_f32_16x16x32_bf16 v[132:135], a[216:219], a[96:99], v[132:135]
    s_waitcnt lgkmcnt(8)
    ds_read_b64_tr_b16 a[204:205], v23 offset:8192
    ds_read_b64_tr_b16 a[206:207], v23 offset:12288
    v_mfma_f32_16x16x32_bf16 v[140:143], a[220:223], a[96:99], v[140:143]
    s_waitcnt lgkmcnt(6)
    ds_read_b64_tr_b16 a[208:209], v24 offset:8192
    ds_read_b64_tr_b16 a[210:211], v24 offset:12288
    v_mfma_f32_16x16x32_bf16 v[84:87], a[192:195], a[104:107], v[84:87]
    s_waitcnt lgkmcnt(6)
    ds_read_b64_tr_b16 a[212:213], v25 offset:8192
    ds_read_b64_tr_b16 a[214:215], v25 offset:12288
    v_mfma_f32_16x16x32_bf16 v[92:95], a[196:199], a[104:107], v[92:95]
    s_waitcnt lgkmcnt(6)
    ds_read_b64_tr_b16 a[216:217], v26 offset:8192
    ds_read_b64_tr_b16 a[218:219], v26 offset:12288
    v_mfma_f32_16x16x32_bf16 v[100:103], a[200:203], a[104:107], v[100:103]
    s_waitcnt lgkmcnt(6)
    ds_read_b64_tr_b16 a[220:221], v27 offset:8192
    ds_read_b64_tr_b16 a[222:223], v27 offset:12288
    v_mfma_f32_16x16x32_bf16 v[108:111], a[204:207], a[104:107], v[108:111]
    s_waitcnt lgkmcnt(6)
    s_waitcnt vmcnt(11)
    s_barrier
    ds_read_b64_tr_b16 a[192:193], v20 offset:32768
    ds_read_b64_tr_b16 a[194:195], v20 offset:36864
    s_add_u32 s42, s52, 3145984
    s_and_b32 s42, s42, 0x3fffff
    s_add_u32 m0, s37, 131072
    s_add_u32 s42, s42, s40
    v_mfma_f32_16x16x32_bf16 v[116:119], a[208:211], a[104:107], v[116:119]
    s_waitcnt lgkmcnt(6)
    ds_read_b64_tr_b16 a[196:197], v21 offset:32768
    ds_read_b64_tr_b16 a[198:199], v21 offset:36864
    buffer_load_dwordx4 v62, s[16:19], s42 offen offset:0  lds
    v_mfma_f32_16x16x32_bf16 v[124:127], a[212:215], a[104:107], v[124:127]
    s_waitcnt lgkmcnt(6)
    ds_read_b64_tr_b16 a[200:201], v22 offset:32768
    ds_read_b64_tr_b16 a[202:203], v22 offset:36864
    buffer_load_dwordx4 v63, s[16:19], s42 offen offset:1024  lds
    v_mfma_f32_16x16x32_bf16 v[132:135], a[216:219], a[104:107], v[132:135]
    s_waitcnt lgkmcnt(6)
    ds_read_b64_tr_b16 a[204:205], v23 offset:32768
    ds_read_b64_tr_b16 a[206:207], v23 offset:36864
    buffer_load_dwordx4 v64, s[16:19], s42 offen offset:2048  lds
    v_mfma_f32_16x16x32_bf16 v[140:143], a[220:223], a[104:107], v[140:143]
    s_waitcnt lgkmcnt(6)
    ds_read_b64_tr_b16 a[208:209], v24 offset:32768
    ds_read_b64_tr_b16 a[210:211], v24 offset:36864
    buffer_load_dwordx4 v65, s[16:19], s42 offen offset:3072  lds
    v_mfma_f32_16x16x32_bf16 v[180:183], a[192:195], a[80:83], v[180:183]
    s_waitcnt lgkmcnt(6)
    ds_read_b64_tr_b16 a[212:213], v25 offset:32768
    ds_read_b64_tr_b16 a[214:215], v25 offset:36864
    s_add_u32 s42, s52, 3670272
    s_and_b32 s42, s42, 0x3fffff
    s_add_u32 m0, s37, 147456
    s_add_u32 s42, s42, s40
    v_mfma_f32_16x16x32_bf16 v[188:191], a[196:199], a[80:83], v[188:191]
    s_waitcnt lgkmcnt(6)
    ds_read_b64_tr_b16 a[216:217], v26 offset:32768
    ds_read_b64_tr_b16 a[218:219], v26 offset:36864
    buffer_load_dwordx4 v62, s[16:19], s42 offen offset:0  lds
    v_mfma_f32_16x16x32_bf16 v[196:199], a[200:203], a[80:83], v[196:199]
    s_waitcnt lgkmcnt(6)
    ds_read_b64_tr_b16 a[220:221], v27 offset:32768
    ds_read_b64_tr_b16 a[222:223], v27 offset:36864
    buffer_load_dwordx4 v63, s[16:19], s42 offen offset:1024  lds
    v_mfma_f32_16x16x32_bf16 v[204:207], a[204:207], a[80:83], v[204:207]
    s_waitcnt lgkmcnt(6)
    ds_read_b64_tr_b16 a[192:193], v20 offset:40960
    ds_read_b64_tr_b16 a[194:195], v20 offset:45056
    buffer_load_dwordx4 v64, s[16:19], s42 offen offset:2048  lds
    v_mfma_f32_16x16x32_bf16 v[212:215], a[208:211], a[80:83], v[212:215]
    s_waitcnt lgkmcnt(6)
    ds_read_b64_tr_b16 a[196:197], v21 offset:40960
    ds_read_b64_tr_b16 a[198:199], v21 offset:45056
    buffer_load_dwordx4 v65, s[16:19], s42 offen offset:3072  lds
    v_mfma_f32_16x16x32_bf16 v[220:223], a[212:215], a[80:83], v[220:223]
    s_waitcnt lgkmcnt(6)
    ds_read_b64_tr_b16 a[200:201], v22 offset:40960
    ds_read_b64_tr_b16 a[202:203], v22 offset:45056
    v_mfma_f32_16x16x32_bf16 v[228:231], a[216:219], a[80:83], v[228:231]
    s_waitcnt lgkmcnt(6)
    ds_read_b64_tr_b16 a[204:205], v23 offset:40960
    ds_read_b64_tr_b16 a[206:207], v23 offset:45056
    v_mfma_f32_16x16x32_bf16 v[236:239], a[220:223], a[80:83], v[236:239]
    s_waitcnt lgkmcnt(6)
    ds_read_b64_tr_b16 a[208:209], v24 offset:40960
    ds_read_b64_tr_b16 a[210:211], v24 offset:45056
    v_mfma_f32_16x16x32_bf16 v[180:183], a[192:195], a[88:91], v[180:183]
    s_waitcnt lgkmcnt(6)
    ds_read_b64_tr_b16 a[212:213], v25 offset:40960
    ds_read_b64_tr_b16 a[214:215], v25 offset:45056
    v_mfma_f32_16x16x32_bf16 v[188:191], a[196:199], a[88:91], v[188:191]
    s_waitcnt lgkmcnt(6)
    ds_read_b64_tr_b16 a[216:217], v26 offset:40960
    ds_read_b64_tr_b16 a[218:219], v26 offset:45056
    v_mfma_f32_16x16x32_bf16 v[196:199], a[200:203], a[88:91], v[196:199]
    s_waitcnt lgkmcnt(6)
    ds_read_b64_tr_b16 a[220:221], v27 offset:40960
    ds_read_b64_tr_b16 a[222:223], v27 offset:45056
    v_mfma_f32_16x16x32_bf16 v[204:207], a[204:207], a[88:91], v[204:207]
    s_waitcnt lgkmcnt(6)
    s_waitcnt vmcnt(8)
    s_barrier
    ds_read_b64 a[112:113], v152 offset:0
    ds_read_b64 a[114:115], v153 offset:0
    ds_read_b64_tr_b16 a[192:193], v28 offset:32768
    ds_read_b64_tr_b16 a[194:195], v28 offset:36864
    s_add_u32 m0, s37, 0
    s_add_u32 s42, s39, 16384
    v_mfma_f32_16x16x32_bf16 v[212:215], a[208:211], a[88:91], v[212:215]
    s_waitcnt lgkmcnt(8)
    ds_read_b64_tr_b16 a[196:197], v29 offset:32768
    ds_read_b64_tr_b16 a[198:199], v29 offset:36864
    buffer_load_dwordx4 v60, s[12:15], s42 offen offset:0 nt lds
    v_mfma_f32_16x16x32_bf16 v[220:223], a[212:215], a[88:91], v[220:223]
    s_waitcnt lgkmcnt(8)
    ds_read_b64_tr_b16 a[200:201], v30 offset:32768
    ds_read_b64_tr_b16 a[202:203], v30 offset:36864
    buffer_load_dwordx4 v61, s[12:15], s42 offen offset:1024 nt lds
    v_mfma_f32_16x16x32_bf16 v[228:231], a[216:219], a[88:91], v[228:231]
    s_waitcnt lgkmcnt(8)
    ds_read_b64_tr_b16 a[204:205], v31 offset:32768
    ds_read_b64_tr_b16 a[206:207], v31 offset:36864
    buffer_load_dwordx4 v60, s[12:15], s42 offen offset:2048 nt lds
    v_mfma_f32_16x16x32_bf16 v[236:239], a[220:223], a[88:91], v[236:239]
    s_waitcnt lgkmcnt(6)
    ds_read_b64_tr_b16 a[208:209], v32 offset:32768
    ds_read_b64_tr_b16 a[210:211], v32 offset:36864
    buffer_load_dwordx4 v61, s[12:15], s42 offen offset:3072 nt lds
    v_mfma_f32_16x16x32_bf16 v[84:87], a[192:195], a[112:115], v[84:87]
    s_waitcnt lgkmcnt(6)
    ds_read_b64_tr_b16 a[212:213], v33 offset:32768
    ds_read_b64_tr_b16 a[214:215], v33 offset:36864
    v_mfma_f32_16x16x32_bf16 v[92:95], a[196:199], a[112:115], v[92:95]
    s_waitcnt lgkmcnt(6)
    ds_read_b64_tr_b16 a[216:217], v34 offset:32768
    ds_read_b64_tr_b16 a[218:219], v34 offset:36864
    v_mfma_f32_16x16x32_bf16 v[100:103], a[200:203], a[112:115], v[100:103]
    s_waitcnt lgkmcnt(6)
    ds_read_b64_tr_b16 a[220:221], v35 offset:32768
    ds_read_b64_tr_b16 a[222:223], v35 offset:36864
    v_mfma_f32_16x16x32_bf16 v[108:111], a[204:207], a[112:115], v[108:111]
    s_waitcnt lgkmcnt(6)
    ds_read_b64 a[120:121], v154 offset:0
    ds_read_b64 a[122:123], v155 offset:0
    ds_read_b64_tr_b16 a[192:193], v28 offset:40960
    ds_read_b64_tr_b16 a[194:195], v28 offset:45056
    v_mfma_f32_16x16x32_bf16 v[116:119], a[208:211], a[112:115], v[116:119]
    s_waitcnt lgkmcnt(8)
    ds_read_b64_tr_b16 a[196:197], v29 offset:40960
    ds_read_b64_tr_b16 a[198:199], v29 offset:45056
    v_mfma_f32_16x16x32_bf16 v[124:127], a[212:215], a[112:115], v[124:127]
    s_waitcnt lgkmcnt(8)
    ds_read_b64_tr_b16 a[200:201], v30 offset:40960
    ds_read_b64_tr_b16 a[202:203], v30 offset:45056
    v_mfma_f32_16x16x32_bf16 v[132:135], a[216:219], a[112:115], v[132:135]
    s_waitcnt lgkmcnt(8)
    ds_read_b64_tr_b16 a[204:205], v31 offset:40960
    ds_read_b64_tr_b16 a[206:207], v31 offset:45056
    v_mfma_f32_16x16x32_bf16 v[140:143], a[220:223], a[112:115], v[140:143]
    s_waitcnt lgkmcnt(6)
    ds_read_b64_tr_b16 a[208:209], v32 offset:40960
    ds_read_b64_tr_b16 a[210:211], v32 offset:45056
    v_mfma_f32_16x16x32_bf16 v[84:87], a[192:195], a[120:123], v[84:87]
    s_waitcnt lgkmcnt(6)
    ds_read_b64_tr_b16 a[212:213], v33 offset:40960
    ds_read_b64_tr_b16 a[214:215], v33 offset:45056
    v_mfma_f32_16x16x32_bf16 v[92:95], a[196:199], a[120:123], v[92:95]
    s_waitcnt lgkmcnt(6)
    ds_read_b64_tr_b16 a[216:217], v34 offset:40960
    ds_read_b64_tr_b16 a[218:219], v34 offset:45056
    v_mfma_f32_16x16x32_bf16 v[100:103], a[200:203], a[120:123], v[100:103]
    s_waitcnt lgkmcnt(6)
    ds_read_b64_tr_b16 a[220:221], v35 offset:40960
    ds_read_b64_tr_b16 a[222:223], v35 offset:45056
    v_mfma_f32_16x16x32_bf16 v[108:111], a[204:207], a[120:123], v[108:111]
    s_waitcnt lgkmcnt(6)
    s_waitcnt vmcnt(8)
    s_barrier
    ds_read_b64_tr_b16 a[192:193], v36 offset:0
    ds_read_b64_tr_b16 a[194:195], v36 offset:4096
    s_add_u32 m0, s37, 32768
    s_add_u32 s42, s39, 49152
    buffer_load_dwordx4 v56, s[8:11], s42 offen offset:0 nt lds
    v_mfma_f32_16x16x32_bf16 v[116:119], a[208:211], a[120:123], v[116:119]
    s_waitcnt lgkmcnt(6)
    ds_read_b64_tr_b16 a[196:197], v37 offset:0
    ds_read_b64_tr_b16 a[198:199], v37 offset:4096
    buffer_load_dwordx4 v57, s[8:11], s42 offen offset:1024 nt lds
    v_mul_f32 v84, s46, v84
    v_mul_f32 v85, s46, v85
    v_mfma_f32_16x16x32_bf16 v[124:127], a[212:215], a[120:123], v[124:127]
    s_waitcnt lgkmcnt(6)
    ds_read_b64_tr_b16 a[200:201], v38 offset:0
    ds_read_b64_tr_b16 a[202:203], v38 offset:4096
    buffer_load_dwordx4 v58, s[8:11], s42 offen offset:2048 nt lds
    v_mul_f32 v86, s46, v86
    v_mul_f32 v87, s46, v87
    v_mfma_f32_16x16x32_bf16 v[132:135], a[216:219], a[120:123], v[132:135]
    s_waitcnt lgkmcnt(6)
    ds_read_b64_tr_b16 a[204:205], v39 offset:0
    ds_read_b64_tr_b16 a[206:207], v39 offset:4096
    buffer_load_dwordx4 v59, s[8:11], s42 offen offset:3072 nt lds
    v_mul_f32 v92, s46, v92
    v_mul_f32 v93, s46, v93
    v_mfma_f32_16x16x32_bf16 v[140:143], a[220:223], a[120:123], v[140:143]
    s_waitcnt lgkmcnt(6)
    ds_read_b64_tr_b16 a[208:209], v40 offset:0
    ds_read_b64_tr_b16 a[210:211], v40 offset:4096
    v_mul_f32 v94, s46, v94
    v_mul_f32 v95, s46, v95
    v_cvt_pk_bf16_f32 v148, v84, v85
    v_cvt_pk_bf16_f32 v149, v86, v87
    v_mfma_f32_16x16x32_bf16 v[180:183], a[192:195], a[96:99], v[180:183]
    s_waitcnt lgkmcnt(6)
    ds_read_b64_tr_b16 a[212:213], v41 offset:0
    ds_read_b64_tr_b16 a[214:215], v41 offset:4096
    v_cvt_pk_bf16_f32 v150, v92, v93
    v_cvt_pk_bf16_f32 v151, v94, v95
    s_nop 0
    v_permlane32_swap_b32 v148, v150
    v_permlane32_swap_b32 v149, v151
    v_mfma_f32_16x16x32_bf16 v[188:191], a[196:199], a[96:99], v[188:191]
    s_waitcnt lgkmcnt(6)
    ds_read_b64_tr_b16 a[216:217], v42 offset:0
    ds_read_b64_tr_b16 a[218:219], v42 offset:4096
    v_permlane16_swap_b32 v148, v150
    v_permlane16_swap_b32 v149, v151
    v_mul_f32 v100, s46, v100
    v_mul_f32 v101, s46, v101
    v_mfma_f32_16x16x32_bf16 v[196:199], a[200:203], a[96:99], v[196:199]
    s_waitcnt lgkmcnt(6)
    ds_read_b64_tr_b16 a[220:221], v43 offset:0
    ds_read_b64_tr_b16 a[222:223], v43 offset:4096
    v_mul_f32 v102, s46, v102
    v_mul_f32 v103, s46, v103
    v_mul_f32 v108, s46, v108
    v_mul_f32 v109, s46, v109
    v_mfma_f32_16x16x32_bf16 v[204:207], a[204:207], a[96:99], v[204:207]
    s_waitcnt lgkmcnt(6)
    ds_read_b64_tr_b16 a[192:193], v36 offset:8192
    ds_read_b64_tr_b16 a[194:195], v36 offset:12288
    v_mul_f32 v110, s46, v110
    v_mul_f32 v111, s46, v111
    v_cvt_pk_bf16_f32 v156, v100, v101
    v_cvt_pk_bf16_f32 v157, v102, v103
    v_mfma_f32_16x16x32_bf16 v[212:215], a[208:211], a[96:99], v[212:215]
    s_waitcnt lgkmcnt(6)
    ds_read_b64_tr_b16 a[196:197], v37 offset:8192
    ds_read_b64_tr_b16 a[198:199], v37 offset:12288
    v_cvt_pk_bf16_f32 v158, v108, v109
    v_cvt_pk_bf16_f32 v159, v110, v111
    s_nop 0
    v_permlane32_swap_b32 v156, v158
    v_permlane32_swap_b32 v157, v159
    v_mfma_f32_16x16x32_bf16 v[220:223], a[212:215], a[96:99], v[220:223]
    s_waitcnt lgkmcnt(6)
    ds_read_b64_tr_b16 a[200:201], v38 offset:8192
    ds_read_b64_tr_b16 a[202:203], v38 offset:12288
    v_permlane16_swap_b32 v156, v158
    v_permlane16_swap_b32 v157, v159
    v_mul_f32 v116, s46, v116
    v_mul_f32 v117, s46, v117
    v_mfma_f32_16x16x32_bf16 v[228:231], a[216:219], a[96:99], v[228:231]
    s_waitcnt lgkmcnt(6)
    ds_read_b64_tr_b16 a[204:205], v39 offset:8192
    ds_read_b64_tr_b16 a[206:207], v39 offset:12288
    v_mul_f32 v118, s46, v118
    v_mul_f32 v119, s46, v119
    v_mul_f32 v124, s46, v124
    v_mul_f32 v125, s46, v125
    v_mfma_f32_16x16x32_bf16 v[236:239], a[220:223], a[96:99], v[236:239]
    s_waitcnt lgkmcnt(6)
    ds_read_b64_tr_b16 a[208:209], v40 offset:8192
    ds_read_b64_tr_b16 a[210:211], v40 offset:12288
    v_mul_f32 v126, s46, v126
    v_mul_f32 v127, s46, v127
    v_cvt_pk_bf16_f32 v164, v116, v117
    v_cvt_pk_bf16_f32 v165, v118, v119
    v_mfma_f32_16x16x32_bf16 v[180:183], a[192:195], a[104:107], v[180:183]
    s_waitcnt lgkmcnt(6)
    ds_read_b64_tr_b16 a[212:213], v41 offset:8192
    ds_read_b64_tr_b16 a[214:215], v41 offset:12288
    v_cvt_pk_bf16_f32 v166, v124, v125
    v_cvt_pk_bf16_f32 v167, v126, v127
    s_nop 0
    v_permlane32_swap_b32 v164, v166
    v_permlane32_swap_b32 v165, v167
    v_mfma_f32_16x16x32_bf16 v[188:191], a[196:199], a[104:107], v[188:191]
    s_waitcnt lgkmcnt(6)
    ds_read_b64_tr_b16 a[216:217], v42 offset:8192
    ds_read_b64_tr_b16 a[218:219], v42 offset:12288
    v_permlane16_swap_b32 v164, v166
    v_permlane16_swap_b32 v165, v167
    v_mul_f32 v132, s46, v132
    v_mul_f32 v133, s46, v133
    v_mfma_f32_16x16x32_bf16 v[196:199], a[200:203], a[104:107], v[196:199]
    s_waitcnt lgkmcnt(6)
    ds_read_b64_tr_b16 a[220:221], v43 offset:8192
    ds_read_b64_tr_b16 a[222:223], v43 offset:12288
    v_mul_f32 v134, s46, v134
    v_mul_f32 v135, s46, v135
    v_mul_f32 v140, s46, v140
    v_mul_f32 v141, s46, v141
    v_mfma_f32_16x16x32_bf16 v[204:207], a[204:207], a[104:107], v[204:207]
    s_waitcnt lgkmcnt(6)
    s_barrier
    ds_read_b128 a[192:195], v44 offset:49152
    ds_read_b128 a[196:199], v45 offset:49152
    s_add_u32 m0, s37, 65536
    s_add_u32 s42, s39, 32768
    buffer_load_dwordx4 v60, s[12:15], s42 offen offset:0 nt lds
    v_mfma_f32_16x16x32_bf16 v[212:215], a[208:211], a[104:107], v[212:215]
    s_waitcnt lgkmcnt(6)
    buffer_load_dwordx4 v61, s[12:15], s42 offen offset:1024 nt lds
    v_mul_f32 v142, s46, v142
    v_mul_f32 v143, s46, v143
    v_cvt_pk_bf16_f32 v172, v132, v133
    v_cvt_pk_bf16_f32 v173, v134, v135
    v_mfma_f32_16x16x32_bf16 v[220:223], a[212:215], a[104:107], v[220:223]
    s_waitcnt lgkmcnt(4)
    ds_read_b128 a[200:203], v46 offset:49152
    ds_read_b128 a[204:207], v47 offset:49152
    buffer_load_dwordx4 v60, s[12:15], s42 offen offset:2048 nt lds
    v_cvt_pk_bf16_f32 v174, v140, v141
    v_cvt_pk_bf16_f32 v175, v142, v143
    v_mfma_f32_16x16x32_bf16 v[228:231], a[216:219], a[104:107], v[228:231]
    s_waitcnt lgkmcnt(4)
    buffer_load_dwordx4 v61, s[12:15], s42 offen offset:3072 nt lds
    v_permlane32_swap_b32 v172, v174
    v_permlane32_swap_b32 v173, v175
    s_nop 0
    v_permlane16_swap_b32 v172, v174
    v_permlane16_swap_b32 v173, v175
    v_mfma_f32_16x16x32_bf16 v[236:239], a[220:223], a[104:107], v[236:239]
    s_waitcnt lgkmcnt(3)
    ds_read_b128 a[208:211], v44 offset:53248
    ds_read_b128 a[212:215], v45 offset:53248
    v_mfma_f32_16x16x32_bf16 v[84:87], a[192:195], v[148:151], 0
    s_waitcnt lgkmcnt(4)
    v_mfma_f32_16x16x32_bf16 v[84:87], a[196:199], v[156:159], v[84:87]
    s_waitcnt lgkmcnt(3)
    ds_read_b128 a[216:219], v46 offset:53248
    ds_read_b128 a[220:223], v47 offset:53248
    v_mfma_f32_16x16x32_bf16 v[84:87], a[200:203], v[164:167], v[84:87]
    s_waitcnt lgkmcnt(4)
    v_mfma_f32_16x16x32_bf16 v[84:87], a[204:207], v[172:175], v[84:87]
    s_waitcnt lgkmcnt(3)
    ds_read_b128 a[192:195], v44 offset:57344
    ds_read_b128 a[196:199], v45 offset:57344
    v_mfma_f32_16x16x32_bf16 v[92:95], a[208:211], v[148:151], 0
    s_waitcnt lgkmcnt(4)
    v_mfma_f32_16x16x32_bf16 v[92:95], a[212:215], v[156:159], v[92:95]
    s_waitcnt lgkmcnt(3)
    ds_read_b128 a[200:203], v46 offset:57344
    ds_read_b128 a[204:207], v47 offset:57344
    v_mfma_f32_16x16x32_bf16 v[92:95], a[216:219], v[164:167], v[92:95]
    s_waitcnt lgkmcnt(4)
    v_mfma_f32_16x16x32_bf16 v[92:95], a[220:223], v[172:175], v[92:95]
    s_waitcnt lgkmcnt(3)
    ds_read_b128 a[208:211], v44 offset:61440
    ds_read_b128 a[212:215], v45 offset:61440
    v_mfma_f32_16x16x32_bf16 v[100:103], a[192:195], v[148:151], 0
    s_waitcnt lgkmcnt(4)
    v_mfma_f32_16x16x32_bf16 v[100:103], a[196:199], v[156:159], v[100:103]
    s_waitcnt lgkmcnt(3)
    ds_read_b128 a[216:219], v46 offset:61440
    ds_read_b128 a[220:223], v47 offset:61440
    v_mfma_f32_16x16x32_bf16 v[100:103], a[200:203], v[164:167], v[100:103]
    s_waitcnt lgkmcnt(4)
    v_mfma_f32_16x16x32_bf16 v[100:103], a[204:207], v[172:175], v[100:103]
    s_waitcnt lgkmcnt(3)
    s_waitcnt vmcnt(12)
    s_barrier
    ds_read_b64_tr_b16 a[192:193], v36 offset:16384
    ds_read_b64_tr_b16 a[194:195], v36 offset:20480
    s_add_u32 m0, s37, 98304
    s_add_u32 s42, s39, 65536
    buffer_load_dwordx4 v56, s[8:11], s42 offen offset:0 nt lds
    v_mfma_f32_16x16x32_bf16 v[108:111], a[208:211], v[148:151], 0
    s_waitcnt lgkmcnt(4)
    ds_read_b64_tr_b16 a[196:197], v37 offset:16384
    ds_read_b64_tr_b16 a[198:199], v37 offset:20480
    buffer_load_dwordx4 v57, s[8:11], s42 offen offset:1024 nt lds
    v_mfma_f32_16x16x32_bf16 v[108:111], a[212:215], v[156:159], v[108:111]
    s_waitcnt lgkmcnt(5)
    ds_read_b64_tr_b16 a[200:201], v38 offset:16384
    ds_read_b64_tr_b16 a[202:203], v38 offset:20480
    buffer_load_dwordx4 v58, s[8:11], s42 offen offset:2048 nt lds
    v_mfma_f32_16x16x32_bf16 v[108:111], a[216:219], v[164:167], v[108:111]
    s_waitcnt lgkmcnt(6)
    ds_read_b64_tr_b16 a[204:205], v39 offset:16384
    ds_read_b64_tr_b16 a[206:207], v39 offset:20480
    buffer_load_dwordx4 v59, s[8:11], s42 offen offset:3072 nt lds
    v_mfma_f32_16x16x32_bf16 v[108:111], a[220:223], v[172:175], v[108:111]
    s_waitcnt lgkmcnt(6)
    ds_read_b64_tr_b16 a[208:209], v40 offset:16384
    ds_read_b64_tr_b16 a[210:211], v40 offset:20480
    v_mfma_f32_16x16x32_bf16 v[180:183], a[192:195], a[112:115], v[180:183]
    s_waitcnt lgkmcnt(6)
    ds_read_b64_tr_b16 a[212:213], v41 offset:16384
    ds_read_b64_tr_b16 a[214:215], v41 offset:20480
    v_mfma_f32_16x16x32_bf16 v[188:191], a[196:199], a[112:115], v[188:191]
    s_waitcnt lgkmcnt(6)
    ds_read_b64_tr_b16 a[216:217], v42 offset:16384
    ds_read_b64_tr_b16 a[218:219], v42 offset:20480
    v_mfma_f32_16x16x32_bf16 v[196:199], a[200:203], a[112:115], v[196:199]
    s_waitcnt lgkmcnt(6)
    ds_read_b64_tr_b16 a[220:221], v43 offset:16384
    ds_read_b64_tr_b16 a[222:223], v43 offset:20480
    v_max3_f32 v1, v84, v85, v86
    v_max3_f32 v1, v1, v87, v92
    v_max3_f32 v1, v1, v93, v94
    v_max3_f32 v1, v1, v95, v100
    v_mfma_f32_16x16x32_bf16 v[204:207], a[204:207], a[112:115], v[204:207]
    s_waitcnt lgkmcnt(6)
    ds_read_b64_tr_b16 a[192:193], v36 offset:24576
    ds_read_b64_tr_b16 a[194:195], v36 offset:28672
    v_max3_f32 v1, v1, v101, v102
    v_max3_f32 v1, v1, v103, v108
    v_max3_f32 v1, v1, v109, v110
    v_max_f32 v1, v1, v111
    v_mfma_f32_16x16x32_bf16 v[212:215], a[208:211], a[112:115], v[212:215]
    s_waitcnt lgkmcnt(6)
    ds_read_b64_tr_b16 a[196:197], v37 offset:24576
    ds_read_b64_tr_b16 a[198:199], v37 offset:28672
    v_mov_b32 v2, v1
    s_nop 1
    v_permlane32_swap_b32 v1, v2
    v_max_f32 v1, v1, v2
    v_mov_b32 v2, v1
    v_mfma_f32_16x16x32_bf16 v[220:223], a[212:215], a[112:115], v[220:223]
    s_waitcnt lgkmcnt(6)
    ds_read_b64_tr_b16 a[200:201], v38 offset:24576
    ds_read_b64_tr_b16 a[202:203], v38 offset:28672
    v_permlane16_swap_b32 v1, v2
    v_max_f32 v1, v1, v2
    v_sub_f32 v76, 0, v1
    v_sub_f32 v77, 0, v1
    v_mfma_f32_16x16x32_bf16 v[228:231], a[216:219], a[112:115], v[228:231]
    s_waitcnt lgkmcnt(6)
    ds_read_b64_tr_b16 a[204:205], v39 offset:24576
    ds_read_b64_tr_b16 a[206:207], v39 offset:28672
    v_sub_f32 v78, 0, v1
    v_sub_f32 v79, 0, v1
    v_sub_f32 v84, v84, v1
    v_sub_f32 v85, v85, v1
    v_mfma_f32_16x16x32_bf16 v[236:239], a[220:223], a[112:115], v[236:239]
    s_waitcnt lgkmcnt(6)
    ds_read_b64_tr_b16 a[208:209], v40 offset:24576
    ds_read_b64_tr_b16 a[210:211], v40 offset:28672
    v_sub_f32 v86, v86, v1
    v_sub_f32 v87, v87, v1
    v_sub_f32 v92, v92, v1
    v_sub_f32 v93, v93, v1
    v_mfma_f32_16x16x32_bf16 v[180:183], a[192:195], a[120:123], v[180:183]
    s_waitcnt lgkmcnt(6)
    ds_read_b64_tr_b16 a[212:213], v41 offset:24576
    ds_read_b64_tr_b16 a[214:215], v41 offset:28672
    v_sub_f32 v94, v94, v1
    v_sub_f32 v95, v95, v1
    v_sub_f32 v100, v100, v1
    v_sub_f32 v101, v101, v1
    v_mfma_f32_16x16x32_bf16 v[188:191], a[196:199], a[120:123], v[188:191]
    s_waitcnt lgkmcnt(6)
    ds_read_b64_tr_b16 a[216:217], v42 offset:24576
    ds_read_b64_tr_b16 a[218:219], v42 offset:28672
    v_sub_f32 v102, v102, v1
    v_sub_f32 v103, v103, v1
    v_sub_f32 v108, v108, v1
    v_sub_f32 v109, v109, v1
    v_mfma_f32_16x16x32_bf16 v[196:199], a[200:203], a[120:123], v[196:199]
    s_waitcnt lgkmcnt(6)
    ds_read_b64_tr_b16 a[220:221], v43 offset:24576
    ds_read_b64_tr_b16 a[222:223], v43 offset:28672
    v_sub_f32 v110, v110, v1
    v_sub_f32 v111, v111, v1
    v_mfma_f32_16x16x32_bf16 v[204:207], a[204:207], a[120:123], v[204:207]
    s_waitcnt lgkmcnt(6)
    s_barrier
    ds_read_b128 a[192:195], v48 offset:49152
    ds_read_b128 a[196:199], v49 offset:49152
    s_add_u32 m0, s37, 131072
    s_add_u32 s42, s39, 49152
    buffer_load_dwordx4 v60, s[12:15], s42 offen offset:0 nt lds
    v_mfma_f32_16x16x32_bf16 v[212:215], a[208:211], a[120:123], v[212:215]
    s_waitcnt lgkmcnt(6)
    buffer_load_dwordx4 v61, s[12:15], s42 offen offset:1024 nt lds
    v_mul_f32 v180, s46, v180
    v_mul_f32 v181, s46, v181
    v_mul_f32 v182, s46, v182
    v_mul_f32 v183, s46, v183
    v_mfma_f32_16x16x32_bf16 v[220:223], a[212:215], a[120:123], v[220:223]
    s_waitcnt lgkmcnt(4)
    ds_read_b128 a[200:203], v50 offset:49152
    ds_read_b128 a[204:207], v51 offset:49152
    buffer_load_dwordx4 v60, s[12:15], s42 offen offset:2048 nt lds
    v_mul_f32 v188, s46, v188
    v_mul_f32 v189, s46, v189
    v_mfma_f32_16x16x32_bf16 v[228:231], a[216:219], a[120:123], v[228:231]
    s_waitcnt lgkmcnt(4)
    buffer_load_dwordx4 v61, s[12:15], s42 offen offset:3072 nt lds
    v_mul_f32 v190, s46, v190
    v_mul_f32 v191, s46, v191
    v_cvt_pk_bf16_f32 v180, v180, v181
    v_cvt_pk_bf16_f32 v181, v182, v183
    v_mfma_f32_16x16x32_bf16 v[236:239], a[220:223], a[120:123], v[236:239]
    s_waitcnt lgkmcnt(3)
    ds_read_b128 a[208:211], v48 offset:53248
    ds_read_b128 a[212:215], v49 offset:53248
    v_exp_f32 v84, v84
    v_exp_f32 v85, v85
    v_mfma_f32_16x16x32_bf16 v[116:119], a[192:195], v[148:151], v[76:79]
    s_waitcnt lgkmcnt(4)
    v_exp_f32 v86, v86
    v_exp_f32 v87, v87
    v_exp_f32 v92, v92
    v_mfma_f32_16x16x32_bf16 v[116:119], a[196:199], v[156:159], v[116:119]
    s_waitcnt lgkmcnt(3)
    ds_read_b128 a[216:219], v50 offset:53248
    ds_read_b128 a[220:223], v51 offset:53248
    v_exp_f32 v93, v93
    v_exp_f32 v94, v94
    v_mfma_f32_16x16x32_bf16 v[116:119], a[200:203], v[164:167], v[116:119]
    s_waitcnt lgkmcnt(4)
    v_exp_f32 v95, v95
    v_cvt_pk_bf16_f32 v84, v84, v85
    v_cvt_pk_bf16_f32 v85, v86, v87
    v_cvt_pk_bf16_f32 v86, v92, v93
    v_cvt_pk_bf16_f32 v87, v94, v95
    v_mfma_f32_16x16x32_bf16 v[116:119], a[204:207], v[172:175], v[116:119]
    s_waitcnt lgkmcnt(3)
    ds_read_b128 a[192:195], v48 offset:57344
    ds_read_b128 a[196:199], v49 offset:57344
    v_exp_f32 v100, v100
    v_exp_f32 v101, v101
    v_mfma_f32_16x16x32_bf16 v[124:127], a[208:211], v[148:151], v[76:79]
    s_waitcnt lgkmcnt(4)
    v_exp_f32 v102, v102
    v_exp_f32 v103, v103
    v_exp_f32 v108, v108
    v_mfma_f32_16x16x32_bf16 v[124:127], a[212:215], v[156:159], v[124:127]
    s_waitcnt lgkmcnt(3)
    ds_read_b128 a[200:203], v50 offset:57344
    ds_read_b128 a[204:207], v51 offset:57344
    v_exp_f32 v109, v109
    v_exp_f32 v110, v110
    v_mfma_f32_16x16x32_bf16 v[124:127], a[216:219], v[164:167], v[124:127]
    s_waitcnt lgkmcnt(4)
    v_exp_f32 v111, v111
    v_cvt_pk_bf16_f32 v100, v100, v101
    v_cvt_pk_bf16_f32 v101, v102, v103
    v_cvt_pk_bf16_f32 v102, v108, v109
    v_cvt_pk_bf16_f32 v103, v110, v111
    v_mfma_f32_16x16x32_bf16 v[124:127], a[220:223], v[172:175], v[124:127]
    s_waitcnt lgkmcnt(3)
    ds_read_b128 a[208:211], v48 offset:61440
    ds_read_b128 a[212:215], v49 offset:61440
    v_cvt_pk_bf16_f32 v182, v188, v189
    v_cvt_pk_bf16_f32 v183, v190, v191
    s_nop 0
    v_permlane32_swap_b32 v180, v182
    v_permlane32_swap_b32 v181, v183
    v_mfma_f32_16x16x32_bf16 v[132:135], a[192:195], v[148:151], v[76:79]
    s_waitcnt lgkmcnt(4)
    v_permlane16_swap_b32 v180, v182
    v_permlane16_swap_b32 v181, v183
    v_mul_f32 v196, s46, v196
    v_mul_f32 v197, s46, v197
    v_mul_f32 v198, s46, v198
    v_mul_f32 v199, s46, v199
    v_mfma_f32_16x16x32_bf16 v[132:135], a[196:199], v[156:159], v[132:135]
    s_waitcnt lgkmcnt(3)
    ds_read_b128 a[216:219], v50 offset:61440
    ds_read_b128 a[220:223], v51 offset:61440
    v_mul_f32 v204, s46, v204
    v_mul_f32 v205, s46, v205
    v_mul_f32 v206, s46, v206
    v_mul_f32 v207, s46, v207
    v_mfma_f32_16x16x32_bf16 v[132:135], a[200:203], v[164:167], v[132:135]
    s_waitcnt lgkmcnt(4)
    v_cvt_pk_bf16_f32 v196, v196, v197
    v_cvt_pk_bf16_f32 v197, v198, v199
    v_cvt_pk_bf16_f32 v198, v204, v205
    v_cvt_pk_bf16_f32 v199, v206, v207
    s_nop 0
    v_permlane32_swap_b32 v196, v198
    v_permlane32_swap_b32 v197, v199
    v_mfma_f32_16x16x32_bf16 v[132:135], a[204:207], v[172:175], v[132:135]
    s_waitcnt lgkmcnt(3)
    v_permlane16_swap_b32 v196, v198
    v_permlane16_swap_b32 v197, v199
    v_mul_f32 v212, s46, v212
    v_mul_f32 v213, s46, v213
    v_mul_f32 v214, s46, v214
    v_mul_f32 v215, s46, v215
    v_mfma_f32_16x16x32_bf16 v[140:143], a[208:211], v[148:151], v[76:79]
    s_waitcnt lgkmcnt(2)
    s_barrier
    ds_read_b64_tr_b16 a[192:193], v20 offset:16384
    ds_read_b64_tr_b16 a[194:195], v20 offset:20480
    s_add_u32 m0, s37, 49152
    s_add_u32 s42, s39, 81920
    buffer_load_dwordx4 v56, s[8:11], s42 offen offset:0 nt lds
    v_mfma_f32_16x16x32_bf16 v[140:143], a[212:215], v[156:159], v[140:143]
    s_waitcnt lgkmcnt(3)
    ds_read_b64_tr_b16 a[196:197], v21 offset:16384
    ds_read_b64_tr_b16 a[198:199], v21 offset:20480
    buffer_load_dwordx4 v57, s[8:11], s42 offen offset:1024 nt lds
    v_mul_f32 v220, s46, v220
    v_mul_f32 v221, s46, v221
    v_mfma_f32_16x16x32_bf16 v[140:143], a[216:219], v[164:167], v[140:143]
    s_waitcnt lgkmcnt(4)
    ds_read_b64_tr_b16 a[200:201], v22 offset:16384
    ds_read_b64_tr_b16 a[202:203], v22 offset:20480
    buffer_load_dwordx4 v58, s[8:11], s42 offen offset:2048 nt lds
    v_mul_f32 v222, s46, v222
    v_mul_f32 v223, s46, v223
    v_mfma_f32_16x16x32_bf16 v[140:143], a[220:223], v[172:175], v[140:143]
    ds_read_b64_tr_b16 a[204:205], v23 offset:16384
    ds_read_b64_tr_b16 a[206:207], v23 offset:20480
    buffer_load_dwordx4 v59, s[8:11], s42 offen offset:3072 nt lds
    v_cvt_pk_bf16_f32 v212, v212, v213
    v_cvt_pk_bf16_f32 v213, v214, v215
    v_mfma_f32_16x16x32_bf16 v[68:71], a[224:227], v[84:87], 0
    s_waitcnt lgkmcnt(6)
    ds_read_b64_tr_b16 a[208:209], v24 offset:16384
    ds_read_b64_tr_b16 a[210:211], v24 offset:20480
    v_cvt_pk_bf16_f32 v214, v220, v221
    v_cvt_pk_bf16_f32 v215, v222, v223
    s_nop 0
    v_permlane32_swap_b32 v212, v214
    v_permlane32_swap_b32 v213, v215
    v_mfma_f32_16x16x32_bf16 a[128:131], a[192:195], v[84:87], 0
    s_waitcnt lgkmcnt(6)
    ds_read_b64_tr_b16 a[212:213], v25 offset:16384
    ds_read_b64_tr_b16 a[214:215], v25 offset:20480
    v_permlane16_swap_b32 v212, v214
    v_permlane16_swap_b32 v213, v215
    v_mul_f32 v228, s46, v228
    v_mul_f32 v229, s46, v229
    v_mfma_f32_16x16x32_bf16 a[136:139], a[196:199], v[84:87], 0
    s_waitcnt lgkmcnt(6)
    ds_read_b64_tr_b16 a[216:217], v26 offset:16384
    ds_read_b64_tr_b16 a[218:219], v26 offset:20480
    v_max3_f32 v19, v116, v117, v118
    v_max3_f32 v19, v19, v119, v124
    v_max3_f32 v19, v19, v125, v126
    v_max3_f32 v19, v19, v127, v132
    v_mfma_f32_16x16x32_bf16 a[144:147], a[200:203], v[84:87], 0
    s_waitcnt lgkmcnt(6)
    ds_read_b64_tr_b16 a[220:221], v27 offset:16384
    ds_read_b64_tr_b16 a[222:223], v27 offset:20480
    v_max3_f32 v19, v19, v133, v134
    v_max3_f32 v19, v19, v135, v140
    v_max3_f32 v19, v19, v141, v142
    v_max_f32 v19, v19, v143
    v_mfma_f32_16x16x32_bf16 a[152:155], a[204:207], v[84:87], 0
    s_waitcnt lgkmcnt(6)
    v_cmp_lt_f32 vcc, s47, v19
    v_mul_f32 v230, s46, v230
    v_mul_f32 v231, s46, v231
    v_mul_f32 v236, s46, v236
    v_mul_f32 v237, s46, v237
    v_mul_f32 v238, s46, v238
    v_mfma_f32_16x16x32_bf16 a[160:163], a[208:211], v[84:87], 0
    s_waitcnt lgkmcnt(4)
    ds_read_b64_tr_b16 a[192:193], v20 offset:24576
    ds_read_b64_tr_b16 a[194:195], v20 offset:28672
    v_mul_f32 v239, s46, v239
    v_cvt_pk_bf16_f32 v228, v228, v229
    v_cvt_pk_bf16_f32 v229, v230, v231
    v_cvt_pk_bf16_f32 v230, v236, v237
    v_mfma_f32_16x16x32_bf16 a[168:171], a[212:215], v[84:87], 0
    s_waitcnt lgkmcnt(4)
    ds_read_b64_tr_b16 a[196:197], v21 offset:24576
    ds_read_b64_tr_b16 a[198:199], v21 offset:28672
    v_cvt_pk_bf16_f32 v231, v238, v239
    v_permlane32_swap_b32 v228, v230
    s_nop 0
    v_permlane32_swap_b32 v229, v231
    v_permlane16_swap_b32 v228, v230
    v_mfma_f32_16x16x32_bf16 a[176:179], a[216:219], v[84:87], 0
    s_waitcnt lgkmcnt(4)
    ds_read_b64_tr_b16 a[200:201], v22 offset:24576
    ds_read_b64_tr_b16 a[202:203], v22 offset:28672
    v_permlane16_swap_b32 v229, v231
    v_mfma_f32_16x16x32_bf16 a[184:187], a[220:223], v[84:87], 0
    ds_read_b64_tr_b16 a[204:205], v23 offset:24576
    ds_read_b64_tr_b16 a[206:207], v23 offset:28672
    v_mfma_f32_16x16x32_bf16 v[68:71], a[224:227], v[100:103], v[68:71]
    s_waitcnt lgkmcnt(6)
    ds_read_b64_tr_b16 a[208:209], v24 offset:24576
    ds_read_b64_tr_b16 a[210:211], v24 offset:28672
    v_mfma_f32_16x16x32_bf16 a[128:131], a[192:195], v[100:103], a[128:131]
    s_waitcnt lgkmcnt(6)
    ds_read_b64_tr_b16 a[212:213], v25 offset:24576
    ds_read_b64_tr_b16 a[214:215], v25 offset:28672
    v_mfma_f32_16x16x32_bf16 a[136:139], a[196:199], v[100:103], a[136:139]
    s_waitcnt lgkmcnt(6)
    ds_read_b64_tr_b16 a[216:217], v26 offset:24576
    ds_read_b64_tr_b16 a[218:219], v26 offset:28672
    v_mfma_f32_16x16x32_bf16 a[144:147], a[200:203], v[100:103], a[144:147]
    s_waitcnt lgkmcnt(6)
    ds_read_b64_tr_b16 a[220:221], v27 offset:24576
    ds_read_b64_tr_b16 a[222:223], v27 offset:28672
    v_mfma_f32_16x16x32_bf16 a[152:155], a[204:207], v[100:103], a[152:155]
    s_waitcnt lgkmcnt(6)
    s_barrier
    ds_read_b128 a[192:195], v48 offset:16384
    ds_read_b128 a[196:199], v49 offset:16384
    s_add_u32 m0, s37, 147456
    s_add_u32 s42, s39, 65536
    buffer_load_dwordx4 v60, s[12:15], s42 offen offset:0 nt lds
    v_mfma_f32_16x16x32_bf16 a[160:163], a[208:211], v[100:103], a[160:163]
    s_waitcnt lgkmcnt(6)
    buffer_load_dwordx4 v61, s[12:15], s42 offen offset:1024 nt lds
    v_mfma_f32_16x16x32_bf16 a[168:171], a[212:215], v[100:103], a[168:171]
    s_waitcnt lgkmcnt(4)
    ds_read_b128 a[200:203], v50 offset:16384
    ds_read_b128 a[204:207], v51 offset:16384
    buffer_load_dwordx4 v60, s[12:15], s42 offen offset:2048 nt lds
    v_mfma_f32_16x16x32_bf16 a[176:179], a[216:219], v[100:103], a[176:179]
    s_waitcnt lgkmcnt(4)
    buffer_load_dwordx4 v61, s[12:15], s42 offen offset:3072 nt lds
    v_mfma_f32_16x16x32_bf16 a[184:187], a[220:223], v[100:103], a[184:187]
    s_cbranch_vccnz w1_t1_slow
w1_t1_back:
    s_waitcnt lgkmcnt(3)
    ds_read_b128 a[208:211], v48 offset:20480
    ds_read_b128 a[212:215], v49 offset:20480
    v_exp_f32 v116, v116
    v_exp_f32 v117, v117
    v_mfma_f32_16x16x32_bf16 v[84:87], a[192:195], v[148:151], v[76:79]
    s_waitcnt lgkmcnt(4)
    v_exp_f32 v118, v118
    v_exp_f32 v119, v119
    v_exp_f32 v124, v124
    v_mfma_f32_16x16x32_bf16 v[84:87], a[196:199], v[156:159], v[84:87]
    s_waitcnt lgkmcnt(3)
    ds_read_b128 a[216:219], v50 offset:20480
    ds_read_b128 a[220:223], v51 offset:20480
    v_exp_f32 v125, v125
    v_exp_f32 v126, v126
    v_mfma_f32_16x16x32_bf16 v[84:87], a[200:203], v[164:167], v[84:87]
    s_waitcnt lgkmcnt(4)
    v_exp_f32 v127, v127
    v_cvt_pk_bf16_f32 v116, v116, v117
    v_cvt_pk_bf16_f32 v117, v118, v119
    v_cvt_pk_bf16_f32 v118, v124, v125
    v_cvt_pk_bf16_f32 v119, v126, v127
    v_mfma_f32_16x16x32_bf16 v[84:87], a[204:207], v[172:175], v[84:87]
    s_waitcnt lgkmcnt(3)
    ds_read_b128 a[192:195], v48 offset:24576
    ds_read_b128 a[196:199], v49 offset:24576
    v_exp_f32 v132, v132
    v_exp_f32 v133, v133
    v_mfma_f32_16x16x32_bf16 v[92:95], a[208:211], v[148:151], v[76:79]
    s_waitcnt lgkmcnt(4)
    v_exp_f32 v134, v134
    v_exp_f32 v135, v135
    v_exp_f32 v140, v140
    v_mfma_f32_16x16x32_bf16 v[92:95], a[212:215], v[156:159], v[92:95]
    s_waitcnt lgkmcnt(3)
    ds_read_b128 a[200:203], v50 offset:24576
    ds_read_b128 a[204:207], v51 offset:24576
    v_exp_f32 v141, v141
    v_exp_f32 v142, v142
    v_mfma_f32_16x16x32_bf16 v[92:95], a[216:219], v[164:167], v[92:95]
    s_waitcnt lgkmcnt(4)
    v_exp_f32 v143, v143
    v_cvt_pk_bf16_f32 v132, v132, v133
    v_cvt_pk_bf16_f32 v133, v134, v135
    v_cvt_pk_bf16_f32 v134, v140, v141
    v_cvt_pk_bf16_f32 v135, v142, v143
    v_mfma_f32_16x16x32_bf16 v[92:95], a[220:223], v[172:175], v[92:95]
    s_waitcnt lgkmcnt(3)
    ds_read_b128 a[208:211], v48 offset:28672
    ds_read_b128 a[212:215], v49 offset:28672
    v_mfma_f32_16x16x32_bf16 v[100:103], a[192:195], v[148:151], v[76:79]
    s_waitcnt lgkmcnt(4)
    v_mfma_f32_16x16x32_bf16 v[100:103], a[196:199], v[156:159], v[100:103]
    s_waitcnt lgkmcnt(3)
    ds_read_b128 a[216:219], v50 offset:28672
    ds_read_b128 a[220:223], v51 offset:28672
    v_mfma_f32_16x16x32_bf16 v[100:103], a[200:203], v[164:167], v[100:103]
    s_waitcnt lgkmcnt(4)
    v_mfma_f32_16x16x32_bf16 v[100:103], a[204:207], v[172:175], v[100:103]
    s_waitcnt lgkmcnt(3)
    v_mfma_f32_16x16x32_bf16 v[108:111], a[208:211], v[148:151], v[76:79]
    s_waitcnt lgkmcnt(2)
    s_waitcnt vmcnt(24)
    s_barrier
    global_load_dword v7, v67, s[88:89]
    ds_read_b64_tr_b16 a[192:193], v20 offset:0
    ds_read_b64_tr_b16 a[194:195], v20 offset:4096
    s_add_u32 m0, s37, 114688
    s_add_u32 s42, s39, 98304
    buffer_load_dwordx4 v56, s[8:11], s42 offen offset:0 nt lds
    v_mfma_f32_16x16x32_bf16 v[108:111], a[212:215], v[156:159], v[108:111]
    s_waitcnt lgkmcnt(3)
    ds_read_b64_tr_b16 a[196:197], v21 offset:0
    ds_read_b64_tr_b16 a[198:199], v21 offset:4096
    buffer_load_dwordx4 v57, s[8:11], s42 offen offset:1024 nt lds
    v_mfma_f32_16x16x32_bf16 v[108:111], a[216:219], v[164:167], v[108:111]
    s_waitcnt lgkmcnt(4)
    ds_read_b64_tr_b16 a[200:201], v22 offset:0
    ds_read_b64_tr_b16 a[202:203], v22 offset:4096
    buffer_load_dwordx4 v58, s[8:11], s42 offen offset:2048 nt lds
    v_mfma_f32_16x16x32_bf16 v[108:111], a[220:223], v[172:175], v[108:111]
    ds_read_b64_tr_b16 a[204:205], v23 offset:0
    ds_read_b64_tr_b16 a[206:207], v23 offset:4096
    buffer_load_dwordx4 v59, s[8:11], s42 offen offset:3072 nt lds
    v_mfma_f32_16x16x32_bf16 v[68:71], a[224:227], v[116:119], v[68:71]
    s_waitcnt lgkmcnt(6)
    ds_read_b64_tr_b16 a[208:209], v24 offset:0
    ds_read_b64_tr_b16 a[210:211], v24 offset:4096
    v_mfma_f32_16x16x32_bf16 a[128:131], a[192:195], v[116:119], a[128:131]
    s_waitcnt lgkmcnt(6)
    ds_read_b64_tr_b16 a[212:213], v25 offset:0
    ds_read_b64_tr_b16 a[214:215], v25 offset:4096
    v_mfma_f32_16x16x32_bf16 a[136:139], a[196:199], v[116:119], a[136:139]
    s_waitcnt lgkmcnt(6)
    ds_read_b64_tr_b16 a[216:217], v26 offset:0
    ds_read_b64_tr_b16 a[218:219], v26 offset:4096
    v_max3_f32 v19, v84, v85, v86
    v_max3_f32 v19, v19, v87, v92
    v_max3_f32 v19, v19, v93, v94
    v_max3_f32 v19, v19, v95, v100
    v_mfma_f32_16x16x32_bf16 a[144:147], a[200:203], v[116:119], a[144:147]
    s_waitcnt lgkmcnt(6)
    ds_read_b64_tr_b16 a[220:221], v27 offset:0
    ds_read_b64_tr_b16 a[222:223], v27 offset:4096
    v_max3_f32 v19, v19, v101, v102
    v_max3_f32 v19, v19, v103, v108
    v_max3_f32 v19, v19, v109, v110
    v_max_f32 v19, v19, v111
    v_mfma_f32_16x16x32_bf16 a[152:155], a[204:207], v[116:119], a[152:155]
    s_waitcnt lgkmcnt(6)
    v_cmp_lt_f32 vcc, s47, v19
    v_mfma_f32_16x16x32_bf16 a[160:163], a[208:211], v[116:119], a[160:163]
    s_waitcnt lgkmcnt(4)
    ds_read_b64_tr_b16 a[192:193], v20 offset:8192
    ds_read_b64_tr_b16 a[194:195], v20 offset:12288
    v_mfma_f32_16x16x32_bf16 a[168:171], a[212:215], v[116:119], a[168:171]
    s_waitcnt lgkmcnt(4)
    ds_read_b64_tr_b16 a[196:197], v21 offset:8192
    ds_read_b64_tr_b16 a[198:199], v21 offset:12288
    v_mfma_f32_16x16x32_bf16 a[176:179], a[216:219], v[116:119], a[176:179]
    s_waitcnt lgkmcnt(4)
    ds_read_b64_tr_b16 a[200:201], v22 offset:8192
    ds_read_b64_tr_b16 a[202:203], v22 offset:12288
    v_mfma_f32_16x16x32_bf16 a[184:187], a[220:223], v[116:119], a[184:187]
    ds_read_b64_tr_b16 a[204:205], v23 offset:8192
    ds_read_b64_tr_b16 a[206:207], v23 offset:12288
    v_mfma_f32_16x16x32_bf16 v[68:71], a[224:227], v[132:135], v[68:71]
    s_waitcnt lgkmcnt(6)
    ds_read_b64_tr_b16 a[208:209], v24 offset:8192
    ds_read_b64_tr_b16 a[210:211], v24 offset:12288
    v_mfma_f32_16x16x32_bf16 a[128:131], a[192:195], v[132:135], a[128:131]
    s_waitcnt lgkmcnt(6)
    ds_read_b64_tr_b16 a[212:213], v25 offset:8192
    ds_read_b64_tr_b16 a[214:215], v25 offset:12288
    v_mfma_f32_16x16x32_bf16 a[136:139], a[196:199], v[132:135], a[136:139]
    s_waitcnt lgkmcnt(6)
    ds_read_b64_tr_b16 a[216:217], v26 offset:8192
    ds_read_b64_tr_b16 a[218:219], v26 offset:12288
    v_mfma_f32_16x16x32_bf16 a[144:147], a[200:203], v[132:135], a[144:147]
    s_waitcnt lgkmcnt(6)
    ds_read_b64_tr_b16 a[220:221], v27 offset:8192
    ds_read_b64_tr_b16 a[222:223], v27 offset:12288
    v_mfma_f32_16x16x32_bf16 a[152:155], a[204:207], v[132:135], a[152:155]
    s_waitcnt lgkmcnt(6)
    s_waitcnt vmcnt(25)
    s_barrier
    ds_read_b128 a[192:195], v44 offset:32768
    ds_read_b128 a[196:199], v45 offset:32768
    s_add_u32 m0, s37, 16384
    s_add_u32 s42, s39, 81920
    buffer_load_dwordx4 v60, s[12:15], s42 offen offset:0 nt lds
    v_mfma_f32_16x16x32_bf16 a[160:163], a[208:211], v[132:135], a[160:163]
    s_waitcnt lgkmcnt(6)
    buffer_load_dwordx4 v61, s[12:15], s42 offen offset:1024 nt lds
    v_mfma_f32_16x16x32_bf16 a[168:171], a[212:215], v[132:135], a[168:171]
    s_waitcnt lgkmcnt(4)
    ds_read_b128 a[200:203], v46 offset:32768
    ds_read_b128 a[204:207], v47 offset:32768
    buffer_load_dwordx4 v60, s[12:15], s42 offen offset:2048 nt lds
    v_mfma_f32_16x16x32_bf16 a[176:179], a[216:219], v[132:135], a[176:179]
    s_waitcnt lgkmcnt(4)
    buffer_load_dwordx4 v61, s[12:15], s42 offen offset:3072 nt lds
    v_mfma_f32_16x16x32_bf16 a[184:187], a[220:223], v[132:135], a[184:187]
    s_cbranch_vccnz w1_t2_slow
w1_t2_back:
    s_waitcnt lgkmcnt(3)
    ds_read_b128 a[208:211], v44 offset:36864
    ds_read_b128 a[212:215], v45 offset:36864
    v_exp_f32 v84, v84
    v_exp_f32 v85, v85
    v_mfma_f32_16x16x32_bf16 v[116:119], a[192:195], v[148:151], v[76:79]
    s_waitcnt lgkmcnt(4)
    v_exp_f32 v86, v86
    v_exp_f32 v87, v87
    v_exp_f32 v92, v92
    v_mfma_f32_16x16x32_bf16 v[116:119], a[196:199], v[156:159], v[116:119]
    s_waitcnt lgkmcnt(3)
    ds_read_b128 a[216:219], v46 offset:36864
    ds_read_b128 a[220:223], v47 offset:36864
    v_exp_f32 v93, v93
    v_exp_f32 v94, v94
    v_mfma_f32_16x16x32_bf16 v[116:119], a[200:203], v[164:167], v[116:119]
    s_waitcnt lgkmcnt(4)
    v_exp_f32 v95, v95
    v_cvt_pk_bf16_f32 v84, v84, v85
    v_cvt_pk_bf16_f32 v85, v86, v87
    v_cvt_pk_bf16_f32 v86, v92, v93
    v_cvt_pk_bf16_f32 v87, v94, v95
    v_mfma_f32_16x16x32_bf16 v[116:119], a[204:207], v[172:175], v[116:119]
    s_waitcnt lgkmcnt(3)
    ds_read_b128 a[192:195], v44 offset:40960
    ds_read_b128 a[196:199], v45 offset:40960
    v_exp_f32 v100, v100
    v_exp_f32 v101, v101
    v_mfma_f32_16x16x32_bf16 v[124:127], a[208:211], v[148:151], v[76:79]
    s_waitcnt lgkmcnt(4)
    v_exp_f32 v102, v102
    v_exp_f32 v103, v103
    v_exp_f32 v108, v108
    v_mfma_f32_16x16x32_bf16 v[124:127], a[212:215], v[156:159], v[124:127]
    s_waitcnt lgkmcnt(3)
    ds_read_b128 a[200:203], v46 offset:40960
    ds_read_b128 a[204:207], v47 offset:40960
    v_exp_f32 v109, v109
    v_exp_f32 v110, v110
    v_mfma_f32_16x16x32_bf16 v[124:127], a[216:219], v[164:167], v[124:127]
    s_waitcnt lgkmcnt(4)
    v_exp_f32 v111, v111
    v_cvt_pk_bf16_f32 v100, v100, v101
    v_cvt_pk_bf16_f32 v101, v102, v103
    v_cvt_pk_bf16_f32 v102, v108, v109
    v_cvt_pk_bf16_f32 v103, v110, v111
    v_mfma_f32_16x16x32_bf16 v[124:127], a[220:223], v[172:175], v[124:127]
    s_waitcnt lgkmcnt(3)
    ds_read_b128 a[208:211], v44 offset:45056
    ds_read_b128 a[212:215], v45 offset:45056
    v_mfma_f32_16x16x32_bf16 v[132:135], a[192:195], v[148:151], v[76:79]
    s_waitcnt lgkmcnt(4)
    v_mfma_f32_16x16x32_bf16 v[132:135], a[196:199], v[156:159], v[132:135]
    s_waitcnt lgkmcnt(3)
    ds_read_b128 a[216:219], v46 offset:45056
    ds_read_b128 a[220:223], v47 offset:45056
    v_mfma_f32_16x16x32_bf16 v[132:135], a[200:203], v[164:167], v[132:135]
    s_waitcnt lgkmcnt(4)
    v_mfma_f32_16x16x32_bf16 v[132:135], a[204:207], v[172:175], v[132:135]
    s_waitcnt lgkmcnt(3)
    v_mfma_f32_16x16x32_bf16 v[140:143], a[208:211], v[148:151], v[76:79]
    s_waitcnt lgkmcnt(2)
    s_waitcnt vmcnt(25)
    s_barrier
    ds_read_b64_tr_b16 a[192:193], v28 offset:0
    ds_read_b64_tr_b16 a[194:195], v28 offset:4096
    s_add_u32 m0, s37, 81920
    s_add_u32 s42, s39, 114688
    buffer_load_dwordx4 v56, s[8:11], s42 offen offset:0 nt lds
    v_mfma_f32_16x16x32_bf16 v[140:143], a[212:215], v[156:159], v[140:143]
    s_waitcnt lgkmcnt(3)
    ds_read_b64_tr_b16 a[196:197], v29 offset:0
    ds_read_b64_tr_b16 a[198:199], v29 offset:4096
    buffer_load_dwordx4 v57, s[8:11], s42 offen offset:1024 nt lds
    v_mfma_f32_16x16x32_bf16 v[140:143], a[216:219], v[164:167], v[140:143]
    s_waitcnt lgkmcnt(4)
    ds_read_b64_tr_b16 a[200:201], v30 offset:0
    ds_read_b64_tr_b16 a[202:203], v30 offset:4096
    buffer_load_dwordx4 v58, s[8:11], s42 offen offset:2048 nt lds
    v_mfma_f32_16x16x32_bf16 v[140:143], a[220:223], v[172:175], v[140:143]
    ds_read_b64_tr_b16 a[204:205], v31 offset:0
    ds_read_b64_tr_b16 a[206:207], v31 offset:4096
    buffer_load_dwordx4 v59, s[8:11], s42 offen offset:3072 nt lds
    v_mfma_f32_16x16x32_bf16 v[68:71], a[224:227], v[84:87], v[68:71]
    s_waitcnt lgkmcnt(6)
    ds_read_b64_tr_b16 a[208:209], v32 offset:0
    ds_read_b64_tr_b16 a[210:211], v32 offset:4096
    v_mfma_f32_16x16x32_bf16 a[128:131], a[192:195], v[84:87], a[128:131]
    s_waitcnt lgkmcnt(6)
    ds_read_b64_tr_b16 a[212:213], v33 offset:0
    ds_read_b64_tr_b16 a[214:215], v33 offset:4096
    v_mfma_f32_16x16x32_bf16 a[136:139], a[196:199], v[84:87], a[136:139]
    s_waitcnt lgkmcnt(6)
    ds_read_b64_tr_b16 a[216:217], v34 offset:0
    ds_read_b64_tr_b16 a[218:219], v34 offset:4096
    v_max3_f32 v19, v116, v117, v118
    v_max3_f32 v19, v19, v119, v124
    v_max3_f32 v19, v19, v125, v126
    v_max3_f32 v19, v19, v127, v132
    v_mfma_f32_16x16x32_bf16 a[144:147], a[200:203], v[84:87], a[144:147]
    s_waitcnt lgkmcnt(6)
    ds_read_b64_tr_b16 a[220:221], v35 offset:0
    ds_read_b64_tr_b16 a[222:223], v35 offset:4096
    v_max3_f32 v19, v19, v133, v134
    v_max3_f32 v19, v19, v135, v140
    v_max3_f32 v19, v19, v141, v142
    v_max_f32 v19, v19, v143
    v_mfma_f32_16x16x32_bf16 a[152:155], a[204:207], v[84:87], a[152:155]
    s_waitcnt lgkmcnt(6)
    v_cmp_lt_f32 vcc, s47, v19
    v_mfma_f32_16x16x32_bf16 a[160:163], a[208:211], v[84:87], a[160:163]
    s_waitcnt lgkmcnt(4)
    ds_read_b64_tr_b16 a[192:193], v28 offset:8192
    ds_read_b64_tr_b16 a[194:195], v28 offset:12288
    v_mfma_f32_16x16x32_bf16 a[168:171], a[212:215], v[84:87], a[168:171]
    s_waitcnt lgkmcnt(4)
    ds_read_b64_tr_b16 a[196:197], v29 offset:8192
    ds_read_b64_tr_b16 a[198:199], v29 offset:12288
    v_mfma_f32_16x16x32_bf16 a[176:179], a[216:219], v[84:87], a[176:179]
    s_waitcnt lgkmcnt(4)
    ds_read_b64_tr_b16 a[200:201], v30 offset:8192
    ds_read_b64_tr_b16 a[202:203], v30 offset:12288
    v_mfma_f32_16x16x32_bf16 a[184:187], a[220:223], v[84:87], a[184:187]
    ds_read_b64_tr_b16 a[204:205], v31 offset:8192
    ds_read_b64_tr_b16 a[206:207], v31 offset:12288
    v_mfma_f32_16x16x32_bf16 v[68:71], a[224:227], v[100:103], v[68:71]
    s_waitcnt lgkmcnt(6)
    ds_read_b64_tr_b16 a[208:209], v32 offset:8192
    ds_read_b64_tr_b16 a[210:211], v32 offset:12288
    v_mfma_f32_16x16x32_bf16 a[128:131], a[192:195], v[100:103], a[128:131]
    s_waitcnt lgkmcnt(6)
    ds_read_b64_tr_b16 a[212:213], v33 offset:8192
    ds_read_b64_tr_b16 a[214:215], v33 offset:12288
    v_mfma_f32_16x16x32_bf16 a[136:139], a[196:199], v[100:103], a[136:139]
    s_waitcnt lgkmcnt(6)
    ds_read_b64_tr_b16 a[216:217], v34 offset:8192
    ds_read_b64_tr_b16 a[218:219], v34 offset:12288
    v_mfma_f32_16x16x32_bf16 a[144:147], a[200:203], v[100:103], a[144:147]
    s_waitcnt lgkmcnt(6)
    ds_read_b64_tr_b16 a[220:221], v35 offset:8192
    ds_read_b64_tr_b16 a[222:223], v35 offset:12288
    v_mfma_f32_16x16x32_bf16 a[152:155], a[204:207], v[100:103], a[152:155]
    s_waitcnt lgkmcnt(6)
    s_waitcnt vmcnt(25)
    s_barrier
    ds_read_b128 a[192:195], v48 offset:32768
    ds_read_b128 a[196:199], v49 offset:32768
    v_mfma_f32_16x16x32_bf16 a[160:163], a[208:211], v[100:103], a[160:163]
    s_waitcnt lgkmcnt(6)
    v_mfma_f32_16x16x32_bf16 a[168:171], a[212:215], v[100:103], a[168:171]
    s_waitcnt lgkmcnt(4)
    ds_read_b128 a[200:203], v50 offset:32768
    ds_read_b128 a[204:207], v51 offset:32768
    v_mfma_f32_16x16x32_bf16 a[176:179], a[216:219], v[100:103], a[176:179]
    s_waitcnt lgkmcnt(4)
    v_mfma_f32_16x16x32_bf16 a[184:187], a[220:223], v[100:103], a[184:187]
    s_cbranch_vccnz w1_t3_slow
w1_t3_back:
    s_waitcnt lgkmcnt(3)
    ds_read_b128 a[208:211], v48 offset:36864
    ds_read_b128 a[212:215], v49 offset:36864
    v_exp_f32 v116, v116
    v_exp_f32 v117, v117
    v_mfma_f32_16x16x32_bf16 v[84:87], a[192:195], v[148:151], v[76:79]
    s_waitcnt lgkmcnt(4)
    v_exp_f32 v118, v118
    v_exp_f32 v119, v119
    v_exp_f32 v124, v124
    v_mfma_f32_16x16x32_bf16 v[84:87], a[196:199], v[156:159], v[84:87]
    s_waitcnt lgkmcnt(3)
    ds_read_b128 a[216:219], v50 offset:36864
    ds_read_b128 a[220:223], v51 offset:36864
    v_exp_f32 v125, v125
    v_exp_f32 v126, v126
    v_mfma_f32_16x16x32_bf16 v[84:87], a[200:203], v[164:167], v[84:87]
    s_waitcnt lgkmcnt(4)
    v_exp_f32 v127, v127
    v_cvt_pk_bf16_f32 v116, v116, v117
    v_cvt_pk_bf16_f32 v117, v118, v119
    v_cvt_pk_bf16_f32 v118, v124, v125
    v_cvt_pk_bf16_f32 v119, v126, v127
    v_mfma_f32_16x16x32_bf16 v[84:87], a[204:207], v[172:175], v[84:87]
    s_waitcnt lgkmcnt(3)
    ds_read_b128 a[192:195], v48 offset:40960
    ds_read_b128 a[196:199], v49 offset:40960
    v_exp_f32 v132, v132
    v_exp_f32 v133, v133
    v_mfma_f32_16x16x32_bf16 v[92:95], a[208:211], v[148:151], v[76:79]
    s_waitcnt lgkmcnt(4)
    v_exp_f32 v134, v134
    v_exp_f32 v135, v135
    v_exp_f32 v140, v140
    v_mfma_f32_16x16x32_bf16 v[92:95], a[212:215], v[156:159], v[92:95]
    s_waitcnt lgkmcnt(3)
    ds_read_b128 a[200:203], v50 offset:40960
    ds_read_b128 a[204:207], v51 offset:40960
    v_exp_f32 v141, v141
    v_exp_f32 v142, v142
    v_mfma_f32_16x16x32_bf16 v[92:95], a[216:219], v[164:167], v[92:95]
    s_waitcnt lgkmcnt(4)
    v_exp_f32 v143, v143
    v_cvt_pk_bf16_f32 v132, v132, v133
    v_cvt_pk_bf16_f32 v133, v134, v135
    v_cvt_pk_bf16_f32 v134, v140, v141
    v_cvt_pk_bf16_f32 v135, v142, v143
    v_mfma_f32_16x16x32_bf16 v[92:95], a[220:223], v[172:175], v[92:95]
    s_waitcnt lgkmcnt(3)
    ds_read_b128 a[208:211], v48 offset:45056
    ds_read_b128 a[212:215], v49 offset:45056
    v_mfma_f32_16x16x32_bf16 v[100:103], a[192:195], v[148:151], v[76:79]
    s_waitcnt lgkmcnt(4)
    v_mfma_f32_16x16x32_bf16 v[100:103], a[196:199], v[156:159], v[100:103]
    s_waitcnt lgkmcnt(3)
    ds_read_b128 a[216:219], v50 offset:45056
    ds_read_b128 a[220:223], v51 offset:45056
    v_mfma_f32_16x16x32_bf16 v[100:103], a[200:203], v[164:167], v[100:103]
    s_waitcnt lgkmcnt(4)
    v_mfma_f32_16x16x32_bf16 v[100:103], a[204:207], v[172:175], v[100:103]
    s_waitcnt lgkmcnt(3)
    v_mfma_f32_16x16x32_bf16 v[108:111], a[208:211], v[148:151], v[76:79]
    s_waitcnt lgkmcnt(2)
    s_waitcnt vmcnt(21)
    s_barrier
    ds_read_b64_tr_b16 a[192:193], v36 offset:0
    ds_read_b64_tr_b16 a[194:195], v36 offset:4096
    s_add_u32 m0, s37, 0
    s_add_u32 s42, s39, 98304
    buffer_load_dwordx4 v60, s[12:15], s42 offen offset:0 nt lds
    v_mfma_f32_16x16x32_bf16 v[108:111], a[212:215], v[156:159], v[108:111]
    s_waitcnt lgkmcnt(3)
    ds_read_b64_tr_b16 a[196:197], v37 offset:0
    ds_read_b64_tr_b16 a[198:199], v37 offset:4096
    buffer_load_dwordx4 v61, s[12:15], s42 offen offset:1024 nt lds
    v_mfma_f32_16x16x32_bf16 v[108:111], a[216:219], v[164:167], v[108:111]
    s_waitcnt lgkmcnt(4)
    ds_read_b64_tr_b16 a[200:201], v38 offset:0
    ds_read_b64_tr_b16 a[202:203], v38 offset:4096
    buffer_load_dwordx4 v60, s[12:15], s42 offen offset:2048 nt lds
    v_mfma_f32_16x16x32_bf16 v[108:111], a[220:223], v[172:175], v[108:111]
    ds_read_b64_tr_b16 a[204:205], v39 offset:0
    ds_read_b64_tr_b16 a[206:207], v39 offset:4096
    buffer_load_dwordx4 v61, s[12:15], s42 offen offset:3072 nt lds
    v_mfma_f32_16x16x32_bf16 v[68:71], a[224:227], v[116:119], v[68:71]
    s_waitcnt lgkmcnt(6)
    ds_read_b64_tr_b16 a[208:209], v40 offset:0
    ds_read_b64_tr_b16 a[210:211], v40 offset:4096
    v_mfma_f32_16x16x32_bf16 a[128:131], a[192:195], v[116:119], a[128:131]
    s_waitcnt lgkmcnt(6)
    ds_read_b64_tr_b16 a[212:213], v41 offset:0
    ds_read_b64_tr_b16 a[214:215], v41 offset:4096
    v_mfma_f32_16x16x32_bf16 a[136:139], a[196:199], v[116:119], a[136:139]
    s_waitcnt lgkmcnt(6)
    ds_read_b64_tr_b16 a[216:217], v42 offset:0
    ds_read_b64_tr_b16 a[218:219], v42 offset:4096
    v_max3_f32 v19, v84, v85, v86
    v_max3_f32 v19, v19, v87, v92
    v_max3_f32 v19, v19, v93, v94
    v_max3_f32 v19, v19, v95, v100
    v_mfma_f32_16x16x32_bf16 a[144:147], a[200:203], v[116:119], a[144:147]
    s_waitcnt lgkmcnt(6)
    ds_read_b64_tr_b16 a[220:221], v43 offset:0
    ds_read_b64_tr_b16 a[222:223], v43 offset:4096
    v_max3_f32 v19, v19, v101, v102
    v_max3_f32 v19, v19, v103, v108
    v_max3_f32 v19, v19, v109, v110
    v_max_f32 v19, v19, v111
    v_mfma_f32_16x16x32_bf16 a[152:155], a[204:207], v[116:119], a[152:155]
    s_waitcnt lgkmcnt(6)
    v_cmp_lt_f32 vcc, s47, v19
    v_mfma_f32_16x16x32_bf16 a[160:163], a[208:211], v[116:119], a[160:163]
    s_waitcnt lgkmcnt(4)
    ds_read_b64_tr_b16 a[192:193], v36 offset:8192
    ds_read_b64_tr_b16 a[194:195], v36 offset:12288
    v_mfma_f32_16x16x32_bf16 a[168:171], a[212:215], v[116:119], a[168:171]
    s_waitcnt lgkmcnt(4)
    ds_read_b64_tr_b16 a[196:197], v37 offset:8192
    ds_read_b64_tr_b16 a[198:199], v37 offset:12288
    v_mfma_f32_16x16x32_bf16 a[176:179], a[216:219], v[116:119], a[176:179]
    s_waitcnt lgkmcnt(4)
    ds_read_b64_tr_b16 a[200:201], v38 offset:8192
    ds_read_b64_tr_b16 a[202:203], v38 offset:12288
    v_mfma_f32_16x16x32_bf16 a[184:187], a[220:223], v[116:119], a[184:187]
    ds_read_b64_tr_b16 a[204:205], v39 offset:8192
    ds_read_b64_tr_b16 a[206:207], v39 offset:12288
    v_mfma_f32_16x16x32_bf16 v[68:71], a[224:227], v[132:135], v[68:71]
    s_waitcnt lgkmcnt(6)
    ds_read_b64_tr_b16 a[208:209], v40 offset:8192
    ds_read_b64_tr_b16 a[210:211], v40 offset:12288
    v_mfma_f32_16x16x32_bf16 a[128:131], a[192:195], v[132:135], a[128:131]
    s_waitcnt lgkmcnt(6)
    ds_read_b64_tr_b16 a[212:213], v41 offset:8192
    ds_read_b64_tr_b16 a[214:215], v41 offset:12288
    v_mfma_f32_16x16x32_bf16 a[136:139], a[196:199], v[132:135], a[136:139]
    s_waitcnt lgkmcnt(6)
    ds_read_b64_tr_b16 a[216:217], v42 offset:8192
    ds_read_b64_tr_b16 a[218:219], v42 offset:12288
    v_mfma_f32_16x16x32_bf16 a[144:147], a[200:203], v[132:135], a[144:147]
    s_waitcnt lgkmcnt(6)
    ds_read_b64_tr_b16 a[220:221], v43 offset:8192
    ds_read_b64_tr_b16 a[222:223], v43 offset:12288
    v_mfma_f32_16x16x32_bf16 a[152:155], a[204:207], v[132:135], a[152:155]
    s_waitcnt lgkmcnt(6)
    s_waitcnt vmcnt(21)
    s_barrier
    ds_read_b128 a[192:195], v44 offset:49152
    ds_read_b128 a[196:199], v45 offset:49152
    s_add_u32 m0, s37, 32768
    s_add_u32 s42, s39, 131072
    buffer_load_dwordx4 v56, s[8:11], s42 offen offset:0 nt lds
    v_mfma_f32_16x16x32_bf16 a[160:163], a[208:211], v[132:135], a[160:163]
    s_waitcnt lgkmcnt(6)
    buffer_load_dwordx4 v57, s[8:11], s42 offen offset:1024 nt lds
    v_mfma_f32_16x16x32_bf16 a[168:171], a[212:215], v[132:135], a[168:171]
    s_waitcnt lgkmcnt(4)
    ds_read_b128 a[200:203], v46 offset:49152
    ds_read_b128 a[204:207], v47 offset:49152
    buffer_load_dwordx4 v58, s[8:11], s42 offen offset:2048 nt lds
    v_mfma_f32_16x16x32_bf16 a[176:179], a[216:219], v[132:135], a[176:179]
    s_waitcnt lgkmcnt(4)
    buffer_load_dwordx4 v59, s[8:11], s42 offen offset:3072 nt lds
    v_mfma_f32_16x16x32_bf16 a[184:187], a[220:223], v[132:135], a[184:187]
    s_cbranch_vccnz w1_t4_slow
w1_t4_back:
    s_waitcnt lgkmcnt(3)
    ds_read_b128 a[208:211], v44 offset:53248
    ds_read_b128 a[212:215], v45 offset:53248
    v_exp_f32 v84, v84
    v_exp_f32 v85, v85
    v_mfma_f32_16x16x32_bf16 v[116:119], a[192:195], v[148:151], v[76:79]
    s_waitcnt lgkmcnt(4)
    v_exp_f32 v86, v86
    v_exp_f32 v87, v87
    v_exp_f32 v92, v92
    v_mfma_f32_16x16x32_bf16 v[116:119], a[196:199], v[156:159], v[116:119]
    s_waitcnt lgkmcnt(3)
    ds_read_b128 a[216:219], v46 offset:53248
    ds_read_b128 a[220:223], v47 offset:53248
    v_exp_f32 v93, v93
    v_exp_f32 v94, v94
    v_mfma_f32_16x16x32_bf16 v[116:119], a[200:203], v[164:167], v[116:119]
    s_waitcnt lgkmcnt(4)
    v_exp_f32 v95, v95
    v_cvt_pk_bf16_f32 v84, v84, v85
    v_cvt_pk_bf16_f32 v85, v86, v87
    v_cvt_pk_bf16_f32 v86, v92, v93
    v_cvt_pk_bf16_f32 v87, v94, v95
    v_mfma_f32_16x16x32_bf16 v[116:119], a[204:207], v[172:175], v[116:119]
    s_waitcnt lgkmcnt(3)
    ds_read_b128 a[192:195], v44 offset:57344
    ds_read_b128 a[196:199], v45 offset:57344
    v_exp_f32 v100, v100
    v_exp_f32 v101, v101
    v_mfma_f32_16x16x32_bf16 v[124:127], a[208:211], v[148:151], v[76:79]
    s_waitcnt lgkmcnt(4)
    v_exp_f32 v102, v102
    v_exp_f32 v103, v103
    v_exp_f32 v108, v108
    v_mfma_f32_16x16x32_bf16 v[124:127], a[212:215], v[156:159], v[124:127]
    s_waitcnt lgkmcnt(3)
    ds_read_b128 a[200:203], v46 offset:57344
    ds_read_b128 a[204:207], v47 offset:57344
    v_exp_f32 v109, v109
    v_exp_f32 v110, v110
    v_mfma_f32_16x16x32_bf16 v[124:127], a[216:219], v[164:167], v[124:127]
    s_waitcnt lgkmcnt(4)
    v_exp_f32 v111, v111
    v_cvt_pk_bf16_f32 v100, v100, v101
    v_cvt_pk_bf16_f32 v101, v102, v103
    v_cvt_pk_bf16_f32 v102, v108, v109
    v_cvt_pk_bf16_f32 v103, v110, v111
    v_mfma_f32_16x16x32_bf16 v[124:127], a[220:223], v[172:175], v[124:127]
    s_waitcnt lgkmcnt(3)
    ds_read_b128 a[208:211], v44 offset:61440
    ds_read_b128 a[212:215], v45 offset:61440
    v_mfma_f32_16x16x32_bf16 v[132:135], a[192:195], v[148:151], v[76:79]
    s_waitcnt lgkmcnt(4)
    v_mfma_f32_16x16x32_bf16 v[132:135], a[196:199], v[156:159], v[132:135]
    s_waitcnt lgkmcnt(3)
    ds_read_b128 a[216:219], v46 offset:61440
    ds_read_b128 a[220:223], v47 offset:61440
    v_mfma_f32_16x16x32_bf16 v[132:135], a[200:203], v[164:167], v[132:135]
    s_waitcnt lgkmcnt(4)
    v_mfma_f32_16x16x32_bf16 v[132:135], a[204:207], v[172:175], v[132:135]
    s_waitcnt lgkmcnt(3)
    v_mfma_f32_16x16x32_bf16 v[140:143], a[208:211], v[148:151], v[76:79]
    s_waitcnt lgkmcnt(2)
    s_waitcnt vmcnt(21)
    s_barrier
    ds_read_b64_tr_b16 a[192:193], v36 offset:16384
    ds_read_b64_tr_b16 a[194:195], v36 offset:20480
    s_add_u32 m0, s37, 65536
    s_add_u32 s42, s39, 114688
    buffer_load_dwordx4 v60, s[12:15], s42 offen offset:0 nt lds
    v_mfma_f32_16x16x32_bf16 v[140:143], a[212:215], v[156:159], v[140:143]
    s_waitcnt lgkmcnt(3)
    ds_read_b64_tr_b16 a[196:197], v37 offset:16384
    ds_read_b64_tr_b16 a[198:199], v37 offset:20480
    buffer_load_dwordx4 v61, s[12:15], s42 offen offset:1024 nt lds
    v_mfma_f32_16x16x32_bf16 v[140:143], a[216:219], v[164:167], v[140:143]
    s_waitcnt lgkmcnt(4)
    ds_read_b64_tr_b16 a[200:201], v38 offset:16384
    ds_read_b64_tr_b16 a[202:203], v38 offset:20480
    buffer_load_dwordx4 v60, s[12:15], s42 offen offset:2048 nt lds
    v_mfma_f32_16x16x32_bf16 v[140:143], a[220:223], v[172:175], v[140:143]
    ds_read_b64_tr_b16 a[204:205], v39 offset:16384
    ds_read_b64_tr_b16 a[206:207], v39 offset:20480
    buffer_load_dwordx4 v61, s[12:15], s42 offen offset:3072 nt lds
    v_mfma_f32_16x16x32_bf16 v[68:71], a[224:227], v[84:87], v[68:71]
    s_waitcnt lgkmcnt(6)
    ds_read_b64_tr_b16 a[208:209], v40 offset:16384
    ds_read_b64_tr_b16 a[210:211], v40 offset:20480
    v_mfma_f32_16x16x32_bf16 a[128:131], a[192:195], v[84:87], a[128:131]
    s_waitcnt lgkmcnt(6)
    ds_read_b64_tr_b16 a[212:213], v41 offset:16384
    ds_read_b64_tr_b16 a[214:215], v41 offset:20480
    v_mfma_f32_16x16x32_bf16 a[136:139], a[196:199], v[84:87], a[136:139]
    s_waitcnt lgkmcnt(6)
    ds_read_b64_tr_b16 a[216:217], v42 offset:16384
    ds_read_b64_tr_b16 a[218:219], v42 offset:20480
    v_max3_f32 v19, v116, v117, v118
    v_max3_f32 v19, v19, v119, v124
    v_max3_f32 v19, v19, v125, v126
    v_max3_f32 v19, v19, v127, v132
    v_mfma_f32_16x16x32_bf16 a[144:147], a[200:203], v[84:87], a[144:147]
    s_waitcnt lgkmcnt(6)
    ds_read_b64_tr_b16 a[220:221], v43 offset:16384
    ds_read_b64_tr_b16 a[222:223], v43 offset:20480
    v_max3_f32 v19, v19, v133, v134
    v_max3_f32 v19, v19, v135, v140
    v_max3_f32 v19, v19, v141, v142
    v_max_f32 v19, v19, v143
    v_mfma_f32_16x16x32_bf16 a[152:155], a[204:207], v[84:87], a[152:155]
    s_waitcnt lgkmcnt(6)
    v_cmp_lt_f32 vcc, s47, v19
    v_mfma_f32_16x16x32_bf16 a[160:163], a[208:211], v[84:87], a[160:163]
    s_waitcnt lgkmcnt(4)
    ds_read_b64_tr_b16 a[192:193], v36 offset:24576
    ds_read_b64_tr_b16 a[194:195], v36 offset:28672
    v_mfma_f32_16x16x32_bf16 a[168:171], a[212:215], v[84:87], a[168:171]
    s_waitcnt lgkmcnt(4)
    ds_read_b64_tr_b16 a[196:197], v37 offset:24576
    ds_read_b64_tr_b16 a[198:199], v37 offset:28672
    v_mfma_f32_16x16x32_bf16 a[176:179], a[216:219], v[84:87], a[176:179]
    s_waitcnt lgkmcnt(4)
    ds_read_b64_tr_b16 a[200:201], v38 offset:24576
    ds_read_b64_tr_b16 a[202:203], v38 offset:28672
    v_mfma_f32_16x16x32_bf16 a[184:187], a[220:223], v[84:87], a[184:187]
    ds_read_b64_tr_b16 a[204:205], v39 offset:24576
    ds_read_b64_tr_b16 a[206:207], v39 offset:28672
    v_mfma_f32_16x16x32_bf16 v[68:71], a[224:227], v[100:103], v[68:71]
    s_waitcnt lgkmcnt(6)
    ds_read_b64_tr_b16 a[208:209], v40 offset:24576
    ds_read_b64_tr_b16 a[210:211], v40 offset:28672
    v_mfma_f32_16x16x32_bf16 a[128:131], a[192:195], v[100:103], a[128:131]
    s_waitcnt lgkmcnt(6)
    ds_read_b64_tr_b16 a[212:213], v41 offset:24576
    ds_read_b64_tr_b16 a[214:215], v41 offset:28672
    v_mfma_f32_16x16x32_bf16 a[136:139], a[196:199], v[100:103], a[136:139]
    s_waitcnt lgkmcnt(6)
    ds_read_b64_tr_b16 a[216:217], v42 offset:24576
    ds_read_b64_tr_b16 a[218:219], v42 offset:28672
    v_mfma_f32_16x16x32_bf16 a[144:147], a[200:203], v[100:103], a[144:147]
    s_waitcnt lgkmcnt(6)
    ds_read_b64_tr_b16 a[220:221], v43 offset:24576
    ds_read_b64_tr_b16 a[222:223], v43 offset:28672
    v_mfma_f32_16x16x32_bf16 a[152:155], a[204:207], v[100:103], a[152:155]
    s_waitcnt lgkmcnt(6)
    s_waitcnt vmcnt(20)
    s_barrier
    ds_read_b128 a[192:195], v48 offset:49152
    ds_read_b128 a[196:199], v49 offset:49152
    s_add_u32 m0, s37, 98304
    s_add_u32 s42, s39, 147456
    buffer_load_dwordx4 v56, s[8:11], s42 offen offset:0 nt lds
    v_mfma_f32_16x16x32_bf16 a[160:163], a[208:211], v[100:103], a[160:163]
    s_waitcnt lgkmcnt(6)
    buffer_load_dwordx4 v57, s[8:11], s42 offen offset:1024 nt lds
    v_mfma_f32_16x16x32_bf16 a[168:171], a[212:215], v[100:103], a[168:171]
    s_waitcnt lgkmcnt(4)
    ds_read_b128 a[200:203], v50 offset:49152
    ds_read_b128 a[204:207], v51 offset:49152
    buffer_load_dwordx4 v58, s[8:11], s42 offen offset:2048 nt lds
    v_mfma_f32_16x16x32_bf16 a[176:179], a[216:219], v[100:103], a[176:179]
    s_waitcnt lgkmcnt(4)
    buffer_load_dwordx4 v59, s[8:11], s42 offen offset:3072 nt lds
    v_mfma_f32_16x16x32_bf16 a[184:187], a[220:223], v[100:103], a[184:187]
    s_cbranch_vccnz w1_t5_slow
w1_t5_back:
    s_waitcnt lgkmcnt(3)
    ds_read_b128 a[208:211], v48 offset:53248
    ds_read_b128 a[212:215], v49 offset:53248
    v_exp_f32 v116, v116
    v_exp_f32 v117, v117
    v_mfma_f32_16x16x32_bf16 v[84:87], a[192:195], v[148:151], v[76:79]
    s_waitcnt lgkmcnt(4)
    v_exp_f32 v118, v118
    v_exp_f32 v119, v119
    v_exp_f32 v124, v124
    v_mfma_f32_16x16x32_bf16 v[84:87], a[196:199], v[156:159], v[84:87]
    s_waitcnt lgkmcnt(3)
    ds_read_b128 a[216:219], v50 offset:53248
    ds_read_b128 a[220:223], v51 offset:53248
    v_exp_f32 v125, v125
    v_exp_f32 v126, v126
    v_mfma_f32_16x16x32_bf16 v[84:87], a[200:203], v[164:167], v[84:87]
    s_waitcnt lgkmcnt(4)
    v_exp_f32 v127, v127
    v_cvt_pk_bf16_f32 v116, v116, v117
    v_cvt_pk_bf16_f32 v117, v118, v119
    v_cvt_pk_bf16_f32 v118, v124, v125
    v_cvt_pk_bf16_f32 v119, v126, v127
    v_mfma_f32_16x16x32_bf16 v[84:87], a[204:207], v[172:175], v[84:87]
    s_waitcnt lgkmcnt(3)
    ds_read_b128 a[192:195], v48 offset:57344
    ds_read_b128 a[196:199], v49 offset:57344
    v_exp_f32 v132, v132
    v_exp_f32 v133, v133
    v_mfma_f32_16x16x32_bf16 v[92:95], a[208:211], v[148:151], v[76:79]
    s_waitcnt lgkmcnt(4)
    v_exp_f32 v134, v134
    v_exp_f32 v135, v135
    v_exp_f32 v140, v140
    v_mfma_f32_16x16x32_bf16 v[92:95], a[212:215], v[156:159], v[92:95]
    s_waitcnt lgkmcnt(3)
    ds_read_b128 a[200:203], v50 offset:57344
    ds_read_b128 a[204:207], v51 offset:57344
    v_exp_f32 v141, v141
    v_exp_f32 v142, v142
    v_mfma_f32_16x16x32_bf16 v[92:95], a[216:219], v[164:167], v[92:95]
    s_waitcnt lgkmcnt(4)
    v_exp_f32 v143, v143
    v_cvt_pk_bf16_f32 v132, v132, v133
    v_cvt_pk_bf16_f32 v133, v134, v135
    v_cvt_pk_bf16_f32 v134, v140, v141
    v_cvt_pk_bf16_f32 v135, v142, v143
    v_mfma_f32_16x16x32_bf16 v[92:95], a[220:223], v[172:175], v[92:95]
    s_waitcnt lgkmcnt(3)
    ds_read_b128 a[208:211], v48 offset:61440
    ds_read_b128 a[212:215], v49 offset:61440
    v_mfma_f32_16x16x32_bf16 v[100:103], a[192:195], v[148:151], v[76:79]
    s_waitcnt lgkmcnt(4)
    v_mfma_f32_16x16x32_bf16 v[100:103], a[196:199], v[156:159], v[100:103]
    s_waitcnt lgkmcnt(3)
    ds_read_b128 a[216:219], v50 offset:61440
    ds_read_b128 a[220:223], v51 offset:61440
    v_mfma_f32_16x16x32_bf16 v[100:103], a[200:203], v[164:167], v[100:103]
    s_waitcnt lgkmcnt(4)
    v_mfma_f32_16x16x32_bf16 v[100:103], a[204:207], v[172:175], v[100:103]
    s_waitcnt lgkmcnt(3)
    v_mfma_f32_16x16x32_bf16 v[108:111], a[208:211], v[148:151], v[76:79]
    s_waitcnt lgkmcnt(2)
    s_waitcnt vmcnt(20)
    s_barrier
    ds_read_b64_tr_b16 a[192:193], v20 offset:16384
    ds_read_b64_tr_b16 a[194:195], v20 offset:20480
    s_add_u32 m0, s37, 131072
    s_add_u32 s42, s39, 131072
    buffer_load_dwordx4 v60, s[12:15], s42 offen offset:0 nt lds
    v_mfma_f32_16x16x32_bf16 v[108:111], a[212:215], v[156:159], v[108:111]
    s_waitcnt lgkmcnt(3)
    ds_read_b64_tr_b16 a[196:197], v21 offset:16384
    ds_read_b64_tr_b16 a[198:199], v21 offset:20480
    buffer_load_dwordx4 v61, s[12:15], s42 offen offset:1024 nt lds
    v_mfma_f32_16x16x32_bf16 v[108:111], a[216:219], v[164:167], v[108:111]
    s_waitcnt lgkmcnt(4)
    ds_read_b64_tr_b16 a[200:201], v22 offset:16384
    ds_read_b64_tr_b16 a[202:203], v22 offset:20480
    buffer_load_dwordx4 v60, s[12:15], s42 offen offset:2048 nt lds
    v_mfma_f32_16x16x32_bf16 v[108:111], a[220:223], v[172:175], v[108:111]
    ds_read_b64_tr_b16 a[204:205], v23 offset:16384
    ds_read_b64_tr_b16 a[206:207], v23 offset:20480
    buffer_load_dwordx4 v61, s[12:15], s42 offen offset:3072 nt lds
    v_mfma_f32_16x16x32_bf16 v[68:71], a[224:227], v[116:119], v[68:71]
    s_waitcnt lgkmcnt(6)
    ds_read_b64_tr_b16 a[208:209], v24 offset:16384
    ds_read_b64_tr_b16 a[210:211], v24 offset:20480
    v_mfma_f32_16x16x32_bf16 a[128:131], a[192:195], v[116:119], a[128:131]
    s_waitcnt lgkmcnt(6)
    ds_read_b64_tr_b16 a[212:213], v25 offset:16384
    ds_read_b64_tr_b16 a[214:215], v25 offset:20480
    v_mfma_f32_16x16x32_bf16 a[136:139], a[196:199], v[116:119], a[136:139]
    s_waitcnt lgkmcnt(6)
    ds_read_b64_tr_b16 a[216:217], v26 offset:16384
    ds_read_b64_tr_b16 a[218:219], v26 offset:20480
    v_max3_f32 v19, v84, v85, v86
    v_max3_f32 v19, v19, v87, v92
    v_max3_f32 v19, v19, v93, v94
    v_max3_f32 v19, v19, v95, v100
    v_mfma_f32_16x16x32_bf16 a[144:147], a[200:203], v[116:119], a[144:147]
    s_waitcnt lgkmcnt(6)
    ds_read_b64_tr_b16 a[220:221], v27 offset:16384
    ds_read_b64_tr_b16 a[222:223], v27 offset:20480
    v_max3_f32 v19, v19, v101, v102
    v_max3_f32 v19, v19, v103, v108
    v_max3_f32 v19, v19, v109, v110
    v_max_f32 v19, v19, v111
    v_mfma_f32_16x16x32_bf16 a[152:155], a[204:207], v[116:119], a[152:155]
    s_waitcnt lgkmcnt(6)
    v_cmp_lt_f32 vcc, s47, v19
    v_mfma_f32_16x16x32_bf16 a[160:163], a[208:211], v[116:119], a[160:163]
    s_waitcnt lgkmcnt(4)
    ds_read_b64_tr_b16 a[192:193], v20 offset:24576
    ds_read_b64_tr_b16 a[194:195], v20 offset:28672
    v_mfma_f32_16x16x32_bf16 a[168:171], a[212:215], v[116:119], a[168:171]
    s_waitcnt lgkmcnt(4)
    ds_read_b64_tr_b16 a[196:197], v21 offset:24576
    ds_read_b64_tr_b16 a[198:199], v21 offset:28672
    v_mfma_f32_16x16x32_bf16 a[176:179], a[216:219], v[116:119], a[176:179]
    s_waitcnt lgkmcnt(4)
    ds_read_b64_tr_b16 a[200:201], v22 offset:24576
    ds_read_b64_tr_b16 a[202:203], v22 offset:28672
    v_mfma_f32_16x16x32_bf16 a[184:187], a[220:223], v[116:119], a[184:187]
    ds_read_b64_tr_b16 a[204:205], v23 offset:24576
    ds_read_b64_tr_b16 a[206:207], v23 offset:28672
    v_mfma_f32_16x16x32_bf16 v[68:71], a[224:227], v[132:135], v[68:71]
    s_waitcnt lgkmcnt(6)
    ds_read_b64_tr_b16 a[208:209], v24 offset:24576
    ds_read_b64_tr_b16 a[210:211], v24 offset:28672
    v_mfma_f32_16x16x32_bf16 a[128:131], a[192:195], v[132:135], a[128:131]
    s_waitcnt lgkmcnt(6)
    ds_read_b64_tr_b16 a[212:213], v25 offset:24576
    ds_read_b64_tr_b16 a[214:215], v25 offset:28672
    v_mfma_f32_16x16x32_bf16 a[136:139], a[196:199], v[132:135], a[136:139]
    s_waitcnt lgkmcnt(6)
    ds_read_b64_tr_b16 a[216:217], v26 offset:24576
    ds_read_b64_tr_b16 a[218:219], v26 offset:28672
    v_mfma_f32_16x16x32_bf16 a[144:147], a[200:203], v[132:135], a[144:147]
    s_waitcnt lgkmcnt(6)
    ds_read_b64_tr_b16 a[220:221], v27 offset:24576
    ds_read_b64_tr_b16 a[222:223], v27 offset:28672
    v_mfma_f32_16x16x32_bf16 a[152:155], a[204:207], v[132:135], a[152:155]
    s_waitcnt lgkmcnt(6)
    s_waitcnt vmcnt(20)
    s_barrier
    ds_read_b128 a[192:195], v48 offset:16384
    ds_read_b128 a[196:199], v49 offset:16384
    v_mfma_f32_16x16x32_bf16 a[160:163], a[208:211], v[132:135], a[160:163]
    s_waitcnt lgkmcnt(6)
    v_mfma_f32_16x16x32_bf16 a[168:171], a[212:215], v[132:135], a[168:171]
    s_waitcnt lgkmcnt(4)
    ds_read_b128 a[200:203], v50 offset:16384
    ds_read_b128 a[204:207], v51 offset:16384
    v_mfma_f32_16x16x32_bf16 a[176:179], a[216:219], v[132:135], a[176:179]
    s_waitcnt lgkmcnt(4)
    v_mfma_f32_16x16x32_bf16 a[184:187], a[220:223], v[132:135], a[184:187]
    s_cbranch_vccnz w1_t6_slow
w1_t6_back:
    s_waitcnt lgkmcnt(3)
    ds_read_b128 a[208:211], v48 offset:20480
    ds_read_b128 a[212:215], v49 offset:20480
    v_exp_f32 v84, v84
    v_exp_f32 v85, v85
    v_mfma_f32_16x16x32_bf16 v[116:119], a[192:195], v[148:151], v[76:79]
    s_waitcnt lgkmcnt(4)
    v_exp_f32 v86, v86
    v_exp_f32 v87, v87
    v_exp_f32 v92, v92
    v_mfma_f32_16x16x32_bf16 v[116:119], a[196:199], v[156:159], v[116:119]
    s_waitcnt lgkmcnt(3)
    ds_read_b128 a[216:219], v50 offset:20480
    ds_read_b128 a[220:223], v51 offset:20480
    v_exp_f32 v93, v93
    v_exp_f32 v94, v94
    v_mfma_f32_16x16x32_bf16 v[116:119], a[200:203], v[164:167], v[116:119]
    s_waitcnt lgkmcnt(4)
    v_exp_f32 v95, v95
    v_cvt_pk_bf16_f32 v84, v84, v85
    v_cvt_pk_bf16_f32 v85, v86, v87
    v_cvt_pk_bf16_f32 v86, v92, v93
    v_cvt_pk_bf16_f32 v87, v94, v95
    v_mfma_f32_16x16x32_bf16 v[116:119], a[204:207], v[172:175], v[116:119]
    s_waitcnt lgkmcnt(3)
    ds_read_b128 a[192:195], v48 offset:24576
    ds_read_b128 a[196:199], v49 offset:24576
    v_exp_f32 v100, v100
    v_exp_f32 v101, v101
    v_mfma_f32_16x16x32_bf16 v[124:127], a[208:211], v[148:151], v[76:79]
    s_waitcnt lgkmcnt(4)
    v_exp_f32 v102, v102
    v_exp_f32 v103, v103
    v_exp_f32 v108, v108
    v_mfma_f32_16x16x32_bf16 v[124:127], a[212:215], v[156:159], v[124:127]
    s_waitcnt lgkmcnt(3)
    ds_read_b128 a[200:203], v50 offset:24576
    ds_read_b128 a[204:207], v51 offset:24576
    v_exp_f32 v109, v109
    v_exp_f32 v110, v110
    v_mfma_f32_16x16x32_bf16 v[124:127], a[216:219], v[164:167], v[124:127]
    s_waitcnt lgkmcnt(4)
    v_exp_f32 v111, v111
    v_cvt_pk_bf16_f32 v100, v100, v101
    v_cvt_pk_bf16_f32 v101, v102, v103
    v_cvt_pk_bf16_f32 v102, v108, v109
    v_cvt_pk_bf16_f32 v103, v110, v111
    v_mfma_f32_16x16x32_bf16 v[124:127], a[220:223], v[172:175], v[124:127]
    s_waitcnt lgkmcnt(3)
    ds_read_b128 a[208:211], v48 offset:28672
    ds_read_b128 a[212:215], v49 offset:28672
    v_mfma_f32_16x16x32_bf16 v[132:135], a[192:195], v[148:151], v[76:79]
    s_waitcnt lgkmcnt(4)
    v_mfma_f32_16x16x32_bf16 v[132:135], a[196:199], v[156:159], v[132:135]
    s_waitcnt lgkmcnt(3)
    ds_read_b128 a[216:219], v50 offset:28672
    ds_read_b128 a[220:223], v51 offset:28672
    v_mfma_f32_16x16x32_bf16 v[132:135], a[200:203], v[164:167], v[132:135]
    s_waitcnt lgkmcnt(4)
    v_mfma_f32_16x16x32_bf16 v[132:135], a[204:207], v[172:175], v[132:135]
    s_waitcnt lgkmcnt(3)
    v_mfma_f32_16x16x32_bf16 v[140:143], a[208:211], v[148:151], v[76:79]
    s_waitcnt lgkmcnt(2)
    s_waitcnt vmcnt(16)
    s_barrier
    global_load_dword v7, v67, s[88:89]
    ds_read_b64_tr_b16 a[192:193], v20 offset:0
    ds_read_b64_tr_b16 a[194:195], v20 offset:4096
    s_add_u32 m0, s37, 49152
    s_add_u32 s42, s39, 163840
    buffer_load_dwordx4 v56, s[8:11], s42 offen offset:0 nt lds
    v_mfma_f32_16x16x32_bf16 v[140:143], a[212:215], v[156:159], v[140:143]
    s_waitcnt lgkmcnt(3)
    ds_read_b64_tr_b16 a[196:197], v21 offset:0
    ds_read_b64_tr_b16 a[198:199], v21 offset:4096
    buffer_load_dwordx4 v57, s[8:11], s42 offen offset:1024 nt lds
    v_mfma_f32_16x16x32_bf16 v[140:143], a[216:219], v[164:167], v[140:143]
    s_waitcnt lgkmcnt(4)
    ds_read_b64_tr_b16 a[200:201], v22 offset:0
    ds_read_b64_tr_b16 a[202:203], v22 offset:4096
    buffer_load_dwordx4 v58, s[8:11], s42 offen offset:2048 nt lds
    v_mfma_f32_16x16x32_bf16 v[140:143], a[220:223], v[172:175], v[140:143]
    ds_read_b64_tr_b16 a[204:205], v23 offset:0
    ds_read_b64_tr_b16 a[206:207], v23 offset:4096
    buffer_load_dwordx4 v59, s[8:11], s42 offen offset:3072 nt lds
    v_mfma_f32_16x16x32_bf16 v[68:71], a[224:227], v[84:87], v[68:71]
    s_waitcnt lgkmcnt(6)
    ds_read_b64_tr_b16 a[208:209], v24 offset:0
    ds_read_b64_tr_b16 a[210:211], v24 offset:4096
    v_mfma_f32_16x16x32_bf16 a[128:131], a[192:195], v[84:87], a[128:131]
    s_waitcnt lgkmcnt(6)
    ds_read_b64_tr_b16 a[212:213], v25 offset:0
    ds_read_b64_tr_b16 a[214:215], v25 offset:4096
    v_mfma_f32_16x16x32_bf16 a[136:139], a[196:199], v[84:87], a[136:139]
    s_waitcnt lgkmcnt(6)
    ds_read_b64_tr_b16 a[216:217], v26 offset:0
    ds_read_b64_tr_b16 a[218:219], v26 offset:4096
    v_max3_f32 v19, v116, v117, v118
    v_max3_f32 v19, v19, v119, v124
    v_max3_f32 v19, v19, v125, v126
    v_max3_f32 v19, v19, v127, v132
    v_mfma_f32_16x16x32_bf16 a[144:147], a[200:203], v[84:87], a[144:147]
    s_waitcnt lgkmcnt(6)
    ds_read_b64_tr_b16 a[220:221], v27 offset:0
    ds_read_b64_tr_b16 a[222:223], v27 offset:4096
    v_max3_f32 v19, v19, v133, v134
    v_max3_f32 v19, v19, v135, v140
    v_max3_f32 v19, v19, v141, v142
    v_max_f32 v19, v19, v143
    v_mfma_f32_16x16x32_bf16 a[152:155], a[204:207], v[84:87], a[152:155]
    s_waitcnt lgkmcnt(6)
    v_cmp_lt_f32 vcc, s47, v19
    v_mfma_f32_16x16x32_bf16 a[160:163], a[208:211], v[84:87], a[160:163]
    s_waitcnt lgkmcnt(4)
    ds_read_b64_tr_b16 a[192:193], v20 offset:8192
    ds_read_b64_tr_b16 a[194:195], v20 offset:12288
    v_mfma_f32_16x16x32_bf16 a[168:171], a[212:215], v[84:87], a[168:171]
    s_waitcnt lgkmcnt(4)
    ds_read_b64_tr_b16 a[196:197], v21 offset:8192
    ds_read_b64_tr_b16 a[198:199], v21 offset:12288
    v_mfma_f32_16x16x32_bf16 a[176:179], a[216:219], v[84:87], a[176:179]
    s_waitcnt lgkmcnt(4)
    ds_read_b64_tr_b16 a[200:201], v22 offset:8192
    ds_read_b64_tr_b16 a[202:203], v22 offset:12288
    v_mfma_f32_16x16x32_bf16 a[184:187], a[220:223], v[84:87], a[184:187]
    ds_read_b64_tr_b16 a[204:205], v23 offset:8192
    ds_read_b64_tr_b16 a[206:207], v23 offset:12288
    v_mfma_f32_16x16x32_bf16 v[68:71], a[224:227], v[100:103], v[68:71]
    s_waitcnt lgkmcnt(6)
    ds_read_b64_tr_b16 a[208:209], v24 offset:8192
    ds_read_b64_tr_b16 a[210:211], v24 offset:12288
    v_mfma_f32_16x16x32_bf16 a[128:131], a[192:195], v[100:103], a[128:131]
    s_waitcnt lgkmcnt(6)
    ds_read_b64_tr_b16 a[212:213], v25 offset:8192
    ds_read_b64_tr_b16 a[214:215], v25 offset:12288
    v_mfma_f32_16x16x32_bf16 a[136:139], a[196:199], v[100:103], a[136:139]
    s_waitcnt lgkmcnt(6)
    ds_read_b64_tr_b16 a[216:217], v26 offset:8192
    ds_read_b64_tr_b16 a[218:219], v26 offset:12288
    v_mfma_f32_16x16x32_bf16 a[144:147], a[200:203], v[100:103], a[144:147]
    s_waitcnt lgkmcnt(6)
    ds_read_b64_tr_b16 a[220:221], v27 offset:8192
    ds_read_b64_tr_b16 a[222:223], v27 offset:12288
    v_mfma_f32_16x16x32_bf16 a[152:155], a[204:207], v[100:103], a[152:155]
    s_waitcnt lgkmcnt(6)
    s_waitcnt vmcnt(17)
    s_barrier
    ds_read_b128 a[192:195], v44 offset:32768
    ds_read_b128 a[196:199], v45 offset:32768
    s_add_u32 m0, s37, 147456
    s_add_u32 s42, s39, 147456
    buffer_load_dwordx4 v60, s[12:15], s42 offen offset:0 nt lds
    v_mfma_f32_16x16x32_bf16 a[160:163], a[208:211], v[100:103], a[160:163]
    s_waitcnt lgkmcnt(6)
    buffer_load_dwordx4 v61, s[12:15], s42 offen offset:1024 nt lds
    v_mfma_f32_16x16x32_bf16 a[168:171], a[212:215], v[100:103], a[168:171]
    s_waitcnt lgkmcnt(4)
    ds_read_b128 a[200:203], v46 offset:32768
    ds_read_b128 a[204:207], v47 offset:32768
    buffer_load_dwordx4 v60, s[12:15], s42 offen offset:2048 nt lds
    v_mfma_f32_16x16x32_bf16 a[176:179], a[216:219], v[100:103], a[176:179]
    s_waitcnt lgkmcnt(4)
    buffer_load_dwordx4 v61, s[12:15], s42 offen offset:3072 nt lds
    v_mfma_f32_16x16x32_bf16 a[184:187], a[220:223], v[100:103], a[184:187]
    s_cbranch_vccnz w1_t7_slow
w1_t7_back:
    s_waitcnt lgkmcnt(3)
    ds_read_b128 a[208:211], v44 offset:36864
    ds_read_b128 a[212:215], v45 offset:36864
    v_exp_f32 v116, v116
    v_exp_f32 v117, v117
    v_mfma_f32_16x16x32_bf16 v[84:87], a[192:195], v[180:183], 0
    s_waitcnt lgkmcnt(4)
    v_exp_f32 v118, v118
    v_exp_f32 v119, v119
    v_exp_f32 v124, v124
    v_mfma_f32_16x16x32_bf16 v[84:87], a[196:199], v[196:199], v[84:87]
    s_waitcnt lgkmcnt(3)
    ds_read_b128 a[216:219], v46 offset:36864
    ds_read_b128 a[220:223], v47 offset:36864
    v_exp_f32 v125, v125
    v_exp_f32 v126, v126
    v_mfma_f32_16x16x32_bf16 v[84:87], a[200:203], v[212:215], v[84:87]
    s_waitcnt lgkmcnt(4)
    v_exp_f32 v127, v127
    v_cvt_pk_bf16_f32 v116, v116, v117
    v_cvt_pk_bf16_f32 v117, v118, v119
    v_cvt_pk_bf16_f32 v118, v124, v125
    v_cvt_pk_bf16_f32 v119, v126, v127
    v_mfma_f32_16x16x32_bf16 v[84:87], a[204:207], v[228:231], v[84:87]
    s_waitcnt lgkmcnt(3)
    ds_read_b128 a[192:195], v44 offset:40960
    ds_read_b128 a[196:199], v45 offset:40960
    v_exp_f32 v132, v132
    v_exp_f32 v133, v133
    v_mfma_f32_16x16x32_bf16 v[92:95], a[208:211], v[180:183], 0
    s_waitcnt lgkmcnt(4)
    v_exp_f32 v134, v134
    v_exp_f32 v135, v135
    v_exp_f32 v140, v140
    v_mfma_f32_16x16x32_bf16 v[92:95], a[212:215], v[196:199], v[92:95]
    s_waitcnt lgkmcnt(3)
    ds_read_b128 a[200:203], v46 offset:40960
    ds_read_b128 a[204:207], v47 offset:40960
    v_exp_f32 v141, v141
    v_exp_f32 v142, v142
    v_mfma_f32_16x16x32_bf16 v[92:95], a[216:219], v[212:215], v[92:95]
    s_waitcnt lgkmcnt(4)
    v_exp_f32 v143, v143
    v_cvt_pk_bf16_f32 v132, v132, v133
    v_cvt_pk_bf16_f32 v133, v134, v135
    v_cvt_pk_bf16_f32 v134, v140, v141
    v_cvt_pk_bf16_f32 v135, v142, v143
    v_mfma_f32_16x16x32_bf16 v[92:95], a[220:223], v[228:231], v[92:95]
    s_waitcnt lgkmcnt(3)
    ds_read_b128 a[208:211], v44 offset:45056
    ds_read_b128 a[212:215], v45 offset:45056
    v_mfma_f32_16x16x32_bf16 v[100:103], a[192:195], v[180:183], 0
    s_waitcnt lgkmcnt(4)
    v_mfma_f32_16x16x32_bf16 v[100:103], a[196:199], v[196:199], v[100:103]
    s_waitcnt lgkmcnt(3)
    ds_read_b128 a[216:219], v46 offset:45056
    ds_read_b128 a[220:223], v47 offset:45056
    v_mfma_f32_16x16x32_bf16 v[100:103], a[200:203], v[212:215], v[100:103]
    s_waitcnt lgkmcnt(4)
    v_mfma_f32_16x16x32_bf16 v[100:103], a[204:207], v[228:231], v[100:103]
    s_waitcnt lgkmcnt(3)
    v_mfma_f32_16x16x32_bf16 v[108:111], a[208:211], v[180:183], 0
    s_waitcnt lgkmcnt(2)
    s_waitcnt vmcnt(17)
    s_barrier
    ds_read_b64_tr_b16 a[192:193], v28 offset:0
    ds_read_b64_tr_b16 a[194:195], v28 offset:4096
    s_add_u32 m0, s37, 114688
    s_add_u32 s42, s39, 180224
    buffer_load_dwordx4 v56, s[8:11], s42 offen offset:0 nt lds
    v_mfma_f32_16x16x32_bf16 v[108:111], a[212:215], v[196:199], v[108:111]
    s_waitcnt lgkmcnt(3)
    ds_read_b64_tr_b16 a[196:197], v29 offset:0
    ds_read_b64_tr_b16 a[198:199], v29 offset:4096
    buffer_load_dwordx4 v57, s[8:11], s42 offen offset:1024 nt lds
    v_mfma_f32_16x16x32_bf16 v[108:111], a[216:219], v[212:215], v[108:111]
    s_waitcnt lgkmcnt(4)
    ds_read_b64_tr_b16 a[200:201], v30 offset:0
    ds_read_b64_tr_b16 a[202:203], v30 offset:4096
    buffer_load_dwordx4 v58, s[8:11], s42 offen offset:2048 nt lds
    v_mfma_f32_16x16x32_bf16 v[108:111], a[220:223], v[228:231], v[108:111]
    ds_read_b64_tr_b16 a[204:205], v31 offset:0
    ds_read_b64_tr_b16 a[206:207], v31 offset:4096
    buffer_load_dwordx4 v59, s[8:11], s42 offen offset:3072 nt lds
    v_mfma_f32_16x16x32_bf16 v[68:71], a[224:227], v[116:119], v[68:71]
    s_waitcnt lgkmcnt(6)
    ds_read_b64_tr_b16 a[208:209], v32 offset:0
    ds_read_b64_tr_b16 a[210:211], v32 offset:4096
    v_mfma_f32_16x16x32_bf16 a[128:131], a[192:195], v[116:119], a[128:131]
    s_waitcnt lgkmcnt(6)
    ds_read_b64_tr_b16 a[212:213], v33 offset:0
    ds_read_b64_tr_b16 a[214:215], v33 offset:4096
    v_mfma_f32_16x16x32_bf16 a[136:139], a[196:199], v[116:119], a[136:139]
    s_waitcnt lgkmcnt(6)
    ds_read_b64_tr_b16 a[216:217], v34 offset:0
    ds_read_b64_tr_b16 a[218:219], v34 offset:4096
    v_max3_f32 v1, v84, v85, v86
    v_max3_f32 v1, v1, v87, v92
    v_max3_f32 v1, v1, v93, v94
    v_max3_f32 v1, v1, v95, v100
    v_mfma_f32_16x16x32_bf16 a[144:147], a[200:203], v[116:119], a[144:147]
    s_waitcnt lgkmcnt(6)
    ds_read_b64_tr_b16 a[220:221], v35 offset:0
    ds_read_b64_tr_b16 a[222:223], v35 offset:4096
    v_max3_f32 v1, v1, v101, v102
    v_max3_f32 v1, v1, v103, v108
    v_max3_f32 v1, v1, v109, v110
    v_max_f32 v1, v1, v111
    v_mfma_f32_16x16x32_bf16 a[152:155], a[204:207], v[116:119], a[152:155]
    s_waitcnt lgkmcnt(6)
    v_mov_b32 v2, v1
    s_nop 1
    v_permlane32_swap_b32 v1, v2
    v_max_f32 v1, v1, v2
    v_mov_b32 v2, v1
    s_nop 1
    v_permlane16_swap_b32 v1, v2
    v_max_f32 v1, v1, v2
    v_mfma_f32_16x16x32_bf16 a[160:163], a[208:211], v[116:119], a[160:163]
    s_waitcnt lgkmcnt(4)
    ds_read_b64_tr_b16 a[192:193], v28 offset:8192
    ds_read_b64_tr_b16 a[194:195], v28 offset:12288
    v_sub_f32 v76, 0, v1
    v_sub_f32 v77, 0, v1
    v_sub_f32 v78, 0, v1
    v_sub_f32 v79, 0, v1
    v_mfma_f32_16x16x32_bf16 a[168:171], a[212:215], v[116:119], a[168:171]
    s_waitcnt lgkmcnt(4)
    ds_read_b64_tr_b16 a[196:197], v29 offset:8192
    ds_read_b64_tr_b16 a[198:199], v29 offset:12288
    v_sub_f32 v84, v84, v1
    v_sub_f32 v85, v85, v1
    v_sub_f32 v86, v86, v1
    v_sub_f32 v87, v87, v1
    v_mfma_f32_16x16x32_bf16 a[176:179], a[216:219], v[116:119], a[176:179]
    s_waitcnt lgkmcnt(4)
    ds_read_b64_tr_b16 a[200:201], v30 offset:8192
    ds_read_b64_tr_b16 a[202:203], v30 offset:12288
    v_sub_f32 v92, v92, v1
    v_sub_f32 v93, v93, v1
    v_sub_f32 v94, v94, v1
    v_sub_f32 v95, v95, v1
    v_mfma_f32_16x16x32_bf16 a[184:187], a[220:223], v[116:119], a[184:187]
    ds_read_b64_tr_b16 a[204:205], v31 offset:8192
    ds_read_b64_tr_b16 a[206:207], v31 offset:12288
    v_sub_f32 v100, v100, v1
    v_sub_f32 v101, v101, v1
    v_sub_f32 v102, v102, v1
    v_sub_f32 v103, v103, v1
    v_mfma_f32_16x16x32_bf16 v[68:71], a[224:227], v[132:135], v[68:71]
    s_waitcnt lgkmcnt(6)
    ds_read_b64_tr_b16 a[208:209], v32 offset:8192
    ds_read_b64_tr_b16 a[210:211], v32 offset:12288
    v_sub_f32 v108, v108, v1
    v_sub_f32 v109, v109, v1
    v_sub_f32 v110, v110, v1
    v_sub_f32 v111, v111, v1
    v_mfma_f32_16x16x32_bf16 a[128:131], a[192:195], v[132:135], a[128:131]
    s_waitcnt lgkmcnt(6)
    ds_read_b64_tr_b16 a[212:213], v33 offset:8192
    ds_read_b64_tr_b16 a[214:215], v33 offset:12288
    v_mfma_f32_16x16x32_bf16 a[136:139], a[196:199], v[132:135], a[136:139]
    s_waitcnt lgkmcnt(6)
    ds_read_b64_tr_b16 a[216:217], v34 offset:8192
    ds_read_b64_tr_b16 a[218:219], v34 offset:12288
    v_mfma_f32_16x16x32_bf16 a[144:147], a[200:203], v[132:135], a[144:147]
    s_waitcnt lgkmcnt(6)
    ds_read_b64_tr_b16 a[220:221], v35 offset:8192
    ds_read_b64_tr_b16 a[222:223], v35 offset:12288
    v_mfma_f32_16x16x32_bf16 a[152:155], a[204:207], v[132:135], a[152:155]
    s_waitcnt lgkmcnt(6)
    s_waitcnt vmcnt(17)
    s_barrier
    ds_read_b128 a[192:195], v48 offset:32768
    ds_read_b128 a[196:199], v49 offset:32768
    s_add_u32 m0, s37, 16384
    s_add_u32 s42, s39, 163840
    buffer_load_dwordx4 v60, s[12:15], s42 offen offset:0 nt lds
    v_mfma_f32_16x16x32_bf16 a[160:163], a[208:211], v[132:135], a[160:163]
    s_waitcnt lgkmcnt(6)
    buffer_load_dwordx4 v61, s[12:15], s42 offen offset:1024 nt lds
    v_mfma_f32_16x16x32_bf16 a[168:171], a[212:215], v[132:135], a[168:171]
    s_waitcnt lgkmcnt(4)
    ds_read_b128 a[200:203], v50 offset:32768
    ds_read_b128 a[204:207], v51 offset:32768
    buffer_load_dwordx4 v60, s[12:15], s42 offen offset:2048 nt lds
    v_mfma_f32_16x16x32_bf16 a[176:179], a[216:219], v[132:135], a[176:179]
    s_waitcnt lgkmcnt(4)
    buffer_load_dwordx4 v61, s[12:15], s42 offen offset:3072 nt lds
    v_mfma_f32_16x16x32_bf16 a[184:187], a[220:223], v[132:135], a[184:187]
    s_waitcnt lgkmcnt(3)
    ds_read_b128 a[208:211], v48 offset:36864
    ds_read_b128 a[212:215], v49 offset:36864
    v_exp_f32 v84, v84
    v_exp_f32 v85, v85
    v_mfma_f32_16x16x32_bf16 v[116:119], a[192:195], v[180:183], v[76:79]
    s_waitcnt lgkmcnt(4)
    v_exp_f32 v86, v86
    v_exp_f32 v87, v87
    v_exp_f32 v92, v92
    v_mfma_f32_16x16x32_bf16 v[116:119], a[196:199], v[196:199], v[116:119]
    s_waitcnt lgkmcnt(3)
    ds_read_b128 a[216:219], v50 offset:36864
    ds_read_b128 a[220:223], v51 offset:36864
    v_exp_f32 v93, v93
    v_exp_f32 v94, v94
    v_mfma_f32_16x16x32_bf16 v[116:119], a[200:203], v[212:215], v[116:119]
    s_waitcnt lgkmcnt(4)
    v_exp_f32 v95, v95
    v_cvt_pk_bf16_f32 v84, v84, v85
    v_cvt_pk_bf16_f32 v85, v86, v87
    v_cvt_pk_bf16_f32 v86, v92, v93
    v_cvt_pk_bf16_f32 v87, v94, v95
    v_mfma_f32_16x16x32_bf16 v[116:119], a[204:207], v[228:231], v[116:119]
    s_waitcnt lgkmcnt(3)
    ds_read_b128 a[192:195], v48 offset:40960
    ds_read_b128 a[196:199], v49 offset:40960
    v_exp_f32 v100, v100
    v_exp_f32 v101, v101
    v_mfma_f32_16x16x32_bf16 v[124:127], a[208:211], v[180:183], v[76:79]
    s_waitcnt lgkmcnt(4)
    v_exp_f32 v102, v102
    v_exp_f32 v103, v103
    v_exp_f32 v108, v108
    v_mfma_f32_16x16x32_bf16 v[124:127], a[212:215], v[196:199], v[124:127]
    s_waitcnt lgkmcnt(3)
    ds_read_b128 a[200:203], v50 offset:40960
    ds_read_b128 a[204:207], v51 offset:40960
    v_exp_f32 v109, v109
    v_exp_f32 v110, v110
    v_mfma_f32_16x16x32_bf16 v[124:127], a[216:219], v[212:215], v[124:127]
    s_waitcnt lgkmcnt(4)
    v_exp_f32 v111, v111
    v_cvt_pk_bf16_f32 v100, v100, v101
    v_cvt_pk_bf16_f32 v101, v102, v103
    v_cvt_pk_bf16_f32 v102, v108, v109
    v_cvt_pk_bf16_f32 v103, v110, v111
    v_mfma_f32_16x16x32_bf16 v[124:127], a[220:223], v[228:231], v[124:127]
    s_waitcnt lgkmcnt(3)
    ds_read_b128 a[208:211], v48 offset:45056
    ds_read_b128 a[212:215], v49 offset:45056
    v_rcp_f32 v17, v68
    v_mfma_f32_16x16x32_bf16 v[132:135], a[192:195], v[180:183], v[76:79]
    s_waitcnt lgkmcnt(4)
    v_accvgpr_read_b32 v244, a128
    v_accvgpr_read_b32 v245, a129
    v_accvgpr_read_b32 v246, a130
    v_accvgpr_read_b32 v247, a131
    v_accvgpr_read_b32 v248, a136
    v_accvgpr_read_b32 v249, a137
    v_mfma_f32_16x16x32_bf16 v[132:135], a[196:199], v[196:199], v[132:135]
    s_waitcnt lgkmcnt(3)
    ds_read_b128 a[216:219], v50 offset:45056
    ds_read_b128 a[220:223], v51 offset:45056
    v_accvgpr_read_b32 v250, a138
    v_accvgpr_read_b32 v251, a139
    v_mul_f32 v244, v17, v244
    v_mul_f32 v245, v17, v245
    v_mfma_f32_16x16x32_bf16 v[132:135], a[200:203], v[212:215], v[132:135]
    s_waitcnt lgkmcnt(4)
    v_mul_f32 v246, v17, v246
    v_mul_f32 v247, v17, v247
    v_mul_f32 v248, v17, v248
    v_mul_f32 v249, v17, v249
    v_mul_f32 v250, v17, v250
    v_mul_f32 v251, v17, v251
    v_mfma_f32_16x16x32_bf16 v[132:135], a[204:207], v[228:231], v[132:135]
    s_waitcnt lgkmcnt(3)
    v_cvt_pk_bf16_f32 v244, v244, v245
    v_cvt_pk_bf16_f32 v245, v246, v247
    v_cvt_pk_bf16_f32 v246, v248, v249
    v_cvt_pk_bf16_f32 v247, v250, v251
    v_accvgpr_write_b32 a0, v244
    v_accvgpr_write_b32 a1, v245
    v_mfma_f32_16x16x32_bf16 v[140:143], a[208:211], v[180:183], v[76:79]
    s_waitcnt lgkmcnt(2)
    s_waitcnt vmcnt(17)
    s_barrier
    ds_read_b64_tr_b16 a[192:193], v36 offset:0
    ds_read_b64_tr_b16 a[194:195], v36 offset:4096
    v_accvgpr_write_b32 a2, v246
    v_accvgpr_write_b32 a3, v247
    v_accvgpr_read_b32 v244, a144
    v_accvgpr_read_b32 v245, a145
    v_mfma_f32_16x16x32_bf16 v[140:143], a[212:215], v[196:199], v[140:143]
    s_waitcnt lgkmcnt(3)
    ds_read_b64_tr_b16 a[196:197], v37 offset:0
    ds_read_b64_tr_b16 a[198:199], v37 offset:4096
    v_accvgpr_read_b32 v246, a146
    v_accvgpr_read_b32 v247, a147
    v_accvgpr_read_b32 v248, a152
    v_accvgpr_read_b32 v249, a153
    v_mfma_f32_16x16x32_bf16 v[140:143], a[216:219], v[212:215], v[140:143]
    s_waitcnt lgkmcnt(4)
    ds_read_b64_tr_b16 a[200:201], v38 offset:0
    ds_read_b64_tr_b16 a[202:203], v38 offset:4096
    v_accvgpr_read_b32 v250, a154
    v_accvgpr_read_b32 v251, a155
    v_mul_f32 v244, v17, v244
    v_mul_f32 v245, v17, v245
    v_mfma_f32_16x16x32_bf16 v[140:143], a[220:223], v[228:231], v[140:143]
    ds_read_b64_tr_b16 a[204:205], v39 offset:0
    ds_read_b64_tr_b16 a[206:207], v39 offset:4096
    v_mul_f32 v246, v17, v246
    v_mul_f32 v247, v17, v247
    v_mul_f32 v248, v17, v248
    v_mul_f32 v249, v17, v249
    v_mfma_f32_16x16x32_bf16 v[68:71], a[224:227], v[84:87], 0
    s_waitcnt lgkmcnt(6)
    ds_read_b64_tr_b16 a[208:209], v40 offset:0
    ds_read_b64_tr_b16 a[210:211], v40 offset:4096
    v_mul_f32 v250, v17, v250
    v_mul_f32 v251, v17, v251
    v_cvt_pk_bf16_f32 v244, v244, v245
    v_cvt_pk_bf16_f32 v245, v246, v247
    v_mfma_f32_16x16x32_bf16 v[148:151], a[192:195], v[84:87], 0
    s_waitcnt lgkmcnt(6)
    ds_read_b64_tr_b16 a[212:213], v41 offset:0
    ds_read_b64_tr_b16 a[214:215], v41 offset:4096
    v_cvt_pk_bf16_f32 v246, v248, v249
    v_cvt_pk_bf16_f32 v247, v250, v251
    v_accvgpr_write_b32 a8, v244
    v_accvgpr_write_b32 a9, v245
    v_mfma_f32_16x16x32_bf16 v[188:191], a[196:199], v[84:87], 0
    s_waitcnt lgkmcnt(6)
    ds_read_b64_tr_b16 a[216:217], v42 offset:0
    ds_read_b64_tr_b16 a[218:219], v42 offset:4096
    v_max3_f32 v19, v116, v117, v118
    v_max3_f32 v19, v19, v119, v124
    v_max3_f32 v19, v19, v125, v126
    v_max3_f32 v19, v19, v127, v132
    v_mfma_f32_16x16x32_bf16 v[156:159], a[200:203], v[84:87], 0
    s_waitcnt lgkmcnt(6)
    ds_read_b64_tr_b16 a[220:221], v43 offset:0
    ds_read_b64_tr_b16 a[222:223], v43 offset:4096
    v_max3_f32 v19, v19, v133, v134
    v_max3_f32 v19, v19, v135, v140
    v_max3_f32 v19, v19, v141, v142
    v_max_f32 v19, v19, v143
    v_mfma_f32_16x16x32_bf16 v[204:207], a[204:207], v[84:87], 0
    s_waitcnt lgkmcnt(6)
    v_cmp_lt_f32 vcc, s47, v19
    v_accvgpr_write_b32 a10, v246
    v_accvgpr_write_b32 a11, v247
    v_accvgpr_read_b32 v244, a160
    v_accvgpr_read_b32 v245, a161
    v_accvgpr_read_b32 v246, a162
    v_mfma_f32_16x16x32_bf16 v[164:167], a[208:211], v[84:87], 0
    s_waitcnt lgkmcnt(4)
    ds_read_b64_tr_b16 a[192:193], v36 offset:8192
    ds_read_b64_tr_b16 a[194:195], v36 offset:12288
    v_accvgpr_read_b32 v247, a163
    v_accvgpr_read_b32 v248, a168
    v_accvgpr_read_b32 v249, a169
    v_accvgpr_read_b32 v250, a170
    v_mfma_f32_16x16x32_bf16 v[220:223], a[212:215], v[84:87], 0
    s_waitcnt lgkmcnt(4)
    ds_read_b64_tr_b16 a[196:197], v37 offset:8192
    ds_read_b64_tr_b16 a[198:199], v37 offset:12288
    v_accvgpr_read_b32 v251, a171
    v_mul_f32 v244, v17, v244
    v_mul_f32 v245, v17, v245
    v_mul_f32 v246, v17, v246
    v_mfma_f32_16x16x32_bf16 v[172:175], a[216:219], v[84:87], 0
    s_waitcnt lgkmcnt(4)
    ds_read_b64_tr_b16 a[200:201], v38 offset:8192
    ds_read_b64_tr_b16 a[202:203], v38 offset:12288
    v_mul_f32 v247, v17, v247
    v_mul_f32 v248, v17, v248
    v_mul_f32 v249, v17, v249
    v_mul_f32 v250, v17, v250
    v_mfma_f32_16x16x32_bf16 v[236:239], a[220:223], v[84:87], 0
    ds_read_b64_tr_b16 a[204:205], v39 offset:8192
    ds_read_b64_tr_b16 a[206:207], v39 offset:12288
    v_mul_f32 v251, v17, v251
    v_cvt_pk_bf16_f32 v244, v244, v245
    v_cvt_pk_bf16_f32 v245, v246, v247
    v_cvt_pk_bf16_f32 v246, v248, v249
    v_mfma_f32_16x16x32_bf16 v[68:71], a[224:227], v[100:103], v[68:71]
    s_waitcnt lgkmcnt(6)
    ds_read_b64_tr_b16 a[208:209], v40 offset:8192
    ds_read_b64_tr_b16 a[210:211], v40 offset:12288
    v_cvt_pk_bf16_f32 v247, v250, v251
    v_accvgpr_write_b32 a16, v244
    v_accvgpr_write_b32 a17, v245
    v_accvgpr_write_b32 a18, v246
    v_mfma_f32_16x16x32_bf16 v[148:151], a[192:195], v[100:103], v[148:151]
    s_waitcnt lgkmcnt(6)
    ds_read_b64_tr_b16 a[212:213], v41 offset:8192
    ds_read_b64_tr_b16 a[214:215], v41 offset:12288
    v_accvgpr_write_b32 a19, v247
    v_accvgpr_read_b32 v244, a176
    v_accvgpr_read_b32 v245, a177
    v_accvgpr_read_b32 v246, a178
    v_mfma_f32_16x16x32_bf16 v[188:191], a[196:199], v[100:103], v[188:191]
    s_waitcnt lgkmcnt(6)
    ds_read_b64_tr_b16 a[216:217], v42 offset:8192
    ds_read_b64_tr_b16 a[218:219], v42 offset:12288
    v_accvgpr_read_b32 v247, a179
    v_accvgpr_read_b32 v248, a184
    v_accvgpr_read_b32 v249, a185
    v_accvgpr_read_b32 v250, a186
    v_mfma_f32_16x16x32_bf16 v[156:159], a[200:203], v[100:103], v[156:159]
    s_waitcnt lgkmcnt(6)
    ds_read_b64_tr_b16 a[220:221], v43 offset:8192
    ds_read_b64_tr_b16 a[222:223], v43 offset:12288
    v_accvgpr_read_b32 v251, a187
    v_mul_f32 v244, v17, v244
    v_mul_f32 v245, v17, v245
    v_mul_f32 v246, v17, v246
    v_mfma_f32_16x16x32_bf16 v[204:207], a[204:207], v[100:103], v[204:207]
    s_waitcnt lgkmcnt(6)
    s_waitcnt vmcnt(12)
    s_barrier
    ds_read_b128 a[192:195], v44 offset:49152
    ds_read_b128 a[196:199], v45 offset:49152
    s_add_u32 s42, s51, 1
    s_lshl_b32 s42, s42, 6
    v_add_u32 v8, s42, v60
    v_and_b32 v8, 0xff, v8
    v_mfma_f32_16x16x32_bf16 v[164:167], a[208:211], v[100:103], v[164:167]
    s_waitcnt lgkmcnt(6)
    v_and_b32 v9, 0x300, v60
    v_lshl_add_u32 v8, v9, 2, v8
    v_add_u32 v62, 0, v8
    v_add_u32 v64, 6144, v8
    v_add_u32 v8, s42, v61
    v_and_b32 v8, 0xff, v8
    v_mfma_f32_16x16x32_bf16 v[220:223], a[212:215], v[100:103], v[220:223]
    s_waitcnt lgkmcnt(4)
    ds_read_b128 a[200:203], v46 offset:49152
    ds_read_b128 a[204:207], v47 offset:49152
    v_and_b32 v9, 0x300, v61
    v_lshl_add_u32 v8, v9, 2, v8
    v_add_u32 v63, 3072, v8
    v_add_u32 v65, 9216, v8
    v_mfma_f32_16x16x32_bf16 v[172:175], a[216:219], v[100:103], v[172:175]
    s_waitcnt lgkmcnt(4)
    s_add_u32 m0, s37, 81920
    s_add_u32 s42, s80, 0
    buffer_load_dwordx4 v62, s[20:23], s42 offen offset:0  lds
    v_mul_f32 v247, v17, v247
    v_mul_f32 v248, v17, v248
    v_mfma_f32_16x16x32_bf16 v[236:239], a[220:223], v[100:103], v[236:239]
    s_cbranch_vccnz w1_t9_slow
w1_t9_back:
    s_waitcnt lgkmcnt(3)
    ds_read_b128 a[208:211], v44 offset:53248
    ds_read_b128 a[212:215], v45 offset:53248
    buffer_load_dwordx4 v63, s[20:23], s42 offen offset:1024  lds
    v_exp_f32 v116, v116
    v_mfma_f32_16x16x32_bf16 v[84:87], a[192:195], v[180:183], v[76:79]
    s_waitcnt lgkmcnt(4)
    buffer_load_dwordx4 v64, s[20:23], s42 offen offset:2048  lds
    v_exp_f32 v117, v117
    v_exp_f32 v118, v118
    v_mfma_f32_16x16x32_bf16 v[84:87], a[196:199], v[196:199], v[84:87]
    s_waitcnt lgkmcnt(3)
    ds_read_b128 a[216:219], v46 offset:53248
    ds_read_b128 a[220:223], v47 offset:53248
    buffer_load_dwordx4 v65, s[20:23], s42 offen offset:3072  lds
    v_exp_f32 v119, v119
    v_mfma_f32_16x16x32_bf16 v[84:87], a[200:203], v[212:215], v[84:87]
    s_waitcnt lgkmcnt(4)
    s_add_u32 m0, s37, 0
    s_add_u32 s42, s39, 196608
    buffer_load_dwordx4 v56, s[8:11], s42 offen offset:0 nt lds
    v_exp_f32 v124, v124
    v_mfma_f32_16x16x32_bf16 v[84:87], a[204:207], v[228:231], v[84:87]
    s_waitcnt lgkmcnt(3)
    ds_read_b128 a[192:195], v44 offset:57344
    ds_read_b128 a[196:199], v45 offset:57344
    buffer_load_dwordx4 v57, s[8:11], s42 offen offset:1024 nt lds
    v_exp_f32 v125, v125
    v_mfma_f32_16x16x32_bf16 v[92:95], a[208:211], v[180:183], v[76:79]
    s_waitcnt lgkmcnt(4)
    buffer_load_dwordx4 v58, s[8:11], s42 offen offset:2048 nt lds
    v_exp_f32 v126, v126
    v_exp_f32 v127, v127
    v_mfma_f32_16x16x32_bf16 v[92:95], a[212:215], v[196:199], v[92:95]
    s_waitcnt lgkmcnt(3)
    ds_read_b128 a[200:203], v46 offset:57344
    ds_read_b128 a[204:207], v47 offset:57344
    buffer_load_dwordx4 v59, s[8:11], s42 offen offset:3072 nt lds
    v_cvt_pk_bf16_f32 v116, v116, v117
    v_cvt_pk_bf16_f32 v117, v118, v119
    v_mfma_f32_16x16x32_bf16 v[92:95], a[216:219], v[212:215], v[92:95]
    s_waitcnt lgkmcnt(4)
    v_cvt_pk_bf16_f32 v118, v124, v125
    v_cvt_pk_bf16_f32 v119, v126, v127
    v_exp_f32 v132, v132
    v_exp_f32 v133, v133
    v_mfma_f32_16x16x32_bf16 v[92:95], a[220:223], v[228:231], v[92:95]
    s_waitcnt lgkmcnt(3)
    ds_read_b128 a[208:211], v44 offset:61440
    ds_read_b128 a[212:215], v45 offset:61440
    v_exp_f32 v134, v134
    v_exp_f32 v135, v135
    v_mfma_f32_16x16x32_bf16 v[100:103], a[192:195], v[180:183], v[76:79]
    s_waitcnt lgkmcnt(4)
    v_exp_f32 v140, v140
    v_exp_f32 v141, v141
    v_exp_f32 v142, v142
    v_mfma_f32_16x16x32_bf16 v[100:103], a[196:199], v[196:199], v[100:103]
    s_waitcnt lgkmcnt(3)
    ds_read_b128 a[216:219], v46 offset:61440
    ds_read_b128 a[220:223], v47 offset:61440
    v_exp_f32 v143, v143
    v_cvt_pk_bf16_f32 v132, v132, v133
    v_cvt_pk_bf16_f32 v133, v134, v135
    v_mfma_f32_16x16x32_bf16 v[100:103], a[200:203], v[212:215], v[100:103]
    s_waitcnt lgkmcnt(4)
    v_cvt_pk_bf16_f32 v134, v140, v141
    v_cvt_pk_bf16_f32 v135, v142, v143
    v_mul_f32 v249, v17, v249
    v_mul_f32 v250, v17, v250
    v_mul_f32 v251, v17, v251
    v_cvt_pk_bf16_f32 v244, v244, v245
    v_mfma_f32_16x16x32_bf16 v[100:103], a[204:207], v[228:231], v[100:103]
    s_waitcnt lgkmcnt(3)
    v_cvt_pk_bf16_f32 v245, v246, v247
    v_cvt_pk_bf16_f32 v246, v248, v249
    v_cvt_pk_bf16_f32 v247, v250, v251
    v_accvgpr_write_b32 a24, v244
    v_accvgpr_write_b32 a25, v245
    v_accvgpr_write_b32 a26, v246
    v_mfma_f32_16x16x32_bf16 v[108:111], a[208:211], v[180:183], v[76:79]
    s_waitcnt lgkmcnt(2)
    s_waitcnt vmcnt(16)
    s_barrier
    ds_read_b64_tr_b16 a[192:193], v36 offset:16384
    ds_read_b64_tr_b16 a[194:195], v36 offset:20480
    s_add_u32 m0, s37, 32768
    s_add_u32 s42, s39, 180224
    buffer_load_dwordx4 v60, s[12:15], s42 offen offset:0 nt lds
    v_mfma_f32_16x16x32_bf16 v[108:111], a[212:215], v[196:199], v[108:111]
    s_waitcnt lgkmcnt(3)
    ds_read_b64_tr_b16 a[196:197], v37 offset:16384
    ds_read_b64_tr_b16 a[198:199], v37 offset:20480
    buffer_load_dwordx4 v61, s[12:15], s42 offen offset:1024 nt lds
    v_accvgpr_write_b32 a27, v247
    v_mfma_f32_16x16x32_bf16 v[108:111], a[216:219], v[212:215], v[108:111]
    s_waitcnt lgkmcnt(4)
    ds_read_b64_tr_b16 a[200:201], v38 offset:16384
    ds_read_b64_tr_b16 a[202:203], v38 offset:20480
    buffer_load_dwordx4 v60, s[12:15], s42 offen offset:2048 nt lds
    v_mfma_f32_16x16x32_bf16 v[108:111], a[220:223], v[228:231], v[108:111]
    ds_read_b64_tr_b16 a[204:205], v39 offset:16384
    ds_read_b64_tr_b16 a[206:207], v39 offset:20480
    buffer_load_dwordx4 v61, s[12:15], s42 offen offset:3072 nt lds
    v_mfma_f32_16x16x32_bf16 v[68:71], a[224:227], v[116:119], v[68:71]
    s_waitcnt lgkmcnt(6)
    ds_read_b64_tr_b16 a[208:209], v40 offset:16384
    ds_read_b64_tr_b16 a[210:211], v40 offset:20480
    v_mfma_f32_16x16x32_bf16 v[148:151], a[192:195], v[116:119], v[148:151]
    s_waitcnt lgkmcnt(6)
    ds_read_b64_tr_b16 a[212:213], v41 offset:16384
    ds_read_b64_tr_b16 a[214:215], v41 offset:20480
    v_mfma_f32_16x16x32_bf16 v[188:191], a[196:199], v[116:119], v[188:191]
    s_waitcnt lgkmcnt(6)
    ds_read_b64_tr_b16 a[216:217], v42 offset:16384
    ds_read_b64_tr_b16 a[218:219], v42 offset:20480
    v_max3_f32 v19, v84, v85, v86
    v_max3_f32 v19, v19, v87, v92
    v_max3_f32 v19, v19, v93, v94
    v_max3_f32 v19, v19, v95, v100
    v_mfma_f32_16x16x32_bf16 v[156:159], a[200:203], v[116:119], v[156:159]
    s_waitcnt lgkmcnt(6)
    ds_read_b64_tr_b16 a[220:221], v43 offset:16384
    ds_read_b64_tr_b16 a[222:223], v43 offset:20480
    v_max3_f32 v19, v19, v101, v102
    v_max3_f32 v19, v19, v103, v108
    v_max3_f32 v19, v19, v109, v110
    v_max_f32 v19, v19, v111
    v_mfma_f32_16x16x32_bf16 v[204:207], a[204:207], v[116:119], v[204:207]
    s_waitcnt lgkmcnt(6)
    v_cmp_lt_f32 vcc, s47, v19
    v_mfma_f32_16x16x32_bf16 v[164:167], a[208:211], v[116:119], v[164:167]
    s_waitcnt lgkmcnt(4)
    ds_read_b64_tr_b16 a[192:193], v36 offset:24576
    ds_read_b64_tr_b16 a[194:195], v36 offset:28672
    v_mfma_f32_16x16x32_bf16 v[220:223], a[212:215], v[116:119], v[220:223]
    s_waitcnt lgkmcnt(4)
    ds_read_b64_tr_b16 a[196:197], v37 offset:24576
    ds_read_b64_tr_b16 a[198:199], v37 offset:28672
    v_mfma_f32_16x16x32_bf16 v[172:175], a[216:219], v[116:119], v[172:175]
    s_waitcnt lgkmcnt(4)
    ds_read_b64_tr_b16 a[200:201], v38 offset:24576
    ds_read_b64_tr_b16 a[202:203], v38 offset:28672
    v_mfma_f32_16x16x32_bf16 v[236:239], a[220:223], v[116:119], v[236:239]
    ds_read_b64_tr_b16 a[204:205], v39 offset:24576
    ds_read_b64_tr_b16 a[206:207], v39 offset:28672
    v_mfma_f32_16x16x32_bf16 v[68:71], a[224:227], v[132:135], v[68:71]
    s_waitcnt lgkmcnt(6)
    ds_read_b64_tr_b16 a[208:209], v40 offset:24576
    ds_read_b64_tr_b16 a[210:211], v40 offset:28672
    v_mfma_f32_16x16x32_bf16 v[148:151], a[192:195], v[132:135], v[148:151]
    s_waitcnt lgkmcnt(6)
    ds_read_b64_tr_b16 a[212:213], v41 offset:24576
    ds_read_b64_tr_b16 a[214:215], v41 offset:28672
    v_mfma_f32_16x16x32_bf16 v[188:191], a[196:199], v[132:135], v[188:191]
    s_waitcnt lgkmcnt(6)
    ds_read_b64_tr_b16 a[216:217], v42 offset:24576
    ds_read_b64_tr_b16 a[218:219], v42 offset:28672
    v_mfma_f32_16x16x32_bf16 v[156:159], a[200:203], v[132:135], v[156:159]
    s_waitcnt lgkmcnt(6)
    ds_read_b64_tr_b16 a[220:221], v43 offset:24576
    ds_read_b64_tr_b16 a[222:223], v43 offset:28672
    v_mfma_f32_16x16x32_bf16 v[204:207], a[204:207], v[132:135], v[204:207]
    s_waitcnt lgkmcnt(6)
    s_waitcnt vmcnt(16)
    s_barrier
    ds_read_b128 a[192:195], v48 offset:49152
    ds_read_b128 a[196:199], v49 offset:49152
    s_add_u32 m0, s37, 65536
    s_add_u32 s42, s80, 65536
    buffer_load_dwordx4 v62, s[20:23], s42 offen offset:0  lds
    v_mfma_f32_16x16x32_bf16 v[164:167], a[208:211], v[132:135], v[164:167]
    s_waitcnt lgkmcnt(6)
    buffer_load_dwordx4 v63, s[20:23], s42 offen offset:1024  lds
    v_mfma_f32_16x16x32_bf16 v[220:223], a[212:215], v[132:135], v[220:223]
    s_waitcnt lgkmcnt(4)
    ds_read_b128 a[200:203], v50 offset:49152
    ds_read_b128 a[204:207], v51 offset:49152
    buffer_load_dwordx4 v64, s[20:23], s42 offen offset:2048  lds
    v_mfma_f32_16x16x32_bf16 v[172:175], a[216:219], v[132:135], v[172:175]
    s_waitcnt lgkmcnt(4)
    buffer_load_dwordx4 v65, s[20:23], s42 offen offset:3072  lds
    v_mfma_f32_16x16x32_bf16 v[236:239], a[220:223], v[132:135], v[236:239]
    s_cbranch_vccnz w1_t10_slow
w1_t10_back:
    s_waitcnt lgkmcnt(3)
    ds_read_b128 a[208:211], v48 offset:53248
    ds_read_b128 a[212:215], v49 offset:53248
    s_add_u32 m0, s37, 98304
    s_add_u32 s42, s39, 212992
    buffer_load_dwordx4 v56, s[8:11], s42 offen offset:0 nt lds
    v_mfma_f32_16x16x32_bf16 v[116:119], a[192:195], v[180:183], v[76:79]
    s_waitcnt lgkmcnt(4)
    buffer_load_dwordx4 v57, s[8:11], s42 offen offset:1024 nt lds
    v_exp_f32 v84, v84
    v_exp_f32 v85, v85
    v_mfma_f32_16x16x32_bf16 v[116:119], a[196:199], v[196:199], v[116:119]
    s_waitcnt lgkmcnt(3)
    ds_read_b128 a[216:219], v50 offset:53248
    ds_read_b128 a[220:223], v51 offset:53248
    buffer_load_dwordx4 v58, s[8:11], s42 offen offset:2048 nt lds
    v_exp_f32 v86, v86
    v_mfma_f32_16x16x32_bf16 v[116:119], a[200:203], v[212:215], v[116:119]
    s_waitcnt lgkmcnt(4)
    buffer_load_dwordx4 v59, s[8:11], s42 offen offset:3072 nt lds
    v_exp_f32 v87, v87
    v_exp_f32 v92, v92
    v_mfma_f32_16x16x32_bf16 v[116:119], a[204:207], v[228:231], v[116:119]
    s_waitcnt lgkmcnt(3)
    ds_read_b128 a[192:195], v48 offset:57344
    ds_read_b128 a[196:199], v49 offset:57344
    v_exp_f32 v93, v93
    v_exp_f32 v94, v94
    v_mfma_f32_16x16x32_bf16 v[124:127], a[208:211], v[180:183], v[76:79]
    s_waitcnt lgkmcnt(4)
    v_exp_f32 v95, v95
    v_cvt_pk_bf16_f32 v84, v84, v85
    v_cvt_pk_bf16_f32 v85, v86, v87
    v_cvt_pk_bf16_f32 v86, v92, v93
    v_cvt_pk_bf16_f32 v87, v94, v95
    v_mfma_f32_16x16x32_bf16 v[124:127], a[212:215], v[196:199], v[124:127]
    s_waitcnt lgkmcnt(3)
    ds_read_b128 a[200:203], v50 offset:57344
    ds_read_b128 a[204:207], v51 offset:57344
    v_exp_f32 v100, v100
    v_exp_f32 v101, v101
    v_mfma_f32_16x16x32_bf16 v[124:127], a[216:219], v[212:215], v[124:127]
    s_waitcnt lgkmcnt(4)
    v_exp_f32 v102, v102
    v_exp_f32 v103, v103
    v_exp_f32 v108, v108
    v_mfma_f32_16x16x32_bf16 v[124:127], a[220:223], v[228:231], v[124:127]
    s_waitcnt lgkmcnt(3)
    ds_read_b128 a[208:211], v48 offset:61440
    ds_read_b128 a[212:215], v49 offset:61440
    v_exp_f32 v109, v109
    v_exp_f32 v110, v110
    v_mfma_f32_16x16x32_bf16 v[132:135], a[192:195], v[180:183], v[76:79]
    s_waitcnt lgkmcnt(4)
    v_exp_f32 v111, v111
    v_cvt_pk_bf16_f32 v100, v100, v101
    v_cvt_pk_bf16_f32 v101, v102, v103
    v_cvt_pk_bf16_f32 v102, v108, v109
    v_cvt_pk_bf16_f32 v103, v110, v111
    v_mfma_f32_16x16x32_bf16 v[132:135], a[196:199], v[196:199], v[132:135]
    s_waitcnt lgkmcnt(3)
    ds_read_b128 a[216:219], v50 offset:61440
    ds_read_b128 a[220:223], v51 offset:61440
    v_mfma_f32_16x16x32_bf16 v[132:135], a[200:203], v[212:215], v[132:135]
    s_waitcnt lgkmcnt(4)
    v_mfma_f32_16x16x32_bf16 v[132:135], a[204:207], v[228:231], v[132:135]
    s_waitcnt lgkmcnt(3)
    v_mfma_f32_16x16x32_bf16 v[140:143], a[208:211], v[180:183], v[76:79]
    s_waitcnt lgkmcnt(2)
    s_waitcnt vmcnt(20)
    s_barrier
    ds_read_b64_tr_b16 a[192:193], v20 offset:16384
    ds_read_b64_tr_b16 a[194:195], v20 offset:20480
    s_add_u32 m0, s37, 131072
    s_add_u32 s42, s39, 196608
    buffer_load_dwordx4 v60, s[12:15], s42 offen offset:0 nt lds
    v_mfma_f32_16x16x32_bf16 v[140:143], a[212:215], v[196:199], v[140:143]
    s_waitcnt lgkmcnt(3)
    ds_read_b64_tr_b16 a[196:197], v21 offset:16384
    ds_read_b64_tr_b16 a[198:199], v21 offset:20480
    buffer_load_dwordx4 v61, s[12:15], s42 offen offset:1024 nt lds
    v_mfma_f32_16x16x32_bf16 v[140:143], a[216:219], v[212:215], v[140:143]
    s_waitcnt lgkmcnt(4)
    ds_read_b64_tr_b16 a[200:201], v22 offset:16384
    ds_read_b64_tr_b16 a[202:203], v22 offset:20480
    buffer_load_dwordx4 v60, s[12:15], s42 offen offset:2048 nt lds
    v_mfma_f32_16x16x32_bf16 v[140:143], a[220:223], v[228:231], v[140:143]
    ds_read_b64_tr_b16 a[204:205], v23 offset:16384
    ds_read_b64_tr_b16 a[206:207], v23 offset:20480
    buffer_load_dwordx4 v61, s[12:15], s42 offen offset:3072 nt lds
    v_mfma_f32_16x16x32_bf16 v[68:71], a[224:227], v[84:87], v[68:71]
    s_waitcnt lgkmcnt(6)
    ds_read_b64_tr_b16 a[208:209], v24 offset:16384
    ds_read_b64_tr_b16 a[210:211], v24 offset:20480
    v_mfma_f32_16x16x32_bf16 v[148:151], a[192:195], v[84:87], v[148:151]
    s_waitcnt lgkmcnt(6)
    ds_read_b64_tr_b16 a[212:213], v25 offset:16384
    ds_read_b64_tr_b16 a[214:215], v25 offset:20480
    v_mfma_f32_16x16x32_bf16 v[188:191], a[196:199], v[84:87], v[188:191]
    s_waitcnt lgkmcnt(6)
    ds_read_b64_tr_b16 a[216:217], v26 offset:16384
    ds_read_b64_tr_b16 a[218:219], v26 offset:20480
    v_max3_f32 v19, v116, v117, v118
    v_max3_f32 v19, v19, v119, v124
    v_max3_f32 v19, v19, v125, v126
    v_max3_f32 v19, v19, v127, v132
    v_mfma_f32_16x16x32_bf16 v[156:159], a[200:203], v[84:87], v[156:159]
    s_waitcnt lgkmcnt(6)
    ds_read_b64_tr_b16 a[220:221], v27 offset:16384
    ds_read_b64_tr_b16 a[222:223], v27 offset:20480
    v_max3_f32 v19, v19, v133, v134
    v_max3_f32 v19, v19, v135, v140
    v_max3_f32 v19, v19, v141, v142
    v_max_f32 v19, v19, v143
    v_mfma_f32_16x16x32_bf16 v[204:207], a[204:207], v[84:87], v[204:207]
    s_waitcnt lgkmcnt(6)
    v_cmp_lt_f32 vcc, s47, v19
    v_mfma_f32_16x16x32_bf16 v[164:167], a[208:211], v[84:87], v[164:167]
    s_waitcnt lgkmcnt(4)
    ds_read_b64_tr_b16 a[192:193], v20 offset:24576
    ds_read_b64_tr_b16 a[194:195], v20 offset:28672
    v_mfma_f32_16x16x32_bf16 v[220:223], a[212:215], v[84:87], v[220:223]
    s_waitcnt lgkmcnt(4)
    ds_read_b64_tr_b16 a[196:197], v21 offset:24576
    ds_read_b64_tr_b16 a[198:199], v21 offset:28672
    v_mfma_f32_16x16x32_bf16 v[172:175], a[216:219], v[84:87], v[172:175]
    s_waitcnt lgkmcnt(4)
    ds_read_b64_tr_b16 a[200:201], v22 offset:24576
    ds_read_b64_tr_b16 a[202:203], v22 offset:28672
    v_mfma_f32_16x16x32_bf16 v[236:239], a[220:223], v[84:87], v[236:239]
    ds_read_b64_tr_b16 a[204:205], v23 offset:24576
    ds_read_b64_tr_b16 a[206:207], v23 offset:28672
    v_mfma_f32_16x16x32_bf16 v[68:71], a[224:227], v[100:103], v[68:71]
    s_waitcnt lgkmcnt(6)
    ds_read_b64_tr_b16 a[208:209], v24 offset:24576
    ds_read_b64_tr_b16 a[210:211], v24 offset:28672
    v_mfma_f32_16x16x32_bf16 v[148:151], a[192:195], v[100:103], v[148:151]
    s_waitcnt lgkmcnt(6)
    ds_read_b64_tr_b16 a[212:213], v25 offset:24576
    ds_read_b64_tr_b16 a[214:215], v25 offset:28672
    v_mfma_f32_16x16x32_bf16 v[188:191], a[196:199], v[100:103], v[188:191]
    s_waitcnt lgkmcnt(6)
    ds_read_b64_tr_b16 a[216:217], v26 offset:24576
    ds_read_b64_tr_b16 a[218:219], v26 offset:28672
    v_mfma_f32_16x16x32_bf16 v[156:159], a[200:203], v[100:103], v[156:159]
    s_waitcnt lgkmcnt(6)
    ds_read_b64_tr_b16 a[220:221], v27 offset:24576
    ds_read_b64_tr_b16 a[222:223], v27 offset:28672
    v_mfma_f32_16x16x32_bf16 v[204:207], a[204:207], v[100:103], v[204:207]
    s_waitcnt lgkmcnt(6)
    s_waitcnt vmcnt(16)
    s_barrier
    ds_read_b128 a[192:195], v44 offset:0
    ds_read_b128 a[196:199], v45 offset:0
    s_add_u32 m0, s37, 49152
    s_add_u32 s42, s80, 131072
    buffer_load_dwordx4 v62, s[20:23], s42 offen offset:0  lds
    v_mfma_f32_16x16x32_bf16 v[164:167], a[208:211], v[100:103], v[164:167]
    s_waitcnt lgkmcnt(6)
    buffer_load_dwordx4 v63, s[20:23], s42 offen offset:1024  lds
    v_mfma_f32_16x16x32_bf16 v[220:223], a[212:215], v[100:103], v[220:223]
    s_waitcnt lgkmcnt(4)
    ds_read_b128 a[200:203], v46 offset:0
    ds_read_b128 a[204:207], v47 offset:0
    buffer_load_dwordx4 v64, s[20:23], s42 offen offset:2048  lds
    v_mfma_f32_16x16x32_bf16 v[172:175], a[216:219], v[100:103], v[172:175]
    s_waitcnt lgkmcnt(4)
    buffer_load_dwordx4 v65, s[20:23], s42 offen offset:3072  lds
    v_mfma_f32_16x16x32_bf16 v[236:239], a[220:223], v[100:103], v[236:239]
    s_cbranch_vccnz w1_t11_slow
w1_t11_back:
    s_waitcnt lgkmcnt(3)
    ds_read_b128 a[208:211], v44 offset:4096
    ds_read_b128 a[212:215], v45 offset:4096
    s_add_u32 m0, s37, 147456
    s_add_u32 s42, s39, 229376
    buffer_load_dwordx4 v56, s[8:11], s42 offen offset:0 nt lds
    v_mfma_f32_16x16x32_bf16 v[84:87], a[192:195], v[180:183], v[76:79]
    s_waitcnt lgkmcnt(4)
    buffer_load_dwordx4 v57, s[8:11], s42 offen offset:1024 nt lds
    v_exp_f32 v116, v116
    v_exp_f32 v117, v117
    v_mfma_f32_16x16x32_bf16 v[84:87], a[196:199], v[196:199], v[84:87]
    s_waitcnt lgkmcnt(3)
    ds_read_b128 a[216:219], v46 offset:4096
    ds_read_b128 a[220:223], v47 offset:4096
    buffer_load_dwordx4 v58, s[8:11], s42 offen offset:2048 nt lds
    v_exp_f32 v118, v118
    v_mfma_f32_16x16x32_bf16 v[84:87], a[200:203], v[212:215], v[84:87]
    s_waitcnt lgkmcnt(4)
    buffer_load_dwordx4 v59, s[8:11], s42 offen offset:3072 nt lds
    v_exp_f32 v119, v119
    v_exp_f32 v124, v124
    v_mfma_f32_16x16x32_bf16 v[84:87], a[204:207], v[228:231], v[84:87]
    s_waitcnt lgkmcnt(3)
    ds_read_b128 a[192:195], v44 offset:8192
    ds_read_b128 a[196:199], v45 offset:8192
    v_exp_f32 v125, v125
    v_exp_f32 v126, v126
    v_mfma_f32_16x16x32_bf16 v[92:95], a[208:211], v[180:183], v[76:79]
    s_waitcnt lgkmcnt(4)
    v_exp_f32 v127, v127
    v_cvt_pk_bf16_f32 v116, v116, v117
    v_cvt_pk_bf16_f32 v117, v118, v119
    v_cvt_pk_bf16_f32 v118, v124, v125
    v_cvt_pk_bf16_f32 v119, v126, v127
    v_mfma_f32_16x16x32_bf16 v[92:95], a[212:215], v[196:199], v[92:95]
    s_waitcnt lgkmcnt(3)
    ds_read_b128 a[200:203], v46 offset:8192
    ds_read_b128 a[204:207], v47 offset:8192
    v_exp_f32 v132, v132
    v_exp_f32 v133, v133
    v_mfma_f32_16x16x32_bf16 v[92:95], a[216:219], v[212:215], v[92:95]
    s_waitcnt lgkmcnt(4)
    v_exp_f32 v134, v134
    v_exp_f32 v135, v135
    v_exp_f32 v140, v140
    v_mfma_f32_16x16x32_bf16 v[92:95], a[220:223], v[228:231], v[92:95]
    s_waitcnt lgkmcnt(3)
    ds_read_b128 a[208:211], v44 offset:12288
    ds_read_b128 a[212:215], v45 offset:12288
    v_exp_f32 v141, v141
    v_exp_f32 v142, v142
    v_mfma_f32_16x16x32_bf16 v[100:103], a[192:195], v[180:183], v[76:79]
    s_waitcnt lgkmcnt(4)
    v_exp_f32 v143, v143
    v_cvt_pk_bf16_f32 v132, v132, v133
    v_cvt_pk_bf16_f32 v133, v134, v135
    v_cvt_pk_bf16_f32 v134, v140, v141
    v_cvt_pk_bf16_f32 v135, v142, v143
    v_mfma_f32_16x16x32_bf16 v[100:103], a[196:199], v[196:199], v[100:103]
    s_waitcnt lgkmcnt(3)
    ds_read_b128 a[216:219], v46 offset:12288
    ds_read_b128 a[220:223], v47 offset:12288
    v_mfma_f32_16x16x32_bf16 v[100:103], a[200:203], v[212:215], v[100:103]
    s_waitcnt lgkmcnt(4)
    v_mfma_f32_16x16x32_bf16 v[100:103], a[204:207], v[228:231], v[100:103]
    s_waitcnt lgkmcnt(3)
    v_mfma_f32_16x16x32_bf16 v[108:111], a[208:211], v[180:183], v[76:79]
    s_waitcnt lgkmcnt(2)
    s_waitcnt vmcnt(20)
    s_barrier
    global_load_dword v7, v67, s[88:89]
    ds_read_b64_tr_b16 a[192:193], v20 offset:32768
    ds_read_b64_tr_b16 a[194:195], v20 offset:36864
    v_mfma_f32_16x16x32_bf16 v[108:111], a[212:215], v[196:199], v[108:111]
    s_waitcnt lgkmcnt(3)
    ds_read_b64_tr_b16 a[196:197], v21 offset:32768
    ds_read_b64_tr_b16 a[198:199], v21 offset:36864
    v_mfma_f32_16x16x32_bf16 v[108:111], a[216:219], v[212:215], v[108:111]
    s_waitcnt lgkmcnt(4)
    ds_read_b64_tr_b16 a[200:201], v22 offset:32768
    ds_read_b64_tr_b16 a[202:203], v22 offset:36864
    v_mfma_f32_16x16x32_bf16 v[108:111], a[220:223], v[228:231], v[108:111]
    ds_read_b64_tr_b16 a[204:205], v23 offset:32768
    ds_read_b64_tr_b16 a[206:207], v23 offset:36864
    v_mfma_f32_16x16x32_bf16 v[68:71], a[224:227], v[116:119], v[68:71]
    s_waitcnt lgkmcnt(6)
    ds_read_b64_tr_b16 a[208:209], v24 offset:32768
    ds_read_b64_tr_b16 a[210:211], v24 offset:36864
    v_mfma_f32_16x16x32_bf16 v[148:151], a[192:195], v[116:119], v[148:151]
    s_waitcnt lgkmcnt(6)
    ds_read_b64_tr_b16 a[212:213], v25 offset:32768
    ds_read_b64_tr_b16 a[214:215], v25 offset:36864
    v_mfma_f32_16x16x32_bf16 v[188:191], a[196:199], v[116:119], v[188:191]
    s_waitcnt lgkmcnt(6)
    ds_read_b64_tr_b16 a[216:217], v26 offset:32768
    ds_read_b64_tr_b16 a[218:219], v26 offset:36864
    v_max3_f32 v19, v84, v85, v86
    v_max3_f32 v19, v19, v87, v92
    v_max3_f32 v19, v19, v93, v94
    v_max3_f32 v19, v19, v95, v100
    v_mfma_f32_16x16x32_bf16 v[156:159], a[200:203], v[116:119], v[156:159]
    s_waitcnt lgkmcnt(6)
    ds_read_b64_tr_b16 a[220:221], v27 offset:32768
    ds_read_b64_tr_b16 a[222:223], v27 offset:36864
    v_max3_f32 v19, v19, v101, v102
    v_max3_f32 v19, v19, v103, v108
    v_max3_f32 v19, v19, v109, v110
    v_max_f32 v19, v19, v111
    v_mfma_f32_16x16x32_bf16 v[204:207], a[204:207], v[116:119], v[204:207]
    s_waitcnt lgkmcnt(6)
    v_cmp_lt_f32 vcc, s47, v19
    v_mfma_f32_16x16x32_bf16 v[164:167], a[208:211], v[116:119], v[164:167]
    s_waitcnt lgkmcnt(4)
    ds_read_b64_tr_b16 a[192:193], v20 offset:40960
    ds_read_b64_tr_b16 a[194:195], v20 offset:45056
    v_mfma_f32_16x16x32_bf16 v[220:223], a[212:215], v[116:119], v[220:223]
    s_waitcnt lgkmcnt(4)
    ds_read_b64_tr_b16 a[196:197], v21 offset:40960
    ds_read_b64_tr_b16 a[198:199], v21 offset:45056
    v_mfma_f32_16x16x32_bf16 v[172:175], a[216:219], v[116:119], v[172:175]
    s_waitcnt lgkmcnt(4)
    ds_read_b64_tr_b16 a[200:201], v22 offset:40960
    ds_read_b64_tr_b16 a[202:203], v22 offset:45056
    v_mfma_f32_16x16x32_bf16 v[236:239], a[220:223], v[116:119], v[236:239]
    ds_read_b64_tr_b16 a[204:205], v23 offset:40960
    ds_read_b64_tr_b16 a[206:207], v23 offset:45056
    v_mfma_f32_16x16x32_bf16 v[68:71], a[224:227], v[132:135], v[68:71]
    s_waitcnt lgkmcnt(6)
    ds_read_b64_tr_b16 a[208:209], v24 offset:40960
    ds_read_b64_tr_b16 a[210:211], v24 offset:45056
    v_mfma_f32_16x16x32_bf16 v[148:151], a[192:195], v[132:135], v[148:151]
    s_waitcnt lgkmcnt(6)
    ds_read_b64_tr_b16 a[212:213], v25 offset:40960
    ds_read_b64_tr_b16 a[214:215], v25 offset:45056
    v_mfma_f32_16x16x32_bf16 v[188:191], a[196:199], v[132:135], v[188:191]
    s_waitcnt lgkmcnt(6)
    ds_read_b64_tr_b16 a[216:217], v26 offset:40960
    ds_read_b64_tr_b16 a[218:219], v26 offset:45056
    v_mfma_f32_16x16x32_bf16 v[156:159], a[200:203], v[132:135], v[156:159]
    s_waitcnt lgkmcnt(6)
    ds_read_b64_tr_b16 a[220:221], v27 offset:40960
    ds_read_b64_tr_b16 a[222:223], v27 offset:45056
    v_mfma_f32_16x16x32_bf16 v[204:207], a[204:207], v[132:135], v[204:207]
    s_waitcnt lgkmcnt(6)
    s_waitcnt vmcnt(13)
    s_barrier
    s_lshl_b32 s43, s48, 2
    buffer_load_dword v10, off, s[32:35], s43 sc1
    ds_read_b128 a[192:195], v48 offset:32768
    ds_read_b128 a[196:199], v49 offset:32768
    s_add_u32 m0, s37, 114688
    s_add_u32 s42, s39, 212992
    buffer_load_dwordx4 v60, s[12:15], s42 offen offset:0 nt lds
    v_mfma_f32_16x16x32_bf16 v[164:167], a[208:211], v[132:135], v[164:167]
    s_waitcnt lgkmcnt(6)
    buffer_load_dwordx4 v61, s[12:15], s42 offen offset:1024 nt lds
    v_mfma_f32_16x16x32_bf16 v[220:223], a[212:215], v[132:135], v[220:223]
    s_waitcnt lgkmcnt(4)
    ds_read_b128 a[200:203], v50 offset:32768
    ds_read_b128 a[204:207], v51 offset:32768
    buffer_load_dwordx4 v60, s[12:15], s42 offen offset:2048 nt lds
    v_mfma_f32_16x16x32_bf16 v[172:175], a[216:219], v[132:135], v[172:175]
    s_waitcnt lgkmcnt(4)
    buffer_load_dwordx4 v61, s[12:15], s42 offen offset:3072 nt lds
    v_mfma_f32_16x16x32_bf16 v[236:239], a[220:223], v[132:135], v[236:239]
    s_cbranch_vccnz w1_t12_slow
w1_t12_back:
    s_waitcnt lgkmcnt(3)
    ds_read_b128 a[208:211], v48 offset:36864
    ds_read_b128 a[212:215], v49 offset:36864
    v_exp_f32 v84, v84
    v_exp_f32 v85, v85
    v_mfma_f32_16x16x32_bf16 v[116:119], a[192:195], v[180:183], v[76:79]
    s_waitcnt lgkmcnt(4)
    v_exp_f32 v86, v86
    v_exp_f32 v87, v87
    v_exp_f32 v92, v92
    v_mfma_f32_16x16x32_bf16 v[116:119], a[196:199], v[196:199], v[116:119]
    s_waitcnt lgkmcnt(3)
    ds_read_b128 a[216:219], v50 offset:36864
    ds_read_b128 a[220:223], v51 offset:36864
    v_exp_f32 v93, v93
    v_exp_f32 v94, v94
    v_mfma_f32_16x16x32_bf16 v[116:119], a[200:203], v[212:215], v[116:119]
    s_waitcnt lgkmcnt(4)
    v_exp_f32 v95, v95
    v_cvt_pk_bf16_f32 v84, v84, v85
    v_cvt_pk_bf16_f32 v85, v86, v87
    v_cvt_pk_bf16_f32 v86, v92, v93
    v_cvt_pk_bf16_f32 v87, v94, v95
    v_mfma_f32_16x16x32_bf16 v[116:119], a[204:207], v[228:231], v[116:119]
    s_waitcnt lgkmcnt(3)
    ds_read_b128 a[192:195], v48 offset:40960
    ds_read_b128 a[196:199], v49 offset:40960
    v_exp_f32 v100, v100
    v_exp_f32 v101, v101
    v_mfma_f32_16x16x32_bf16 v[124:127], a[208:211], v[180:183], v[76:79]
    s_waitcnt lgkmcnt(4)
    v_exp_f32 v102, v102
    v_exp_f32 v103, v103
    v_exp_f32 v108, v108
    v_mfma_f32_16x16x32_bf16 v[124:127], a[212:215], v[196:199], v[124:127]
    s_waitcnt lgkmcnt(3)
    ds_read_b128 a[200:203], v50 offset:40960
    ds_read_b128 a[204:207], v51 offset:40960
    v_exp_f32 v109, v109
    v_exp_f32 v110, v110
    v_mfma_f32_16x16x32_bf16 v[124:127], a[216:219], v[212:215], v[124:127]
    s_waitcnt lgkmcnt(4)
    v_exp_f32 v111, v111
    v_cvt_pk_bf16_f32 v100, v100, v101
    v_cvt_pk_bf16_f32 v101, v102, v103
    v_cvt_pk_bf16_f32 v102, v108, v109
    v_cvt_pk_bf16_f32 v103, v110, v111
    v_mfma_f32_16x16x32_bf16 v[124:127], a[220:223], v[228:231], v[124:127]
    s_waitcnt lgkmcnt(3)
    ds_read_b128 a[208:211], v48 offset:45056
    ds_read_b128 a[212:215], v49 offset:45056
    v_mfma_f32_16x16x32_bf16 v[132:135], a[192:195], v[180:183], v[76:79]
    s_waitcnt lgkmcnt(4)
    v_mfma_f32_16x16x32_bf16 v[132:135], a[196:199], v[196:199], v[132:135]
    s_waitcnt lgkmcnt(3)
    ds_read_b128 a[216:219], v50 offset:45056
    ds_read_b128 a[220:223], v51 offset:45056
    v_mfma_f32_16x16x32_bf16 v[132:135], a[200:203], v[212:215], v[132:135]
    s_waitcnt lgkmcnt(4)
    v_mfma_f32_16x16x32_bf16 v[132:135], a[204:207], v[228:231], v[132:135]
    s_waitcnt lgkmcnt(3)
    v_mfma_f32_16x16x32_bf16 v[140:143], a[208:211], v[180:183], v[76:79]
    s_waitcnt lgkmcnt(2)
    s_waitcnt vmcnt(14)
    s_barrier
    ds_read_b64_tr_b16 a[192:193], v36 offset:0
    ds_read_b64_tr_b16 a[194:195], v36 offset:4096
    s_add_u32 m0, s37, 16384
    s_add_u32 s42, s80, 196608
    buffer_load_dwordx4 v62, s[20:23], s42 offen offset:0  lds
    v_mfma_f32_16x16x32_bf16 v[140:143], a[212:215], v[196:199], v[140:143]
    s_waitcnt lgkmcnt(3)
    ds_read_b64_tr_b16 a[196:197], v37 offset:0
    ds_read_b64_tr_b16 a[198:199], v37 offset:4096
    buffer_load_dwordx4 v63, s[20:23], s42 offen offset:1024  lds
    v_mfma_f32_16x16x32_bf16 v[140:143], a[216:219], v[212:215], v[140:143]
    s_waitcnt lgkmcnt(4)
    ds_read_b64_tr_b16 a[200:201], v38 offset:0
    ds_read_b64_tr_b16 a[202:203], v38 offset:4096
    buffer_load_dwordx4 v64, s[20:23], s42 offen offset:2048  lds
    v_mfma_f32_16x16x32_bf16 v[140:143], a[220:223], v[228:231], v[140:143]
    ds_read_b64_tr_b16 a[204:205], v39 offset:0
    ds_read_b64_tr_b16 a[206:207], v39 offset:4096
    buffer_load_dwordx4 v65, s[20:23], s42 offen offset:3072  lds
    v_mfma_f32_16x16x32_bf16 v[68:71], a[224:227], v[84:87], v[68:71]
    s_waitcnt lgkmcnt(6)
    ds_read_b64_tr_b16 a[208:209], v40 offset:0
    ds_read_b64_tr_b16 a[210:211], v40 offset:4096
    s_add_u32 m0, s37, 0
    s_add_u32 s42, s39, 245760
    buffer_load_dwordx4 v56, s[8:11], s42 offen offset:0 nt lds
    v_mfma_f32_16x16x32_bf16 v[148:151], a[192:195], v[84:87], v[148:151]
    s_waitcnt lgkmcnt(6)
    ds_read_b64_tr_b16 a[212:213], v41 offset:0
    ds_read_b64_tr_b16 a[214:215], v41 offset:4096
    buffer_load_dwordx4 v57, s[8:11], s42 offen offset:1024 nt lds
    v_mfma_f32_16x16x32_bf16 v[188:191], a[196:199], v[84:87], v[188:191]
    s_waitcnt lgkmcnt(6)
    ds_read_b64_tr_b16 a[216:217], v42 offset:0
    ds_read_b64_tr_b16 a[218:219], v42 offset:4096
    buffer_load_dwordx4 v58, s[8:11], s42 offen offset:2048 nt lds
    v_max3_f32 v19, v116, v117, v118
    v_max3_f32 v19, v19, v119, v124
    v_mfma_f32_16x16x32_bf16 v[156:159], a[200:203], v[84:87], v[156:159]
    s_waitcnt lgkmcnt(6)
    ds_read_b64_tr_b16 a[220:221], v43 offset:0
    ds_read_b64_tr_b16 a[222:223], v43 offset:4096
    buffer_load_dwordx4 v59, s[8:11], s42 offen offset:3072 nt lds
    v_max3_f32 v19, v19, v125, v126
    v_max3_f32 v19, v19, v127, v132
    v_mfma_f32_16x16x32_bf16 v[204:207], a[204:207], v[84:87], v[204:207]
    s_waitcnt lgkmcnt(6)
    v_max3_f32 v19, v19, v133, v134
    v_max3_f32 v19, v19, v135, v140
    v_max3_f32 v19, v19, v141, v142
    v_max_f32 v19, v19, v143
    v_cmp_lt_f32 vcc, s47, v19
    v_mfma_f32_16x16x32_bf16 v[164:167], a[208:211], v[84:87], v[164:167]
    s_waitcnt lgkmcnt(4)
    ds_read_b64_tr_b16 a[192:193], v36 offset:8192
    ds_read_b64_tr_b16 a[194:195], v36 offset:12288
    v_mfma_f32_16x16x32_bf16 v[220:223], a[212:215], v[84:87], v[220:223]
    s_waitcnt lgkmcnt(4)
    ds_read_b64_tr_b16 a[196:197], v37 offset:8192
    ds_read_b64_tr_b16 a[198:199], v37 offset:12288
    v_mfma_f32_16x16x32_bf16 v[172:175], a[216:219], v[84:87], v[172:175]
    s_waitcnt lgkmcnt(4)
    ds_read_b64_tr_b16 a[200:201], v38 offset:8192
    ds_read_b64_tr_b16 a[202:203], v38 offset:12288
    v_mfma_f32_16x16x32_bf16 v[236:239], a[220:223], v[84:87], v[236:239]
    ds_read_b64_tr_b16 a[204:205], v39 offset:8192
    ds_read_b64_tr_b16 a[206:207], v39 offset:12288
    v_mfma_f32_16x16x32_bf16 v[68:71], a[224:227], v[100:103], v[68:71]
    s_waitcnt lgkmcnt(6)
    ds_read_b64_tr_b16 a[208:209], v40 offset:8192
    ds_read_b64_tr_b16 a[210:211], v40 offset:12288
    v_mfma_f32_16x16x32_bf16 v[148:151], a[192:195], v[100:103], v[148:151]
    s_waitcnt lgkmcnt(6)
    ds_read_b64_tr_b16 a[212:213], v41 offset:8192
    ds_read_b64_tr_b16 a[214:215], v41 offset:12288
    v_mfma_f32_16x16x32_bf16 v[188:191], a[196:199], v[100:103], v[188:191]
    s_waitcnt lgkmcnt(6)
    ds_read_b64_tr_b16 a[216:217], v42 offset:8192
    ds_read_b64_tr_b16 a[218:219], v42 offset:12288
    v_mfma_f32_16x16x32_bf16 v[156:159], a[200:203], v[100:103], v[156:159]
    s_waitcnt lgkmcnt(6)
    ds_read_b64_tr_b16 a[220:221], v43 offset:8192
    ds_read_b64_tr_b16 a[222:223], v43 offset:12288
    v_mfma_f32_16x16x32_bf16 v[204:207], a[204:207], v[100:103], v[204:207]
    s_waitcnt lgkmcnt(6)
    s_waitcnt vmcnt(14)
    s_barrier
    ds_read_b128 a[192:195], v52 offset:16384
    ds_read_b128 a[196:199], v53 offset:16384
    s_add_u32 m0, s37, 32768
    s_add_u32 s42, s39, 229376
    buffer_load_dwordx4 v60, s[12:15], s42 offen offset:0 nt lds
    v_mfma_f32_16x16x32_bf16 v[164:167], a[208:211], v[100:103], v[164:167]
    s_waitcnt lgkmcnt(6)
    buffer_load_dwordx4 v61, s[12:15], s42 offen offset:1024 nt lds
    v_mfma_f32_16x16x32_bf16 v[220:223], a[212:215], v[100:103], v[220:223]
    s_waitcnt lgkmcnt(4)
    ds_read_b128 a[200:203], v54 offset:16384
    ds_read_b128 a[204:207], v55 offset:16384
    buffer_load_dwordx4 v60, s[12:15], s42 offen offset:2048 nt lds
    v_mfma_f32_16x16x32_bf16 v[172:175], a[216:219], v[100:103], v[172:175]
    s_waitcnt lgkmcnt(4)
    buffer_load_dwordx4 v61, s[12:15], s42 offen offset:3072 nt lds
    v_mfma_f32_16x16x32_bf16 v[236:239], a[220:223], v[100:103], v[236:239]
    s_cbranch_vccnz w1_t13_slow
w1_t13_back:
    s_waitcnt lgkmcnt(3)
    ds_read_b128 a[208:211], v52 offset:20480
    ds_read_b128 a[212:215], v53 offset:20480
    v_exp_f32 v116, v116
    v_exp_f32 v117, v117
    v_mfma_f32_16x16x32_bf16 v[84:87], a[192:195], v[180:183], v[76:79]
    s_waitcnt lgkmcnt(4)
    v_exp_f32 v118, v118
    v_exp_f32 v119, v119
    v_exp_f32 v124, v124
    v_mfma_f32_16x16x32_bf16 v[84:87], a[196:199], v[196:199], v[84:87]
    s_waitcnt lgkmcnt(3)
    ds_read_b128 a[216:219], v54 offset:20480
    ds_read_b128 a[220:223], v55 offset:20480
    v_exp_f32 v125, v125
    v_exp_f32 v126, v126
    v_mfma_f32_16x16x32_bf16 v[84:87], a[200:203], v[212:215], v[84:87]
    s_waitcnt lgkmcnt(4)
    v_exp_f32 v127, v127
    v_cvt_pk_bf16_f32 v116, v116, v117
    v_cvt_pk_bf16_f32 v117, v118, v119
    v_cvt_pk_bf16_f32 v118, v124, v125
    v_cvt_pk_bf16_f32 v119, v126, v127
    v_mfma_f32_16x16x32_bf16 v[84:87], a[204:207], v[228:231], v[84:87]
    s_waitcnt lgkmcnt(3)
    ds_read_b128 a[192:195], v52 offset:24576
    ds_read_b128 a[196:199], v53 offset:24576
    v_exp_f32 v132, v132
    v_exp_f32 v133, v133
    v_mfma_f32_16x16x32_bf16 v[92:95], a[208:211], v[180:183], v[76:79]
    s_waitcnt lgkmcnt(4)
    v_exp_f32 v134, v134
    v_exp_f32 v135, v135
    v_exp_f32 v140, v140
    v_mfma_f32_16x16x32_bf16 v[92:95], a[212:215], v[196:199], v[92:95]
    s_waitcnt lgkmcnt(3)
    ds_read_b128 a[200:203], v54 offset:24576
    ds_read_b128 a[204:207], v55 offset:24576
    v_exp_f32 v141, v141
    v_exp_f32 v142, v142
    v_mfma_f32_16x16x32_bf16 v[92:95], a[216:219], v[212:215], v[92:95]
    s_waitcnt lgkmcnt(4)
    v_exp_f32 v143, v143
    v_cvt_pk_bf16_f32 v132, v132, v133
    v_cvt_pk_bf16_f32 v133, v134, v135
    v_cvt_pk_bf16_f32 v134, v140, v141
    v_cvt_pk_bf16_f32 v135, v142, v143
    v_mfma_f32_16x16x32_bf16 v[92:95], a[220:223], v[228:231], v[92:95]
    s_waitcnt lgkmcnt(3)
    ds_read_b128 a[208:211], v52 offset:28672
    ds_read_b128 a[212:215], v53 offset:28672
    v_mfma_f32_16x16x32_bf16 v[100:103], a[192:195], v[180:183], v[76:79]
    s_waitcnt lgkmcnt(4)
    v_mfma_f32_16x16x32_bf16 v[100:103], a[196:199], v[196:199], v[100:103]
    s_waitcnt lgkmcnt(3)
    ds_read_b128 a[216:219], v54 offset:28672
    ds_read_b128 a[220:223], v55 offset:28672
    v_mfma_f32_16x16x32_bf16 v[100:103], a[200:203], v[212:215], v[100:103]
    s_waitcnt lgkmcnt(4)
    v_mfma_f32_16x16x32_bf16 v[100:103], a[204:207], v[228:231], v[100:103]
    s_waitcnt lgkmcnt(3)
    v_mfma_f32_16x16x32_bf16 v[108:111], a[208:211], v[180:183], v[76:79]
    s_waitcnt lgkmcnt(2)
    s_waitcnt vmcnt(12)
    s_barrier
    v_cmp_gt_u32 s[62:63], 3, v10
    s_nop 0
    s_cmp_lg_u64 s[62:63], 0
    s_cbranch_scc1 w1_pcnt_spin
w1_pcnt_back:
    ds_read_b64_tr_b16 a[192:193], v28 offset:49152
    ds_read_b64_tr_b16 a[194:195], v28 offset:53248
    s_add_u32 m0, s37, 98304
    s_add_u32 s42, s39, 245760
    buffer_load_dwordx4 v60, s[12:15], s42 offen offset:0 nt lds
    v_mfma_f32_16x16x32_bf16 v[108:111], a[212:215], v[196:199], v[108:111]
    s_waitcnt lgkmcnt(3)
    ds_read_b64_tr_b16 a[196:197], v29 offset:49152
    ds_read_b64_tr_b16 a[198:199], v29 offset:53248
    buffer_load_dwordx4 v61, s[12:15], s42 offen offset:1024 nt lds
    v_mfma_f32_16x16x32_bf16 v[108:111], a[216:219], v[212:215], v[108:111]
    s_waitcnt lgkmcnt(4)
    ds_read_b64_tr_b16 a[200:201], v30 offset:49152
    ds_read_b64_tr_b16 a[202:203], v30 offset:53248
    buffer_load_dwordx4 v60, s[12:15], s42 offen offset:2048 nt lds
    v_mfma_f32_16x16x32_bf16 v[108:111], a[220:223], v[228:231], v[108:111]
    ds_read_b64_tr_b16 a[204:205], v31 offset:49152
    ds_read_b64_tr_b16 a[206:207], v31 offset:53248
    buffer_load_dwordx4 v61, s[12:15], s42 offen offset:3072 nt lds
    v_mfma_f32_16x16x32_bf16 v[68:71], a[224:227], v[116:119], v[68:71]
    s_waitcnt lgkmcnt(6)
    ds_read_b64_tr_b16 a[208:209], v32 offset:49152
    ds_read_b64_tr_b16 a[210:211], v32 offset:53248
    v_mfma_f32_16x16x32_bf16 v[148:151], a[192:195], v[116:119], v[148:151]
    s_waitcnt lgkmcnt(6)
    ds_read_b64_tr_b16 a[212:213], v33 offset:49152
    ds_read_b64_tr_b16 a[214:215], v33 offset:53248
    v_mfma_f32_16x16x32_bf16 v[188:191], a[196:199], v[116:119], v[188:191]
    s_waitcnt lgkmcnt(6)
    ds_read_b64_tr_b16 a[216:217], v34 offset:49152
    ds_read_b64_tr_b16 a[218:219], v34 offset:53248
    v_max3_f32 v19, v84, v85, v86
    v_max3_f32 v19, v19, v87, v92
    v_max3_f32 v19, v19, v93, v94
    v_max3_f32 v19, v19, v95, v100
    v_mfma_f32_16x16x32_bf16 v[156:159], a[200:203], v[116:119], v[156:159]
    s_waitcnt lgkmcnt(6)
    ds_read_b64_tr_b16 a[220:221], v35 offset:49152
    ds_read_b64_tr_b16 a[222:223], v35 offset:53248
    v_max3_f32 v19, v19, v101, v102
    v_max3_f32 v19, v19, v103, v108
    v_max3_f32 v19, v19, v109, v110
    v_max_f32 v19, v19, v111
    v_mfma_f32_16x16x32_bf16 v[204:207], a[204:207], v[116:119], v[204:207]
    s_waitcnt lgkmcnt(6)
    v_cmp_lt_f32 vcc, s47, v19
    v_mfma_f32_16x16x32_bf16 v[164:167], a[208:211], v[116:119], v[164:167]
    s_waitcnt lgkmcnt(4)
    ds_read_b64_tr_b16 a[192:193], v28 offset:57344
    ds_read_b64_tr_b16 a[194:195], v28 offset:61440
    v_mfma_f32_16x16x32_bf16 v[220:223], a[212:215], v[116:119], v[220:223]
    s_waitcnt lgkmcnt(4)
    ds_read_b64_tr_b16 a[196:197], v29 offset:57344
    ds_read_b64_tr_b16 a[198:199], v29 offset:61440
    v_mfma_f32_16x16x32_bf16 v[172:175], a[216:219], v[116:119], v[172:175]
    s_waitcnt lgkmcnt(4)
    ds_read_b64_tr_b16 a[200:201], v30 offset:57344
    ds_read_b64_tr_b16 a[202:203], v30 offset:61440
    v_mfma_f32_16x16x32_bf16 v[236:239], a[220:223], v[116:119], v[236:239]
    ds_read_b64_tr_b16 a[204:205], v31 offset:57344
    ds_read_b64_tr_b16 a[206:207], v31 offset:61440
    v_mfma_f32_16x16x32_bf16 v[68:71], a[224:227], v[132:135], v[68:71]
    s_waitcnt lgkmcnt(6)
    ds_read_b64_tr_b16 a[208:209], v32 offset:57344
    ds_read_b64_tr_b16 a[210:211], v32 offset:61440
    v_mfma_f32_16x16x32_bf16 v[148:151], a[192:195], v[132:135], v[148:151]
    s_waitcnt lgkmcnt(6)
    ds_read_b64_tr_b16 a[212:213], v33 offset:57344
    ds_read_b64_tr_b16 a[214:215], v33 offset:61440
    v_mfma_f32_16x16x32_bf16 v[188:191], a[196:199], v[132:135], v[188:191]
    s_waitcnt lgkmcnt(6)
    ds_read_b64_tr_b16 a[216:217], v34 offset:57344
    ds_read_b64_tr_b16 a[218:219], v34 offset:61440
    v_mfma_f32_16x16x32_bf16 v[156:159], a[200:203], v[132:135], v[156:159]
    s_waitcnt lgkmcnt(6)
    ds_read_b64_tr_b16 a[220:221], v35 offset:57344
    ds_read_b64_tr_b16 a[222:223], v35 offset:61440
    v_mfma_f32_16x16x32_bf16 v[204:207], a[204:207], v[132:135], v[204:207]
    s_waitcnt lgkmcnt(6)
    s_waitcnt vmcnt(8)
    s_barrier
    ds_read_b128 a[192:195], v44 offset:0
    ds_read_b128 a[196:199], v45 offset:0
    s_add_u32 s42, s84, 0
    buffer_store_dwordx4 a[0:3], v16, s[24:27], s42 offen offset:0 sc1
    v_mfma_f32_16x16x32_bf16 v[164:167], a[208:211], v[132:135], v[164:167]
    s_waitcnt lgkmcnt(6)
    buffer_store_dwordx4 a[8:11], v16, s[24:27], s42 offen offset:1024 sc1
    v_mfma_f32_16x16x32_bf16 v[220:223], a[212:215], v[132:135], v[220:223]
    s_waitcnt lgkmcnt(4)
    ds_read_b128 a[200:203], v46 offset:0
    ds_read_b128 a[204:207], v47 offset:0
    v_mfma_f32_16x16x32_bf16 v[172:175], a[216:219], v[132:135], v[172:175]
    s_waitcnt lgkmcnt(4)
    v_mfma_f32_16x16x32_bf16 v[236:239], a[220:223], v[132:135], v[236:239]
    s_cbranch_vccnz w1_t14_slow
w1_t14_back:
    s_waitcnt lgkmcnt(3)
    ds_read_b128 a[208:211], v44 offset:4096
    ds_read_b128 a[212:215], v45 offset:4096
    v_exp_f32 v84, v84
    v_exp_f32 v85, v85
    v_mfma_f32_16x16x32_bf16 v[116:119], a[192:195], v[180:183], v[76:79]
    s_waitcnt lgkmcnt(4)
    v_exp_f32 v86, v86
    v_exp_f32 v87, v87
    v_exp_f32 v92, v92
    v_mfma_f32_16x16x32_bf16 v[116:119], a[196:199], v[196:199], v[116:119]
    s_waitcnt lgkmcnt(3)
    ds_read_b128 a[216:219], v46 offset:4096
    ds_read_b128 a[220:223], v47 offset:4096
    v_exp_f32 v93, v93
    v_exp_f32 v94, v94
    v_mfma_f32_16x16x32_bf16 v[116:119], a[200:203], v[212:215], v[116:119]
    s_waitcnt lgkmcnt(4)
    v_exp_f32 v95, v95
    v_cvt_pk_bf16_f32 v84, v84, v85
    v_cvt_pk_bf16_f32 v85, v86, v87
    v_cvt_pk_bf16_f32 v86, v92, v93
    v_cvt_pk_bf16_f32 v87, v94, v95
    v_mfma_f32_16x16x32_bf16 v[116:119], a[204:207], v[228:231], v[116:119]
    s_waitcnt lgkmcnt(3)
    ds_read_b128 a[192:195], v44 offset:8192
    ds_read_b128 a[196:199], v45 offset:8192
    v_exp_f32 v100, v100
    v_exp_f32 v101, v101
    v_mfma_f32_16x16x32_bf16 v[124:127], a[208:211], v[180:183], v[76:79]
    s_waitcnt lgkmcnt(4)
    v_exp_f32 v102, v102
    v_exp_f32 v103, v103
    v_exp_f32 v108, v108
    v_mfma_f32_16x16x32_bf16 v[124:127], a[212:215], v[196:199], v[124:127]
    s_waitcnt lgkmcnt(3)
    ds_read_b128 a[200:203], v46 offset:8192
    ds_read_b128 a[204:207], v47 offset:8192
    v_exp_f32 v109, v109
    v_exp_f32 v110, v110
    v_mfma_f32_16x16x32_bf16 v[124:127], a[216:219], v[212:215], v[124:127]
    s_waitcnt lgkmcnt(4)
    v_exp_f32 v111, v111
    v_cvt_pk_bf16_f32 v100, v100, v101
    v_cvt_pk_bf16_f32 v101, v102, v103
    v_cvt_pk_bf16_f32 v102, v108, v109
    v_cvt_pk_bf16_f32 v103, v110, v111
    v_mfma_f32_16x16x32_bf16 v[124:127], a[220:223], v[228:231], v[124:127]
    s_waitcnt lgkmcnt(3)
    ds_read_b128 a[208:211], v44 offset:12288
    ds_read_b128 a[212:215], v45 offset:12288
    v_mfma_f32_16x16x32_bf16 v[132:135], a[192:195], v[180:183], v[76:79]
    s_waitcnt lgkmcnt(4)
    v_mfma_f32_16x16x32_bf16 v[132:135], a[196:199], v[196:199], v[132:135]
    s_waitcnt lgkmcnt(3)
    ds_read_b128 a[216:219], v46 offset:12288
    ds_read_b128 a[220:223], v47 offset:12288
    v_mfma_f32_16x16x32_bf16 v[132:135], a[200:203], v[212:215], v[132:135]
    s_waitcnt lgkmcnt(4)
    v_mfma_f32_16x16x32_bf16 v[132:135], a[204:207], v[228:231], v[132:135]
    s_waitcnt lgkmcnt(3)
    v_mfma_f32_16x16x32_bf16 v[140:143], a[208:211], v[180:183], v[76:79]
    s_waitcnt lgkmcnt(2)
    s_waitcnt vmcnt(6)
    s_barrier
    ds_read_b64_tr_b16 a[192:193], v20 offset:32768
    ds_read_b64_tr_b16 a[194:195], v20 offset:36864
    s_add_u32 s42, s84, 3670016
    buffer_store_dwordx4 a[16:19], v16, s[24:27], s42 offen offset:0 sc1
    v_mfma_f32_16x16x32_bf16 v[140:143], a[212:215], v[196:199], v[140:143]
    s_waitcnt lgkmcnt(3)
    ds_read_b64_tr_b16 a[196:197], v21 offset:32768
    ds_read_b64_tr_b16 a[198:199], v21 offset:36864
    buffer_store_dwordx4 a[24:27], v16, s[24:27], s42 offen offset:1024 sc1
    v_mfma_f32_16x16x32_bf16 v[140:143], a[216:219], v[212:215], v[140:143]
    s_waitcnt lgkmcnt(4)
    ds_read_b64_tr_b16 a[200:201], v22 offset:32768
    ds_read_b64_tr_b16 a[202:203], v22 offset:36864
    s_add_u32 m0, s37, 131072
    s_add_u32 s42, s81, 0
    buffer_load_dwordx4 v62, s[20:23], s42 offen offset:0  lds
    v_mfma_f32_16x16x32_bf16 v[140:143], a[220:223], v[228:231], v[140:143]
    ds_read_b64_tr_b16 a[204:205], v23 offset:32768
    ds_read_b64_tr_b16 a[206:207], v23 offset:36864
    buffer_load_dwordx4 v63, s[20:23], s42 offen offset:1024  lds
    v_mfma_f32_16x16x32_bf16 v[68:71], a[224:227], v[84:87], v[68:71]
    s_waitcnt lgkmcnt(6)
    ds_read_b64_tr_b16 a[208:209], v24 offset:32768
    ds_read_b64_tr_b16 a[210:211], v24 offset:36864
    buffer_load_dwordx4 v64, s[20:23], s42 offen offset:2048  lds
    v_mfma_f32_16x16x32_bf16 v[148:151], a[192:195], v[84:87], v[148:151]
    s_waitcnt lgkmcnt(6)
    ds_read_b64_tr_b16 a[212:213], v25 offset:32768
    ds_read_b64_tr_b16 a[214:215], v25 offset:36864
    buffer_load_dwordx4 v65, s[20:23], s42 offen offset:3072  lds
    v_mfma_f32_16x16x32_bf16 v[188:191], a[196:199], v[84:87], v[188:191]
    s_waitcnt lgkmcnt(6)
    ds_read_b64_tr_b16 a[216:217], v26 offset:32768
    ds_read_b64_tr_b16 a[218:219], v26 offset:36864
    v_max3_f32 v19, v116, v117, v118
    v_max3_f32 v19, v19, v119, v124
    v_max3_f32 v19, v19, v125, v126
    v_max3_f32 v19, v19, v127, v132
    v_mfma_f32_16x16x32_bf16 v[156:159], a[200:203], v[84:87], v[156:159]
    s_waitcnt lgkmcnt(6)
    ds_read_b64_tr_b16 a[220:221], v27 offset:32768
    ds_read_b64_tr_b16 a[222:223], v27 offset:36864
    v_max3_f32 v19, v19, v133, v134
    v_max3_f32 v19, v19, v135, v140
    v_max3_f32 v19, v19, v141, v142
    v_max_f32 v19, v19, v143
    v_mfma_f32_16x16x32_bf16 v[204:207], a[204:207], v[84:87], v[204:207]
    s_waitcnt lgkmcnt(6)
    v_cmp_lt_f32 vcc, s47, v19
    v_mfma_f32_16x16x32_bf16 v[164:167], a[208:211], v[84:87], v[164:167]
    s_waitcnt lgkmcnt(4)
    ds_read_b64_tr_b16 a[192:193], v20 offset:40960
    ds_read_b64_tr_b16 a[194:195], v20 offset:45056
    v_mfma_f32_16x16x32_bf16 v[220:223], a[212:215], v[84:87], v[220:223]
    s_waitcnt lgkmcnt(4)
    ds_read_b64_tr_b16 a[196:197], v21 offset:40960
    ds_read_b64_tr_b16 a[198:199], v21 offset:45056
    v_mfma_f32_16x16x32_bf16 v[172:175], a[216:219], v[84:87], v[172:175]
    s_waitcnt lgkmcnt(4)
    ds_read_b64_tr_b16 a[200:201], v22 offset:40960
    ds_read_b64_tr_b16 a[202:203], v22 offset:45056
    v_mfma_f32_16x16x32_bf16 v[236:239], a[220:223], v[84:87], v[236:239]
    ds_read_b64_tr_b16 a[204:205], v23 offset:40960
    ds_read_b64_tr_b16 a[206:207], v23 offset:45056
    v_mfma_f32_16x16x32_bf16 v[68:71], a[224:227], v[100:103], v[68:71]
    s_waitcnt lgkmcnt(6)
    ds_read_b64_tr_b16 a[208:209], v24 offset:40960
    ds_read_b64_tr_b16 a[210:211], v24 offset:45056
    v_mfma_f32_16x16x32_bf16 v[148:151], a[192:195], v[100:103], v[148:151]
    s_waitcnt lgkmcnt(6)
    ds_read_b64_tr_b16 a[212:213], v25 offset:40960
    ds_read_b64_tr_b16 a[214:215], v25 offset:45056
    v_mfma_f32_16x16x32_bf16 v[188:191], a[196:199], v[100:103], v[188:191]
    s_waitcnt lgkmcnt(6)
    ds_read_b64_tr_b16 a[216:217], v26 offset:40960
    ds_read_b64_tr_b16 a[218:219], v26 offset:45056
    v_mfma_f32_16x16x32_bf16 v[156:159], a[200:203], v[100:103], v[156:159]
    s_waitcnt lgkmcnt(6)
    ds_read_b64_tr_b16 a[220:221], v27 offset:40960
    ds_read_b64_tr_b16 a[222:223], v27 offset:45056
    v_mfma_f32_16x16x32_bf16 v[204:207], a[204:207], v[100:103], v[204:207]
    s_waitcnt lgkmcnt(6)
    s_barrier
    ds_read_b64_tr_b16 a[192:193], v28 offset:16384
    ds_read_b64_tr_b16 a[194:195], v28 offset:20480
    s_add_u32 m0, s37, 147456
    s_add_u32 s42, s82, 0
    buffer_load_dwordx4 v62, s[20:23], s42 offen offset:0  lds
    v_mfma_f32_16x16x32_bf16 v[164:167], a[208:211], v[100:103], v[164:167]
    s_waitcnt lgkmcnt(6)
    ds_read_b64_tr_b16 a[196:197], v29 offset:16384
    ds_read_b64_tr_b16 a[198:199], v29 offset:20480
    buffer_load_dwordx4 v63, s[20:23], s42 offen offset:1024  lds
    v_mfma_f32_16x16x32_bf16 v[220:223], a[212:215], v[100:103], v[220:223]
    s_waitcnt lgkmcnt(6)
    ds_read_b64_tr_b16 a[200:201], v30 offset:16384
    ds_read_b64_tr_b16 a[202:203], v30 offset:20480
    buffer_load_dwordx4 v64, s[20:23], s42 offen offset:2048  lds
    v_mfma_f32_16x16x32_bf16 v[172:175], a[216:219], v[100:103], v[172:175]
    s_waitcnt lgkmcnt(6)
    ds_read_b64_tr_b16 a[204:205], v31 offset:16384
    ds_read_b64_tr_b16 a[206:207], v31 offset:20480
    buffer_load_dwordx4 v65, s[20:23], s42 offen offset:3072  lds
    v_mfma_f32_16x16x32_bf16 v[236:239], a[220:223], v[100:103], v[236:239]
    s_cbranch_vccnz w1_t15_slow
w1_t15_back:
    s_waitcnt lgkmcnt(6)
    ds_read_b64_tr_b16 a[208:209], v32 offset:16384
    ds_read_b64_tr_b16 a[210:211], v32 offset:20480
    v_exp_f32 v116, v116
    v_exp_f32 v117, v117
    v_mfma_f32_16x16x32_bf16 v[180:183], a[192:195], a[0:3], 0
    s_waitcnt lgkmcnt(6)
    ds_read_b64_tr_b16 a[212:213], v33 offset:16384
    ds_read_b64_tr_b16 a[214:215], v33 offset:20480
    v_exp_f32 v118, v118
    v_exp_f32 v119, v119
    v_mfma_f32_16x16x32_bf16 v[84:87], a[196:199], a[0:3], 0
    s_waitcnt lgkmcnt(6)
    ds_read_b64_tr_b16 a[216:217], v34 offset:16384
    ds_read_b64_tr_b16 a[218:219], v34 offset:20480
    v_exp_f32 v124, v124
    v_exp_f32 v125, v125
    v_mfma_f32_16x16x32_bf16 v[196:199], a[200:203], a[0:3], 0
    s_waitcnt lgkmcnt(6)
    ds_read_b64_tr_b16 a[220:221], v35 offset:16384
    ds_read_b64_tr_b16 a[222:223], v35 offset:20480
    v_exp_f32 v126, v126
    v_exp_f32 v127, v127
    v_mfma_f32_16x16x32_bf16 v[92:95], a[204:207], a[0:3], 0
    s_waitcnt lgkmcnt(6)
    ds_read_b64_tr_b16 a[192:193], v28 offset:24576
    ds_read_b64_tr_b16 a[194:195], v28 offset:28672
    v_cvt_pk_bf16_f32 v116, v116, v117
    v_cvt_pk_bf16_f32 v117, v118, v119
    v_cvt_pk_bf16_f32 v118, v124, v125
    v_cvt_pk_bf16_f32 v119, v126, v127
    v_mfma_f32_16x16x32_bf16 v[212:215], a[208:211], a[0:3], 0
    s_waitcnt lgkmcnt(6)
    ds_read_b64_tr_b16 a[196:197], v29 offset:24576
    ds_read_b64_tr_b16 a[198:199], v29 offset:28672
    v_exp_f32 v132, v132
    v_exp_f32 v133, v133
    v_mfma_f32_16x16x32_bf16 v[100:103], a[212:215], a[0:3], 0
    s_waitcnt lgkmcnt(6)
    ds_read_b64_tr_b16 a[200:201], v30 offset:24576
    ds_read_b64_tr_b16 a[202:203], v30 offset:28672
    v_exp_f32 v134, v134
    v_exp_f32 v135, v135
    v_mfma_f32_16x16x32_bf16 v[228:231], a[216:219], a[0:3], 0
    s_waitcnt lgkmcnt(6)
    ds_read_b64_tr_b16 a[204:205], v31 offset:24576
    ds_read_b64_tr_b16 a[206:207], v31 offset:28672
    v_exp_f32 v140, v140
    v_exp_f32 v141, v141
    v_mfma_f32_16x16x32_bf16 v[108:111], a[220:223], a[0:3], 0
    s_waitcnt lgkmcnt(6)
    ds_read_b64_tr_b16 a[208:209], v32 offset:24576
    ds_read_b64_tr_b16 a[210:211], v32 offset:28672
    v_exp_f32 v142, v142
    v_exp_f32 v143, v143
    v_mfma_f32_16x16x32_bf16 v[180:183], a[192:195], a[8:11], v[180:183]
    s_waitcnt lgkmcnt(6)
    ds_read_b64_tr_b16 a[212:213], v33 offset:24576
    ds_read_b64_tr_b16 a[214:215], v33 offset:28672
    v_cvt_pk_bf16_f32 v132, v132, v133
    v_cvt_pk_bf16_f32 v133, v134, v135
    v_cvt_pk_bf16_f32 v134, v140, v141
    v_cvt_pk_bf16_f32 v135, v142, v143
    v_mfma_f32_16x16x32_bf16 v[84:87], a[196:199], a[8:11], v[84:87]
    s_waitcnt lgkmcnt(6)
    ds_read_b64_tr_b16 a[216:217], v34 offset:24576
    ds_read_b64_tr_b16 a[218:219], v34 offset:28672
    v_mfma_f32_16x16x32_bf16 v[196:199], a[200:203], a[8:11], v[196:199]
    s_waitcnt lgkmcnt(6)
    ds_read_b64_tr_b16 a[220:221], v35 offset:24576
    ds_read_b64_tr_b16 a[222:223], v35 offset:28672
    v_mfma_f32_16x16x32_bf16 v[92:95], a[204:207], a[8:11], v[92:95]
    s_waitcnt lgkmcnt(6)
    s_barrier
    s_waitcnt vmcnt(8)
    s_add_u32 s43, s53, 0
    buffer_store_dword v13, v14, s[24:27], s43 offen sc1
    ds_read_b64_tr_b16 a[192:193], v28 offset:0
    ds_read_b64_tr_b16 a[194:195], v28 offset:4096
    s_add_u32 m0, s37, 114688
    s_add_u32 s42, s83, 0
    buffer_load_dwordx4 v62, s[20:23], s42 offen offset:0  lds
    v_mfma_f32_16x16x32_bf16 v[212:215], a[208:211], a[8:11], v[212:215]
    s_waitcnt lgkmcnt(6)
    ds_read_b64_tr_b16 a[196:197], v29 offset:0
    ds_read_b64_tr_b16 a[198:199], v29 offset:4096
    buffer_load_dwordx4 v63, s[20:23], s42 offen offset:1024  lds
    v_mfma_f32_16x16x32_bf16 v[100:103], a[212:215], a[8:11], v[100:103]
    s_waitcnt lgkmcnt(6)
    ds_read_b64_tr_b16 a[200:201], v30 offset:0
    ds_read_b64_tr_b16 a[202:203], v30 offset:4096
    buffer_load_dwordx4 v64, s[20:23], s42 offen offset:2048  lds
    v_mfma_f32_16x16x32_bf16 v[228:231], a[216:219], a[8:11], v[228:231]
    s_waitcnt lgkmcnt(6)
    ds_read_b64_tr_b16 a[204:205], v31 offset:0
    ds_read_b64_tr_b16 a[206:207], v31 offset:4096
    buffer_load_dwordx4 v65, s[20:23], s42 offen offset:3072  lds
    v_mfma_f32_16x16x32_bf16 v[108:111], a[220:223], a[8:11], v[108:111]
    s_waitcnt lgkmcnt(6)
    ds_read_b64_tr_b16 a[208:209], v32 offset:0
    ds_read_b64_tr_b16 a[210:211], v32 offset:4096
    v_mfma_f32_16x16x32_bf16 v[180:183], a[192:195], a[16:19], v[180:183]
    s_waitcnt lgkmcnt(6)
    ds_read_b64_tr_b16 a[212:213], v33 offset:0
    ds_read_b64_tr_b16 a[214:215], v33 offset:4096
    v_mfma_f32_16x16x32_bf16 v[84:87], a[196:199], a[16:19], v[84:87]
    s_waitcnt lgkmcnt(6)
    ds_read_b64_tr_b16 a[216:217], v34 offset:0
    ds_read_b64_tr_b16 a[218:219], v34 offset:4096
    v_mfma_f32_16x16x32_bf16 v[196:199], a[200:203], a[16:19], v[196:199]
    s_waitcnt lgkmcnt(6)
    ds_read_b64_tr_b16 a[220:221], v35 offset:0
    ds_read_b64_tr_b16 a[222:223], v35 offset:4096
    v_mfma_f32_16x16x32_bf16 v[92:95], a[204:207], a[16:19], v[92:95]
    s_waitcnt lgkmcnt(6)
    ds_read_b64_tr_b16 a[192:193], v28 offset:8192
    ds_read_b64_tr_b16 a[194:195], v28 offset:12288
    v_mfma_f32_16x16x32_bf16 v[212:215], a[208:211], a[16:19], v[212:215]
    s_waitcnt lgkmcnt(6)
    ds_read_b64_tr_b16 a[196:197], v29 offset:8192
    ds_read_b64_tr_b16 a[198:199], v29 offset:12288
    v_mfma_f32_16x16x32_bf16 v[100:103], a[212:215], a[16:19], v[100:103]
    s_waitcnt lgkmcnt(6)
    ds_read_b64_tr_b16 a[200:201], v30 offset:8192
    ds_read_b64_tr_b16 a[202:203], v30 offset:12288
    v_mfma_f32_16x16x32_bf16 v[228:231], a[216:219], a[16:19], v[228:231]
    s_waitcnt lgkmcnt(6)
    ds_read_b64_tr_b16 a[204:205], v31 offset:8192
    ds_read_b64_tr_b16 a[206:207], v31 offset:12288
    v_mfma_f32_16x16x32_bf16 v[108:111], a[220:223], a[16:19], v[108:111]
    s_waitcnt lgkmcnt(6)
    ds_read_b64_tr_b16 a[208:209], v32 offset:8192
    ds_read_b64_tr_b16 a[210:211], v32 offset:12288
    v_mfma_f32_16x16x32_bf16 v[180:183], a[192:195], a[24:27], v[180:183]
    s_waitcnt lgkmcnt(6)
    ds_read_b64_tr_b16 a[212:213], v33 offset:8192
    ds_read_b64_tr_b16 a[214:215], v33 offset:12288
    v_mfma_f32_16x16x32_bf16 v[84:87], a[196:199], a[24:27], v[84:87]
    s_waitcnt lgkmcnt(6)
    ds_read_b64_tr_b16 a[216:217], v34 offset:8192
    ds_read_b64_tr_b16 a[218:219], v34 offset:12288
    v_mfma_f32_16x16x32_bf16 v[196:199], a[200:203], a[24:27], v[196:199]
    s_waitcnt lgkmcnt(6)
    ds_read_b64_tr_b16 a[220:221], v35 offset:8192
    ds_read_b64_tr_b16 a[222:223], v35 offset:12288
    v_mfma_f32_16x16x32_bf16 v[92:95], a[204:207], a[24:27], v[92:95]
    s_waitcnt lgkmcnt(6)
    v_mfma_f32_16x16x32_bf16 v[212:215], a[208:211], a[24:27], v[212:215]
    s_waitcnt lgkmcnt(4)
    s_barrier
    s_add_u32 s43, s54, 0
    buffer_load_dword v10, v11, s[24:27], s43 offen sc1
    ds_read_b64_tr_b16 a[192:193], v28 offset:32768
    ds_read_b64_tr_b16 a[194:195], v28 offset:36864
    s_add_u32 m0, s37, 0
    s_add_u32 s42, s81, 65536
    buffer_load_dwordx4 v62, s[20:23], s42 offen offset:0  lds
    v_mfma_f32_16x16x32_bf16 v[100:103], a[212:215], a[24:27], v[100:103]
    s_waitcnt lgkmcnt(4)
    ds_read_b64_tr_b16 a[196:197], v29 offset:32768
    ds_read_b64_tr_b16 a[198:199], v29 offset:36864
    buffer_load_dwordx4 v63, s[20:23], s42 offen offset:1024  lds
    v_mfma_f32_16x16x32_bf16 v[228:231], a[216:219], a[24:27], v[228:231]
    s_waitcnt lgkmcnt(4)
    ds_read_b64_tr_b16 a[200:201], v30 offset:32768
    ds_read_b64_tr_b16 a[202:203], v30 offset:36864
    buffer_load_dwordx4 v64, s[20:23], s42 offen offset:2048  lds
    v_mfma_f32_16x16x32_bf16 v[108:111], a[220:223], a[24:27], v[108:111]
    ds_read_b64_tr_b16 a[204:205], v31 offset:32768
    ds_read_b64_tr_b16 a[206:207], v31 offset:36864
    buffer_load_dwordx4 v65, s[20:23], s42 offen offset:3072  lds
    v_mfma_f32_16x16x32_bf16 v[68:71], a[224:227], v[116:119], v[68:71]
    s_waitcnt lgkmcnt(6)
    ds_read_b64_tr_b16 a[208:209], v32 offset:32768
    ds_read_b64_tr_b16 a[210:211], v32 offset:36864
    v_mfma_f32_16x16x32_bf16 v[148:151], a[192:195], v[116:119], v[148:151]
    s_waitcnt lgkmcnt(6)
    ds_read_b64_tr_b16 a[212:213], v33 offset:32768
    ds_read_b64_tr_b16 a[214:215], v33 offset:36864
    v_mfma_f32_16x16x32_bf16 v[188:191], a[196:199], v[116:119], v[188:191]
    s_waitcnt lgkmcnt(6)
    ds_read_b64_tr_b16 a[216:217], v34 offset:32768
    ds_read_b64_tr_b16 a[218:219], v34 offset:36864
    v_mfma_f32_16x16x32_bf16 v[156:159], a[200:203], v[116:119], v[156:159]
    s_waitcnt lgkmcnt(6)
    ds_read_b64_tr_b16 a[220:221], v35 offset:32768
    ds_read_b64_tr_b16 a[222:223], v35 offset:36864
    v_mfma_f32_16x16x32_bf16 v[204:207], a[204:207], v[116:119], v[204:207]
    s_waitcnt lgkmcnt(6)
    v_mfma_f32_16x16x32_bf16 v[164:167], a[208:211], v[116:119], v[164:167]
    s_waitcnt lgkmcnt(4)
    ds_read_b64_tr_b16 a[192:193], v28 offset:40960
    ds_read_b64_tr_b16 a[194:195], v28 offset:45056
    v_mfma_f32_16x16x32_bf16 v[220:223], a[212:215], v[116:119], v[220:223]
    s_waitcnt lgkmcnt(4)
    ds_read_b64_tr_b16 a[196:197], v29 offset:40960
    ds_read_b64_tr_b16 a[198:199], v29 offset:45056
    v_mfma_f32_16x16x32_bf16 v[172:175], a[216:219], v[116:119], v[172:175]
    s_waitcnt lgkmcnt(4)
    ds_read_b64_tr_b16 a[200:201], v30 offset:40960
    ds_read_b64_tr_b16 a[202:203], v30 offset:45056
    v_mfma_f32_16x16x32_bf16 v[236:239], a[220:223], v[116:119], v[236:239]
    ds_read_b64_tr_b16 a[204:205], v31 offset:40960
    ds_read_b64_tr_b16 a[206:207], v31 offset:45056
    v_mfma_f32_16x16x32_bf16 v[68:71], a[224:227], v[132:135], v[68:71]
    s_waitcnt lgkmcnt(6)
    ds_read_b64_tr_b16 a[208:209], v32 offset:40960
    ds_read_b64_tr_b16 a[210:211], v32 offset:45056
    v_mfma_f32_16x16x32_bf16 v[148:151], a[192:195], v[132:135], v[148:151]
    s_waitcnt lgkmcnt(6)
    ds_read_b64_tr_b16 a[212:213], v33 offset:40960
    ds_read_b64_tr_b16 a[214:215], v33 offset:45056
    v_mfma_f32_16x16x32_bf16 v[188:191], a[196:199], v[132:135], v[188:191]
    s_waitcnt lgkmcnt(6)
    ds_read_b64_tr_b16 a[216:217], v34 offset:40960
    ds_read_b64_tr_b16 a[218:219], v34 offset:45056
    v_mfma_f32_16x16x32_bf16 v[156:159], a[200:203], v[132:135], v[156:159]
    s_waitcnt lgkmcnt(6)
    ds_read_b64_tr_b16 a[220:221], v35 offset:40960
    ds_read_b64_tr_b16 a[222:223], v35 offset:45056
    v_mfma_f32_16x16x32_bf16 v[204:207], a[204:207], v[132:135], v[204:207]
    s_waitcnt lgkmcnt(6)
    s_barrier
    s_waitcnt vmcnt(4)
    v_cmp_ne_u32 s[62:63], 1, v10
    s_nop 0
    s_cmp_lg_u64 s[62:63], 0
    s_cbranch_scc1 w1_p0_spin
w1_p0_back:
    ds_read_b64_tr_b16 a[192:193], v20 offset:49152
    ds_read_b64_tr_b16 a[194:195], v20 offset:53248
    s_add_u32 s42, s85, 0
    buffer_load_dwordx4 a[32:35], v16, s[24:27], s42 offen offset:0 sc1
    v_mfma_f32_16x16x32_bf16 v[164:167], a[208:211], v[132:135], v[164:167]
    s_waitcnt lgkmcnt(6)
    ds_read_b64_tr_b16 a[196:197], v21 offset:49152
    ds_read_b64_tr_b16 a[198:199], v21 offset:53248
    buffer_load_dwordx4 a[40:43], v16, s[24:27], s42 offen offset:1024 sc1
    v_mfma_f32_16x16x32_bf16 v[220:223], a[212:215], v[132:135], v[220:223]
    s_waitcnt lgkmcnt(6)
    ds_read_b64_tr_b16 a[200:201], v22 offset:49152
    ds_read_b64_tr_b16 a[202:203], v22 offset:53248
    v_mfma_f32_16x16x32_bf16 v[172:175], a[216:219], v[132:135], v[172:175]
    s_waitcnt lgkmcnt(6)
    ds_read_b64_tr_b16 a[204:205], v23 offset:49152
    ds_read_b64_tr_b16 a[206:207], v23 offset:53248
    v_mfma_f32_16x16x32_bf16 v[236:239], a[220:223], v[132:135], v[236:239]
    s_waitcnt lgkmcnt(6)
    ds_read_b64_tr_b16 a[208:209], v24 offset:49152
    ds_read_b64_tr_b16 a[210:211], v24 offset:53248
    v_rcp_f32 v17, v68
    s_nop 0
    v_mul_f32 v148, v17, v148
    v_mul_f32 v149, v17, v149
    v_mul_f32 v150, v17, v150
    v_mul_f32 v151, v17, v151
    v_mul_f32 v188, v17, v188
    v_mul_f32 v189, v17, v189
    v_mul_f32 v190, v17, v190
    v_mul_f32 v191, v17, v191
    v_cvt_pk_bf16_f32 v116, v148, v149
    v_cvt_pk_bf16_f32 v117, v150, v151
    v_cvt_pk_bf16_f32 v118, v188, v189
    v_cvt_pk_bf16_f32 v119, v190, v191
    s_add_u32 s43, s84, 7340032
    buffer_store_dwordx4 v[116:119], v16, s[24:27], s43 offen sc1
    v_mul_f32 v156, v17, v156
    v_mul_f32 v157, v17, v157
    v_mul_f32 v158, v17, v158
    v_mul_f32 v159, v17, v159
    v_mul_f32 v204, v17, v204
    v_mul_f32 v205, v17, v205
    v_mul_f32 v206, v17, v206
    v_mul_f32 v207, v17, v207
    v_cvt_pk_bf16_f32 v124, v156, v157
    v_cvt_pk_bf16_f32 v125, v158, v159
    v_cvt_pk_bf16_f32 v126, v204, v205
    v_cvt_pk_bf16_f32 v127, v206, v207
    s_add_u32 s43, s84, 7341056
    buffer_store_dwordx4 v[124:127], v16, s[24:27], s43 offen sc1
    v_mul_f32 v164, v17, v164
    v_mul_f32 v165, v17, v165
    v_mul_f32 v166, v17, v166
    v_mul_f32 v167, v17, v167
    v_mul_f32 v220, v17, v220
    v_mul_f32 v221, v17, v221
    v_mul_f32 v222, v17, v222
    v_mul_f32 v223, v17, v223
    v_cvt_pk_bf16_f32 v140, v164, v165
    v_cvt_pk_bf16_f32 v141, v166, v167
    v_cvt_pk_bf16_f32 v142, v220, v221
    v_cvt_pk_bf16_f32 v143, v222, v223
    s_add_u32 s43, s84, 11010048
    buffer_store_dwordx4 v[140:143], v16, s[24:27], s43 offen sc1
    v_mul_f32 v172, v17, v172
    v_mul_f32 v173, v17, v173
    v_mul_f32 v174, v17, v174
    v_mul_f32 v175, v17, v175
    v_mul_f32 v236, v17, v236
    v_mul_f32 v237, v17, v237
    v_mul_f32 v238, v17, v238
    v_mul_f32 v239, v17, v239
    v_cvt_pk_bf16_f32 v132, v172, v173
    v_cvt_pk_bf16_f32 v133, v174, v175
    v_cvt_pk_bf16_f32 v134, v236, v237
    v_cvt_pk_bf16_f32 v135, v238, v239
    s_add_u32 s43, s84, 11011072
    buffer_store_dwordx4 v[132:135], v16, s[24:27], s43 offen sc1
    v_mfma_f32_16x16x32_bf16 v[180:183], a[192:195], v[116:119], v[180:183]
    s_waitcnt lgkmcnt(6)
    ds_read_b64_tr_b16 a[212:213], v25 offset:49152
    ds_read_b64_tr_b16 a[214:215], v25 offset:53248
    v_mfma_f32_16x16x32_bf16 v[84:87], a[196:199], v[116:119], v[84:87]
    s_waitcnt lgkmcnt(6)
    ds_read_b64_tr_b16 a[216:217], v26 offset:49152
    ds_read_b64_tr_b16 a[218:219], v26 offset:53248
    v_mfma_f32_16x16x32_bf16 v[196:199], a[200:203], v[116:119], v[196:199]
    s_waitcnt lgkmcnt(6)
    ds_read_b64_tr_b16 a[220:221], v27 offset:49152
    ds_read_b64_tr_b16 a[222:223], v27 offset:53248
    v_mfma_f32_16x16x32_bf16 v[92:95], a[204:207], v[116:119], v[92:95]
    s_waitcnt lgkmcnt(6)
    ds_read_b64_tr_b16 a[192:193], v20 offset:57344
    ds_read_b64_tr_b16 a[194:195], v20 offset:61440
    v_mfma_f32_16x16x32_bf16 v[212:215], a[208:211], v[116:119], v[212:215]
    s_waitcnt lgkmcnt(6)
    ds_read_b64_tr_b16 a[196:197], v21 offset:57344
    ds_read_b64_tr_b16 a[198:199], v21 offset:61440
    v_mfma_f32_16x16x32_bf16 v[100:103], a[212:215], v[116:119], v[100:103]
    s_waitcnt lgkmcnt(6)
    ds_read_b64_tr_b16 a[200:201], v22 offset:57344
    ds_read_b64_tr_b16 a[202:203], v22 offset:61440
    v_mfma_f32_16x16x32_bf16 v[228:231], a[216:219], v[116:119], v[228:231]
    s_waitcnt lgkmcnt(6)
    ds_read_b64_tr_b16 a[204:205], v23 offset:57344
    ds_read_b64_tr_b16 a[206:207], v23 offset:61440
    v_mfma_f32_16x16x32_bf16 v[108:111], a[220:223], v[116:119], v[108:111]
    s_waitcnt lgkmcnt(6)
    ds_read_b64_tr_b16 a[208:209], v24 offset:57344
    ds_read_b64_tr_b16 a[210:211], v24 offset:61440
    v_mfma_f32_16x16x32_bf16 v[180:183], a[192:195], v[124:127], v[180:183]
    s_waitcnt lgkmcnt(6)
    ds_read_b64_tr_b16 a[212:213], v25 offset:57344
    ds_read_b64_tr_b16 a[214:215], v25 offset:61440
    v_mfma_f32_16x16x32_bf16 v[84:87], a[196:199], v[124:127], v[84:87]
    s_waitcnt lgkmcnt(6)
    ds_read_b64_tr_b16 a[216:217], v26 offset:57344
    ds_read_b64_tr_b16 a[218:219], v26 offset:61440
    v_mfma_f32_16x16x32_bf16 v[196:199], a[200:203], v[124:127], v[196:199]
    s_waitcnt lgkmcnt(6)
    ds_read_b64_tr_b16 a[220:221], v27 offset:57344
    ds_read_b64_tr_b16 a[222:223], v27 offset:61440
    v_mfma_f32_16x16x32_bf16 v[92:95], a[204:207], v[124:127], v[92:95]
    s_waitcnt lgkmcnt(6)
    s_barrier
    ds_read_b64_tr_b16 a[192:193], v20 offset:16384
    ds_read_b64_tr_b16 a[194:195], v20 offset:20480
    s_add_u32 s42, s86, 0
    buffer_load_dwordx4 a[64:67], v16, s[24:27], s42 offen offset:0 sc1
    v_mfma_f32_16x16x32_bf16 v[212:215], a[208:211], v[124:127], v[212:215]
    s_waitcnt lgkmcnt(6)
    ds_read_b64_tr_b16 a[196:197], v21 offset:16384
    ds_read_b64_tr_b16 a[198:199], v21 offset:20480
    buffer_load_dwordx4 a[72:75], v16, s[24:27], s42 offen offset:1024 sc1
    v_mfma_f32_16x16x32_bf16 v[100:103], a[212:215], v[124:127], v[100:103]
    s_waitcnt lgkmcnt(6)
    ds_read_b64_tr_b16 a[200:201], v22 offset:16384
    ds_read_b64_tr_b16 a[202:203], v22 offset:20480
    s_add_u32 m0, s37, 32768
    s_add_u32 s42, s82, 65536
    buffer_load_dwordx4 v62, s[20:23], s42 offen offset:0  lds
    v_mfma_f32_16x16x32_bf16 v[228:231], a[216:219], v[124:127], v[228:231]
    s_waitcnt lgkmcnt(6)
    ds_read_b64_tr_b16 a[204:205], v23 offset:16384
    ds_read_b64_tr_b16 a[206:207], v23 offset:20480
    buffer_load_dwordx4 v63, s[20:23], s42 offen offset:1024  lds
    v_mfma_f32_16x16x32_bf16 v[108:111], a[220:223], v[124:127], v[108:111]
    s_waitcnt lgkmcnt(6)
    ds_read_b64_tr_b16 a[208:209], v24 offset:16384
    ds_read_b64_tr_b16 a[210:211], v24 offset:20480
    buffer_load_dwordx4 v64, s[20:23], s42 offen offset:2048  lds
    v_mfma_f32_16x16x32_bf16 v[180:183], a[192:195], v[140:143], v[180:183]
    s_waitcnt lgkmcnt(6)
    ds_read_b64_tr_b16 a[212:213], v25 offset:16384
    ds_read_b64_tr_b16 a[214:215], v25 offset:20480
    buffer_load_dwordx4 v65, s[20:23], s42 offen offset:3072  lds
    v_mfma_f32_16x16x32_bf16 v[84:87], a[196:199], v[140:143], v[84:87]
    s_waitcnt lgkmcnt(6)
    ds_read_b64_tr_b16 a[216:217], v26 offset:16384
    ds_read_b64_tr_b16 a[218:219], v26 offset:20480
    s_add_u32 s42, s87, 0
    buffer_load_dwordx4 a[96:99], v16, s[24:27], s42 offen offset:0 sc1
    v_mfma_f32_16x16x32_bf16 v[196:199], a[200:203], v[140:143], v[196:199]
    s_waitcnt lgkmcnt(6)
    ds_read_b64_tr_b16 a[220:221], v27 offset:16384
    ds_read_b64_tr_b16 a[222:223], v27 offset:20480
    buffer_load_dwordx4 a[104:107], v16, s[24:27], s42 offen offset:1024 sc1
    v_mfma_f32_16x16x32_bf16 v[92:95], a[204:207], v[140:143], v[92:95]
    s_waitcnt lgkmcnt(6)
    ds_read_b64_tr_b16 a[192:193], v20 offset:24576
    ds_read_b64_tr_b16 a[194:195], v20 offset:28672
    v_mfma_f32_16x16x32_bf16 v[212:215], a[208:211], v[140:143], v[212:215]
    s_waitcnt lgkmcnt(6)
    ds_read_b64_tr_b16 a[196:197], v21 offset:24576
    ds_read_b64_tr_b16 a[198:199], v21 offset:28672
    v_mfma_f32_16x16x32_bf16 v[100:103], a[212:215], v[140:143], v[100:103]
    s_waitcnt lgkmcnt(6)
    ds_read_b64_tr_b16 a[200:201], v22 offset:24576
    ds_read_b64_tr_b16 a[202:203], v22 offset:28672
    v_mfma_f32_16x16x32_bf16 v[228:231], a[216:219], v[140:143], v[228:231]
    s_waitcnt lgkmcnt(6)
    ds_read_b64_tr_b16 a[204:205], v23 offset:24576
    ds_read_b64_tr_b16 a[206:207], v23 offset:28672
    v_mfma_f32_16x16x32_bf16 v[108:111], a[220:223], v[140:143], v[108:111]
    s_waitcnt lgkmcnt(6)
    ds_read_b64_tr_b16 a[208:209], v24 offset:24576
    ds_read_b64_tr_b16 a[210:211], v24 offset:28672
    v_mfma_f32_16x16x32_bf16 v[180:183], a[192:195], v[132:135], v[180:183]
    s_waitcnt lgkmcnt(6)
    ds_read_b64_tr_b16 a[212:213], v25 offset:24576
    ds_read_b64_tr_b16 a[214:215], v25 offset:28672
    v_mfma_f32_16x16x32_bf16 v[84:87], a[196:199], v[132:135], v[84:87]
    s_waitcnt lgkmcnt(6)
    ds_read_b64_tr_b16 a[216:217], v26 offset:24576
    ds_read_b64_tr_b16 a[218:219], v26 offset:28672
    v_mfma_f32_16x16x32_bf16 v[196:199], a[200:203], v[132:135], v[196:199]
    s_waitcnt lgkmcnt(6)
    ds_read_b64_tr_b16 a[220:221], v27 offset:24576
    ds_read_b64_tr_b16 a[222:223], v27 offset:28672
    v_mfma_f32_16x16x32_bf16 v[92:95], a[204:207], v[132:135], v[92:95]
    s_waitcnt lgkmcnt(6)
    s_barrier
    s_waitcnt vmcnt(8)
    s_add_u32 s43, s53, 131072
    buffer_store_dword v13, v14, s[24:27], s43 offen sc1
    ds_read_b64_tr_b16 a[192:193], v36 offset:0
    ds_read_b64_tr_b16 a[194:195], v36 offset:4096
    s_add_u32 s42, s85, 3670016
    buffer_load_dwordx4 a[48:51], v16, s[24:27], s42 offen offset:0 sc1
    v_mfma_f32_16x16x32_bf16 v[212:215], a[208:211], v[132:135], v[212:215]
    s_waitcnt lgkmcnt(6)
    ds_read_b64_tr_b16 a[196:197], v37 offset:0
    ds_read_b64_tr_b16 a[198:199], v37 offset:4096
    buffer_load_dwordx4 a[56:59], v16, s[24:27], s42 offen offset:1024 sc1
    v_mfma_f32_16x16x32_bf16 v[100:103], a[212:215], v[132:135], v[100:103]
    s_waitcnt lgkmcnt(6)
    ds_read_b64_tr_b16 a[200:201], v38 offset:0
    ds_read_b64_tr_b16 a[202:203], v38 offset:4096
    s_add_u32 m0, s37, 81920
    s_add_u32 s42, s83, 65536
    buffer_load_dwordx4 v62, s[20:23], s42 offen offset:0  lds
    v_mfma_f32_16x16x32_bf16 v[228:231], a[216:219], v[132:135], v[228:231]
    s_waitcnt lgkmcnt(6)
    ds_read_b64_tr_b16 a[204:205], v39 offset:0
    ds_read_b64_tr_b16 a[206:207], v39 offset:4096
    buffer_load_dwordx4 v63, s[20:23], s42 offen offset:1024  lds
    v_mfma_f32_16x16x32_bf16 v[108:111], a[220:223], v[132:135], v[108:111]
    s_waitcnt lgkmcnt(6)
    ds_read_b64_tr_b16 a[208:209], v40 offset:0
    ds_read_b64_tr_b16 a[210:211], v40 offset:4096
    buffer_load_dwordx4 v64, s[20:23], s42 offen offset:2048  lds
    v_mfma_f32_16x16x32_bf16 v[180:183], a[192:195], a[32:35], v[180:183]
    s_waitcnt lgkmcnt(6)
    ds_read_b64_tr_b16 a[212:213], v41 offset:0
    ds_read_b64_tr_b16 a[214:215], v41 offset:4096
    buffer_load_dwordx4 v65, s[20:23], s42 offen offset:3072  lds
    v_mfma_f32_16x16x32_bf16 v[84:87], a[196:199], a[32:35], v[84:87]
    s_waitcnt lgkmcnt(6)
    ds_read_b64_tr_b16 a[216:217], v42 offset:0
    ds_read_b64_tr_b16 a[218:219], v42 offset:4096
    v_mfma_f32_16x16x32_bf16 v[196:199], a[200:203], a[32:35], v[196:199]
    s_waitcnt lgkmcnt(6)
    ds_read_b64_tr_b16 a[220:221], v43 offset:0
    ds_read_b64_tr_b16 a[222:223], v43 offset:4096
    v_mfma_f32_16x16x32_bf16 v[92:95], a[204:207], a[32:35], v[92:95]
    s_waitcnt lgkmcnt(6)
    ds_read_b64_tr_b16 a[192:193], v36 offset:8192
    ds_read_b64_tr_b16 a[194:195], v36 offset:12288
    v_mfma_f32_16x16x32_bf16 v[212:215], a[208:211], a[32:35], v[212:215]
    s_waitcnt lgkmcnt(6)
    ds_read_b64_tr_b16 a[196:197], v37 offset:8192
    ds_read_b64_tr_b16 a[198:199], v37 offset:12288
    v_mfma_f32_16x16x32_bf16 v[100:103], a[212:215], a[32:35], v[100:103]
    s_waitcnt lgkmcnt(6)
    ds_read_b64_tr_b16 a[200:201], v38 offset:8192
    ds_read_b64_tr_b16 a[202:203], v38 offset:12288
    v_mfma_f32_16x16x32_bf16 v[228:231], a[216:219], a[32:35], v[228:231]
    s_waitcnt lgkmcnt(6)
    ds_read_b64_tr_b16 a[204:205], v39 offset:8192
    ds_read_b64_tr_b16 a[206:207], v39 offset:12288
    v_mfma_f32_16x16x32_bf16 v[108:111], a[220:223], a[32:35], v[108:111]
    s_waitcnt lgkmcnt(6)
    ds_read_b64_tr_b16 a[208:209], v40 offset:8192
    ds_read_b64_tr_b16 a[210:211], v40 offset:12288
    v_mfma_f32_16x16x32_bf16 v[180:183], a[192:195], a[40:43], v[180:183]
    s_waitcnt lgkmcnt(6)
    ds_read_b64_tr_b16 a[212:213], v41 offset:8192
    ds_read_b64_tr_b16 a[214:215], v41 offset:12288
    v_mfma_f32_16x16x32_bf16 v[84:87], a[196:199], a[40:43], v[84:87]
    s_waitcnt lgkmcnt(6)
    ds_read_b64_tr_b16 a[216:217], v42 offset:8192
    ds_read_b64_tr_b16 a[218:219], v42 offset:12288
    v_mfma_f32_16x16x32_bf16 v[196:199], a[200:203], a[40:43], v[196:199]
    s_waitcnt lgkmcnt(6)
    ds_read_b64_tr_b16 a[220:221], v43 offset:8192
    ds_read_b64_tr_b16 a[222:223], v43 offset:12288
    v_mfma_f32_16x16x32_bf16 v[92:95], a[204:207], a[40:43], v[92:95]
    s_waitcnt lgkmcnt(6)
    s_barrier
    ds_read_b64_tr_b16 a[192:193], v36 offset:16384
    ds_read_b64_tr_b16 a[194:195], v36 offset:20480
    s_add_u32 s42, s86, 3670016
    buffer_load_dwordx4 a[80:83], v16, s[24:27], s42 offen offset:0 sc1
    v_mfma_f32_16x16x32_bf16 v[212:215], a[208:211], a[40:43], v[212:215]
    s_waitcnt lgkmcnt(6)
    ds_read_b64_tr_b16 a[196:197], v37 offset:16384
    ds_read_b64_tr_b16 a[198:199], v37 offset:20480
    buffer_load_dwordx4 a[88:91], v16, s[24:27], s42 offen offset:1024 sc1
    v_mfma_f32_16x16x32_bf16 v[100:103], a[212:215], a[40:43], v[100:103]
    s_waitcnt lgkmcnt(6)
    ds_read_b64_tr_b16 a[200:201], v38 offset:16384
    ds_read_b64_tr_b16 a[202:203], v38 offset:20480
    s_add_u32 s42, s87, 3670016
    buffer_load_dwordx4 a[112:115], v16, s[24:27], s42 offen offset:0 sc1
    v_mfma_f32_16x16x32_bf16 v[228:231], a[216:219], a[40:43], v[228:231]
    s_waitcnt lgkmcnt(6)
    ds_read_b64_tr_b16 a[204:205], v39 offset:16384
    ds_read_b64_tr_b16 a[206:207], v39 offset:20480
    buffer_load_dwordx4 a[120:123], v16, s[24:27], s42 offen offset:1024 sc1
    v_mfma_f32_16x16x32_bf16 v[108:111], a[220:223], a[40:43], v[108:111]
    s_waitcnt vmcnt(17)
    s_waitcnt lgkmcnt(6)
    ds_read_b64_tr_b16 a[208:209], v40 offset:16384
    ds_read_b64_tr_b16 a[210:211], v40 offset:20480
    s_add_u32 m0, s37, 65536
    s_add_u32 s42, s81, 131072
    buffer_load_dwordx4 v62, s[20:23], s42 offen offset:0  lds
    v_mfma_f32_16x16x32_bf16 v[180:183], a[192:195], a[64:67], v[180:183]
    s_waitcnt lgkmcnt(6)
    ds_read_b64_tr_b16 a[212:213], v41 offset:16384
    ds_read_b64_tr_b16 a[214:215], v41 offset:20480
    buffer_load_dwordx4 v63, s[20:23], s42 offen offset:1024  lds
    v_mfma_f32_16x16x32_bf16 v[84:87], a[196:199], a[64:67], v[84:87]
    s_waitcnt lgkmcnt(6)
    ds_read_b64_tr_b16 a[216:217], v42 offset:16384
    ds_read_b64_tr_b16 a[218:219], v42 offset:20480
    buffer_load_dwordx4 v64, s[20:23], s42 offen offset:2048  lds
    v_mfma_f32_16x16x32_bf16 v[196:199], a[200:203], a[64:67], v[196:199]
    s_waitcnt lgkmcnt(6)
    ds_read_b64_tr_b16 a[220:221], v43 offset:16384
    ds_read_b64_tr_b16 a[222:223], v43 offset:20480
    buffer_load_dwordx4 v65, s[20:23], s42 offen offset:3072  lds
    v_mfma_f32_16x16x32_bf16 v[92:95], a[204:207], a[64:67], v[92:95]
    s_waitcnt lgkmcnt(6)
    ds_read_b64_tr_b16 a[192:193], v36 offset:24576
    ds_read_b64_tr_b16 a[194:195], v36 offset:28672
    v_mfma_f32_16x16x32_bf16 v[212:215], a[208:211], a[64:67], v[212:215]
    s_waitcnt lgkmcnt(6)
    ds_read_b64_tr_b16 a[196:197], v37 offset:24576
    ds_read_b64_tr_b16 a[198:199], v37 offset:28672
    v_mfma_f32_16x16x32_bf16 v[100:103], a[212:215], a[64:67], v[100:103]
    s_waitcnt lgkmcnt(6)
    ds_read_b64_tr_b16 a[200:201], v38 offset:24576
    ds_read_b64_tr_b16 a[202:203], v38 offset:28672
    v_mfma_f32_16x16x32_bf16 v[228:231], a[216:219], a[64:67], v[228:231]
    s_waitcnt lgkmcnt(6)
    ds_read_b64_tr_b16 a[204:205], v39 offset:24576
    ds_read_b64_tr_b16 a[206:207], v39 offset:28672
    v_mfma_f32_16x16x32_bf16 v[108:111], a[220:223], a[64:67], v[108:111]
    s_waitcnt lgkmcnt(6)
    ds_read_b64_tr_b16 a[208:209], v40 offset:24576
    ds_read_b64_tr_b16 a[210:211], v40 offset:28672
    v_mfma_f32_16x16x32_bf16 v[180:183], a[192:195], a[72:75], v[180:183]
    s_waitcnt lgkmcnt(6)
    ds_read_b64_tr_b16 a[212:213], v41 offset:24576
    ds_read_b64_tr_b16 a[214:215], v41 offset:28672
    v_mfma_f32_16x16x32_bf16 v[84:87], a[196:199], a[72:75], v[84:87]
    s_waitcnt lgkmcnt(6)
    ds_read_b64_tr_b16 a[216:217], v42 offset:24576
    ds_read_b64_tr_b16 a[218:219], v42 offset:28672
    v_mfma_f32_16x16x32_bf16 v[196:199], a[200:203], a[72:75], v[196:199]
    s_waitcnt lgkmcnt(6)
    ds_read_b64_tr_b16 a[220:221], v43 offset:24576
    ds_read_b64_tr_b16 a[222:223], v43 offset:28672
    v_mfma_f32_16x16x32_bf16 v[92:95], a[204:207], a[72:75], v[92:95]
    s_waitcnt lgkmcnt(6)
    s_barrier
    s_add_u32 s43, s54, 131072
    buffer_load_dword v10, v11, s[24:27], s43 offen sc1
    ds_read_b64_tr_b16 a[192:193], v28 offset:49152
    ds_read_b64_tr_b16 a[194:195], v28 offset:53248
    s_add_u32 m0, s37, 98304
    s_add_u32 s42, s82, 131072
    buffer_load_dwordx4 v62, s[20:23], s42 offen offset:0  lds
    v_mfma_f32_16x16x32_bf16 v[212:215], a[208:211], a[72:75], v[212:215]
    s_waitcnt lgkmcnt(6)
    ds_read_b64_tr_b16 a[196:197], v29 offset:49152
    ds_read_b64_tr_b16 a[198:199], v29 offset:53248
    buffer_load_dwordx4 v63, s[20:23], s42 offen offset:1024  lds
    v_mfma_f32_16x16x32_bf16 v[100:103], a[212:215], a[72:75], v[100:103]
    s_waitcnt lgkmcnt(6)
    ds_read_b64_tr_b16 a[200:201], v30 offset:49152
    ds_read_b64_tr_b16 a[202:203], v30 offset:53248
    buffer_load_dwordx4 v64, s[20:23], s42 offen offset:2048  lds
    v_mfma_f32_16x16x32_bf16 v[228:231], a[216:219], a[72:75], v[228:231]
    s_waitcnt lgkmcnt(6)
    ds_read_b64_tr_b16 a[204:205], v31 offset:49152
    ds_read_b64_tr_b16 a[206:207], v31 offset:53248
    buffer_load_dwordx4 v65, s[20:23], s42 offen offset:3072  lds
    v_mfma_f32_16x16x32_bf16 v[108:111], a[220:223], a[72:75], v[108:111]
    s_waitcnt vmcnt(20)
    s_waitcnt lgkmcnt(6)
    ds_read_b64_tr_b16 a[208:209], v32 offset:49152
    ds_read_b64_tr_b16 a[210:211], v32 offset:53248
    s_add_u32 m0, s37, 49152
    s_add_u32 s42, s83, 131072
    buffer_load_dwordx4 v62, s[20:23], s42 offen offset:0  lds
    v_mfma_f32_16x16x32_bf16 v[180:183], a[192:195], a[96:99], v[180:183]
    s_waitcnt lgkmcnt(6)
    ds_read_b64_tr_b16 a[212:213], v33 offset:49152
    ds_read_b64_tr_b16 a[214:215], v33 offset:53248
    buffer_load_dwordx4 v63, s[20:23], s42 offen offset:1024  lds
    v_mfma_f32_16x16x32_bf16 v[84:87], a[196:199], a[96:99], v[84:87]
    s_waitcnt lgkmcnt(6)
    ds_read_b64_tr_b16 a[216:217], v34 offset:49152
    ds_read_b64_tr_b16 a[218:219], v34 offset:53248
    buffer_load_dwordx4 v64, s[20:23], s42 offen offset:2048  lds
    v_mfma_f32_16x16x32_bf16 v[196:199], a[200:203], a[96:99], v[196:199]
    s_waitcnt lgkmcnt(6)
    ds_read_b64_tr_b16 a[220:221], v35 offset:49152
    ds_read_b64_tr_b16 a[222:223], v35 offset:53248
    buffer_load_dwordx4 v65, s[20:23], s42 offen offset:3072  lds
    v_mfma_f32_16x16x32_bf16 v[92:95], a[204:207], a[96:99], v[92:95]
    s_waitcnt lgkmcnt(6)
    ds_read_b64_tr_b16 a[192:193], v28 offset:57344
    ds_read_b64_tr_b16 a[194:195], v28 offset:61440
    v_mfma_f32_16x16x32_bf16 v[212:215], a[208:211], a[96:99], v[212:215]
    s_waitcnt lgkmcnt(6)
    ds_read_b64_tr_b16 a[196:197], v29 offset:57344
    ds_read_b64_tr_b16 a[198:199], v29 offset:61440
    v_mfma_f32_16x16x32_bf16 v[100:103], a[212:215], a[96:99], v[100:103]
    s_waitcnt lgkmcnt(6)
    ds_read_b64_tr_b16 a[200:201], v30 offset:57344
    ds_read_b64_tr_b16 a[202:203], v30 offset:61440
    v_mfma_f32_16x16x32_bf16 v[228:231], a[216:219], a[96:99], v[228:231]
    s_waitcnt lgkmcnt(6)
    ds_read_b64_tr_b16 a[204:205], v31 offset:57344
    ds_read_b64_tr_b16 a[206:207], v31 offset:61440
    v_mfma_f32_16x16x32_bf16 v[108:111], a[220:223], a[96:99], v[108:111]
    s_waitcnt lgkmcnt(6)
    ds_read_b64_tr_b16 a[208:209], v32 offset:57344
    ds_read_b64_tr_b16 a[210:211], v32 offset:61440
    v_mfma_f32_16x16x32_bf16 v[180:183], a[192:195], a[104:107], v[180:183]
    s_waitcnt lgkmcnt(6)
    ds_read_b64_tr_b16 a[212:213], v33 offset:57344
    ds_read_b64_tr_b16 a[214:215], v33 offset:61440
    v_mfma_f32_16x16x32_bf16 v[84:87], a[196:199], a[104:107], v[84:87]
    s_waitcnt lgkmcnt(6)
    ds_read_b64_tr_b16 a[216:217], v34 offset:57344
    ds_read_b64_tr_b16 a[218:219], v34 offset:61440
    v_mfma_f32_16x16x32_bf16 v[196:199], a[200:203], a[104:107], v[196:199]
    s_waitcnt lgkmcnt(6)
    ds_read_b64_tr_b16 a[220:221], v35 offset:57344
    ds_read_b64_tr_b16 a[222:223], v35 offset:61440
    v_mfma_f32_16x16x32_bf16 v[92:95], a[204:207], a[104:107], v[92:95]
    s_waitcnt lgkmcnt(6)
    s_barrier
    s_waitcnt vmcnt(8)
    v_cmp_ne_u32 s[62:63], 1, v10
    s_nop 0
    s_cmp_lg_u64 s[62:63], 0
    s_cbranch_scc1 w1_p1_spin
w1_p1_back:
    ds_read_b64_tr_b16 a[192:193], v20 offset:0
    ds_read_b64_tr_b16 a[194:195], v20 offset:4096
    s_add_u32 s42, s85, 7340032
    buffer_load_dwordx4 a[128:131], v16, s[24:27], s42 offen offset:0 sc1
    v_mfma_f32_16x16x32_bf16 v[212:215], a[208:211], a[104:107], v[212:215]
    s_waitcnt lgkmcnt(6)
    ds_read_b64_tr_b16 a[196:197], v21 offset:0
    ds_read_b64_tr_b16 a[198:199], v21 offset:4096
    buffer_load_dwordx4 a[136:139], v16, s[24:27], s42 offen offset:1024 sc1
    v_mfma_f32_16x16x32_bf16 v[100:103], a[212:215], a[104:107], v[100:103]
    s_waitcnt lgkmcnt(6)
    ds_read_b64_tr_b16 a[200:201], v22 offset:0
    ds_read_b64_tr_b16 a[202:203], v22 offset:4096
    s_add_u32 m0, s37, 16384
    s_add_u32 s42, s81, 196608
    buffer_load_dwordx4 v62, s[20:23], s42 offen offset:0  lds
    v_mfma_f32_16x16x32_bf16 v[228:231], a[216:219], a[104:107], v[228:231]
    s_waitcnt lgkmcnt(6)
    ds_read_b64_tr_b16 a[204:205], v23 offset:0
    ds_read_b64_tr_b16 a[206:207], v23 offset:4096
    buffer_load_dwordx4 v63, s[20:23], s42 offen offset:1024  lds
    v_mfma_f32_16x16x32_bf16 v[108:111], a[220:223], a[104:107], v[108:111]
    s_waitcnt lgkmcnt(6)
    ds_read_b64_tr_b16 a[208:209], v24 offset:0
    ds_read_b64_tr_b16 a[210:211], v24 offset:4096
    buffer_load_dwordx4 v64, s[20:23], s42 offen offset:2048  lds
    v_mfma_f32_16x16x32_bf16 v[180:183], a[192:195], a[48:51], v[180:183]
    s_waitcnt lgkmcnt(6)
    ds_read_b64_tr_b16 a[212:213], v25 offset:0
    ds_read_b64_tr_b16 a[214:215], v25 offset:4096
    buffer_load_dwordx4 v65, s[20:23], s42 offen offset:3072  lds
    v_mfma_f32_16x16x32_bf16 v[84:87], a[196:199], a[48:51], v[84:87]
    s_waitcnt lgkmcnt(6)
    ds_read_b64_tr_b16 a[216:217], v26 offset:0
    ds_read_b64_tr_b16 a[218:219], v26 offset:4096
    v_mfma_f32_16x16x32_bf16 v[196:199], a[200:203], a[48:51], v[196:199]
    s_waitcnt lgkmcnt(6)
    ds_read_b64_tr_b16 a[220:221], v27 offset:0
    ds_read_b64_tr_b16 a[222:223], v27 offset:4096
    v_mfma_f32_16x16x32_bf16 v[92:95], a[204:207], a[48:51], v[92:95]
    s_waitcnt lgkmcnt(6)
    ds_read_b64_tr_b16 a[192:193], v20 offset:8192
    ds_read_b64_tr_b16 a[194:195], v20 offset:12288
    v_mfma_f32_16x16x32_bf16 v[212:215], a[208:211], a[48:51], v[212:215]
    s_waitcnt lgkmcnt(6)
    ds_read_b64_tr_b16 a[196:197], v21 offset:8192
    ds_read_b64_tr_b16 a[198:199], v21 offset:12288
    v_mfma_f32_16x16x32_bf16 v[100:103], a[212:215], a[48:51], v[100:103]
    s_waitcnt lgkmcnt(6)
    ds_read_b64_tr_b16 a[200:201], v22 offset:8192
    ds_read_b64_tr_b16 a[202:203], v22 offset:12288
    v_mfma_f32_16x16x32_bf16 v[228:231], a[216:219], a[48:51], v[228:231]
    s_waitcnt lgkmcnt(6)
    ds_read_b64_tr_b16 a[204:205], v23 offset:8192
    ds_read_b64_tr_b16 a[206:207], v23 offset:12288
    v_mfma_f32_16x16x32_bf16 v[108:111], a[220:223], a[48:51], v[108:111]
    s_waitcnt lgkmcnt(6)
    ds_read_b64_tr_b16 a[208:209], v24 offset:8192
    ds_read_b64_tr_b16 a[210:211], v24 offset:12288
    v_mfma_f32_16x16x32_bf16 v[180:183], a[192:195], a[56:59], v[180:183]
    s_waitcnt lgkmcnt(6)
    ds_read_b64_tr_b16 a[212:213], v25 offset:8192
    ds_read_b64_tr_b16 a[214:215], v25 offset:12288
    v_mfma_f32_16x16x32_bf16 v[84:87], a[196:199], a[56:59], v[84:87]
    s_waitcnt lgkmcnt(6)
    ds_read_b64_tr_b16 a[216:217], v26 offset:8192
    ds_read_b64_tr_b16 a[218:219], v26 offset:12288
    v_mfma_f32_16x16x32_bf16 v[196:199], a[200:203], a[56:59], v[196:199]
    s_waitcnt lgkmcnt(6)
    ds_read_b64_tr_b16 a[220:221], v27 offset:8192
    ds_read_b64_tr_b16 a[222:223], v27 offset:12288
    v_mfma_f32_16x16x32_bf16 v[92:95], a[204:207], a[56:59], v[92:95]
    s_waitcnt lgkmcnt(6)
    s_barrier
    ds_read_b64_tr_b16 a[192:193], v20 offset:32768
    ds_read_b64_tr_b16 a[194:195], v20 offset:36864
    s_add_u32 s42, s86, 7340032
    buffer_load_dwordx4 a[160:163], v16, s[24:27], s42 offen offset:0 sc1
    v_mfma_f32_16x16x32_bf16 v[212:215], a[208:211], a[56:59], v[212:215]
    s_waitcnt lgkmcnt(6)
    ds_read_b64_tr_b16 a[196:197], v21 offset:32768
    ds_read_b64_tr_b16 a[198:199], v21 offset:36864
    buffer_load_dwordx4 a[168:171], v16, s[24:27], s42 offen offset:1024 sc1
    v_mfma_f32_16x16x32_bf16 v[100:103], a[212:215], a[56:59], v[100:103]
    s_waitcnt lgkmcnt(6)
    ds_read_b64_tr_b16 a[200:201], v22 offset:32768
    ds_read_b64_tr_b16 a[202:203], v22 offset:36864
    s_add_u32 s42, s87, 7340032
    buffer_load_dwordx4 a[224:227], v16, s[24:27], s42 offen offset:0 sc1
    v_mfma_f32_16x16x32_bf16 v[228:231], a[216:219], a[56:59], v[228:231]
    s_waitcnt lgkmcnt(6)
    ds_read_b64_tr_b16 a[204:205], v23 offset:32768
    ds_read_b64_tr_b16 a[206:207], v23 offset:36864
    buffer_load_dwordx4 a[232:235], v16, s[24:27], s42 offen offset:1024 sc1
    v_mfma_f32_16x16x32_bf16 v[108:111], a[220:223], a[56:59], v[108:111]
    s_waitcnt lgkmcnt(6)
    ds_read_b64_tr_b16 a[208:209], v24 offset:32768
    ds_read_b64_tr_b16 a[210:211], v24 offset:36864
    s_add_u32 m0, s37, 131072
    s_add_u32 s42, s82, 196608
    buffer_load_dwordx4 v62, s[20:23], s42 offen offset:0  lds
    v_mfma_f32_16x16x32_bf16 v[180:183], a[192:195], a[80:83], v[180:183]
    s_waitcnt lgkmcnt(6)
    ds_read_b64_tr_b16 a[212:213], v25 offset:32768
    ds_read_b64_tr_b16 a[214:215], v25 offset:36864
    buffer_load_dwordx4 v63, s[20:23], s42 offen offset:1024  lds
    v_mfma_f32_16x16x32_bf16 v[84:87], a[196:199], a[80:83], v[84:87]
    s_waitcnt lgkmcnt(6)
    ds_read_b64_tr_b16 a[216:217], v20 offset:40960
    ds_read_b64_tr_b16 a[218:219], v20 offset:45056
    buffer_load_dwordx4 v64, s[20:23], s42 offen offset:2048  lds
    v_mfma_f32_16x16x32_bf16 v[196:199], a[200:203], a[80:83], v[196:199]
    s_waitcnt lgkmcnt(6)
    ds_read_b64_tr_b16 a[220:221], v21 offset:40960
    ds_read_b64_tr_b16 a[222:223], v21 offset:45056
    buffer_load_dwordx4 v65, s[20:23], s42 offen offset:3072  lds
    v_mfma_f32_16x16x32_bf16 v[92:95], a[204:207], a[80:83], v[92:95]
    s_waitcnt lgkmcnt(6)
    ds_read_b64_tr_b16 a[192:193], v22 offset:40960
    ds_read_b64_tr_b16 a[194:195], v22 offset:45056
    v_mfma_f32_16x16x32_bf16 v[212:215], a[208:211], a[80:83], v[212:215]
    s_waitcnt lgkmcnt(6)
    ds_read_b64_tr_b16 a[196:197], v23 offset:40960
    ds_read_b64_tr_b16 a[198:199], v23 offset:45056
    v_mfma_f32_16x16x32_bf16 v[100:103], a[212:215], a[80:83], v[100:103]
    s_waitcnt lgkmcnt(6)
    ds_read_b64_tr_b16 a[200:201], v24 offset:40960
    ds_read_b64_tr_b16 a[202:203], v24 offset:45056
    v_mfma_f32_16x16x32_bf16 v[180:183], a[216:219], a[88:91], v[180:183]
    s_waitcnt lgkmcnt(6)
    ds_read_b64_tr_b16 a[204:205], v25 offset:40960
    ds_read_b64_tr_b16 a[206:207], v25 offset:45056
    v_mfma_f32_16x16x32_bf16 v[84:87], a[220:223], a[88:91], v[84:87]
    s_waitcnt lgkmcnt(6)
    s_barrier
    ds_read_b64_tr_b16 a[208:209], v28 offset:16384
    ds_read_b64_tr_b16 a[210:211], v28 offset:20480
    s_add_u32 s42, s85, 11010048
    buffer_load_dwordx4 a[144:147], v16, s[24:27], s42 offen offset:0 sc1
    v_mfma_f32_16x16x32_bf16 v[196:199], a[192:195], a[88:91], v[196:199]
    s_waitcnt lgkmcnt(6)
    ds_read_b64_tr_b16 a[212:213], v29 offset:16384
    ds_read_b64_tr_b16 a[214:215], v29 offset:20480
    buffer_load_dwordx4 a[152:155], v16, s[24:27], s42 offen offset:1024 sc1
    v_mfma_f32_16x16x32_bf16 v[92:95], a[196:199], a[88:91], v[92:95]
    s_waitcnt lgkmcnt(6)
    ds_read_b64_tr_b16 a[216:217], v30 offset:16384
    ds_read_b64_tr_b16 a[218:219], v30 offset:20480
    s_add_u32 m0, s37, 147456
    s_add_u32 s42, s83, 196608
    buffer_load_dwordx4 v62, s[20:23], s42 offen offset:0  lds
    v_mfma_f32_16x16x32_bf16 v[212:215], a[200:203], a[88:91], v[212:215]
    s_waitcnt lgkmcnt(6)
    ds_read_b64_tr_b16 a[220:221], v31 offset:16384
    ds_read_b64_tr_b16 a[222:223], v31 offset:20480
    buffer_load_dwordx4 v63, s[20:23], s42 offen offset:1024  lds
    v_mfma_f32_16x16x32_bf16 v[100:103], a[204:207], a[88:91], v[100:103]
    s_waitcnt lgkmcnt(6)
    ds_read_b64_tr_b16 a[192:193], v32 offset:16384
    ds_read_b64_tr_b16 a[194:195], v32 offset:20480
    buffer_load_dwordx4 v64, s[20:23], s42 offen offset:2048  lds
    v_mfma_f32_16x16x32_bf16 v[180:183], a[208:211], a[112:115], v[180:183]
    s_waitcnt lgkmcnt(6)
    ds_read_b64_tr_b16 a[196:197], v33 offset:16384
    ds_read_b64_tr_b16 a[198:199], v33 offset:20480
    buffer_load_dwordx4 v65, s[20:23], s42 offen offset:3072  lds
    v_mfma_f32_16x16x32_bf16 v[84:87], a[212:215], a[112:115], v[84:87]
    s_waitcnt lgkmcnt(6)
    ds_read_b64_tr_b16 a[200:201], v28 offset:24576
    ds_read_b64_tr_b16 a[202:203], v28 offset:28672
    v_mfma_f32_16x16x32_bf16 v[196:199], a[216:219], a[112:115], v[196:199]
    s_waitcnt lgkmcnt(6)
    ds_read_b64_tr_b16 a[204:205], v29 offset:24576
    ds_read_b64_tr_b16 a[206:207], v29 offset:28672
    v_mfma_f32_16x16x32_bf16 v[92:95], a[220:223], a[112:115], v[92:95]
    s_waitcnt lgkmcnt(6)
    ds_read_b64_tr_b16 a[208:209], v30 offset:24576
    ds_read_b64_tr_b16 a[210:211], v30 offset:28672
    v_mfma_f32_16x16x32_bf16 v[212:215], a[192:195], a[112:115], v[212:215]
    s_waitcnt lgkmcnt(6)
    ds_read_b64_tr_b16 a[212:213], v31 offset:24576
    ds_read_b64_tr_b16 a[214:215], v31 offset:28672
    v_mfma_f32_16x16x32_bf16 v[100:103], a[196:199], a[112:115], v[100:103]
    s_waitcnt lgkmcnt(6)
    ds_read_b64_tr_b16 a[216:217], v32 offset:24576
    ds_read_b64_tr_b16 a[218:219], v32 offset:28672
    v_mfma_f32_16x16x32_bf16 v[180:183], a[200:203], a[120:123], v[180:183]
    s_waitcnt lgkmcnt(6)
    ds_read_b64_tr_b16 a[220:221], v33 offset:24576
    ds_read_b64_tr_b16 a[222:223], v33 offset:28672
    v_mfma_f32_16x16x32_bf16 v[84:87], a[204:207], a[120:123], v[84:87]
    s_waitcnt lgkmcnt(6)
    s_barrier
    ds_read_b64_tr_b16 a[192:193], v28 offset:0
    ds_read_b64_tr_b16 a[194:195], v28 offset:4096
    s_add_u32 s42, s86, 11010048
    buffer_load_dwordx4 a[176:179], v16, s[24:27], s42 offen offset:0 sc1
    v_mfma_f32_16x16x32_bf16 v[196:199], a[208:211], a[120:123], v[196:199]
    s_waitcnt lgkmcnt(6)
    ds_read_b64_tr_b16 a[196:197], v29 offset:0
    ds_read_b64_tr_b16 a[198:199], v29 offset:4096
    buffer_load_dwordx4 a[184:187], v16, s[24:27], s42 offen offset:1024 sc1
    v_mfma_f32_16x16x32_bf16 v[92:95], a[212:215], a[120:123], v[92:95]
    s_waitcnt lgkmcnt(6)
    ds_read_b64_tr_b16 a[200:201], v30 offset:0
    ds_read_b64_tr_b16 a[202:203], v30 offset:4096
    s_add_u32 s42, s87, 11010048
    buffer_load_dwordx4 a[240:243], v16, s[24:27], s42 offen offset:0 sc1
    v_mfma_f32_16x16x32_bf16 v[212:215], a[216:219], a[120:123], v[212:215]
    s_waitcnt lgkmcnt(6)
    ds_read_b64_tr_b16 a[204:205], v31 offset:0
    ds_read_b64_tr_b16 a[206:207], v31 offset:4096
    buffer_load_dwordx4 a[248:251], v16, s[24:27], s42 offen offset:1024 sc1
    v_mfma_f32_16x16x32_bf16 v[100:103], a[220:223], a[120:123], v[100:103]
    s_waitcnt vmcnt(22)
    s_waitcnt lgkmcnt(6)
    ds_read_b64_tr_b16 a[208:209], v32 offset:0
    ds_read_b64_tr_b16 a[210:211], v32 offset:4096
    v_mfma_f32_16x16x32_bf16 v[180:183], a[192:195], a[128:131], v[180:183]
    s_waitcnt lgkmcnt(6)
    ds_read_b64_tr_b16 a[212:213], v33 offset:0
    ds_read_b64_tr_b16 a[214:215], v33 offset:4096
    v_mfma_f32_16x16x32_bf16 v[84:87], a[196:199], a[128:131], v[84:87]
    s_waitcnt lgkmcnt(6)
    ds_read_b64_tr_b16 a[216:217], v28 offset:8192
    ds_read_b64_tr_b16 a[218:219], v28 offset:12288
    v_mfma_f32_16x16x32_bf16 v[196:199], a[200:203], a[128:131], v[196:199]
    s_waitcnt lgkmcnt(6)
    ds_read_b64_tr_b16 a[220:221], v29 offset:8192
    ds_read_b64_tr_b16 a[222:223], v29 offset:12288
    v_mfma_f32_16x16x32_bf16 v[92:95], a[204:207], a[128:131], v[92:95]
    s_waitcnt lgkmcnt(6)
    ds_read_b64_tr_b16 a[192:193], v30 offset:8192
    ds_read_b64_tr_b16 a[194:195], v30 offset:12288
    v_mfma_f32_16x16x32_bf16 v[212:215], a[208:211], a[128:131], v[212:215]
    s_waitcnt lgkmcnt(6)
    ds_read_b64_tr_b16 a[196:197], v31 offset:8192
    ds_read_b64_tr_b16 a[198:199], v31 offset:12288
    v_mfma_f32_16x16x32_bf16 v[100:103], a[212:215], a[128:131], v[100:103]
    s_waitcnt lgkmcnt(6)
    ds_read_b64_tr_b16 a[200:201], v32 offset:8192
    ds_read_b64_tr_b16 a[202:203], v32 offset:12288
    v_mfma_f32_16x16x32_bf16 v[180:183], a[216:219], a[136:139], v[180:183]
    s_waitcnt lgkmcnt(6)
    ds_read_b64_tr_b16 a[204:205], v33 offset:8192
    ds_read_b64_tr_b16 a[206:207], v33 offset:12288
    v_mfma_f32_16x16x32_bf16 v[84:87], a[220:223], a[136:139], v[84:87]
    s_waitcnt lgkmcnt(6)
    s_barrier
    ds_read_b64_tr_b16 a[208:209], v28 offset:32768
    ds_read_b64_tr_b16 a[210:211], v28 offset:36864
    v_mfma_f32_16x16x32_bf16 v[196:199], a[192:195], a[136:139], v[196:199]
    s_waitcnt lgkmcnt(6)
    ds_read_b64_tr_b16 a[212:213], v29 offset:32768
    ds_read_b64_tr_b16 a[214:215], v29 offset:36864
    v_mfma_f32_16x16x32_bf16 v[92:95], a[196:199], a[136:139], v[92:95]
    s_waitcnt lgkmcnt(6)
    ds_read_b64_tr_b16 a[216:217], v30 offset:32768
    ds_read_b64_tr_b16 a[218:219], v30 offset:36864
    v_mfma_f32_16x16x32_bf16 v[212:215], a[200:203], a[136:139], v[212:215]
    s_waitcnt lgkmcnt(6)
    ds_read_b64_tr_b16 a[220:221], v31 offset:32768
    ds_read_b64_tr_b16 a[222:223], v31 offset:36864
    v_mfma_f32_16x16x32_bf16 v[100:103], a[204:207], a[136:139], v[100:103]
    s_waitcnt vmcnt(16)
    s_waitcnt lgkmcnt(6)
    ds_read_b64_tr_b16 a[192:193], v32 offset:32768
    ds_read_b64_tr_b16 a[194:195], v32 offset:36864
    v_mfma_f32_16x16x32_bf16 v[180:183], a[208:211], a[160:163], v[180:183]
    s_waitcnt lgkmcnt(6)
    ds_read_b64_tr_b16 a[196:197], v33 offset:32768
    ds_read_b64_tr_b16 a[198:199], v33 offset:36864
    v_mfma_f32_16x16x32_bf16 v[84:87], a[212:215], a[160:163], v[84:87]
    s_waitcnt lgkmcnt(6)
    ds_read_b64_tr_b16 a[200:201], v28 offset:40960
    ds_read_b64_tr_b16 a[202:203], v28 offset:45056
    v_mfma_f32_16x16x32_bf16 v[196:199], a[216:219], a[160:163], v[196:199]
    s_waitcnt lgkmcnt(6)
    ds_read_b64_tr_b16 a[204:205], v29 offset:40960
    ds_read_b64_tr_b16 a[206:207], v29 offset:45056
    v_mfma_f32_16x16x32_bf16 v[92:95], a[220:223], a[160:163], v[92:95]
    s_waitcnt lgkmcnt(6)
    ds_read_b64_tr_b16 a[208:209], v30 offset:40960
    ds_read_b64_tr_b16 a[210:211], v30 offset:45056
    v_mfma_f32_16x16x32_bf16 v[212:215], a[192:195], a[160:163], v[212:215]
    s_waitcnt lgkmcnt(6)
    ds_read_b64_tr_b16 a[212:213], v31 offset:40960
    ds_read_b64_tr_b16 a[214:215], v31 offset:45056
    v_mfma_f32_16x16x32_bf16 v[100:103], a[196:199], a[160:163], v[100:103]
    s_waitcnt lgkmcnt(6)
    ds_read_b64_tr_b16 a[216:217], v32 offset:40960
    ds_read_b64_tr_b16 a[218:219], v32 offset:45056
    v_mfma_f32_16x16x32_bf16 v[180:183], a[200:203], a[168:171], v[180:183]
    s_waitcnt lgkmcnt(6)
    ds_read_b64_tr_b16 a[220:221], v33 offset:40960
    ds_read_b64_tr_b16 a[222:223], v33 offset:45056
    v_mfma_f32_16x16x32_bf16 v[84:87], a[204:207], a[168:171], v[84:87]
    s_waitcnt lgkmcnt(6)
    s_waitcnt vmcnt(4)
    s_barrier
    ds_read_b64_tr_b16 a[192:193], v20 offset:49152
    ds_read_b64_tr_b16 a[194:195], v20 offset:53248
    v_mfma_f32_16x16x32_bf16 v[196:199], a[208:211], a[168:171], v[196:199]
    s_waitcnt lgkmcnt(6)
    ds_read_b64_tr_b16 a[196:197], v21 offset:49152
    ds_read_b64_tr_b16 a[198:199], v21 offset:53248
    v_mfma_f32_16x16x32_bf16 v[92:95], a[212:215], a[168:171], v[92:95]
    s_waitcnt lgkmcnt(6)
    ds_read_b64_tr_b16 a[200:201], v22 offset:49152
    ds_read_b64_tr_b16 a[202:203], v22 offset:53248
    v_mfma_f32_16x16x32_bf16 v[212:215], a[216:219], a[168:171], v[212:215]
    s_waitcnt lgkmcnt(6)
    ds_read_b64_tr_b16 a[204:205], v23 offset:49152
    ds_read_b64_tr_b16 a[206:207], v23 offset:53248
    v_mfma_f32_16x16x32_bf16 v[100:103], a[220:223], a[168:171], v[100:103]
    s_waitcnt lgkmcnt(6)
    ds_read_b64_tr_b16 a[208:209], v24 offset:49152
    ds_read_b64_tr_b16 a[210:211], v24 offset:53248
    v_mfma_f32_16x16x32_bf16 v[180:183], a[192:195], a[224:227], v[180:183]
    s_waitcnt lgkmcnt(6)
    ds_read_b64_tr_b16 a[212:213], v25 offset:49152
    ds_read_b64_tr_b16 a[214:215], v25 offset:53248
    v_mfma_f32_16x16x32_bf16 v[84:87], a[196:199], a[224:227], v[84:87]
    s_waitcnt lgkmcnt(6)
    ds_read_b64_tr_b16 a[216:217], v20 offset:57344
    ds_read_b64_tr_b16 a[218:219], v20 offset:61440
    v_mfma_f32_16x16x32_bf16 v[196:199], a[200:203], a[224:227], v[196:199]
    s_waitcnt lgkmcnt(6)
    ds_read_b64_tr_b16 a[220:221], v21 offset:57344
    ds_read_b64_tr_b16 a[222:223], v21 offset:61440
    v_mfma_f32_16x16x32_bf16 v[92:95], a[204:207], a[224:227], v[92:95]
    s_waitcnt lgkmcnt(6)
    ds_read_b64_tr_b16 a[192:193], v22 offset:57344
    ds_read_b64_tr_b16 a[194:195], v22 offset:61440
    v_mfma_f32_16x16x32_bf16 v[212:215], a[208:211], a[224:227], v[212:215]
    s_waitcnt lgkmcnt(6)
    ds_read_b64_tr_b16 a[196:197], v23 offset:57344
    ds_read_b64_tr_b16 a[198:199], v23 offset:61440
    v_mfma_f32_16x16x32_bf16 v[100:103], a[212:215], a[224:227], v[100:103]
    s_waitcnt lgkmcnt(6)
    ds_read_b64_tr_b16 a[200:201], v24 offset:57344
    ds_read_b64_tr_b16 a[202:203], v24 offset:61440
    v_mfma_f32_16x16x32_bf16 v[180:183], a[216:219], a[232:235], v[180:183]
    s_waitcnt lgkmcnt(6)
    ds_read_b64_tr_b16 a[204:205], v25 offset:57344
    ds_read_b64_tr_b16 a[206:207], v25 offset:61440
    v_mfma_f32_16x16x32_bf16 v[84:87], a[220:223], a[232:235], v[84:87]
    s_waitcnt lgkmcnt(6)
    ds_read_b64_tr_b16 a[208:209], v20 offset:16384
    ds_read_b64_tr_b16 a[210:211], v20 offset:20480
    v_mfma_f32_16x16x32_bf16 v[196:199], a[192:195], a[232:235], v[196:199]
    s_waitcnt lgkmcnt(6)
    ds_read_b64_tr_b16 a[212:213], v21 offset:16384
    ds_read_b64_tr_b16 a[214:215], v21 offset:20480
    v_mfma_f32_16x16x32_bf16 v[92:95], a[196:199], a[232:235], v[92:95]
    s_waitcnt lgkmcnt(6)
    ds_read_b64_tr_b16 a[216:217], v22 offset:16384
    ds_read_b64_tr_b16 a[218:219], v22 offset:20480
    v_mfma_f32_16x16x32_bf16 v[212:215], a[200:203], a[232:235], v[212:215]
    s_waitcnt lgkmcnt(6)
    ds_read_b64_tr_b16 a[220:221], v23 offset:16384
    ds_read_b64_tr_b16 a[222:223], v23 offset:20480
    v_mfma_f32_16x16x32_bf16 v[100:103], a[204:207], a[232:235], v[100:103]
    s_waitcnt lgkmcnt(6)
    ds_read_b64_tr_b16 a[192:193], v24 offset:16384
    ds_read_b64_tr_b16 a[194:195], v24 offset:20480
    v_mfma_f32_16x16x32_bf16 v[180:183], a[208:211], a[144:147], v[180:183]
    s_waitcnt lgkmcnt(6)
    ds_read_b64_tr_b16 a[196:197], v25 offset:16384
    ds_read_b64_tr_b16 a[198:199], v25 offset:20480
    v_mfma_f32_16x16x32_bf16 v[84:87], a[212:215], a[144:147], v[84:87]
    s_waitcnt lgkmcnt(6)
    ds_read_b64_tr_b16 a[200:201], v20 offset:24576
    ds_read_b64_tr_b16 a[202:203], v20 offset:28672
    v_mfma_f32_16x16x32_bf16 v[196:199], a[216:219], a[144:147], v[196:199]
    s_waitcnt lgkmcnt(6)
    ds_read_b64_tr_b16 a[204:205], v21 offset:24576
    ds_read_b64_tr_b16 a[206:207], v21 offset:28672
    v_mfma_f32_16x16x32_bf16 v[92:95], a[220:223], a[144:147], v[92:95]
    s_waitcnt lgkmcnt(6)
    ds_read_b64_tr_b16 a[208:209], v22 offset:24576
    ds_read_b64_tr_b16 a[210:211], v22 offset:28672
    v_mfma_f32_16x16x32_bf16 v[212:215], a[192:195], a[144:147], v[212:215]
    s_waitcnt lgkmcnt(6)
    ds_read_b64_tr_b16 a[212:213], v23 offset:24576
    ds_read_b64_tr_b16 a[214:215], v23 offset:28672
    v_mfma_f32_16x16x32_bf16 v[100:103], a[196:199], a[144:147], v[100:103]
    s_waitcnt lgkmcnt(6)
    ds_read_b64_tr_b16 a[216:217], v24 offset:24576
    ds_read_b64_tr_b16 a[218:219], v24 offset:28672
    v_mfma_f32_16x16x32_bf16 v[180:183], a[200:203], a[152:155], v[180:183]
    s_waitcnt lgkmcnt(6)
    ds_read_b64_tr_b16 a[220:221], v25 offset:24576
    ds_read_b64_tr_b16 a[222:223], v25 offset:28672
    v_mfma_f32_16x16x32_bf16 v[84:87], a[204:207], a[152:155], v[84:87]
    s_waitcnt lgkmcnt(6)
    ds_read_b64_tr_b16 a[192:193], v36 offset:0
    ds_read_b64_tr_b16 a[194:195], v36 offset:4096
    v_mfma_f32_16x16x32_bf16 v[196:199], a[208:211], a[152:155], v[196:199]
    s_waitcnt lgkmcnt(6)
    ds_read_b64_tr_b16 a[196:197], v37 offset:0
    ds_read_b64_tr_b16 a[198:199], v37 offset:4096
    v_mfma_f32_16x16x32_bf16 v[92:95], a[212:215], a[152:155], v[92:95]
    s_waitcnt lgkmcnt(6)
    ds_read_b64_tr_b16 a[200:201], v38 offset:0
    ds_read_b64_tr_b16 a[202:203], v38 offset:4096
    v_mfma_f32_16x16x32_bf16 v[212:215], a[216:219], a[152:155], v[212:215]
    s_waitcnt lgkmcnt(6)
    ds_read_b64_tr_b16 a[204:205], v39 offset:0
    ds_read_b64_tr_b16 a[206:207], v39 offset:4096
    v_mfma_f32_16x16x32_bf16 v[100:103], a[220:223], a[152:155], v[100:103]
    s_waitcnt vmcnt(2)
    s_waitcnt lgkmcnt(6)
    ds_read_b64_tr_b16 a[208:209], v40 offset:0
    ds_read_b64_tr_b16 a[210:211], v40 offset:4096
    v_mfma_f32_16x16x32_bf16 v[180:183], a[192:195], a[176:179], v[180:183]
    s_waitcnt lgkmcnt(6)
    ds_read_b64_tr_b16 a[212:213], v41 offset:0
    ds_read_b64_tr_b16 a[214:215], v41 offset:4096
    v_mfma_f32_16x16x32_bf16 v[84:87], a[196:199], a[176:179], v[84:87]
    s_waitcnt lgkmcnt(6)
    ds_read_b64_tr_b16 a[216:217], v36 offset:8192
    ds_read_b64_tr_b16 a[218:219], v36 offset:12288
    v_mfma_f32_16x16x32_bf16 v[196:199], a[200:203], a[176:179], v[196:199]
    s_waitcnt lgkmcnt(6)
    ds_read_b64_tr_b16 a[220:221], v37 offset:8192
    ds_read_b64_tr_b16 a[222:223], v37 offset:12288
    v_mfma_f32_16x16x32_bf16 v[92:95], a[204:207], a[176:179], v[92:95]
    s_waitcnt lgkmcnt(6)
    ds_read_b64_tr_b16 a[192:193], v38 offset:8192
    ds_read_b64_tr_b16 a[194:195], v38 offset:12288
    v_mfma_f32_16x16x32_bf16 v[212:215], a[208:211], a[176:179], v[212:215]
    s_waitcnt lgkmcnt(6)
    ds_read_b64_tr_b16 a[196:197], v39 offset:8192
    ds_read_b64_tr_b16 a[198:199], v39 offset:12288
    v_mfma_f32_16x16x32_bf16 v[100:103], a[212:215], a[176:179], v[100:103]
    s_waitcnt lgkmcnt(6)
    ds_read_b64_tr_b16 a[200:201], v40 offset:8192
    ds_read_b64_tr_b16 a[202:203], v40 offset:12288
    v_mfma_f32_16x16x32_bf16 v[180:183], a[216:219], a[184:187], v[180:183]
    s_waitcnt lgkmcnt(6)
    ds_read_b64_tr_b16 a[204:205], v41 offset:8192
    ds_read_b64_tr_b16 a[206:207], v41 offset:12288
    v_mfma_f32_16x16x32_bf16 v[84:87], a[220:223], a[184:187], v[84:87]
    s_waitcnt lgkmcnt(6)
    ds_read_b64_tr_b16 a[208:209], v36 offset:16384
    ds_read_b64_tr_b16 a[210:211], v36 offset:20480
    v_mfma_f32_16x16x32_bf16 v[196:199], a[192:195], a[184:187], v[196:199]
    s_waitcnt lgkmcnt(6)
    ds_read_b64_tr_b16 a[212:213], v37 offset:16384
    ds_read_b64_tr_b16 a[214:215], v37 offset:20480
    v_mfma_f32_16x16x32_bf16 v[92:95], a[196:199], a[184:187], v[92:95]
    s_waitcnt lgkmcnt(6)
    ds_read_b64_tr_b16 a[216:217], v38 offset:16384
    ds_read_b64_tr_b16 a[218:219], v38 offset:20480
    v_mfma_f32_16x16x32_bf16 v[212:215], a[200:203], a[184:187], v[212:215]
    s_waitcnt lgkmcnt(6)
    ds_read_b64_tr_b16 a[220:221], v39 offset:16384
    ds_read_b64_tr_b16 a[222:223], v39 offset:20480
    v_mfma_f32_16x16x32_bf16 v[100:103], a[204:207], a[184:187], v[100:103]
    s_waitcnt vmcnt(0)
    s_waitcnt lgkmcnt(6)
    ds_read_b64_tr_b16 a[192:193], v40 offset:16384
    ds_read_b64_tr_b16 a[194:195], v40 offset:20480
    v_mfma_f32_16x16x32_bf16 v[180:183], a[208:211], a[240:243], v[180:183]
    s_waitcnt lgkmcnt(6)
    ds_read_b64_tr_b16 a[196:197], v41 offset:16384
    ds_read_b64_tr_b16 a[198:199], v41 offset:20480
    v_mfma_f32_16x16x32_bf16 v[84:87], a[212:215], a[240:243], v[84:87]
    s_waitcnt lgkmcnt(6)
    ds_read_b64_tr_b16 a[200:201], v36 offset:24576
    ds_read_b64_tr_b16 a[202:203], v36 offset:28672
    v_mfma_f32_16x16x32_bf16 v[196:199], a[216:219], a[240:243], v[196:199]
    s_waitcnt lgkmcnt(6)
    ds_read_b64_tr_b16 a[204:205], v37 offset:24576
    ds_read_b64_tr_b16 a[206:207], v37 offset:28672
    v_mfma_f32_16x16x32_bf16 v[92:95], a[220:223], a[240:243], v[92:95]
    s_waitcnt lgkmcnt(6)
    ds_read_b64_tr_b16 a[208:209], v38 offset:24576
    ds_read_b64_tr_b16 a[210:211], v38 offset:28672
    v_mfma_f32_16x16x32_bf16 v[212:215], a[192:195], a[240:243], v[212:215]
    s_waitcnt lgkmcnt(6)
    ds_read_b64_tr_b16 a[212:213], v39 offset:24576
    ds_read_b64_tr_b16 a[214:215], v39 offset:28672
    v_mfma_f32_16x16x32_bf16 v[100:103], a[196:199], a[240:243], v[100:103]
    s_waitcnt lgkmcnt(6)
    ds_read_b64_tr_b16 a[216:217], v40 offset:24576
    ds_read_b64_tr_b16 a[218:219], v40 offset:28672
    v_mfma_f32_16x16x32_bf16 v[180:183], a[200:203], a[248:251], v[180:183]
    s_waitcnt lgkmcnt(6)
    ds_read_b64_tr_b16 a[220:221], v41 offset:24576
    ds_read_b64_tr_b16 a[222:223], v41 offset:28672
    v_mfma_f32_16x16x32_bf16 v[84:87], a[204:207], a[248:251], v[84:87]
    s_waitcnt lgkmcnt(6)
    ds_read_b64_tr_b16 a[192:193], v26 offset:32768
    ds_read_b64_tr_b16 a[194:195], v26 offset:36864
    v_mfma_f32_16x16x32_bf16 v[196:199], a[208:211], a[248:251], v[196:199]
    s_waitcnt lgkmcnt(6)
    ds_read_b64_tr_b16 a[196:197], v27 offset:32768
    ds_read_b64_tr_b16 a[198:199], v27 offset:36864
    v_mfma_f32_16x16x32_bf16 v[92:95], a[212:215], a[248:251], v[92:95]
    s_waitcnt lgkmcnt(6)
    ds_read_b64_tr_b16 a[200:201], v26 offset:40960
    ds_read_b64_tr_b16 a[202:203], v26 offset:45056
    v_mfma_f32_16x16x32_bf16 v[212:215], a[216:219], a[248:251], v[212:215]
    s_waitcnt lgkmcnt(6)
    ds_read_b64_tr_b16 a[204:205], v27 offset:40960
    ds_read_b64_tr_b16 a[206:207], v27 offset:45056
    v_cvt_pk_bf16_f32 v180, v180, v181
    v_cvt_pk_bf16_f32 v181, v182, v183
    v_cvt_pk_bf16_f32 v182, v84, v85
    v_cvt_pk_bf16_f32 v183, v86, v87
    v_mfma_f32_16x16x32_bf16 v[100:103], a[220:223], a[248:251], v[100:103]
    s_waitcnt lgkmcnt(6)
    ds_read_b64_tr_b16 a[208:209], v34 offset:16384
    ds_read_b64_tr_b16 a[210:211], v34 offset:20480
    buffer_store_dwordx4 v[180:183], v16, s[24:27], s56 offen offset:0 sc1
    v_mfma_f32_16x16x32_bf16 v[228:231], a[192:195], a[80:83], v[228:231]
    s_waitcnt lgkmcnt(6)
    ds_read_b64_tr_b16 a[212:213], v35 offset:16384
    ds_read_b64_tr_b16 a[214:215], v35 offset:20480
    v_cvt_pk_bf16_f32 v196, v196, v197
    v_cvt_pk_bf16_f32 v197, v198, v199
    v_cvt_pk_bf16_f32 v198, v92, v93
    v_cvt_pk_bf16_f32 v199, v94, v95
    v_mfma_f32_16x16x32_bf16 v[108:111], a[196:199], a[80:83], v[108:111]
    s_waitcnt lgkmcnt(6)
    ds_read_b64_tr_b16 a[216:217], v34 offset:24576
    ds_read_b64_tr_b16 a[218:219], v34 offset:28672
    buffer_store_dwordx4 v[196:199], v16, s[24:27], s57 offen offset:0 sc1
    v_mfma_f32_16x16x32_bf16 v[228:231], a[200:203], a[88:91], v[228:231]
    s_waitcnt lgkmcnt(6)
    ds_read_b64_tr_b16 a[220:221], v35 offset:24576
    ds_read_b64_tr_b16 a[222:223], v35 offset:28672
    v_cvt_pk_bf16_f32 v212, v212, v213
    v_cvt_pk_bf16_f32 v213, v214, v215
    v_cvt_pk_bf16_f32 v214, v100, v101
    v_cvt_pk_bf16_f32 v215, v102, v103
    v_mfma_f32_16x16x32_bf16 v[108:111], a[204:207], a[88:91], v[108:111]
    s_waitcnt lgkmcnt(6)
    ds_read_b64_tr_b16 a[192:193], v34 offset:0
    ds_read_b64_tr_b16 a[194:195], v34 offset:4096
    buffer_store_dwordx4 v[212:215], v16, s[24:27], s58 offen offset:0 sc1
    v_mfma_f32_16x16x32_bf16 v[228:231], a[208:211], a[112:115], v[228:231]
    s_waitcnt lgkmcnt(6)
    ds_read_b64_tr_b16 a[196:197], v35 offset:0
    ds_read_b64_tr_b16 a[198:199], v35 offset:4096
    v_mfma_f32_16x16x32_bf16 v[108:111], a[212:215], a[112:115], v[108:111]
    s_waitcnt lgkmcnt(6)
    ds_read_b64_tr_b16 a[200:201], v34 offset:8192
    ds_read_b64_tr_b16 a[202:203], v34 offset:12288
    v_mfma_f32_16x16x32_bf16 v[228:231], a[216:219], a[120:123], v[228:231]
    s_waitcnt lgkmcnt(6)
    ds_read_b64_tr_b16 a[204:205], v35 offset:8192
    ds_read_b64_tr_b16 a[206:207], v35 offset:12288
    v_mfma_f32_16x16x32_bf16 v[108:111], a[220:223], a[120:123], v[108:111]
    s_waitcnt lgkmcnt(6)
    ds_read_b64_tr_b16 a[208:209], v34 offset:32768
    ds_read_b64_tr_b16 a[210:211], v34 offset:36864
    v_mfma_f32_16x16x32_bf16 v[228:231], a[192:195], a[128:131], v[228:231]
    s_waitcnt lgkmcnt(6)
    ds_read_b64_tr_b16 a[212:213], v35 offset:32768
    ds_read_b64_tr_b16 a[214:215], v35 offset:36864
    v_mfma_f32_16x16x32_bf16 v[108:111], a[196:199], a[128:131], v[108:111]
    s_waitcnt lgkmcnt(6)
    ds_read_b64_tr_b16 a[216:217], v34 offset:40960
    ds_read_b64_tr_b16 a[218:219], v34 offset:45056
    v_mfma_f32_16x16x32_bf16 v[228:231], a[200:203], a[136:139], v[228:231]
    s_waitcnt lgkmcnt(6)
    ds_read_b64_tr_b16 a[220:221], v35 offset:40960
    ds_read_b64_tr_b16 a[222:223], v35 offset:45056
    v_mfma_f32_16x16x32_bf16 v[108:111], a[204:207], a[136:139], v[108:111]
    s_waitcnt lgkmcnt(6)
    ds_read_b64_tr_b16 a[192:193], v26 offset:49152
    ds_read_b64_tr_b16 a[194:195], v26 offset:53248
    v_mfma_f32_16x16x32_bf16 v[228:231], a[208:211], a[160:163], v[228:231]
    s_waitcnt lgkmcnt(6)
    ds_read_b64_tr_b16 a[196:197], v27 offset:49152
    ds_read_b64_tr_b16 a[198:199], v27 offset:53248
    v_mfma_f32_16x16x32_bf16 v[108:111], a[212:215], a[160:163], v[108:111]
    s_waitcnt lgkmcnt(6)
    ds_read_b64_tr_b16 a[200:201], v26 offset:57344
    ds_read_b64_tr_b16 a[202:203], v26 offset:61440
    v_mfma_f32_16x16x32_bf16 v[228:231], a[216:219], a[168:171], v[228:231]
    s_waitcnt lgkmcnt(6)
    ds_read_b64_tr_b16 a[204:205], v27 offset:57344
    ds_read_b64_tr_b16 a[206:207], v27 offset:61440
    v_mfma_f32_16x16x32_bf16 v[108:111], a[220:223], a[168:171], v[108:111]
    s_waitcnt lgkmcnt(6)
    ds_read_b64_tr_b16 a[208:209], v26 offset:16384
    ds_read_b64_tr_b16 a[210:211], v26 offset:20480
    v_mfma_f32_16x16x32_bf16 v[228:231], a[192:195], a[224:227], v[228:231]
    s_waitcnt lgkmcnt(6)
    ds_read_b64_tr_b16 a[212:213], v27 offset:16384
    ds_read_b64_tr_b16 a[214:215], v27 offset:20480
    v_mfma_f32_16x16x32_bf16 v[108:111], a[196:199], a[224:227], v[108:111]
    s_waitcnt lgkmcnt(6)
    ds_read_b64_tr_b16 a[216:217], v26 offset:24576
    ds_read_b64_tr_b16 a[218:219], v26 offset:28672
    v_mfma_f32_16x16x32_bf16 v[228:231], a[200:203], a[232:235], v[228:231]
    s_waitcnt lgkmcnt(6)
    ds_read_b64_tr_b16 a[220:221], v27 offset:24576
    ds_read_b64_tr_b16 a[222:223], v27 offset:28672
    v_mfma_f32_16x16x32_bf16 v[108:111], a[204:207], a[232:235], v[108:111]
    s_waitcnt vmcnt(0)
    s_add_u32 s43, s53, 262144
    buffer_store_dword v13, v14, s[24:27], s43 offen sc1
    s_waitcnt lgkmcnt(6)
    ds_read_b64_tr_b16 a[192:193], v42 offset:0
    ds_read_b64_tr_b16 a[194:195], v42 offset:4096
    v_mfma_f32_16x16x32_bf16 v[228:231], a[208:211], a[144:147], v[228:231]
    s_waitcnt lgkmcnt(6)
    ds_read_b64_tr_b16 a[196:197], v43 offset:0
    ds_read_b64_tr_b16 a[198:199], v43 offset:4096
    v_mfma_f32_16x16x32_bf16 v[108:111], a[212:215], a[144:147], v[108:111]
    s_waitcnt lgkmcnt(6)
    ds_read_b64_tr_b16 a[200:201], v42 offset:8192
    ds_read_b64_tr_b16 a[202:203], v42 offset:12288
    v_mfma_f32_16x16x32_bf16 v[228:231], a[216:219], a[152:155], v[228:231]
    s_waitcnt lgkmcnt(6)
    ds_read_b64_tr_b16 a[204:205], v43 offset:8192
    ds_read_b64_tr_b16 a[206:207], v43 offset:12288
    v_mfma_f32_16x16x32_bf16 v[108:111], a[220:223], a[152:155], v[108:111]
    s_waitcnt lgkmcnt(6)
    ds_read_b64_tr_b16 a[208:209], v42 offset:16384
    ds_read_b64_tr_b16 a[210:211], v42 offset:20480
    v_mfma_f32_16x16x32_bf16 v[228:231], a[192:195], a[176:179], v[228:231]
    s_waitcnt lgkmcnt(6)
    ds_read_b64_tr_b16 a[212:213], v43 offset:16384
    ds_read_b64_tr_b16 a[214:215], v43 offset:20480
    v_mfma_f32_16x16x32_bf16 v[108:111], a[196:199], a[176:179], v[108:111]
    s_waitcnt lgkmcnt(6)
    ds_read_b64_tr_b16 a[216:217], v42 offset:24576
    ds_read_b64_tr_b16 a[218:219], v42 offset:28672
    v_mfma_f32_16x16x32_bf16 v[228:231], a[200:203], a[184:187], v[228:231]
    s_waitcnt lgkmcnt(6)
    ds_read_b64_tr_b16 a[220:221], v43 offset:24576
    ds_read_b64_tr_b16 a[222:223], v43 offset:28672
    v_mfma_f32_16x16x32_bf16 v[108:111], a[204:207], a[184:187], v[108:111]
    s_waitcnt lgkmcnt(6)
    v_mfma_f32_16x16x32_bf16 v[228:231], a[208:211], a[240:243], v[228:231]
    s_waitcnt lgkmcnt(4)
    v_mfma_f32_16x16x32_bf16 v[108:111], a[212:215], a[240:243], v[108:111]
    s_waitcnt lgkmcnt(2)
    v_mfma_f32_16x16x32_bf16 v[228:231], a[216:219], a[248:251], v[228:231]
    s_waitcnt lgkmcnt(0)
    v_mfma_f32_16x16x32_bf16 v[108:111], a[220:223], a[248:251], v[108:111]
    s_mov_b32 s43, s55
    buffer_load_dword v10, v12, s[24:27], s43 offen sc1
    s_waitcnt vmcnt(0)
    v_cmp_ne_u32 s[62:63], 1, v10
    s_nop 0
    s_cmp_lg_u64 s[62:63], 0
    s_cbranch_scc1 w1_p2_spin
w1_p2_back:
    s_add_u32 s42, s59, 1835008
    s_add_u32 s43, s59, 3670016
    buffer_load_dwordx4 v[148:151], v16, s[24:27], s59 offen offset:0 sc1
    buffer_load_dwordx4 v[156:159], v16, s[24:27], s42 offen offset:0 sc1
    buffer_load_dwordx4 v[164:167], v16, s[24:27], s43 offen offset:0 sc1
    s_waitcnt vmcnt(2)
    v_lshlrev_b32 v244, 16, v148
    v_and_b32 v245, 0xffff0000, v148
    v_pk_add_f32 v[228:229], v[228:229], v[244:245]
    v_lshlrev_b32 v246, 16, v149
    v_and_b32 v247, 0xffff0000, v149
    v_pk_add_f32 v[230:231], v[230:231], v[246:247]
    v_lshlrev_b32 v248, 16, v150
    v_and_b32 v249, 0xffff0000, v150
    v_pk_add_f32 v[108:109], v[108:109], v[248:249]
    v_lshlrev_b32 v250, 16, v151
    v_and_b32 v251, 0xffff0000, v151
    v_pk_add_f32 v[110:111], v[110:111], v[250:251]
    s_waitcnt vmcnt(1)
    v_lshlrev_b32 v244, 16, v156
    v_and_b32 v245, 0xffff0000, v156
    v_pk_add_f32 v[228:229], v[228:229], v[244:245]
    v_lshlrev_b32 v246, 16, v157
    v_and_b32 v247, 0xffff0000, v157
    v_pk_add_f32 v[230:231], v[230:231], v[246:247]
    v_lshlrev_b32 v248, 16, v158
    v_and_b32 v249, 0xffff0000, v158
    v_pk_add_f32 v[108:109], v[108:109], v[248:249]
    v_lshlrev_b32 v250, 16, v159
    v_and_b32 v251, 0xffff0000, v159
    v_pk_add_f32 v[110:111], v[110:111], v[250:251]
    s_waitcnt vmcnt(0)
    v_lshlrev_b32 v244, 16, v164
    v_and_b32 v245, 0xffff0000, v164
    v_pk_add_f32 v[228:229], v[228:229], v[244:245]
    v_lshlrev_b32 v246, 16, v165
    v_and_b32 v247, 0xffff0000, v165
    v_pk_add_f32 v[230:231], v[230:231], v[246:247]
    v_lshlrev_b32 v248, 16, v166
    v_and_b32 v249, 0xffff0000, v166
    v_pk_add_f32 v[108:109], v[108:109], v[248:249]
    v_lshlrev_b32 v250, 16, v167
    v_and_b32 v251, 0xffff0000, v167
    v_pk_add_f32 v[110:111], v[110:111], v[250:251]
    v_cvt_pk_bf16_f32 v228, v228, v229
    v_cvt_pk_bf16_f32 v229, v230, v231
    v_cvt_pk_bf16_f32 v230, v108, v109
    v_cvt_pk_bf16_f32 v231, v110, v111
    s_nop 0
    v_permlane32_swap_b32 v228, v230
    v_permlane32_swap_b32 v229, v231
    s_nop 0
    v_permlane16_swap_b32 v228, v230
    v_permlane16_swap_b32 v229, v231
    s_add_u32 s43, s60, 16384
    buffer_store_dwordx4 v[228:231], v66, s[28:31], s60 offen sc1
    s_endpgm

k1_end:
    s_endpgm
w2_pcnt_spin:
    s_mov_b32 s61, 0
w2_pcnt_again:
    s_lshl_b32 s43, s48, 2
    buffer_load_dword v10, off, s[32:35], s43 sc1
    s_add_u32 s61, s61, 1
    s_cmp_ge_u32 s61, 2000000
    s_waitcnt vmcnt(0)
    s_cbranch_scc1 w2_pcnt_back
    v_cmp_gt_u32 s[62:63], 3, v10
    s_nop 0
    s_cmp_lg_u64 s[62:63], 0
    s_cbranch_scc1 w2_pcnt_again
    s_branch w2_pcnt_back
w2_p0_spin:
    s_mov_b32 s61, 0
w2_p0_again:
    s_add_u32 s43, s54, 0
    buffer_load_dword v10, v11, s[24:27], s43 offen sc1
    s_add_u32 s61, s61, 1
    s_cmp_ge_u32 s61, 2000000
    s_waitcnt vmcnt(0)
    s_cbranch_scc1 w2_p0_back
    v_cmp_ne_u32 s[62:63], 1, v10
    s_nop 0
    s_cmp_lg_u64 s[62:63], 0
    s_cbranch_scc1 w2_p0_again
    s_branch w2_p0_back
w2_p1_spin:
    s_mov_b32 s61, 0
w2_p1_again:
    s_add_u32 s43, s54, 131072
    buffer_load_dword v10, v11, s[24:27], s43 offen sc1
    s_add_u32 s61, s61, 1
    s_cmp_ge_u32 s61, 2000000
    s_waitcnt vmcnt(0)
    s_cbranch_scc1 w2_p1_back
    v_cmp_ne_u32 s[62:63], 1, v10
    s_nop 0
    s_cmp_lg_u64 s[62:63], 0
    s_cbranch_scc1 w2_p1_again
    s_branch w2_p1_back
w2_p2_spin:
    s_mov_b32 s61, 0
w2_p2_again:
    s_mov_b32 s43, s55
    buffer_load_dword v10, v12, s[24:27], s43 offen sc1
    s_add_u32 s61, s61, 1
    s_cmp_ge_u32 s61, 2000000
    s_waitcnt vmcnt(0)
    s_cbranch_scc1 w2_p2_back
    v_cmp_ne_u32 s[62:63], 1, v10
    s_nop 0
    s_cmp_lg_u64 s[62:63], 0
    s_cbranch_scc1 w2_p2_again
    s_branch w2_p2_back
w2_t1_slow:
    s_call_b64 s[44:45], w2_resc10
    s_branch w2_t1_back
w2_t2_slow:
    s_call_b64 s[44:45], w2_resc00
    s_branch w2_t2_back
w2_t3_slow:
    s_call_b64 s[44:45], w2_resc10
    s_branch w2_t3_back
w2_t4_slow:
    s_call_b64 s[44:45], w2_resc00
    s_branch w2_t4_back
w2_t5_slow:
    s_call_b64 s[44:45], w2_resc10
    s_branch w2_t5_back
w2_t6_slow:
    s_call_b64 s[44:45], w2_resc00
    s_branch w2_t6_back
w2_t7_slow:
    s_call_b64 s[44:45], w2_resc10
    s_branch w2_t7_back
w2_t9_slow:
    s_call_b64 s[44:45], w2_resc11
    s_branch w2_t9_back
w2_t10_slow:
    s_call_b64 s[44:45], w2_resc01
    s_branch w2_t10_back
w2_t11_slow:
    s_call_b64 s[44:45], w2_resc11
    s_branch w2_t11_back
w2_t12_slow:
    s_call_b64 s[44:45], w2_resc01
    s_branch w2_t12_back
w2_t13_slow:
    s_call_b64 s[44:45], w2_resc11
    s_branch w2_t13_back
w2_t14_slow:
    s_call_b64 s[44:45], w2_resc01
    s_branch w2_t14_back
w2_t15_slow:
    s_call_b64 s[44:45], w2_resc11
    s_branch w2_t15_back
w2_resc00:
    s_nop 7
    s_nop 7
    v_max3_f32 v1, v84, v85, v86
    v_max3_f32 v3, v88, v89, v90
    v_max3_f32 v1, v1, v87, v92
    v_max3_f32 v3, v3, v91, v96
    v_max3_f32 v1, v1, v93, v94
    v_max3_f32 v3, v3, v97, v98
    v_max3_f32 v1, v1, v95, v100
    v_max3_f32 v3, v3, v99, v104
    v_max3_f32 v1, v1, v101, v102
    v_max3_f32 v3, v3, v105, v106
    v_max3_f32 v1, v1, v103, v108
    v_max3_f32 v3, v3, v107, v112
    v_max3_f32 v1, v1, v109, v110
    v_max3_f32 v3, v3, v113, v114
    v_max_f32 v1, v1, v111
    v_max_f32 v3, v3, v115
    v_mov_b32 v2, v1
    v_mov_b32 v4, v3
    s_nop 0
    v_permlane32_swap_b32 v1, v2
    v_permlane32_swap_b32 v3, v4
    v_max_f32 v1, v1, v2
    v_max_f32 v3, v3, v4
    v_mov_b32 v2, v1
    v_mov_b32 v4, v3
    s_nop 0
    v_permlane16_swap_b32 v1, v2
    v_permlane16_swap_b32 v3, v4
    v_max_f32 v1, v1, v2
    v_max_f32 v3, v3, v4
    v_max_f32 v1, 0, v1
    v_sub_f32 v76, v76, v1
    v_sub_f32 v77, v77, v1
    v_sub_f32 v78, v78, v1
    v_sub_f32 v79, v79, v1
    v_sub_f32 v84, v84, v1
    v_sub_f32 v85, v85, v1
    v_sub_f32 v86, v86, v1
    v_sub_f32 v87, v87, v1
    v_sub_f32 v92, v92, v1
    v_sub_f32 v93, v93, v1
    v_sub_f32 v94, v94, v1
    v_sub_f32 v95, v95, v1
    v_sub_f32 v100, v100, v1
    v_sub_f32 v101, v101, v1
    v_sub_f32 v102, v102, v1
    v_sub_f32 v103, v103, v1
    v_sub_f32 v108, v108, v1
    v_sub_f32 v109, v109, v1
    v_sub_f32 v110, v110, v1
    v_sub_f32 v111, v111, v1
    v_exp_f32 v2, -v1
    s_nop 0
    v_mul_f32 v68, v2, v68
    v_mul_f32 v69, v2, v69
    v_mul_f32 v70, v2, v70
    v_mul_f32 v71, v2, v71
    v_accvgpr_read_b32 v5, a128
    v_mul_f32 v5, v2, v5
    v_accvgpr_write_b32 a128, v5
    v_accvgpr_read_b32 v5, a129
    v_mul_f32 v5, v2, v5
    v_accvgpr_write_b32 a129, v5
    v_accvgpr_read_b32 v5, a130
    v_mul_f32 v5, v2, v5
    v_accvgpr_write_b32 a130, v5
    v_accvgpr_read_b32 v5, a131
    v_mul_f32 v5, v2, v5
    v_accvgpr_write_b32 a131, v5
    v_accvgpr_read_b32 v5, a136
    v_mul_f32 v5, v2, v5
    v_accvgpr_write_b32 a136, v5
    v_accvgpr_read_b32 v5, a137
    v_mul_f32 v5, v2, v5
    v_accvgpr_write_b32 a137, v5
    v_accvgpr_read_b32 v5, a138
    v_mul_f32 v5, v2, v5
    v_accvgpr_write_b32 a138, v5
    v_accvgpr_read_b32 v5, a139
    v_mul_f32 v5, v2, v5
    v_accvgpr_write_b32 a139, v5
    v_accvgpr_read_b32 v5, a144
    v_mul_f32 v5, v2, v5
    v_accvgpr_write_b32 a144, v5
    v_accvgpr_read_b32 v5, a145
    v_mul_f32 v5, v2, v5
    v_accvgpr_write_b32 a145, v5
    v_accvgpr_read_b32 v5, a146
    v_mul_f32 v5, v2, v5
    v_accvgpr_write_b32 a146, v5
    v_accvgpr_read_b32 v5, a147
    v_mul_f32 v5, v2, v5
    v_accvgpr_write_b32 a147, v5
    v_accvgpr_read_b32 v5, a152
    v_mul_f32 v5, v2, v5
    v_accvgpr_write_b32 a152, v5
    v_accvgpr_read_b32 v5, a153
    v_mul_f32 v5, v2, v5
    v_accvgpr_write_b32 a153, v5
    v_accvgpr_read_b32 v5, a154
    v_mul_f32 v5, v2, v5
    v_accvgpr_write_b32 a154, v5
    v_accvgpr_read_b32 v5, a155
    v_mul_f32 v5, v2, v5
    v_accvgpr_write_b32 a155, v5
    v_accvgpr_read_b32 v5, a160
    v_mul_f32 v5, v2, v5
    v_accvgpr_write_b32 a160, v5
    v_accvgpr_read_b32 v5, a161
    v_mul_f32 v5, v2, v5
    v_accvgpr_write_b32 a161, v5
    v_accvgpr_read_b32 v5, a162
    v_mul_f32 v5, v2, v5
    v_accvgpr_write_b32 a162, v5
    v_accvgpr_read_b32 v5, a163
    v_mul_f32 v5, v2, v5
    v_accvgpr_write_b32 a163, v5
    v_accvgpr_read_b32 v5, a168
    v_mul_f32 v5, v2, v5
    v_accvgpr_write_b32 a168, v5
    v_accvgpr_read_b32 v5, a169
    v_mul_f32 v5, v2, v5
    v_accvgpr_write_b32 a169, v5
    v_accvgpr_read_b32 v5, a170
    v_mul_f32 v5, v2, v5
    v_accvgpr_write_b32 a170, v5
    v_accvgpr_read_b32 v5, a171
    v_mul_f32 v5, v2, v5
    v_accvgpr_write_b32 a171, v5
    v_accvgpr_read_b32 v5, a176
    v_mul_f32 v5, v2, v5
    v_accvgpr_write_b32 a176, v5
    v_accvgpr_read_b32 v5, a177
    v_mul_f32 v5, v2, v5
    v_accvgpr_write_b32 a177, v5
    v_accvgpr_read_b32 v5, a178
    v_mul_f32 v5, v2, v5
    v_accvgpr_write_b32 a178, v5
    v_accvgpr_read_b32 v5, a179
    v_mul_f32 v5, v2, v5
    v_accvgpr_write_b32 a179, v5
    v_accvgpr_read_b32 v5, a184
    v_mul_f32 v5, v2, v5
    v_accvgpr_write_b32 a184, v5
    v_accvgpr_read_b32 v5, a185
    v_mul_f32 v5, v2, v5
    v_accvgpr_write_b32 a185, v5
    v_accvgpr_read_b32 v5, a186
    v_mul_f32 v5, v2, v5
    v_accvgpr_write_b32 a186, v5
    v_accvgpr_read_b32 v5, a187
    v_mul_f32 v5, v2, v5
    v_accvgpr_write_b32 a187, v5
    v_max_f32 v3, 0, v3
    v_sub_f32 v80, v80, v3
    v_sub_f32 v81, v81, v3
    v_sub_f32 v82, v82, v3
    v_sub_f32 v83, v83, v3
    v_sub_f32 v88, v88, v3
    v_sub_f32 v89, v89, v3
    v_sub_f32 v90, v90, v3
    v_sub_f32 v91, v91, v3
    v_sub_f32 v96, v96, v3
    v_sub_f32 v97, v97, v3
    v_sub_f32 v98, v98, v3
    v_sub_f32 v99, v99, v3
    v_sub_f32 v104, v104, v3
    v_sub_f32 v105, v105, v3
    v_sub_f32 v106, v106, v3
    v_sub_f32 v107, v107, v3
    v_sub_f32 v112, v112, v3
    v_sub_f32 v113, v113, v3
    v_sub_f32 v114, v114, v3
    v_sub_f32 v115, v115, v3
    v_exp_f32 v4, -v3
    s_nop 0
    v_mul_f32 v72, v4, v72
    v_mul_f32 v73, v4, v73
    v_mul_f32 v74, v4, v74
    v_mul_f32 v75, v4, v75
    v_accvgpr_read_b32 v5, a132
    v_mul_f32 v5, v4, v5
    v_accvgpr_write_b32 a132, v5
    v_accvgpr_read_b32 v5, a133
    v_mul_f32 v5, v4, v5
    v_accvgpr_write_b32 a133, v5
    v_accvgpr_read_b32 v5, a134
    v_mul_f32 v5, v4, v5
    v_accvgpr_write_b32 a134, v5
    v_accvgpr_read_b32 v5, a135
    v_mul_f32 v5, v4, v5
    v_accvgpr_write_b32 a135, v5
    v_accvgpr_read_b32 v5, a140
    v_mul_f32 v5, v4, v5
    v_accvgpr_write_b32 a140, v5
    v_accvgpr_read_b32 v5, a141
    v_mul_f32 v5, v4, v5
    v_accvgpr_write_b32 a141, v5
    v_accvgpr_read_b32 v5, a142
    v_mul_f32 v5, v4, v5
    v_accvgpr_write_b32 a142, v5
    v_accvgpr_read_b32 v5, a143
    v_mul_f32 v5, v4, v5
    v_accvgpr_write_b32 a143, v5
    v_accvgpr_read_b32 v5, a148
    v_mul_f32 v5, v4, v5
    v_accvgpr_write_b32 a148, v5
    v_accvgpr_read_b32 v5, a149
    v_mul_f32 v5, v4, v5
    v_accvgpr_write_b32 a149, v5
    v_accvgpr_read_b32 v5, a150
    v_mul_f32 v5, v4, v5
    v_accvgpr_write_b32 a150, v5
    v_accvgpr_read_b32 v5, a151
    v_mul_f32 v5, v4, v5
    v_accvgpr_write_b32 a151, v5
    v_accvgpr_read_b32 v5, a156
    v_mul_f32 v5, v4, v5
    v_accvgpr_write_b32 a156, v5
    v_accvgpr_read_b32 v5, a157
    v_mul_f32 v5, v4, v5
    v_accvgpr_write_b32 a157, v5
    v_accvgpr_read_b32 v5, a158
    v_mul_f32 v5, v4, v5
    v_accvgpr_write_b32 a158, v5
    v_accvgpr_read_b32 v5, a159
    v_mul_f32 v5, v4, v5
    v_accvgpr_write_b32 a159, v5
    v_accvgpr_read_b32 v5, a164
    v_mul_f32 v5, v4, v5
    v_accvgpr_write_b32 a164, v5
    v_accvgpr_read_b32 v5, a165
    v_mul_f32 v5, v4, v5
    v_accvgpr_write_b32 a165, v5
    v_accvgpr_read_b32 v5, a166
    v_mul_f32 v5, v4, v5
    v_accvgpr_write_b32 a166, v5
    v_accvgpr_read_b32 v5, a167
    v_mul_f32 v5, v4, v5
    v_accvgpr_write_b32 a167, v5
    v_accvgpr_read_b32 v5, a172
    v_mul_f32 v5, v4, v5
    v_accvgpr_write_b32 a172, v5
    v_accvgpr_read_b32 v5, a173
    v_mul_f32 v5, v4, v5
    v_accvgpr_write_b32 a173, v5
    v_accvgpr_read_b32 v5, a174
    v_mul_f32 v5, v4, v5
    v_accvgpr_write_b32 a174, v5
    v_accvgpr_read_b32 v5, a175
    v_mul_f32 v5, v4, v5
    v_accvgpr_write_b32 a175, v5
    v_accvgpr_read_b32 v5, a180
    v_mul_f32 v5, v4, v5
    v_accvgpr_write_b32 a180, v5
    v_accvgpr_read_b32 v5, a181
    v_mul_f32 v5, v4, v5
    v_accvgpr_write_b32 a181, v5
    v_accvgpr_read_b32 v5, a182
    v_mul_f32 v5, v4, v5
    v_accvgpr_write_b32 a182, v5
    v_accvgpr_read_b32 v5, a183
    v_mul_f32 v5, v4, v5
    v_accvgpr_write_b32 a183, v5
    v_accvgpr_read_b32 v5, a188
    v_mul_f32 v5, v4, v5
    v_accvgpr_write_b32 a188, v5
    v_accvgpr_read_b32 v5, a189
    v_mul_f32 v5, v4, v5
    v_accvgpr_write_b32 a189, v5
    v_accvgpr_read_b32 v5, a190
    v_mul_f32 v5, v4, v5
    v_accvgpr_write_b32 a190, v5
    v_accvgpr_read_b32 v5, a191
    v_mul_f32 v5, v4, v5
    v_accvgpr_write_b32 a191, v5
    s_nop 3
    s_setpc_b64 s[44:45]
w2_resc01:
    s_nop 7
    s_nop 7
    v_max3_f32 v1, v84, v85, v86
    v_max3_f32 v3, v88, v89, v90
    v_max3_f32 v1, v1, v87, v92
    v_max3_f32 v3, v3, v91, v96
    v_max3_f32 v1, v1, v93, v94
    v_max3_f32 v3, v3, v97, v98
    v_max3_f32 v1, v1, v95, v100
    v_max3_f32 v3, v3, v99, v104
    v_max3_f32 v1, v1, v101, v102
    v_max3_f32 v3, v3, v105, v106
    v_max3_f32 v1, v1, v103, v108
    v_max3_f32 v3, v3, v107, v112
    v_max3_f32 v1, v1, v109, v110
    v_max3_f32 v3, v3, v113, v114
    v_max_f32 v1, v1, v111
    v_max_f32 v3, v3, v115
    v_mov_b32 v2, v1
    v_mov_b32 v4, v3
    s_nop 0
    v_permlane32_swap_b32 v1, v2
    v_permlane32_swap_b32 v3, v4
    v_max_f32 v1, v1, v2
    v_max_f32 v3, v3, v4
    v_mov_b32 v2, v1
    v_mov_b32 v4, v3
    s_nop 0
    v_permlane16_swap_b32 v1, v2
    v_permlane16_swap_b32 v3, v4
    v_max_f32 v1, v1, v2
    v_max_f32 v3, v3, v4
    v_max_f32 v1, 0, v1
    v_sub_f32 v76, v76, v1
    v_sub_f32 v77, v77, v1
    v_sub_f32 v78, v78, v1
    v_sub_f32 v79, v79, v1
    v_sub_f32 v84, v84, v1
    v_sub_f32 v85, v85, v1
    v_sub_f32 v86, v86, v1
    v_sub_f32 v87, v87, v1
    v_sub_f32 v92, v92, v1
    v_sub_f32 v93, v93, v1
    v_sub_f32 v94, v94, v1
    v_sub_f32 v95, v95, v1
    v_sub_f32 v100, v100, v1
    v_sub_f32 v101, v101, v1
    v_sub_f32 v102, v102, v1
    v_sub_f32 v103, v103, v1
    v_sub_f32 v108, v108, v1
    v_sub_f32 v109, v109, v1
    v_sub_f32 v110, v110, v1
    v_sub_f32 v111, v111, v1
    v_exp_f32 v2, -v1
    s_nop 0
    v_mul_f32 v68, v2, v68
    v_mul_f32 v69, v2, v69
    v_mul_f32 v70, v2, v70
    v_mul_f32 v71, v2, v71
    v_mul_f32 v148, v2, v148
    v_mul_f32 v149, v2, v149
    v_mul_f32 v150, v2, v150
    v_mul_f32 v151, v2, v151
    v_mul_f32 v188, v2, v188
    v_mul_f32 v189, v2, v189
    v_mul_f32 v190, v2, v190
    v_mul_f32 v191, v2, v191
    v_mul_f32 v156, v2, v156
    v_mul_f32 v157, v2, v157
    v_mul_f32 v158, v2, v158
    v_mul_f32 v159, v2, v159
    v_mul_f32 v204, v2, v204
    v_mul_f32 v205, v2, v205
    v_mul_f32 v206, v2, v206
    v_mul_f32 v207, v2, v207
    v_mul_f32 v164, v2, v164
    v_mul_f32 v165, v2, v165
    v_mul_f32 v166, v2, v166
    v_mul_f32 v167, v2, v167
    v_mul_f32 v220, v2, v220
    v_mul_f32 v221, v2, v221
    v_mul_f32 v222, v2, v222
    v_mul_f32 v223, v2, v223
    v_mul_f32 v172, v2, v172
    v_mul_f32 v173, v2, v173
    v_mul_f32 v174, v2, v174
    v_mul_f32 v175, v2, v175
    v_mul_f32 v236, v2, v236
    v_mul_f32 v237, v2, v237
    v_mul_f32 v238, v2, v238
    v_mul_f32 v239, v2, v239
    v_max_f32 v3, 0, v3
    v_sub_f32 v80, v80, v3
    v_sub_f32 v81, v81, v3
    v_sub_f32 v82, v82, v3
    v_sub_f32 v83, v83, v3
    v_sub_f32 v88, v88, v3
    v_sub_f32 v89, v89, v3
    v_sub_f32 v90, v90, v3
    v_sub_f32 v91, v91, v3
    v_sub_f32 v96, v96, v3
    v_sub_f32 v97, v97, v3
    v_sub_f32 v98, v98, v3
    v_sub_f32 v99, v99, v3
    v_sub_f32 v104, v104, v3
    v_sub_f32 v105, v105, v3
    v_sub_f32 v106, v106, v3
    v_sub_f32 v107, v107, v3
    v_sub_f32 v112, v112, v3
    v_sub_f32 v113, v113, v3
    v_sub_f32 v114, v114, v3
    v_sub_f32 v115, v115, v3
    v_exp_f32 v4, -v3
    s_nop 0
    v_mul_f32 v72, v4, v72
    v_mul_f32 v73, v4, v73
    v_mul_f32 v74, v4, v74
    v_mul_f32 v75, v4, v75
    v_mul_f32 v152, v4, v152
    v_mul_f32 v153, v4, v153
    v_mul_f32 v154, v4, v154
    v_mul_f32 v155, v4, v155
    v_mul_f32 v192, v4, v192
    v_mul_f32 v193, v4, v193
    v_mul_f32 v194, v4, v194
    v_mul_f32 v195, v4, v195
    v_mul_f32 v160, v4, v160
    v_mul_f32 v161, v4, v161
    v_mul_f32 v162, v4, v162
    v_mul_f32 v163, v4, v163
    v_mul_f32 v208, v4, v208
    v_mul_f32 v209, v4, v209
    v_mul_f32 v210, v4, v210
    v_mul_f32 v211, v4, v211
    v_mul_f32 v168, v4, v168
    v_mul_f32 v169, v4, v169
    v_mul_f32 v170, v4, v170
    v_mul_f32 v171, v4, v171
    v_mul_f32 v224, v4, v224
    v_mul_f32 v225, v4, v225
    v_mul_f32 v226, v4, v226
    v_mul_f32 v227, v4, v227
    v_mul_f32 v176, v4, v176
    v_mul_f32 v177, v4, v177
    v_mul_f32 v178, v4, v178
    v_mul_f32 v179, v4, v179
    v_mul_f32 v240, v4, v240
    v_mul_f32 v241, v4, v241
    v_mul_f32 v242, v4, v242
    v_mul_f32 v243, v4, v243
    s_nop 3
    s_setpc_b64 s[44:45]
w2_resc10:
    s_nop 7
    s_nop 7
    v_max3_f32 v1, v116, v117, v118
    v_max3_f32 v3, v120, v121, v122
    v_max3_f32 v1, v1, v119, v124
    v_max3_f32 v3, v3, v123, v128
    v_max3_f32 v1, v1, v125, v126
    v_max3_f32 v3, v3, v129, v130
    v_max3_f32 v1, v1, v127, v132
    v_max3_f32 v3, v3, v131, v136
    v_max3_f32 v1, v1, v133, v134
    v_max3_f32 v3, v3, v137, v138
    v_max3_f32 v1, v1, v135, v140
    v_max3_f32 v3, v3, v139, v144
    v_max3_f32 v1, v1, v141, v142
    v_max3_f32 v3, v3, v145, v146
    v_max_f32 v1, v1, v143
    v_max_f32 v3, v3, v147
    v_mov_b32 v2, v1
    v_mov_b32 v4, v3
    s_nop 0
    v_permlane32_swap_b32 v1, v2
    v_permlane32_swap_b32 v3, v4
    v_max_f32 v1, v1, v2
    v_max_f32 v3, v3, v4
    v_mov_b32 v2, v1
    v_mov_b32 v4, v3
    s_nop 0
    v_permlane16_swap_b32 v1, v2
    v_permlane16_swap_b32 v3, v4
    v_max_f32 v1, v1, v2
    v_max_f32 v3, v3, v4
    v_max_f32 v1, 0, v1
    v_sub_f32 v76, v76, v1
    v_sub_f32 v77, v77, v1
    v_sub_f32 v78, v78, v1
    v_sub_f32 v79, v79, v1
    v_sub_f32 v116, v116, v1
    v_sub_f32 v117, v117, v1
    v_sub_f32 v118, v118, v1
    v_sub_f32 v119, v119, v1
    v_sub_f32 v124, v124, v1
    v_sub_f32 v125, v125, v1
    v_sub_f32 v126, v126, v1
    v_sub_f32 v127, v127, v1
    v_sub_f32 v132, v132, v1
    v_sub_f32 v133, v133, v1
    v_sub_f32 v134, v134, v1
    v_sub_f32 v135, v135, v1
    v_sub_f32 v140, v140, v1
    v_sub_f32 v141, v141, v1
    v_sub_f32 v142, v142, v1
    v_sub_f32 v143, v143, v1
    v_exp_f32 v2, -v1
    s_nop 0
    v_mul_f32 v68, v2, v68
    v_mul_f32 v69, v2, v69
    v_mul_f32 v70, v2, v70
    v_mul_f32 v71, v2, v71
    v_accvgpr_read_b32 v5, a128
    v_mul_f32 v5, v2, v5
    v_accvgpr_write_b32 a128, v5
    v_accvgpr_read_b32 v5, a129
    v_mul_f32 v5, v2, v5
    v_accvgpr_write_b32 a129, v5
    v_accvgpr_read_b32 v5, a130
    v_mul_f32 v5, v2, v5
    v_accvgpr_write_b32 a130, v5
    v_accvgpr_read_b32 v5, a131
    v_mul_f32 v5, v2, v5
    v_accvgpr_write_b32 a131, v5
    v_accvgpr_read_b32 v5, a136
    v_mul_f32 v5, v2, v5
    v_accvgpr_write_b32 a136, v5
    v_accvgpr_read_b32 v5, a137
    v_mul_f32 v5, v2, v5
    v_accvgpr_write_b32 a137, v5
    v_accvgpr_read_b32 v5, a138
    v_mul_f32 v5, v2, v5
    v_accvgpr_write_b32 a138, v5
    v_accvgpr_read_b32 v5, a139
    v_mul_f32 v5, v2, v5
    v_accvgpr_write_b32 a139, v5
    v_accvgpr_read_b32 v5, a144
    v_mul_f32 v5, v2, v5
    v_accvgpr_write_b32 a144, v5
    v_accvgpr_read_b32 v5, a145
    v_mul_f32 v5, v2, v5
    v_accvgpr_write_b32 a145, v5
    v_accvgpr_read_b32 v5, a146
    v_mul_f32 v5, v2, v5
    v_accvgpr_write_b32 a146, v5
    v_accvgpr_read_b32 v5, a147
    v_mul_f32 v5, v2, v5
    v_accvgpr_write_b32 a147, v5
    v_accvgpr_read_b32 v5, a152
    v_mul_f32 v5, v2, v5
    v_accvgpr_write_b32 a152, v5
    v_accvgpr_read_b32 v5, a153
    v_mul_f32 v5, v2, v5
    v_accvgpr_write_b32 a153, v5
    v_accvgpr_read_b32 v5, a154
    v_mul_f32 v5, v2, v5
    v_accvgpr_write_b32 a154, v5
    v_accvgpr_read_b32 v5, a155
    v_mul_f32 v5, v2, v5
    v_accvgpr_write_b32 a155, v5
    v_accvgpr_read_b32 v5, a160
    v_mul_f32 v5, v2, v5
    v_accvgpr_write_b32 a160, v5
    v_accvgpr_read_b32 v5, a161
    v_mul_f32 v5, v2, v5
    v_accvgpr_write_b32 a161, v5
    v_accvgpr_read_b32 v5, a162
    v_mul_f32 v5, v2, v5
    v_accvgpr_write_b32 a162, v5
    v_accvgpr_read_b32 v5, a163
    v_mul_f32 v5, v2, v5
    v_accvgpr_write_b32 a163, v5
    v_accvgpr_read_b32 v5, a168
    v_mul_f32 v5, v2, v5
    v_accvgpr_write_b32 a168, v5
    v_accvgpr_read_b32 v5, a169
    v_mul_f32 v5, v2, v5
    v_accvgpr_write_b32 a169, v5
    v_accvgpr_read_b32 v5, a170
    v_mul_f32 v5, v2, v5
    v_accvgpr_write_b32 a170, v5
    v_accvgpr_read_b32 v5, a171
    v_mul_f32 v5, v2, v5
    v_accvgpr_write_b32 a171, v5
    v_accvgpr_read_b32 v5, a176
    v_mul_f32 v5, v2, v5
    v_accvgpr_write_b32 a176, v5
    v_accvgpr_read_b32 v5, a177
    v_mul_f32 v5, v2, v5
    v_accvgpr_write_b32 a177, v5
    v_accvgpr_read_b32 v5, a178
    v_mul_f32 v5, v2, v5
    v_accvgpr_write_b32 a178, v5
    v_accvgpr_read_b32 v5, a179
    v_mul_f32 v5, v2, v5
    v_accvgpr_write_b32 a179, v5
    v_accvgpr_read_b32 v5, a184
    v_mul_f32 v5, v2, v5
    v_accvgpr_write_b32 a184, v5
    v_accvgpr_read_b32 v5, a185
    v_mul_f32 v5, v2, v5
    v_accvgpr_write_b32 a185, v5
    v_accvgpr_read_b32 v5, a186
    v_mul_f32 v5, v2, v5
    v_accvgpr_write_b32 a186, v5
    v_accvgpr_read_b32 v5, a187
    v_mul_f32 v5, v2, v5
    v_accvgpr_write_b32 a187, v5
    v_max_f32 v3, 0, v3
    v_sub_f32 v80, v80, v3
    v_sub_f32 v81, v81, v3
    v_sub_f32 v82, v82, v3
    v_sub_f32 v83, v83, v3
    v_sub_f32 v120, v120, v3
    v_sub_f32 v121, v121, v3
    v_sub_f32 v122, v122, v3
    v_sub_f32 v123, v123, v3
    v_sub_f32 v128, v128, v3
    v_sub_f32 v129, v129, v3
    v_sub_f32 v130, v130, v3
    v_sub_f32 v131, v131, v3
    v_sub_f32 v136, v136, v3
    v_sub_f32 v137, v137, v3
    v_sub_f32 v138, v138, v3
    v_sub_f32 v139, v139, v3
    v_sub_f32 v144, v144, v3
    v_sub_f32 v145, v145, v3
    v_sub_f32 v146, v146, v3
    v_sub_f32 v147, v147, v3
    v_exp_f32 v4, -v3
    s_nop 0
    v_mul_f32 v72, v4, v72
    v_mul_f32 v73, v4, v73
    v_mul_f32 v74, v4, v74
    v_mul_f32 v75, v4, v75
    v_accvgpr_read_b32 v5, a132
    v_mul_f32 v5, v4, v5
    v_accvgpr_write_b32 a132, v5
    v_accvgpr_read_b32 v5, a133
    v_mul_f32 v5, v4, v5
    v_accvgpr_write_b32 a133, v5
    v_accvgpr_read_b32 v5, a134
    v_mul_f32 v5, v4, v5
    v_accvgpr_write_b32 a134, v5
    v_accvgpr_read_b32 v5, a135
    v_mul_f32 v5, v4, v5
    v_accvgpr_write_b32 a135, v5
    v_accvgpr_read_b32 v5, a140
    v_mul_f32 v5, v4, v5
    v_accvgpr_write_b32 a140, v5
    v_accvgpr_read_b32 v5, a141
    v_mul_f32 v5, v4, v5
    v_accvgpr_write_b32 a141, v5
    v_accvgpr_read_b32 v5, a142
    v_mul_f32 v5, v4, v5
    v_accvgpr_write_b32 a142, v5
    v_accvgpr_read_b32 v5, a143
    v_mul_f32 v5, v4, v5
    v_accvgpr_write_b32 a143, v5
    v_accvgpr_read_b32 v5, a148
    v_mul_f32 v5, v4, v5
    v_accvgpr_write_b32 a148, v5
    v_accvgpr_read_b32 v5, a149
    v_mul_f32 v5, v4, v5
    v_accvgpr_write_b32 a149, v5
    v_accvgpr_read_b32 v5, a150
    v_mul_f32 v5, v4, v5
    v_accvgpr_write_b32 a150, v5
    v_accvgpr_read_b32 v5, a151
    v_mul_f32 v5, v4, v5
    v_accvgpr_write_b32 a151, v5
    v_accvgpr_read_b32 v5, a156
    v_mul_f32 v5, v4, v5
    v_accvgpr_write_b32 a156, v5
    v_accvgpr_read_b32 v5, a157
    v_mul_f32 v5, v4, v5
    v_accvgpr_write_b32 a157, v5
    v_accvgpr_read_b32 v5, a158
    v_mul_f32 v5, v4, v5
    v_accvgpr_write_b32 a158, v5
    v_accvgpr_read_b32 v5, a159
    v_mul_f32 v5, v4, v5
    v_accvgpr_write_b32 a159, v5
    v_accvgpr_read_b32 v5, a164
    v_mul_f32 v5, v4, v5
    v_accvgpr_write_b32 a164, v5
    v_accvgpr_read_b32 v5, a165
    v_mul_f32 v5, v4, v5
    v_accvgpr_write_b32 a165, v5
    v_accvgpr_read_b32 v5, a166
    v_mul_f32 v5, v4, v5
    v_accvgpr_write_b32 a166, v5
    v_accvgpr_read_b32 v5, a167
    v_mul_f32 v5, v4, v5
    v_accvgpr_write_b32 a167, v5
    v_accvgpr_read_b32 v5, a172
    v_mul_f32 v5, v4, v5
    v_accvgpr_write_b32 a172, v5
    v_accvgpr_read_b32 v5, a173
    v_mul_f32 v5, v4, v5
    v_accvgpr_write_b32 a173, v5
    v_accvgpr_read_b32 v5, a174
    v_mul_f32 v5, v4, v5
    v_accvgpr_write_b32 a174, v5
    v_accvgpr_read_b32 v5, a175
    v_mul_f32 v5, v4, v5
    v_accvgpr_write_b32 a175, v5
    v_accvgpr_read_b32 v5, a180
    v_mul_f32 v5, v4, v5
    v_accvgpr_write_b32 a180, v5
    v_accvgpr_read_b32 v5, a181
    v_mul_f32 v5, v4, v5
    v_accvgpr_write_b32 a181, v5
    v_accvgpr_read_b32 v5, a182
    v_mul_f32 v5, v4, v5
    v_accvgpr_write_b32 a182, v5
    v_accvgpr_read_b32 v5, a183
    v_mul_f32 v5, v4, v5
    v_accvgpr_write_b32 a183, v5
    v_accvgpr_read_b32 v5, a188
    v_mul_f32 v5, v4, v5
    v_accvgpr_write_b32 a188, v5
    v_accvgpr_read_b32 v5, a189
    v_mul_f32 v5, v4, v5
    v_accvgpr_write_b32 a189, v5
    v_accvgpr_read_b32 v5, a190
    v_mul_f32 v5, v4, v5
    v_accvgpr_write_b32 a190, v5
    v_accvgpr_read_b32 v5, a191
    v_mul_f32 v5, v4, v5
    v_accvgpr_write_b32 a191, v5
    s_nop 3
    s_setpc_b64 s[44:45]
w2_resc11:
    s_nop 7
    s_nop 7
    v_max3_f32 v1, v116, v117, v118
    v_max3_f32 v3, v120, v121, v122
    v_max3_f32 v1, v1, v119, v124
    v_max3_f32 v3, v3, v123, v128
    v_max3_f32 v1, v1, v125, v126
    v_max3_f32 v3, v3, v129, v130
    v_max3_f32 v1, v1, v127, v132
    v_max3_f32 v3, v3, v131, v136
    v_max3_f32 v1, v1, v133, v134
    v_max3_f32 v3, v3, v137, v138
    v_max3_f32 v1, v1, v135, v140
    v_max3_f32 v3, v3, v139, v144
    v_max3_f32 v1, v1, v141, v142
    v_max3_f32 v3, v3, v145, v146
    v_max_f32 v1, v1, v143
    v_max_f32 v3, v3, v147
    v_mov_b32 v2, v1
    v_mov_b32 v4, v3
    s_nop 0
    v_permlane32_swap_b32 v1, v2
    v_permlane32_swap_b32 v3, v4
    v_max_f32 v1, v1, v2
    v_max_f32 v3, v3, v4
    v_mov_b32 v2, v1
    v_mov_b32 v4, v3
    s_nop 0
    v_permlane16_swap_b32 v1, v2
    v_permlane16_swap_b32 v3, v4
    v_max_f32 v1, v1, v2
    v_max_f32 v3, v3, v4
    v_max_f32 v1, 0, v1
    v_sub_f32 v76, v76, v1
    v_sub_f32 v77, v77, v1
    v_sub_f32 v78, v78, v1
    v_sub_f32 v79, v79, v1
    v_sub_f32 v116, v116, v1
    v_sub_f32 v117, v117, v1
    v_sub_f32 v118, v118, v1
    v_sub_f32 v119, v119, v1
    v_sub_f32 v124, v124, v1
    v_sub_f32 v125, v125, v1
    v_sub_f32 v126, v126, v1
    v_sub_f32 v127, v127, v1
    v_sub_f32 v132, v132, v1
    v_sub_f32 v133, v133, v1
    v_sub_f32 v134, v134, v1
    v_sub_f32 v135, v135, v1
    v_sub_f32 v140, v140, v1
    v_sub_f32 v141, v141, v1
    v_sub_f32 v142, v142, v1
    v_sub_f32 v143, v143, v1
    v_exp_f32 v2, -v1
    s_nop 0
    v_mul_f32 v68, v2, v68
    v_mul_f32 v69, v2, v69
    v_mul_f32 v70, v2, v70
    v_mul_f32 v71, v2, v71
    v_mul_f32 v148, v2, v148
    v_mul_f32 v149, v2, v149
    v_mul_f32 v150, v2, v150
    v_mul_f32 v151, v2, v151
    v_mul_f32 v188, v2, v188
    v_mul_f32 v189, v2, v189
    v_mul_f32 v190, v2, v190
    v_mul_f32 v191, v2, v191
    v_mul_f32 v156, v2, v156
    v_mul_f32 v157, v2, v157
    v_mul_f32 v158, v2, v158
    v_mul_f32 v159, v2, v159
    v_mul_f32 v204, v2, v204
    v_mul_f32 v205, v2, v205
    v_mul_f32 v206, v2, v206
    v_mul_f32 v207, v2, v207
    v_mul_f32 v164, v2, v164
    v_mul_f32 v165, v2, v165
    v_mul_f32 v166, v2, v166
    v_mul_f32 v167, v2, v167
    v_mul_f32 v220, v2, v220
    v_mul_f32 v221, v2, v221
    v_mul_f32 v222, v2, v222
    v_mul_f32 v223, v2, v223
    v_mul_f32 v172, v2, v172
    v_mul_f32 v173, v2, v173
    v_mul_f32 v174, v2, v174
    v_mul_f32 v175, v2, v175
    v_mul_f32 v236, v2, v236
    v_mul_f32 v237, v2, v237
    v_mul_f32 v238, v2, v238
    v_mul_f32 v239, v2, v239
    v_max_f32 v3, 0, v3
    v_sub_f32 v80, v80, v3
    v_sub_f32 v81, v81, v3
    v_sub_f32 v82, v82, v3
    v_sub_f32 v83, v83, v3
    v_sub_f32 v120, v120, v3
    v_sub_f32 v121, v121, v3
    v_sub_f32 v122, v122, v3
    v_sub_f32 v123, v123, v3
    v_sub_f32 v128, v128, v3
    v_sub_f32 v129, v129, v3
    v_sub_f32 v130, v130, v3
    v_sub_f32 v131, v131, v3
    v_sub_f32 v136, v136, v3
    v_sub_f32 v137, v137, v3
    v_sub_f32 v138, v138, v3
    v_sub_f32 v139, v139, v3
    v_sub_f32 v144, v144, v3
    v_sub_f32 v145, v145, v3
    v_sub_f32 v146, v146, v3
    v_sub_f32 v147, v147, v3
    v_exp_f32 v4, -v3
    s_nop 0
    v_mul_f32 v72, v4, v72
    v_mul_f32 v73, v4, v73
    v_mul_f32 v74, v4, v74
    v_mul_f32 v75, v4, v75
    v_mul_f32 v152, v4, v152
    v_mul_f32 v153, v4, v153
    v_mul_f32 v154, v4, v154
    v_mul_f32 v155, v4, v155
    v_mul_f32 v192, v4, v192
    v_mul_f32 v193, v4, v193
    v_mul_f32 v194, v4, v194
    v_mul_f32 v195, v4, v195
    v_mul_f32 v160, v4, v160
    v_mul_f32 v161, v4, v161
    v_mul_f32 v162, v4, v162
    v_mul_f32 v163, v4, v163
    v_mul_f32 v208, v4, v208
    v_mul_f32 v209, v4, v209
    v_mul_f32 v210, v4, v210
    v_mul_f32 v211, v4, v211
    v_mul_f32 v168, v4, v168
    v_mul_f32 v169, v4, v169
    v_mul_f32 v170, v4, v170
    v_mul_f32 v171, v4, v171
    v_mul_f32 v224, v4, v224
    v_mul_f32 v225, v4, v225
    v_mul_f32 v226, v4, v226
    v_mul_f32 v227, v4, v227
    v_mul_f32 v176, v4, v176
    v_mul_f32 v177, v4, v177
    v_mul_f32 v178, v4, v178
    v_mul_f32 v179, v4, v179
    v_mul_f32 v240, v4, v240
    v_mul_f32 v241, v4, v241
    v_mul_f32 v242, v4, v242
    v_mul_f32 v243, v4, v243
    s_nop 3
    s_setpc_b64 s[44:45]

w1_pcnt_spin:
    s_mov_b32 s61, 0
w1_pcnt_again:
    s_lshl_b32 s43, s48, 2
    buffer_load_dword v10, off, s[32:35], s43 sc1
    s_add_u32 s61, s61, 1
    s_cmp_ge_u32 s61, 2000000
    s_waitcnt vmcnt(0)
    s_cbranch_scc1 w1_pcnt_back
    v_cmp_gt_u32 s[62:63], 3, v10
    s_nop 0
    s_cmp_lg_u64 s[62:63], 0
    s_cbranch_scc1 w1_pcnt_again
    s_branch w1_pcnt_back
w1_p0_spin:
    s_mov_b32 s61, 0
w1_p0_again:
    s_add_u32 s43, s54, 0
    buffer_load_dword v10, v11, s[24:27], s43 offen sc1
    s_add_u32 s61, s61, 1
    s_cmp_ge_u32 s61, 2000000
    s_waitcnt vmcnt(0)
    s_cbranch_scc1 w1_p0_back
    v_cmp_ne_u32 s[62:63], 1, v10
    s_nop 0
    s_cmp_lg_u64 s[62:63], 0
    s_cbranch_scc1 w1_p0_again
    s_branch w1_p0_back
w1_p1_spin:
    s_mov_b32 s61, 0
w1_p1_again:
    s_add_u32 s43, s54, 131072
    buffer_load_dword v10, v11, s[24:27], s43 offen sc1
    s_add_u32 s61, s61, 1
    s_cmp_ge_u32 s61, 2000000
    s_waitcnt vmcnt(0)
    s_cbranch_scc1 w1_p1_back
    v_cmp_ne_u32 s[62:63], 1, v10
    s_nop 0
    s_cmp_lg_u64 s[62:63], 0
    s_cbranch_scc1 w1_p1_again
    s_branch w1_p1_back
w1_p2_spin:
    s_mov_b32 s61, 0
w1_p2_again:
    s_mov_b32 s43, s55
    buffer_load_dword v10, v12, s[24:27], s43 offen sc1
    s_add_u32 s61, s61, 1
    s_cmp_ge_u32 s61, 2000000
    s_waitcnt vmcnt(0)
    s_cbranch_scc1 w1_p2_back
    v_cmp_ne_u32 s[62:63], 1, v10
    s_nop 0
    s_cmp_lg_u64 s[62:63], 0
    s_cbranch_scc1 w1_p2_again
    s_branch w1_p2_back
w1_t1_slow:
    s_call_b64 s[44:45], w1_resc10
    s_branch w1_t1_back
w1_t2_slow:
    s_call_b64 s[44:45], w1_resc00
    s_branch w1_t2_back
w1_t3_slow:
    s_call_b64 s[44:45], w1_resc10
    s_branch w1_t3_back
w1_t4_slow:
    s_call_b64 s[44:45], w1_resc00
    s_branch w1_t4_back
w1_t5_slow:
    s_call_b64 s[44:45], w1_resc10
    s_branch w1_t5_back
w1_t6_slow:
    s_call_b64 s[44:45], w1_resc00
    s_branch w1_t6_back
w1_t7_slow:
    s_call_b64 s[44:45], w1_resc10
    s_branch w1_t7_back
w1_t9_slow:
    s_call_b64 s[44:45], w1_resc11
    s_branch w1_t9_back
w1_t10_slow:
    s_call_b64 s[44:45], w1_resc01
    s_branch w1_t10_back
w1_t11_slow:
    s_call_b64 s[44:45], w1_resc11
    s_branch w1_t11_back
w1_t12_slow:
    s_call_b64 s[44:45], w1_resc01
    s_branch w1_t12_back
w1_t13_slow:
    s_call_b64 s[44:45], w1_resc11
    s_branch w1_t13_back
w1_t14_slow:
    s_call_b64 s[44:45], w1_resc01
    s_branch w1_t14_back
w1_t15_slow:
    s_call_b64 s[44:45], w1_resc11
    s_branch w1_t15_back
w1_resc00:
    s_nop 7
    s_nop 7
    v_max3_f32 v1, v84, v85, v86
    v_max3_f32 v1, v1, v87, v92
    v_max3_f32 v1, v1, v93, v94
    v_max3_f32 v1, v1, v95, v100
    v_max3_f32 v1, v1, v101, v102
    v_max3_f32 v1, v1, v103, v108
    v_max3_f32 v1, v1, v109, v110
    v_max_f32 v1, v1, v111
    v_mov_b32 v2, v1
    s_nop 1
    v_permlane32_swap_b32 v1, v2
    v_max_f32 v1, v1, v2
    v_mov_b32 v2, v1
    s_nop 1
    v_permlane16_swap_b32 v1, v2
    v_max_f32 v1, v1, v2
    v_max_f32 v1, 0, v1
    v_sub_f32 v76, v76, v1
    v_sub_f32 v77, v77, v1
    v_sub_f32 v78, v78, v1
    v_sub_f32 v79, v79, v1
    v_sub_f32 v84, v84, v1
    v_sub_f32 v85, v85, v1
    v_sub_f32 v86, v86, v1
    v_sub_f32 v87, v87, v1
    v_sub_f32 v92, v92, v1
    v_sub_f32 v93, v93, v1
    v_sub_f32 v94, v94, v1
    v_sub_f32 v95, v95, v1
    v_sub_f32 v100, v100, v1
    v_sub_f32 v101, v101, v1
    v_sub_f32 v102, v102, v1
    v_sub_f32 v103, v103, v1
    v_sub_f32 v108, v108, v1
    v_sub_f32 v109, v109, v1
    v_sub_f32 v110, v110, v1
    v_sub_f32 v111, v111, v1
    v_exp_f32 v2, -v1
    s_nop 0
    v_mul_f32 v68, v2, v68
    v_mul_f32 v69, v2, v69
    v_mul_f32 v70, v2, v70
    v_mul_f32 v71, v2, v71
    v_accvgpr_read_b32 v5, a128
    v_mul_f32 v5, v2, v5
    v_accvgpr_write_b32 a128, v5
    v_accvgpr_read_b32 v5, a129
    v_mul_f32 v5, v2, v5
    v_accvgpr_write_b32 a129, v5
    v_accvgpr_read_b32 v5, a130
    v_mul_f32 v5, v2, v5
    v_accvgpr_write_b32 a130, v5
    v_accvgpr_read_b32 v5, a131
    v_mul_f32 v5, v2, v5
    v_accvgpr_write_b32 a131, v5
    v_accvgpr_read_b32 v5, a136
    v_mul_f32 v5, v2, v5
    v_accvgpr_write_b32 a136, v5
    v_accvgpr_read_b32 v5, a137
    v_mul_f32 v5, v2, v5
    v_accvgpr_write_b32 a137, v5
    v_accvgpr_read_b32 v5, a138
    v_mul_f32 v5, v2, v5
    v_accvgpr_write_b32 a138, v5
    v_accvgpr_read_b32 v5, a139
    v_mul_f32 v5, v2, v5
    v_accvgpr_write_b32 a139, v5
    v_accvgpr_read_b32 v5, a144
    v_mul_f32 v5, v2, v5
    v_accvgpr_write_b32 a144, v5
    v_accvgpr_read_b32 v5, a145
    v_mul_f32 v5, v2, v5
    v_accvgpr_write_b32 a145, v5
    v_accvgpr_read_b32 v5, a146
    v_mul_f32 v5, v2, v5
    v_accvgpr_write_b32 a146, v5
    v_accvgpr_read_b32 v5, a147
    v_mul_f32 v5, v2, v5
    v_accvgpr_write_b32 a147, v5
    v_accvgpr_read_b32 v5, a152
    v_mul_f32 v5, v2, v5
    v_accvgpr_write_b32 a152, v5
    v_accvgpr_read_b32 v5, a153
    v_mul_f32 v5, v2, v5
    v_accvgpr_write_b32 a153, v5
    v_accvgpr_read_b32 v5, a154
    v_mul_f32 v5, v2, v5
    v_accvgpr_write_b32 a154, v5
    v_accvgpr_read_b32 v5, a155
    v_mul_f32 v5, v2, v5
    v_accvgpr_write_b32 a155, v5
    v_accvgpr_read_b32 v5, a160
    v_mul_f32 v5, v2, v5
    v_accvgpr_write_b32 a160, v5
    v_accvgpr_read_b32 v5, a161
    v_mul_f32 v5, v2, v5
    v_accvgpr_write_b32 a161, v5
    v_accvgpr_read_b32 v5, a162
    v_mul_f32 v5, v2, v5
    v_accvgpr_write_b32 a162, v5
    v_accvgpr_read_b32 v5, a163
    v_mul_f32 v5, v2, v5
    v_accvgpr_write_b32 a163, v5
    v_accvgpr_read_b32 v5, a168
    v_mul_f32 v5, v2, v5
    v_accvgpr_write_b32 a168, v5
    v_accvgpr_read_b32 v5, a169
    v_mul_f32 v5, v2, v5
    v_accvgpr_write_b32 a169, v5
    v_accvgpr_read_b32 v5, a170
    v_mul_f32 v5, v2, v5
    v_accvgpr_write_b32 a170, v5
    v_accvgpr_read_b32 v5, a171
    v_mul_f32 v5, v2, v5
    v_accvgpr_write_b32 a171, v5
    v_accvgpr_read_b32 v5, a176
    v_mul_f32 v5, v2, v5
    v_accvgpr_write_b32 a176, v5
    v_accvgpr_read_b32 v5, a177
    v_mul_f32 v5, v2, v5
    v_accvgpr_write_b32 a177, v5
    v_accvgpr_read_b32 v5, a178
    v_mul_f32 v5, v2, v5
    v_accvgpr_write_b32 a178, v5
    v_accvgpr_read_b32 v5, a179
    v_mul_f32 v5, v2, v5
    v_accvgpr_write_b32 a179, v5
    v_accvgpr_read_b32 v5, a184
    v_mul_f32 v5, v2, v5
    v_accvgpr_write_b32 a184, v5
    v_accvgpr_read_b32 v5, a185
    v_mul_f32 v5, v2, v5
    v_accvgpr_write_b32 a185, v5
    v_accvgpr_read_b32 v5, a186
    v_mul_f32 v5, v2, v5
    v_accvgpr_write_b32 a186, v5
    v_accvgpr_read_b32 v5, a187
    v_mul_f32 v5, v2, v5
    v_accvgpr_write_b32 a187, v5
    s_nop 3
    s_setpc_b64 s[44:45]
w1_resc01:
    s_nop 7
    s_nop 7
    v_max3_f32 v1, v84, v85, v86
    v_max3_f32 v1, v1, v87, v92
    v_max3_f32 v1, v1, v93, v94
    v_max3_f32 v1, v1, v95, v100
    v_max3_f32 v1, v1, v101, v102
    v_max3_f32 v1, v1, v103, v108
    v_max3_f32 v1, v1, v109, v110
    v_max_f32 v1, v1, v111
    v_mov_b32 v2, v1
    s_nop 1
    v_permlane32_swap_b32 v1, v2
    v_max_f32 v1, v1, v2
    v_mov_b32 v2, v1
    s_nop 1
    v_permlane16_swap_b32 v1, v2
    v_max_f32 v1, v1, v2
    v_max_f32 v1, 0, v1
    v_sub_f32 v76, v76, v1
    v_sub_f32 v77, v77, v1
    v_sub_f32 v78, v78, v1
    v_sub_f32 v79, v79, v1
    v_sub_f32 v84, v84, v1
    v_sub_f32 v85, v85, v1
    v_sub_f32 v86, v86, v1
    v_sub_f32 v87, v87, v1
    v_sub_f32 v92, v92, v1
    v_sub_f32 v93, v93, v1
    v_sub_f32 v94, v94, v1
    v_sub_f32 v95, v95, v1
    v_sub_f32 v100, v100, v1
    v_sub_f32 v101, v101, v1
    v_sub_f32 v102, v102, v1
    v_sub_f32 v103, v103, v1
    v_sub_f32 v108, v108, v1
    v_sub_f32 v109, v109, v1
    v_sub_f32 v110, v110, v1
    v_sub_f32 v111, v111, v1
    v_exp_f32 v2, -v1
    s_nop 0
    v_mul_f32 v68, v2, v68
    v_mul_f32 v69, v2, v69
    v_mul_f32 v70, v2, v70
    v_mul_f32 v71, v2, v71
    v_mul_f32 v148, v2, v148
    v_mul_f32 v149, v2, v149
    v_mul_f32 v150, v2, v150
    v_mul_f32 v151, v2, v151
    v_mul_f32 v188, v2, v188
    v_mul_f32 v189, v2, v189
    v_mul_f32 v190, v2, v190
    v_mul_f32 v191, v2, v191
    v_mul_f32 v156, v2, v156
    v_mul_f32 v157, v2, v157
    v_mul_f32 v158, v2, v158
    v_mul_f32 v159, v2, v159
    v_mul_f32 v204, v2, v204
    v_mul_f32 v205, v2, v205
    v_mul_f32 v206, v2, v206
    v_mul_f32 v207, v2, v207
    v_mul_f32 v164, v2, v164
    v_mul_f32 v165, v2, v165
    v_mul_f32 v166, v2, v166
    v_mul_f32 v167, v2, v167
    v_mul_f32 v220, v2, v220
    v_mul_f32 v221, v2, v221
    v_mul_f32 v222, v2, v222
    v_mul_f32 v223, v2, v223
    v_mul_f32 v172, v2, v172
    v_mul_f32 v173, v2, v173
    v_mul_f32 v174, v2, v174
    v_mul_f32 v175, v2, v175
    v_mul_f32 v236, v2, v236
    v_mul_f32 v237, v2, v237
    v_mul_f32 v238, v2, v238
    v_mul_f32 v239, v2, v239
    s_nop 3
    s_setpc_b64 s[44:45]
w1_resc10:
    s_nop 7
    s_nop 7
    v_max3_f32 v1, v116, v117, v118
    v_max3_f32 v1, v1, v119, v124
    v_max3_f32 v1, v1, v125, v126
    v_max3_f32 v1, v1, v127, v132
    v_max3_f32 v1, v1, v133, v134
    v_max3_f32 v1, v1, v135, v140
    v_max3_f32 v1, v1, v141, v142
    v_max_f32 v1, v1, v143
    v_mov_b32 v2, v1
    s_nop 1
    v_permlane32_swap_b32 v1, v2
    v_max_f32 v1, v1, v2
    v_mov_b32 v2, v1
    s_nop 1
    v_permlane16_swap_b32 v1, v2
    v_max_f32 v1, v1, v2
    v_max_f32 v1, 0, v1
    v_sub_f32 v76, v76, v1
    v_sub_f32 v77, v77, v1
    v_sub_f32 v78, v78, v1
    v_sub_f32 v79, v79, v1
    v_sub_f32 v116, v116, v1
    v_sub_f32 v117, v117, v1
    v_sub_f32 v118, v118, v1
    v_sub_f32 v119, v119, v1
    v_sub_f32 v124, v124, v1
    v_sub_f32 v125, v125, v1
    v_sub_f32 v126, v126, v1
    v_sub_f32 v127, v127, v1
    v_sub_f32 v132, v132, v1
    v_sub_f32 v133, v133, v1
    v_sub_f32 v134, v134, v1
    v_sub_f32 v135, v135, v1
    v_sub_f32 v140, v140, v1
    v_sub_f32 v141, v141, v1
    v_sub_f32 v142, v142, v1
    v_sub_f32 v143, v143, v1
    v_exp_f32 v2, -v1
    s_nop 0
    v_mul_f32 v68, v2, v68
    v_mul_f32 v69, v2, v69
    v_mul_f32 v70, v2, v70
    v_mul_f32 v71, v2, v71
    v_accvgpr_read_b32 v5, a128
    v_mul_f32 v5, v2, v5
    v_accvgpr_write_b32 a128, v5
    v_accvgpr_read_b32 v5, a129
    v_mul_f32 v5, v2, v5
    v_accvgpr_write_b32 a129, v5
    v_accvgpr_read_b32 v5, a130
    v_mul_f32 v5, v2, v5
    v_accvgpr_write_b32 a130, v5
    v_accvgpr_read_b32 v5, a131
    v_mul_f32 v5, v2, v5
    v_accvgpr_write_b32 a131, v5
    v_accvgpr_read_b32 v5, a136
    v_mul_f32 v5, v2, v5
    v_accvgpr_write_b32 a136, v5
    v_accvgpr_read_b32 v5, a137
    v_mul_f32 v5, v2, v5
    v_accvgpr_write_b32 a137, v5
    v_accvgpr_read_b32 v5, a138
    v_mul_f32 v5, v2, v5
    v_accvgpr_write_b32 a138, v5
    v_accvgpr_read_b32 v5, a139
    v_mul_f32 v5, v2, v5
    v_accvgpr_write_b32 a139, v5
    v_accvgpr_read_b32 v5, a144
    v_mul_f32 v5, v2, v5
    v_accvgpr_write_b32 a144, v5
    v_accvgpr_read_b32 v5, a145
    v_mul_f32 v5, v2, v5
    v_accvgpr_write_b32 a145, v5
    v_accvgpr_read_b32 v5, a146
    v_mul_f32 v5, v2, v5
    v_accvgpr_write_b32 a146, v5
    v_accvgpr_read_b32 v5, a147
    v_mul_f32 v5, v2, v5
    v_accvgpr_write_b32 a147, v5
    v_accvgpr_read_b32 v5, a152
    v_mul_f32 v5, v2, v5
    v_accvgpr_write_b32 a152, v5
    v_accvgpr_read_b32 v5, a153
    v_mul_f32 v5, v2, v5
    v_accvgpr_write_b32 a153, v5
    v_accvgpr_read_b32 v5, a154
    v_mul_f32 v5, v2, v5
    v_accvgpr_write_b32 a154, v5
    v_accvgpr_read_b32 v5, a155
    v_mul_f32 v5, v2, v5
    v_accvgpr_write_b32 a155, v5
    v_accvgpr_read_b32 v5, a160
    v_mul_f32 v5, v2, v5
    v_accvgpr_write_b32 a160, v5
    v_accvgpr_read_b32 v5, a161
    v_mul_f32 v5, v2, v5
    v_accvgpr_write_b32 a161, v5
    v_accvgpr_read_b32 v5, a162
    v_mul_f32 v5, v2, v5
    v_accvgpr_write_b32 a162, v5
    v_accvgpr_read_b32 v5, a163
    v_mul_f32 v5, v2, v5
    v_accvgpr_write_b32 a163, v5
    v_accvgpr_read_b32 v5, a168
    v_mul_f32 v5, v2, v5
    v_accvgpr_write_b32 a168, v5
    v_accvgpr_read_b32 v5, a169
    v_mul_f32 v5, v2, v5
    v_accvgpr_write_b32 a169, v5
    v_accvgpr_read_b32 v5, a170
    v_mul_f32 v5, v2, v5
    v_accvgpr_write_b32 a170, v5
    v_accvgpr_read_b32 v5, a171
    v_mul_f32 v5, v2, v5
    v_accvgpr_write_b32 a171, v5
    v_accvgpr_read_b32 v5, a176
    v_mul_f32 v5, v2, v5
    v_accvgpr_write_b32 a176, v5
    v_accvgpr_read_b32 v5, a177
    v_mul_f32 v5, v2, v5
    v_accvgpr_write_b32 a177, v5
    v_accvgpr_read_b32 v5, a178
    v_mul_f32 v5, v2, v5
    v_accvgpr_write_b32 a178, v5
    v_accvgpr_read_b32 v5, a179
    v_mul_f32 v5, v2, v5
    v_accvgpr_write_b32 a179, v5
    v_accvgpr_read_b32 v5, a184
    v_mul_f32 v5, v2, v5
    v_accvgpr_write_b32 a184, v5
    v_accvgpr_read_b32 v5, a185
    v_mul_f32 v5, v2, v5
    v_accvgpr_write_b32 a185, v5
    v_accvgpr_read_b32 v5, a186
    v_mul_f32 v5, v2, v5
    v_accvgpr_write_b32 a186, v5
    v_accvgpr_read_b32 v5, a187
    v_mul_f32 v5, v2, v5
    v_accvgpr_write_b32 a187, v5
    s_nop 3
    s_setpc_b64 s[44:45]
w1_resc11:
    s_nop 7
    s_nop 7
    v_max3_f32 v1, v116, v117, v118
    v_max3_f32 v1, v1, v119, v124
    v_max3_f32 v1, v1, v125, v126
    v_max3_f32 v1, v1, v127, v132
    v_max3_f32 v1, v1, v133, v134
    v_max3_f32 v1, v1, v135, v140
    v_max3_f32 v1, v1, v141, v142
    v_max_f32 v1, v1, v143
    v_mov_b32 v2, v1
    s_nop 1
    v_permlane32_swap_b32 v1, v2
    v_max_f32 v1, v1, v2
    v_mov_b32 v2, v1
    s_nop 1
    v_permlane16_swap_b32 v1, v2
    v_max_f32 v1, v1, v2
    v_max_f32 v1, 0, v1
    v_sub_f32 v76, v76, v1
    v_sub_f32 v77, v77, v1
    v_sub_f32 v78, v78, v1
    v_sub_f32 v79, v79, v1
    v_sub_f32 v116, v116, v1
    v_sub_f32 v117, v117, v1
    v_sub_f32 v118, v118, v1
    v_sub_f32 v119, v119, v1
    v_sub_f32 v124, v124, v1
    v_sub_f32 v125, v125, v1
    v_sub_f32 v126, v126, v1
    v_sub_f32 v127, v127, v1
    v_sub_f32 v132, v132, v1
    v_sub_f32 v133, v133, v1
    v_sub_f32 v134, v134, v1
    v_sub_f32 v135, v135, v1
    v_sub_f32 v140, v140, v1
    v_sub_f32 v141, v141, v1
    v_sub_f32 v142, v142, v1
    v_sub_f32 v143, v143, v1
    v_exp_f32 v2, -v1
    s_nop 0
    v_mul_f32 v68, v2, v68
    v_mul_f32 v69, v2, v69
    v_mul_f32 v70, v2, v70
    v_mul_f32 v71, v2, v71
    v_mul_f32 v148, v2, v148
    v_mul_f32 v149, v2, v149
    v_mul_f32 v150, v2, v150
    v_mul_f32 v151, v2, v151
    v_mul_f32 v188, v2, v188
    v_mul_f32 v189, v2, v189
    v_mul_f32 v190, v2, v190
    v_mul_f32 v191, v2, v191
    v_mul_f32 v156, v2, v156
    v_mul_f32 v157, v2, v157
    v_mul_f32 v158, v2, v158
    v_mul_f32 v159, v2, v159
    v_mul_f32 v204, v2, v204
    v_mul_f32 v205, v2, v205
    v_mul_f32 v206, v2, v206
    v_mul_f32 v207, v2, v207
    v_mul_f32 v164, v2, v164
    v_mul_f32 v165, v2, v165
    v_mul_f32 v166, v2, v166
    v_mul_f32 v167, v2, v167
    v_mul_f32 v220, v2, v220
    v_mul_f32 v221, v2, v221
    v_mul_f32 v222, v2, v222
    v_mul_f32 v223, v2, v223
    v_mul_f32 v172, v2, v172
    v_mul_f32 v173, v2, v173
    v_mul_f32 v174, v2, v174
    v_mul_f32 v175, v2, v175
    v_mul_f32 v236, v2, v236
    v_mul_f32 v237, v2, v237
    v_mul_f32 v238, v2, v238
    v_mul_f32 v239, v2, v239
    s_nop 3
    s_setpc_b64 s[44:45]

k1_codeend:
    s_endpgm
.section .rodata,"a"
.p2align 6

.amdhsa_kernel standalone__mha_block_cached__near_ridge_kernel
  .amdhsa_next_free_vgpr 512
  .amdhsa_next_free_sgpr 102
  .amdhsa_accum_offset 256
  .amdhsa_group_segment_fixed_size 0
  .amdhsa_kernarg_size 64
  .amdhsa_user_sgpr_count 2
  .amdhsa_user_sgpr_kernarg_segment_ptr 1
  .amdhsa_system_sgpr_workgroup_id_x 1
  .amdhsa_float_denorm_mode_32 3
.end_amdhsa_kernel
```
